```python
import torch

def _softmax(x, axis=-1):
    return torch.softmax(x, dim=axis)
def _gelu(x):
    return torch.nn.functional.gelu(x, approximate="tanh")
def _silu(x):
    return torch.nn.functional.silu(x)
def _sigmoid(x):
    return torch.sigmoid(x)
def _layernorm(x, axis=-1, eps=1e-5):
    m = x.mean(dim=axis, keepdim=True)
    v = x.var(dim=axis, keepdim=True, unbiased=False)
    return (x - m) / torch.sqrt(v + eps)
def _scatter_add(tgt, idx, src, axis=0):
    return tgt.clone().index_add_(axis, idx, src)
def _segment_sum(src, seg, n):
    out = torch.zeros((n,) + src.shape[1:], dtype=src.dtype)
    return out.index_add_(0, seg, src)
def _pad(x, pw):
    flat = tuple(v for pair in reversed(pw) for v in pair)
    return torch.nn.functional.pad(x, flat)

kernel_name = 'gated_mix__compressed_kv_cla__dense_activation_gelu__prompt'

def setup_inputs():

    _w = (lambda a: (lambda t: t.to(torch.bfloat16) if t.is_floating_point() else t)(torch.as_tensor(a)))
    def _A_setup():
        B, H, Sq, Sk, D, M = 1, 32, 2048, 2048, 128, 640
        Dc = 4 * D
        return {
            "x": _w((lambda *s: torch.randn(*s, dtype=torch.bfloat16) * 0.05)(B, Sq, M)),
            "c_kv": _w((lambda *s: torch.randn(*s, dtype=torch.bfloat16) * 0.4)(B, Sk, Dc)),
            "w_q": _w((lambda *s: torch.randn(*s, dtype=torch.bfloat16) * 6.4)(M, H, D) * (M ** -0.5)),
            "w_uk": _w((lambda *s: torch.randn(*s, dtype=torch.bfloat16) * 6.4)(Dc, H, D) * (Dc ** -0.5)),
            "w_uv": _w((lambda *s: torch.randn(*s, dtype=torch.bfloat16) * 0.4)(Dc, H, D) * (Dc ** -0.5)),
            "w_o": _w((lambda *s: torch.randn(*s, dtype=torch.bfloat16) * 0.4)(H, D, M) * ((H * D) ** -0.5)),
        }
    _A_in = _A_setup()

    def _B_setup():
        B, S, D, F = 1, 2048, 640, 1728
        return {
            "x": _w((lambda *s: torch.randn(*s, dtype=torch.bfloat16) * 0.05)(B, S, D)),
            "w1": _w((lambda *s: torch.randn(*s, dtype=torch.bfloat16) * 3.2)(D, F) * (D ** -0.5)),
            "b1": _w((lambda *s: torch.randn(*s, dtype=torch.bfloat16) * 3.2)(F) * 0.01),
            "w2": _w((lambda *s: torch.randn(*s, dtype=torch.bfloat16) * 0.4)(F, D) * (F ** -0.5)),
            "b2": _w((lambda *s: torch.randn(*s, dtype=torch.bfloat16) * 0.8)(D) * 0.01),
        }
    _B_in = _B_setup()

    return {
        "A_x": _A_in["x"],
        "A_c_kv": _A_in["c_kv"],
        "A_w_q": _A_in["w_q"],
        "A_w_uk": _A_in["w_uk"],
        "A_w_uv": _A_in["w_uv"],
        "A_w_o": _A_in["w_o"],
        "B_x": _B_in["x"],
        "B_w1": _B_in["w1"],
        "B_b1": _B_in["b1"],
        "B_w2": _B_in["w2"],
        "B_b2": _B_in["b2"],
        "gate_w": _w((lambda *s: torch.randn(*s, dtype=torch.bfloat16) * 0.05)(640) * 16.0),
    }

def reference(A_x, A_c_kv, A_w_q, A_w_uk, A_w_uv, A_w_o, B_x, B_w1, B_b1, B_w2, B_b2, gate_w):
    def _A_ref(x, c_kv, w_q, w_uk, w_uv, w_o):
        B, Sq, M = x.shape[0], x.shape[1], x.shape[2]
        Sk = c_kv.shape[1]
        H, D = w_q.shape[1], w_q.shape[2]
        q = torch.einsum("bqm,mhd->bhqd", x, w_q)
        k = torch.einsum("bkc,chd->bhkd", c_kv, w_uk)
        v = torch.einsum("bkc,chd->bhkd", c_kv, w_uv)
        scores = torch.einsum("bhqd,bhkd->bhqk", q, k) * (D ** -0.5)
        off = Sk - Sq
        qi = torch.arange(Sq)[:, None]
        kj = torch.arange(Sk)[None, :]
        cmask = kj <= (qi + off)
        scores = torch.where(cmask[None, None], scores, -1e9)
        p = _softmax(scores, axis=-1)
        ctx = torch.einsum("bhqk,bhkd->bhqd", p, v)
        return torch.einsum("bhqd,hdm->bqm", ctx, w_o)

    def _B_ref(x, w1, b1, w2, b2):
        h = torch.einsum("bsd,df->bsf", x, w1) + b1
        h = _gelu(h)
        return torch.einsum("bsf,fd->bsd", h, w2) + b2

    x = A_x
    g = _sigmoid((x * gate_w).sum(-1, keepdims=True))
    a = _A_ref(x, A_c_kv, A_w_q, A_w_uk, A_w_uv, A_w_o)
    b = _B_ref(x, B_w1, B_b1, B_w2, B_b2)
    return g * a + (1 - g) * b
```

```asm
; @launch grid=(256,1,1) block=(256,1,1) lds=163840
.amdgcn_target "amdgcn-amd-amdhsa--gfx950"
.text
.globl gated_mix__compressed_kv_cla__dense_activation_gelu__prompt_kernel
.p2align 8
.type gated_mix__compressed_kv_cla__dense_activation_gelu__prompt_kernel,@function
gated_mix__compressed_kv_cla__dense_activation_gelu__prompt_kernel:
    s_cmp_lt_u32 s2, 256
    s_cbranch_scc1 L_go
    s_endpgm
L_go:
    s_load_dwordx2 s[12:13], s[0:1], 8
    s_load_dwordx2 s[16:17], s[0:1], 24
    s_load_dwordx2 s[20:21], s[0:1], 32
    s_load_dwordx2 s[8:9], s[0:1], 112
    s_load_dwordx2 s[24:25], s[0:1], 0
    s_load_dwordx2 s[28:29], s[0:1], 16
    s_load_dwordx2 s[32:33], s[0:1], 56
    s_load_dwordx2 s[36:37], s[0:1], 40
    s_load_dwordx2 s[40:41], s[0:1], 72
    s_load_dwordx2 s[44:45], s[0:1], 64
    s_load_dwordx2 s[48:49], s[0:1], 80
    s_load_dwordx2 s[52:53], s[0:1], 96
    s_load_dwordx2 s[86:87], s[0:1], 88
    s_getpc_b64 s[60:61]
L_pc:
    s_mov_b32 s62, L_code_end - L_pc
    s_mov_b32 s63, 0x20000
    s_lshr_b32 s64, s2, 3
    s_lshl_b32 s64, s64, 12
    v_lshlrev_b32 v1, 4, v0
    buffer_load_dwordx4 a[248:251], v1, s[60:63], s64 offen
    v_lshrrev_b32 v1, 6, v0
    v_and_b32 v0, 63, v0
    v_readfirstlane_b32 s3, v1
    s_and_b32 s4, s2, 7
    s_bfe_u32 s5, s2, 0x20003
    s_lshr_b32 s6, s2, 5
    s_lshl_b32 s7, s4, 2
    s_add_u32 s7, s7, s5
    v_lshrrev_b32 v16, 3, v0
    v_and_b32 v17, 7, v0
    v_lshrrev_b32 v18, 4, v0
    v_xor_b32 v19, v17, v18
    v_xor_b32 v20, 4, v19
    v_lshlrev_b32 v19, 4, v19
    v_lshlrev_b32 v20, 4, v20
    v_lshl_add_u32 v2, v16, 10, v19
    v_lshl_add_u32 v3, v16, 10, v20
    v_add_u32 v3, 8192, v3
    v_and_b32 v21, 3, v16
    v_lshrrev_b32 v22, 2, v16
    v_lshl_add_u32 v21, v22, 3, v21
    s_lshl_b32 s76, s3, 4
    v_add_u32 v21, s76, v21
    v_lshlrev_b32 v22, 1, v18
    v_xor_b32 v24, v17, v22
    v_lshlrev_b32 v22, 4, v24
    v_lshl_add_u32 v6, v21, 13, v22
    s_lshl_b32 s60, s3, 13
    s_lshr_b32 s76, s3, 1
    s_lshl_b32 s76, s76, 12
    s_and_b32 s77, s3, 1
    s_lshl_b32 s77, s77, 10
    s_add_u32 s61, s76, s77
    s_add_u32 s61, s61, 65536
    s_lshl_b32 s70, s7, 8
    s_add_u32 s76, s70, 0
    s_and_b32 s76, s76, 0x300
    s_andn2_b32 s98, s70, 0x300
    s_or_b32 s98, s98, s76
    s_add_u32 s76, s70, 256
    s_and_b32 s76, s76, 0x300
    s_andn2_b32 s99, s70, 0x300
    s_or_b32 s99, s99, s76
    s_add_u32 s76, s70, 512
    s_and_b32 s76, s76, 0x300
    s_andn2_b32 s100, s70, 0x300
    s_or_b32 s100, s100, s76
    s_add_u32 s76, s70, 768
    s_and_b32 s76, s76, 0x300
    s_andn2_b32 s101, s70, 0x300
    s_or_b32 s101, s101, s76
    s_lshl_b32 s76, s6, 2
    s_add_u32 s76, s76, s3
    s_lshl_b32 s62, s76, 16
    s_add_u32 s63, s62, 16384
    s_add_u32 s64, s62, 32768
    s_add_u32 s65, s62, 49152
    s_lshl_b32 s77, s7, 5
    s_add_u32 s76, s76, s77
    s_lshl_b32 s74, s76, 15
    s_mov_b32 s14, 2097152
    s_mov_b32 s15, 0x20000
    s_mov_b32 s18, 4194304
    s_mov_b32 s19, 0x20000
    s_mov_b32 s22, 4194304
    s_mov_b32 s23, 0x20000
    s_mov_b32 s10, 268435456
    s_mov_b32 s11, 0x20000
    s_waitcnt lgkmcnt(0)
    s_add_u32 m0, s61, 0
    s_add_u32 s77, s98, 0
    buffer_load_dwordx4 v6, s[16:19], s77 offen nt lds
    s_add_u32 m0, s61, 8192
    s_add_u32 s79, s99, 128
    buffer_load_dwordx4 v6, s[16:19], s79 offen nt lds
    s_add_u32 m0, s61, 16384
    s_add_u32 s77, s100, 0
    buffer_load_dwordx4 v6, s[20:23], s77 offen nt lds
    s_add_u32 m0, s61, 24576
    s_add_u32 s79, s101, 128
    buffer_load_dwordx4 v6, s[20:23], s79 offen nt lds
    s_add_u32 m0, s61, 2048
    s_add_u32 s78, s98, 32768
    buffer_load_dwordx4 v6, s[16:19], s78 offen nt lds
    s_add_u32 m0, s61, 10240
    s_add_u32 s76, s99, 32896
    buffer_load_dwordx4 v6, s[16:19], s76 offen nt lds
    s_add_u32 m0, s61, 18432
    s_add_u32 s78, s100, 32768
    buffer_load_dwordx4 v6, s[20:23], s78 offen nt lds
    s_add_u32 m0, s61, 26624
    s_add_u32 s76, s101, 32896
    buffer_load_dwordx4 v6, s[20:23], s76 offen nt lds
    s_add_u32 s0, s8, 84148224
    s_addc_u32 s1, s9, 0
    s_load_dword s97, s[0:1], 0
    v_lshlrev_b32 v1, 4, v0
    v_mul_u32_u24 v23, 1280, v16
    v_add_u32 v4, v23, v19
    v_add_u32 v5, v23, v20
    v_add_u32 v5, 10240, v5
    v_and_b32 v25, 1, v18
    v_lshlrev_b32 v25, 2, v25
    v_xor_b32 v25, v25, v17
    v_lshl_add_u32 v14, v25, 4, v23
    s_lshl_b32 s76, s6, 3
    s_add_u32 s80, s76, s3
    s_sub_u32 s81, s76, s3
    s_add_u32 s81, s81, 7
    s_sub_u32 s76, 120, s76
    s_add_u32 s82, s76, s3
    s_sub_u32 s83, s76, s3
    s_add_u32 s83, s83, 7
    s_mul_i32 s66, s80, 20480
    s_mul_i32 s67, s81, 20480
    s_mul_i32 s68, s82, 20480
    s_mul_i32 s69, s83, 20480
    s_mul_i32 s76, s6, 5
    s_sub_u32 s77, s4, s76
    s_and_b32 s77, s77, 7
    s_lshl_b32 s84, s5, 3
    s_add_u32 s84, s84, s4
    s_add_u32 s78, s77, 19
    s_cmp_lt_u32 s77, 5
    s_cselect_b32 s85, 1, 0
    s_cmp_eq_u32 s5, 3
    s_cselect_b32 s84, s78, s84
    s_cselect_b32 s85, s85, 0
    s_lshl_b32 s71, s84, 7
    v_mul_u32_u24 v23, 3456, v21
    v_add_u32 v7, v23, v22
    v_and_b32 v23, 1, v21
    v_cmp_eq_u32 vcc, v23, v24
    v_and_b32 v23, 0xfe, v21
    v_lshlrev_b32 v23, 1, v23
    v_mov_b32 v25, 536870912
    v_cndmask_b32 v23, v25, v23, vcc
    s_mov_b64 s[56:57], s[32:33]
    s_mov_b32 s58, 2211840
    s_mov_b32 s59, 0x20000
    s_mov_b32 s34, 2211840
    s_mov_b32 s72, 13824
    s_mov_b32 s73, 207360
    s_cmp_lg_u32 s85, 0
    s_cselect_b64 vcc, -1, 0
    s_cselect_b64 s[32:33], s[86:87], s[32:33]
    s_cmov_b32 s34, 1280
    s_cmov_b32 s72, 8
    s_cmov_b32 s73, 120
    s_cmov_b32 s71, 0
    s_mov_b32 s35, 0x20000
    v_cndmask_b32 v7, v7, v23, vcc
    s_sub_u32 s71, s71, s73
    v_and_b32 v21, 15, v0
    v_lshrrev_b32 v22, 1, v21
    v_xor_b32 v22, v22, v18
    v_lshlrev_b32 v22, 4, v22
    v_lshl_add_u32 v21, v21, 7, v22
    v_add_u32 v8, s60, v21
    v_xor_b32 v9, 64, v8
    v_bfe_u32 v21, v0, 2, 3
    v_lshrrev_b32 v22, 5, v0
    v_lshlrev_b32 v22, 10, v22
    v_lshl_add_u32 v22, v21, 7, v22
    v_and_b32 v23, 1, v0
    v_lshl_add_u32 v22, v23, 3, v22
    v_add_u32 v22, 65536, v22
    v_and_b32 v21, 6, v21
    v_bfe_u32 v23, v0, 1, 1
    v_or_b32 v21, v21, v23
    v_xor_b32 v23, 0, v21
    v_lshl_add_u32 v10, v23, 4, v22
    v_xor_b32 v23, 2, v21
    v_lshl_add_u32 v11, v23, 4, v22
    v_xor_b32 v23, 4, v21
    v_lshl_add_u32 v12, v23, 4, v22
    v_xor_b32 v23, 6, v21
    v_lshl_add_u32 v13, v23, 4, v22
    s_mov_b32 s26, 2621440
    s_mov_b32 s27, 0x20000
    s_mov_b32 s30, 5242880
    s_mov_b32 s31, 0x20000
    s_mov_b32 s38, 5242880
    s_mov_b32 s39, 0x20000
    s_mov_b32 s42, 2211840
    s_mov_b32 s43, 0x20000
    s_mov_b32 s46, 3456
    s_mov_b32 s47, 0x20000
    s_mov_b32 s50, 1280
    s_mov_b32 s51, 0x20000
    s_mov_b32 s54, 2621440
    s_mov_b32 s55, 0x20000
    s_lshl_b32 s76, s2, 2
    s_add_u32 s76, s76, s3
    s_mul_i32 s77, s76, 52429
    s_lshr_b32 s77, s77, 19
    s_mul_i32 s78, s77, 39680
    s_lshl_b32 s79, s76, 7
    s_add_u32 s86, s78, s79
    s_lshl_b32 s88, s76, 12
    s_add_u32 s88, s88, 58720256
    s_add_u32 s76, s76, 1024
    s_mul_i32 s77, s76, 52429
    s_lshr_b32 s77, s77, 19
    s_mul_i32 s78, s77, 39680
    s_lshl_b32 s79, s76, 7
    s_add_u32 s87, s78, s79
    s_lshl_b32 s89, s76, 12
    s_add_u32 s89, s89, 58720256
    s_sub_u32 s77, s87, 5242880
    s_cmp_lt_u32 s76, 1280
    s_cselect_b64 s[40:41], s[36:37], s[40:41]
    s_cmov_b32 s42, 5242880
    s_cselect_b32 s87, s87, s77
    s_cmp_ge_u32 s76, 1820
    s_cmov_b32 s89, 536870912
    s_lshr_b32 s76, s3, 1
    s_lshl_b32 s76, s76, 15
    s_and_b32 s77, s3, 1
    s_lshl_b32 s77, s77, 12
    s_add_u32 s90, s76, s77
    s_add_u32 s90, s90, 90112
    s_lshl_b32 s76, s3, 5
    s_add_u32 s76, s76, s7
    s_lshl_b32 s76, s76, 2
    s_add_u32 s76, s76, 83886080
    s_lshl_b32 s77, s6, 9
    s_add_u32 s91, s76, s77
    s_sub_u32 s92, s76, s77
    s_add_u32 s92, s92, 7680
    s_sub_u32 s76, 15, s6
    s_bitcmp1_b32 s4, 0
    s_cselect_b32 s76, s76, s6
    s_lshl_b32 s76, s76, 2
    s_add_u32 s76, s76, s5
    s_lshl_b32 s76, s76, 2
    s_add_u32 s76, s76, s3
    s_lshl_b32 s76, s76, 7
    s_lshr_b32 s77, s4, 1
    s_lshl_b32 s77, s77, 2
    s_add_u32 s76, s76, s77
    s_add_u32 s93, s76, 83951616
    s_lshl_b32 s95, s2, 2
    s_add_u32 s95, s95, 84082688
    s_cmp_eq_u32 s3, 0
    s_cselect_b32 s95, s95, 536870912
    s_lshl_b32 s76, s2, 2
    s_add_u32 s76, s76, s3
    v_lshlrev_b32 v23, 7, v0
    v_mov_b32 v25, 536870912
    s_mul_i32 s77, s76, 2560
    s_mul_i32 s78, s76, 2304
    s_lshl_b32 s79, s76, 11
    v_add_u32 v29, s79, v23
    v_add_u32 v26, s77, v23
    v_add_u32 v27, s78, v23
    s_lshr_b32 s76, s2, 3
    s_lshl_b32 s76, s76, 2
    s_add_u32 s76, s76, s3
    s_lshl_b32 s78, s76, 13
    s_mul_i32 s76, s76, 40960
    s_lshl_b32 s77, s4, 10
    s_add_u32 s78, s78, s77
    v_add_u32 v30, s78, v23
    s_add_u32 s76, s76, s77
    v_add_u32 v28, s76, v23
    v_cmp_gt_u32 vcc, 10, v0
    s_nop 1
    v_cndmask_b32 v26, v25, v26, vcc
    v_cmp_gt_u32 vcc, 9, v0
    s_nop 1
    v_cndmask_b32 v27, v25, v27, vcc
    v_cmp_gt_u32 vcc, 8, v0
    s_nop 1
    v_cndmask_b32 v28, v25, v28, vcc
    v_cmp_gt_u32 vcc, 16, v0
    s_nop 1
    v_cndmask_b32 v29, v25, v29, vcc
    v_cmp_gt_u32 vcc, 8, v0
    s_nop 1
    v_cndmask_b32 v30, v25, v30, vcc
    s_waitcnt lgkmcnt(0)
    s_mul_i32 s97, s97, 0x9e3779b5
    s_add_u32 s97, s97, 0x7f4a7c15
    s_add_u32 m0, s60, 0
    s_add_u32 s77, s62, 0
    buffer_load_dwordx4 v2, s[12:15], s77 offen lds
    s_add_u32 m0, s60, 1024
    s_add_u32 s78, s62, 0
    buffer_load_dwordx4 v3, s[12:15], s78 offen lds
    s_add_u32 m0, s60, 2048
    s_add_u32 s79, s63, 0
    buffer_load_dwordx4 v2, s[12:15], s79 offen lds
    s_add_u32 m0, s60, 3072
    s_add_u32 s76, s63, 0
    buffer_load_dwordx4 v3, s[12:15], s76 offen lds
    s_add_u32 m0, s60, 4096
    s_add_u32 s77, s64, 0
    buffer_load_dwordx4 v2, s[12:15], s77 offen lds
    s_add_u32 m0, s60, 5120
    s_add_u32 s78, s64, 0
    buffer_load_dwordx4 v3, s[12:15], s78 offen lds
    s_add_u32 m0, s60, 6144
    s_add_u32 s79, s65, 0
    buffer_load_dwordx4 v2, s[12:15], s79 offen lds
    s_add_u32 m0, s60, 7168
    s_add_u32 s76, s65, 0
    buffer_load_dwordx4 v3, s[12:15], s76 offen lds
    s_mov_b64 exec, 0
    s_cmp_eq_u32 s3, 0
    s_cbranch_scc1 pad0
    s_cmp_eq_u32 s3, 1
    s_cbranch_scc1 pad1
    s_cmp_eq_u32 s3, 2
    s_cbranch_scc1 pad2
    s_branch pad3
.p2align 12
L_body:
hopret0:
    s_mov_b64 exec, -1
    s_add_u32 m0, s61, 32768
    s_add_u32 s77, s98, 524288
    buffer_load_dwordx4 v6, s[16:19], s77 offen nt lds
    s_add_u32 m0, s61, 40960
    s_add_u32 s79, s99, 524416
    buffer_load_dwordx4 v6, s[16:19], s79 offen nt lds
    s_add_u32 m0, s61, 49152
    s_add_u32 s77, s100, 524288
    buffer_load_dwordx4 v6, s[20:23], s77 offen nt lds
    s_add_u32 m0, s61, 57344
    s_add_u32 s79, s101, 524416
    buffer_load_dwordx4 v6, s[20:23], s79 offen nt lds
    s_add_u32 m0, s61, 34816
    s_add_u32 s78, s98, 557056
    buffer_load_dwordx4 v6, s[16:19], s78 offen nt lds
    s_add_u32 m0, s61, 43008
    s_add_u32 s76, s99, 557184
    buffer_load_dwordx4 v6, s[16:19], s76 offen nt lds
    s_add_u32 m0, s61, 51200
    s_add_u32 s78, s100, 557056
    buffer_load_dwordx4 v6, s[20:23], s78 offen nt lds
    s_add_u32 m0, s61, 59392
    s_add_u32 s76, s101, 557184
    buffer_load_dwordx4 v6, s[20:23], s76 offen nt lds
    s_waitcnt vmcnt(8)
    s_barrier
    ds_read_b128 a[32:35], v8 offset:0
    ds_read_b128 a[36:39], v9 offset:0
    ds_read_b128 a[40:43], v8 offset:2048
    ds_read_b128 a[44:47], v9 offset:2048
    ds_read_b128 a[48:51], v8 offset:4096
    ds_read_b128 a[52:55], v9 offset:4096
    ds_read_b128 a[56:59], v8 offset:6144
    ds_read_b128 a[60:63], v9 offset:6144
    ds_read_b64_tr_b16 a[96:97], v10 offset:0
    ds_read_b64_tr_b16 a[98:99], v10 offset:2048
    ds_read_b64_tr_b16 a[100:101], v10 offset:4096
    ds_read_b64_tr_b16 a[102:103], v10 offset:6144
    ds_read_b64_tr_b16 a[104:105], v11 offset:0
    ds_read_b64_tr_b16 a[106:107], v11 offset:2048
    ds_read_b64_tr_b16 a[108:109], v11 offset:4096
    ds_read_b64_tr_b16 a[110:111], v11 offset:6144
    s_waitcnt lgkmcnt(4)
    v_mfma_f32_16x16x32_bf16 v[96:99], a[96:99], a[32:35], 0
    s_add_u32 m0, s60, 32768
    ds_read_b64_tr_b16 a[112:113], v12 offset:0
    ds_read_b64_tr_b16 a[114:115], v12 offset:2048
    v_mfma_f32_16x16x32_bf16 v[96:99], a[100:103], a[36:39], v[96:99]
    s_add_u32 s77, s62, 128
    buffer_load_dwordx4 v2, s[12:15], s77 offen lds
    v_mfma_f32_16x16x32_bf16 v[100:103], a[100:103], a[44:47], 0
    ds_read_b64_tr_b16 a[116:117], v12 offset:4096
    ds_read_b64_tr_b16 a[118:119], v12 offset:6144
    v_mfma_f32_16x16x32_bf16 v[100:103], a[96:99], a[40:43], v[100:103]
    v_mfma_f32_16x16x32_bf16 v[104:107], a[96:99], a[48:51], 0
    s_add_u32 m0, s60, 33792
    v_mfma_f32_16x16x32_bf16 v[104:107], a[100:103], a[52:55], v[104:107]
    s_add_u32 s78, s62, 128
    buffer_load_dwordx4 v3, s[12:15], s78 offen lds
    v_mfma_f32_16x16x32_bf16 v[108:111], a[100:103], a[60:63], 0
    v_mfma_f32_16x16x32_bf16 v[108:111], a[96:99], a[56:59], v[108:111]
    s_waitcnt lgkmcnt(4)
    v_mfma_f32_16x16x32_bf16 v[112:115], a[104:107], a[32:35], 0
    s_add_u32 m0, s60, 34816
    ds_read_b64_tr_b16 a[120:121], v13 offset:0
    ds_read_b64_tr_b16 a[122:123], v13 offset:2048
    v_mfma_f32_16x16x32_bf16 v[112:115], a[108:111], a[36:39], v[112:115]
    s_add_u32 s79, s63, 128
    buffer_load_dwordx4 v2, s[12:15], s79 offen lds
    v_mfma_f32_16x16x32_bf16 v[116:119], a[108:111], a[44:47], 0
    ds_read_b64_tr_b16 a[124:125], v13 offset:4096
    ds_read_b64_tr_b16 a[126:127], v13 offset:6144
    v_mfma_f32_16x16x32_bf16 v[116:119], a[104:107], a[40:43], v[116:119]
    v_mfma_f32_16x16x32_bf16 v[120:123], a[104:107], a[48:51], 0
    s_add_u32 m0, s60, 35840
    v_mfma_f32_16x16x32_bf16 v[120:123], a[108:111], a[52:55], v[120:123]
    s_add_u32 s76, s63, 128
    buffer_load_dwordx4 v3, s[12:15], s76 offen lds
    v_mfma_f32_16x16x32_bf16 v[124:127], a[108:111], a[60:63], 0
    v_mfma_f32_16x16x32_bf16 v[124:127], a[104:107], a[56:59], v[124:127]
    s_waitcnt lgkmcnt(4)
    v_mfma_f32_16x16x32_bf16 v[128:131], a[112:115], a[32:35], 0
    s_add_u32 m0, s60, 36864
    ds_read_b64_tr_b16 a[96:97], v10 offset:8192
    ds_read_b64_tr_b16 a[98:99], v10 offset:10240
    v_mfma_f32_16x16x32_bf16 v[128:131], a[116:119], a[36:39], v[128:131]
    s_add_u32 s77, s64, 128
    buffer_load_dwordx4 v2, s[12:15], s77 offen lds
    v_mfma_f32_16x16x32_bf16 v[132:135], a[116:119], a[44:47], 0
    ds_read_b64_tr_b16 a[100:101], v10 offset:12288
    ds_read_b64_tr_b16 a[102:103], v10 offset:14336
    v_mfma_f32_16x16x32_bf16 v[132:135], a[112:115], a[40:43], v[132:135]
    v_mfma_f32_16x16x32_bf16 v[136:139], a[112:115], a[48:51], 0
    s_add_u32 m0, s60, 37888
    v_mfma_f32_16x16x32_bf16 v[136:139], a[116:119], a[52:55], v[136:139]
    s_add_u32 s78, s64, 128
    buffer_load_dwordx4 v3, s[12:15], s78 offen lds
    v_mfma_f32_16x16x32_bf16 v[140:143], a[116:119], a[60:63], 0
    v_mfma_f32_16x16x32_bf16 v[140:143], a[112:115], a[56:59], v[140:143]
    s_waitcnt lgkmcnt(4)
    v_mfma_f32_16x16x32_bf16 v[144:147], a[120:123], a[32:35], 0
    s_add_u32 m0, s60, 38912
    ds_read_b64_tr_b16 a[104:105], v11 offset:8192
    ds_read_b64_tr_b16 a[106:107], v11 offset:10240
    v_mfma_f32_16x16x32_bf16 v[144:147], a[124:127], a[36:39], v[144:147]
    s_add_u32 s79, s65, 128
    buffer_load_dwordx4 v2, s[12:15], s79 offen lds
    v_mfma_f32_16x16x32_bf16 v[148:151], a[124:127], a[44:47], 0
    ds_read_b64_tr_b16 a[108:109], v11 offset:12288
    ds_read_b64_tr_b16 a[110:111], v11 offset:14336
    v_mfma_f32_16x16x32_bf16 v[148:151], a[120:123], a[40:43], v[148:151]
    v_mfma_f32_16x16x32_bf16 v[152:155], a[120:123], a[48:51], 0
    s_add_u32 m0, s60, 39936
    v_mfma_f32_16x16x32_bf16 v[152:155], a[124:127], a[52:55], v[152:155]
    s_add_u32 s76, s65, 128
    buffer_load_dwordx4 v3, s[12:15], s76 offen lds
    v_mfma_f32_16x16x32_bf16 v[156:159], a[124:127], a[60:63], 0
    v_mfma_f32_16x16x32_bf16 v[156:159], a[120:123], a[56:59], v[156:159]
    s_waitcnt lgkmcnt(4)
    v_mfma_f32_16x16x32_bf16 v[176:179], a[96:99], a[32:35], 0
    ds_read_b64_tr_b16 a[112:113], v12 offset:8192
    ds_read_b64_tr_b16 a[114:115], v12 offset:10240
    v_mfma_f32_16x16x32_bf16 v[176:179], a[100:103], a[36:39], v[176:179]
    buffer_load_dword a252, v29, s[12:15], 0 offen
    v_mfma_f32_16x16x32_bf16 v[192:195], a[100:103], a[44:47], 0
    ds_read_b64_tr_b16 a[116:117], v12 offset:12288
    ds_read_b64_tr_b16 a[118:119], v12 offset:14336
    v_mfma_f32_16x16x32_bf16 v[192:195], a[96:99], a[40:43], v[192:195]
    v_mfma_f32_16x16x32_bf16 v[208:211], a[96:99], a[48:51], 0
    s_add_u32 m0, s61, 65536
    v_mfma_f32_16x16x32_bf16 v[208:211], a[100:103], a[52:55], v[208:211]
    s_add_u32 s77, s98, 1048576
    buffer_load_dwordx4 v6, s[16:19], s77 offen nt lds
    v_mfma_f32_16x16x32_bf16 v[224:227], a[100:103], a[60:63], 0
    v_mfma_f32_16x16x32_bf16 v[224:227], a[96:99], a[56:59], v[224:227]
    s_waitcnt lgkmcnt(4)
    v_mfma_f32_16x16x32_bf16 v[32:35], a[104:107], a[32:35], 0
    s_add_u32 m0, s61, 73728
    ds_read_b64_tr_b16 a[120:121], v13 offset:8192
    ds_read_b64_tr_b16 a[122:123], v13 offset:10240
    v_mfma_f32_16x16x32_bf16 v[32:35], a[108:111], a[36:39], v[32:35]
    s_add_u32 s79, s99, 1048704
    buffer_load_dwordx4 v6, s[16:19], s79 offen nt lds
    v_mfma_f32_16x16x32_bf16 v[48:51], a[108:111], a[44:47], 0
    ds_read_b64_tr_b16 a[124:125], v13 offset:12288
    ds_read_b64_tr_b16 a[126:127], v13 offset:14336
    v_mfma_f32_16x16x32_bf16 v[48:51], a[104:107], a[40:43], v[48:51]
    v_mfma_f32_16x16x32_bf16 v[64:67], a[104:107], a[48:51], 0
    s_add_u32 m0, s61, 81920
    v_mfma_f32_16x16x32_bf16 v[64:67], a[108:111], a[52:55], v[64:67]
    s_add_u32 s77, s100, 1048576
    buffer_load_dwordx4 v6, s[20:23], s77 offen nt lds
    v_mfma_f32_16x16x32_bf16 v[80:83], a[108:111], a[60:63], 0
    v_mfma_f32_16x16x32_bf16 v[80:83], a[104:107], a[56:59], v[80:83]
    s_waitcnt lgkmcnt(4)
    v_mfma_f32_16x16x32_bf16 v[180:183], a[112:115], a[32:35], 0
    s_add_u32 m0, s61, 90112
    ds_read_b64_tr_b16 a[96:97], v10 offset:16384
    ds_read_b64_tr_b16 a[98:99], v10 offset:18432
    v_mfma_f32_16x16x32_bf16 v[180:183], a[116:119], a[36:39], v[180:183]
    s_add_u32 s79, s101, 1048704
    buffer_load_dwordx4 v6, s[20:23], s79 offen nt lds
    v_mfma_f32_16x16x32_bf16 v[196:199], a[116:119], a[44:47], 0
    ds_read_b64_tr_b16 a[100:101], v10 offset:20480
    ds_read_b64_tr_b16 a[102:103], v10 offset:22528
    v_mfma_f32_16x16x32_bf16 v[196:199], a[112:115], a[40:43], v[196:199]
    v_mfma_f32_16x16x32_bf16 v[212:215], a[112:115], a[48:51], 0
    s_add_u32 m0, s61, 67584
    v_mfma_f32_16x16x32_bf16 v[212:215], a[116:119], a[52:55], v[212:215]
    s_add_u32 s78, s98, 1081344
    buffer_load_dwordx4 v6, s[16:19], s78 offen nt lds
    v_mfma_f32_16x16x32_bf16 v[228:231], a[116:119], a[60:63], 0
    v_mfma_f32_16x16x32_bf16 v[228:231], a[112:115], a[56:59], v[228:231]
    s_waitcnt lgkmcnt(4)
    v_mfma_f32_16x16x32_bf16 v[36:39], a[120:123], a[32:35], 0
    s_add_u32 m0, s61, 75776
    ds_read_b64_tr_b16 a[104:105], v11 offset:16384
    ds_read_b64_tr_b16 a[106:107], v11 offset:18432
    v_mfma_f32_16x16x32_bf16 v[36:39], a[124:127], a[36:39], v[36:39]
    s_add_u32 s76, s99, 1081472
    buffer_load_dwordx4 v6, s[16:19], s76 offen nt lds
    v_mfma_f32_16x16x32_bf16 v[52:55], a[124:127], a[44:47], 0
    ds_read_b64_tr_b16 a[108:109], v11 offset:20480
    ds_read_b64_tr_b16 a[110:111], v11 offset:22528
    v_mfma_f32_16x16x32_bf16 v[52:55], a[120:123], a[40:43], v[52:55]
    v_mfma_f32_16x16x32_bf16 v[68:71], a[120:123], a[48:51], 0
    s_add_u32 m0, s61, 83968
    v_mfma_f32_16x16x32_bf16 v[68:71], a[124:127], a[52:55], v[68:71]
    s_add_u32 s78, s100, 1081344
    buffer_load_dwordx4 v6, s[20:23], s78 offen nt lds
    v_mfma_f32_16x16x32_bf16 v[84:87], a[124:127], a[60:63], 0
    s_mov_b32 s75, 0
    buffer_load_dword a252, v26, s[24:27], s75 offen
    v_mfma_f32_16x16x32_bf16 v[84:87], a[120:123], a[56:59], v[84:87]
    s_waitcnt lgkmcnt(4)
    v_mfma_f32_16x16x32_bf16 v[184:187], a[32:35], a[96:99], 0
    s_add_u32 m0, s61, 92160
    ds_read_b64_tr_b16 a[112:113], v12 offset:16384
    ds_read_b64_tr_b16 a[114:115], v12 offset:18432
    v_mfma_f32_16x16x32_bf16 v[184:187], a[36:39], a[100:103], v[184:187]
    s_add_u32 s76, s101, 1081472
    buffer_load_dwordx4 v6, s[20:23], s76 offen nt lds
    v_mfma_f32_16x16x32_bf16 v[200:203], a[44:47], a[100:103], 0
    ds_read_b64_tr_b16 a[116:117], v12 offset:20480
    ds_read_b64_tr_b16 a[118:119], v12 offset:22528
    v_mfma_f32_16x16x32_bf16 v[200:203], a[40:43], a[96:99], v[200:203]
    v_mfma_f32_16x16x32_bf16 v[216:219], a[48:51], a[96:99], 0
    s_add_u32 m0, s60, 0
    v_mfma_f32_16x16x32_bf16 v[216:219], a[52:55], a[100:103], v[216:219]
    s_add_u32 s77, s62, 256
    buffer_load_dwordx4 v2, s[12:15], s77 offen lds
    v_mfma_f32_16x16x32_bf16 v[232:235], a[60:63], a[100:103], 0
    v_mfma_f32_16x16x32_bf16 v[232:235], a[56:59], a[96:99], v[232:235]
    s_waitcnt lgkmcnt(4)
    v_mfma_f32_16x16x32_bf16 v[40:43], a[32:35], a[104:107], 0
    s_add_u32 m0, s60, 1024
    ds_read_b64_tr_b16 a[120:121], v13 offset:16384
    ds_read_b64_tr_b16 a[122:123], v13 offset:18432
    v_mfma_f32_16x16x32_bf16 v[40:43], a[36:39], a[108:111], v[40:43]
    s_add_u32 s78, s62, 256
    buffer_load_dwordx4 v3, s[12:15], s78 offen lds
    v_mfma_f32_16x16x32_bf16 v[56:59], a[44:47], a[108:111], 0
    ds_read_b64_tr_b16 a[124:125], v13 offset:20480
    ds_read_b64_tr_b16 a[126:127], v13 offset:22528
    v_mfma_f32_16x16x32_bf16 v[56:59], a[40:43], a[104:107], v[56:59]
    v_mfma_f32_16x16x32_bf16 v[72:75], a[48:51], a[104:107], 0
    s_add_u32 m0, s60, 2048
    v_mfma_f32_16x16x32_bf16 v[72:75], a[52:55], a[108:111], v[72:75]
    s_add_u32 s79, s63, 256
    buffer_load_dwordx4 v2, s[12:15], s79 offen lds
    v_mfma_f32_16x16x32_bf16 v[88:91], a[60:63], a[108:111], 0
    v_mfma_f32_16x16x32_bf16 v[88:91], a[56:59], a[104:107], v[88:91]
    s_waitcnt lgkmcnt(4)
    v_mfma_f32_16x16x32_bf16 v[188:191], a[32:35], a[112:115], 0
    s_add_u32 m0, s60, 3072
    ds_read_b64_tr_b16 a[96:97], v10 offset:24576
    ds_read_b64_tr_b16 a[98:99], v10 offset:26624
    v_mfma_f32_16x16x32_bf16 v[188:191], a[36:39], a[116:119], v[188:191]
    s_add_u32 s76, s63, 256
    buffer_load_dwordx4 v3, s[12:15], s76 offen lds
    v_mfma_f32_16x16x32_bf16 v[204:207], a[44:47], a[116:119], 0
    ds_read_b64_tr_b16 a[100:101], v10 offset:28672
    ds_read_b64_tr_b16 a[102:103], v10 offset:30720
    v_mfma_f32_16x16x32_bf16 v[204:207], a[40:43], a[112:115], v[204:207]
    v_mfma_f32_16x16x32_bf16 v[220:223], a[48:51], a[112:115], 0
    s_waitcnt vmcnt(14)
    ds_read_b128 a[64:67], v8 offset:32768
    ds_read_b128 a[68:71], v9 offset:32768
    v_mfma_f32_16x16x32_bf16 v[220:223], a[52:55], a[116:119], v[220:223]
    s_add_u32 m0, s60, 4096
    v_mfma_f32_16x16x32_bf16 v[236:239], a[60:63], a[116:119], 0
    s_add_u32 s77, s64, 256
    buffer_load_dwordx4 v2, s[12:15], s77 offen lds
    v_mfma_f32_16x16x32_bf16 v[236:239], a[56:59], a[112:115], v[236:239]
    s_waitcnt lgkmcnt(6)
    v_mfma_f32_16x16x32_bf16 v[44:47], a[32:35], a[120:123], 0
    ds_read_b64_tr_b16 a[104:105], v11 offset:24576
    ds_read_b64_tr_b16 a[106:107], v11 offset:26624
    v_mfma_f32_16x16x32_bf16 v[44:47], a[36:39], a[124:127], v[44:47]
    v_mfma_f32_16x16x32_bf16 v[60:63], a[44:47], a[124:127], 0
    s_add_u32 m0, s60, 5120
    ds_read_b64_tr_b16 a[108:109], v11 offset:28672
    ds_read_b64_tr_b16 a[110:111], v11 offset:30720
    v_mfma_f32_16x16x32_bf16 v[60:63], a[40:43], a[120:123], v[60:63]
    s_add_u32 s78, s64, 256
    buffer_load_dwordx4 v3, s[12:15], s78 offen lds
    v_mfma_f32_16x16x32_bf16 v[76:79], a[48:51], a[120:123], 0
    ds_read_b128 a[72:75], v8 offset:34816
    ds_read_b128 a[76:79], v9 offset:34816
    v_mfma_f32_16x16x32_bf16 v[76:79], a[52:55], a[124:127], v[76:79]
    v_mfma_f32_16x16x32_bf16 v[92:95], a[60:63], a[124:127], 0
    v_mfma_f32_16x16x32_bf16 v[92:95], a[56:59], a[120:123], v[92:95]
    s_waitcnt lgkmcnt(8)
    v_mfma_f32_16x16x32_bf16 v[160:163], a[32:35], a[96:99], 0
    s_add_u32 m0, s60, 6144
    ds_read_b64_tr_b16 a[112:113], v12 offset:24576
    ds_read_b64_tr_b16 a[114:115], v12 offset:26624
    v_mfma_f32_16x16x32_bf16 v[160:163], a[36:39], a[100:103], v[160:163]
    s_add_u32 s79, s65, 256
    buffer_load_dwordx4 v2, s[12:15], s79 offen lds
    v_mfma_f32_16x16x32_bf16 v[164:167], a[44:47], a[100:103], 0
    ds_read_b64_tr_b16 a[116:117], v12 offset:28672
    ds_read_b64_tr_b16 a[118:119], v12 offset:30720
    v_mfma_f32_16x16x32_bf16 v[164:167], a[40:43], a[96:99], v[164:167]
    v_mfma_f32_16x16x32_bf16 v[168:171], a[48:51], a[96:99], 0
    s_add_u32 m0, s60, 7168
    ds_read_b128 a[80:83], v8 offset:36864
    ds_read_b128 a[84:87], v9 offset:36864
    v_mfma_f32_16x16x32_bf16 v[168:171], a[52:55], a[100:103], v[168:171]
    s_add_u32 s76, s65, 256
    buffer_load_dwordx4 v3, s[12:15], s76 offen lds
    v_mfma_f32_16x16x32_bf16 v[172:175], a[60:63], a[100:103], 0
    s_add_u32 s75, s86, 0
    buffer_load_dwordx4 a[208:211], v14, s[36:39], s75 offen nt
    v_mfma_f32_16x16x32_bf16 v[172:175], a[56:59], a[96:99], v[172:175]
    s_waitcnt lgkmcnt(8)
    v_mfma_f32_16x16x32_bf16 v[240:243], a[32:35], a[104:107], 0
    s_add_u32 m0, s60, 32768
    ds_read_b64_tr_b16 a[120:121], v13 offset:24576
    ds_read_b64_tr_b16 a[122:123], v13 offset:26624
    v_mfma_f32_16x16x32_bf16 v[240:243], a[36:39], a[108:111], v[240:243]
    s_add_u32 s77, s62, 384
    buffer_load_dwordx4 v2, s[12:15], s77 offen lds
    v_mfma_f32_16x16x32_bf16 v[244:247], a[44:47], a[108:111], 0
    ds_read_b64_tr_b16 a[124:125], v13 offset:28672
    ds_read_b64_tr_b16 a[126:127], v13 offset:30720
    v_mfma_f32_16x16x32_bf16 v[244:247], a[40:43], a[104:107], v[244:247]
    v_mfma_f32_16x16x32_bf16 v[248:251], a[48:51], a[104:107], 0
    s_add_u32 m0, s60, 33792
    ds_read_b128 a[88:91], v8 offset:38912
    ds_read_b128 a[92:95], v9 offset:38912
    v_add_u32 v10, 32768, v10
    v_add_u32 v11, 32768, v11
    v_mfma_f32_16x16x32_bf16 v[248:251], a[52:55], a[108:111], v[248:251]
    s_add_u32 s78, s62, 384
    buffer_load_dwordx4 v3, s[12:15], s78 offen lds
    v_mfma_f32_16x16x32_bf16 v[252:255], a[60:63], a[108:111], 0
    v_add_u32 v12, 32768, v12
    v_add_u32 v13, 32768, v13
    v_mfma_f32_16x16x32_bf16 v[252:255], a[56:59], a[104:107], v[252:255]
    s_waitcnt vmcnt(29) lgkmcnt(0)
    s_barrier
    v_mfma_f32_16x16x32_bf16 a[0:3], a[32:35], a[112:115], 0
    s_add_u32 m0, s60, 34816
    ds_read_b64_tr_b16 a[96:97], v10 offset:0
    ds_read_b64_tr_b16 a[98:99], v10 offset:2048
    v_mfma_f32_16x16x32_bf16 a[0:3], a[36:39], a[116:119], a[0:3]
    s_add_u32 s79, s63, 384
    buffer_load_dwordx4 v2, s[12:15], s79 offen lds
    v_mfma_f32_16x16x32_bf16 a[4:7], a[44:47], a[116:119], 0
    ds_read_b64_tr_b16 a[100:101], v10 offset:4096
    ds_read_b64_tr_b16 a[102:103], v10 offset:6144
    v_mfma_f32_16x16x32_bf16 a[4:7], a[40:43], a[112:115], a[4:7]
    v_mfma_f32_16x16x32_bf16 a[8:11], a[48:51], a[112:115], 0
    s_add_u32 m0, s60, 35840
    v_mfma_f32_16x16x32_bf16 a[8:11], a[52:55], a[116:119], a[8:11]
    s_add_u32 s76, s63, 384
    buffer_load_dwordx4 v3, s[12:15], s76 offen lds
    v_mfma_f32_16x16x32_bf16 a[12:15], a[60:63], a[116:119], 0
    v_mfma_f32_16x16x32_bf16 a[12:15], a[56:59], a[112:115], a[12:15]
    s_waitcnt lgkmcnt(6)
    v_mfma_f32_16x16x32_bf16 a[16:19], a[32:35], a[120:123], 0
    s_add_u32 m0, s60, 36864
    ds_read_b64_tr_b16 a[104:105], v11 offset:0
    ds_read_b64_tr_b16 a[106:107], v11 offset:2048
    v_mfma_f32_16x16x32_bf16 a[16:19], a[36:39], a[124:127], a[16:19]
    s_add_u32 s77, s64, 384
    buffer_load_dwordx4 v2, s[12:15], s77 offen lds
    v_mfma_f32_16x16x32_bf16 a[20:23], a[44:47], a[124:127], 0
    ds_read_b64_tr_b16 a[108:109], v11 offset:4096
    ds_read_b64_tr_b16 a[110:111], v11 offset:6144
    v_mfma_f32_16x16x32_bf16 a[20:23], a[40:43], a[120:123], a[20:23]
    v_mfma_f32_16x16x32_bf16 a[24:27], a[48:51], a[120:123], 0
    s_add_u32 m0, s60, 37888
    v_mfma_f32_16x16x32_bf16 a[24:27], a[52:55], a[124:127], a[24:27]
    s_add_u32 s78, s64, 384
    buffer_load_dwordx4 v3, s[12:15], s78 offen lds
    v_mfma_f32_16x16x32_bf16 a[28:31], a[60:63], a[124:127], 0
    v_mfma_f32_16x16x32_bf16 a[28:31], a[56:59], a[120:123], a[28:31]
    s_waitcnt lgkmcnt(4)
    v_mfma_f32_16x16x32_bf16 v[96:99], a[96:99], a[64:67], v[96:99]
    s_add_u32 m0, s60, 38912
    ds_read_b64_tr_b16 a[112:113], v12 offset:0
    ds_read_b64_tr_b16 a[114:115], v12 offset:2048
    v_mfma_f32_16x16x32_bf16 v[96:99], a[100:103], a[68:71], v[96:99]
    s_add_u32 s79, s65, 384
    buffer_load_dwordx4 v2, s[12:15], s79 offen lds
    v_mfma_f32_16x16x32_bf16 v[100:103], a[100:103], a[76:79], v[100:103]
    ds_read_b64_tr_b16 a[116:117], v12 offset:4096
    ds_read_b64_tr_b16 a[118:119], v12 offset:6144
    v_mfma_f32_16x16x32_bf16 v[100:103], a[96:99], a[72:75], v[100:103]
    v_mfma_f32_16x16x32_bf16 v[104:107], a[96:99], a[80:83], v[104:107]
    s_add_u32 m0, s60, 39936
    v_mfma_f32_16x16x32_bf16 v[104:107], a[100:103], a[84:87], v[104:107]
    s_add_u32 s76, s65, 384
    buffer_load_dwordx4 v3, s[12:15], s76 offen lds
    v_mfma_f32_16x16x32_bf16 v[108:111], a[100:103], a[92:95], v[108:111]
    v_mfma_f32_16x16x32_bf16 v[108:111], a[96:99], a[88:91], v[108:111]
    s_waitcnt lgkmcnt(4)
    v_mfma_f32_16x16x32_bf16 v[112:115], a[104:107], a[64:67], v[112:115]
    s_add_u32 m0, s61, 0
    ds_read_b64_tr_b16 a[120:121], v13 offset:0
    ds_read_b64_tr_b16 a[122:123], v13 offset:2048
    v_mfma_f32_16x16x32_bf16 v[112:115], a[108:111], a[68:71], v[112:115]
    s_add_u32 s77, s98, 1572864
    buffer_load_dwordx4 v6, s[16:19], s77 offen nt lds
    v_mfma_f32_16x16x32_bf16 v[116:119], a[108:111], a[76:79], v[116:119]
    ds_read_b64_tr_b16 a[124:125], v13 offset:4096
    ds_read_b64_tr_b16 a[126:127], v13 offset:6144
    v_mfma_f32_16x16x32_bf16 v[116:119], a[104:107], a[72:75], v[116:119]
    v_mfma_f32_16x16x32_bf16 v[120:123], a[104:107], a[80:83], v[120:123]
    s_add_u32 m0, s61, 8192
    v_mfma_f32_16x16x32_bf16 v[120:123], a[108:111], a[84:87], v[120:123]
    s_add_u32 s79, s99, 1572992
    buffer_load_dwordx4 v6, s[16:19], s79 offen nt lds
    v_mfma_f32_16x16x32_bf16 v[124:127], a[108:111], a[92:95], v[124:127]
    s_mov_b32 s75, 0
    buffer_load_dword a252, v28, s[28:31], s75 offen
    v_mfma_f32_16x16x32_bf16 v[124:127], a[104:107], a[88:91], v[124:127]
    s_waitcnt lgkmcnt(4)
    v_mfma_f32_16x16x32_bf16 v[128:131], a[112:115], a[64:67], v[128:131]
    s_add_u32 m0, s61, 16384
    ds_read_b64_tr_b16 a[96:97], v10 offset:8192
    ds_read_b64_tr_b16 a[98:99], v10 offset:10240
    v_mfma_f32_16x16x32_bf16 v[128:131], a[116:119], a[68:71], v[128:131]
    s_add_u32 s77, s100, 1572864
    buffer_load_dwordx4 v6, s[20:23], s77 offen nt lds
    v_mfma_f32_16x16x32_bf16 v[132:135], a[116:119], a[76:79], v[132:135]
    ds_read_b64_tr_b16 a[100:101], v10 offset:12288
    ds_read_b64_tr_b16 a[102:103], v10 offset:14336
    v_mfma_f32_16x16x32_bf16 v[132:135], a[112:115], a[72:75], v[132:135]
    v_mfma_f32_16x16x32_bf16 v[136:139], a[112:115], a[80:83], v[136:139]
    s_add_u32 m0, s61, 24576
    v_mfma_f32_16x16x32_bf16 v[136:139], a[116:119], a[84:87], v[136:139]
    s_add_u32 s79, s101, 1572992
    buffer_load_dwordx4 v6, s[20:23], s79 offen nt lds
    v_mfma_f32_16x16x32_bf16 v[140:143], a[116:119], a[92:95], v[140:143]
    v_mfma_f32_16x16x32_bf16 v[140:143], a[112:115], a[88:91], v[140:143]
    s_waitcnt lgkmcnt(4)
    v_mfma_f32_16x16x32_bf16 v[144:147], a[120:123], a[64:67], v[144:147]
    s_add_u32 m0, s61, 2048
    ds_read_b64_tr_b16 a[104:105], v11 offset:8192
    ds_read_b64_tr_b16 a[106:107], v11 offset:10240
    v_mfma_f32_16x16x32_bf16 v[144:147], a[124:127], a[68:71], v[144:147]
    s_add_u32 s78, s98, 1605632
    buffer_load_dwordx4 v6, s[16:19], s78 offen nt lds
    v_mfma_f32_16x16x32_bf16 v[148:151], a[124:127], a[76:79], v[148:151]
    ds_read_b64_tr_b16 a[108:109], v11 offset:12288
    ds_read_b64_tr_b16 a[110:111], v11 offset:14336
    v_mfma_f32_16x16x32_bf16 v[148:151], a[120:123], a[72:75], v[148:151]
    v_mfma_f32_16x16x32_bf16 v[152:155], a[120:123], a[80:83], v[152:155]
    s_add_u32 m0, s61, 10240
    v_mfma_f32_16x16x32_bf16 v[152:155], a[124:127], a[84:87], v[152:155]
    s_add_u32 s76, s99, 1605760
    buffer_load_dwordx4 v6, s[16:19], s76 offen nt lds
    v_mfma_f32_16x16x32_bf16 v[156:159], a[124:127], a[92:95], v[156:159]
    v_mfma_f32_16x16x32_bf16 v[156:159], a[120:123], a[88:91], v[156:159]
    s_waitcnt lgkmcnt(4)
    v_mfma_f32_16x16x32_bf16 v[176:179], a[96:99], a[64:67], v[176:179]
    s_add_u32 m0, s61, 18432
    ds_read_b64_tr_b16 a[112:113], v12 offset:8192
    ds_read_b64_tr_b16 a[114:115], v12 offset:10240
    v_mfma_f32_16x16x32_bf16 v[176:179], a[100:103], a[68:71], v[176:179]
    s_add_u32 s78, s100, 1605632
    buffer_load_dwordx4 v6, s[20:23], s78 offen nt lds
    v_mfma_f32_16x16x32_bf16 v[192:195], a[100:103], a[76:79], v[192:195]
    ds_read_b64_tr_b16 a[116:117], v12 offset:12288
    ds_read_b64_tr_b16 a[118:119], v12 offset:14336
    v_mfma_f32_16x16x32_bf16 v[192:195], a[96:99], a[72:75], v[192:195]
    v_mfma_f32_16x16x32_bf16 v[208:211], a[96:99], a[80:83], v[208:211]
    s_add_u32 m0, s61, 26624
    v_mfma_f32_16x16x32_bf16 v[208:211], a[100:103], a[84:87], v[208:211]
    s_add_u32 s76, s101, 1605760
    buffer_load_dwordx4 v6, s[20:23], s76 offen nt lds
    v_mfma_f32_16x16x32_bf16 v[224:227], a[100:103], a[92:95], v[224:227]
    v_mfma_f32_16x16x32_bf16 v[224:227], a[96:99], a[88:91], v[224:227]
    s_waitcnt lgkmcnt(4)
    v_mfma_f32_16x16x32_bf16 v[32:35], a[104:107], a[64:67], v[32:35]
    ds_read_b64_tr_b16 a[120:121], v13 offset:8192
    ds_read_b64_tr_b16 a[122:123], v13 offset:10240
    v_mfma_f32_16x16x32_bf16 v[32:35], a[108:111], a[68:71], v[32:35]
    v_mfma_f32_16x16x32_bf16 v[48:51], a[108:111], a[76:79], v[48:51]
    ds_read_b64_tr_b16 a[124:125], v13 offset:12288
    ds_read_b64_tr_b16 a[126:127], v13 offset:14336
    v_mfma_f32_16x16x32_bf16 v[48:51], a[104:107], a[72:75], v[48:51]
    v_mfma_f32_16x16x32_bf16 v[64:67], a[104:107], a[80:83], v[64:67]
    v_mfma_f32_16x16x32_bf16 v[64:67], a[108:111], a[84:87], v[64:67]
    v_mfma_f32_16x16x32_bf16 v[80:83], a[108:111], a[92:95], v[80:83]
    v_mfma_f32_16x16x32_bf16 v[80:83], a[104:107], a[88:91], v[80:83]
    s_waitcnt lgkmcnt(4)
    v_mfma_f32_16x16x32_bf16 v[180:183], a[112:115], a[64:67], v[180:183]
    ds_read_b64_tr_b16 a[96:97], v10 offset:16384
    ds_read_b64_tr_b16 a[98:99], v10 offset:18432
    v_mfma_f32_16x16x32_bf16 v[180:183], a[116:119], a[68:71], v[180:183]
    v_mfma_f32_16x16x32_bf16 v[196:199], a[116:119], a[76:79], v[196:199]
    ds_read_b64_tr_b16 a[100:101], v10 offset:20480
    ds_read_b64_tr_b16 a[102:103], v10 offset:22528
    v_mfma_f32_16x16x32_bf16 v[196:199], a[112:115], a[72:75], v[196:199]
    v_mfma_f32_16x16x32_bf16 v[212:215], a[112:115], a[80:83], v[212:215]
    s_lshl_b32 s75, s3, 20
    buffer_load_dword a252, v23, s[44:47], s75 offen
    v_mfma_f32_16x16x32_bf16 v[212:215], a[116:119], a[84:87], v[212:215]
    v_mfma_f32_16x16x32_bf16 v[228:231], a[116:119], a[92:95], v[228:231]
    v_mfma_f32_16x16x32_bf16 v[228:231], a[112:115], a[88:91], v[228:231]
    s_waitcnt lgkmcnt(4)
    v_mfma_f32_16x16x32_bf16 v[36:39], a[120:123], a[64:67], v[36:39]
    ds_read_b64_tr_b16 a[104:105], v11 offset:16384
    ds_read_b64_tr_b16 a[106:107], v11 offset:18432
    v_mfma_f32_16x16x32_bf16 v[36:39], a[124:127], a[68:71], v[36:39]
    s_lshl_b32 s75, s3, 20
    buffer_load_dword a252, v23, s[48:51], s75 offen
    v_mfma_f32_16x16x32_bf16 v[52:55], a[124:127], a[76:79], v[52:55]
    ds_read_b64_tr_b16 a[108:109], v11 offset:20480
    ds_read_b64_tr_b16 a[110:111], v11 offset:22528
    v_mfma_f32_16x16x32_bf16 v[52:55], a[120:123], a[72:75], v[52:55]
    v_mfma_f32_16x16x32_bf16 v[68:71], a[120:123], a[80:83], v[68:71]
    v_mfma_f32_16x16x32_bf16 v[68:71], a[124:127], a[84:87], v[68:71]
    v_mfma_f32_16x16x32_bf16 v[84:87], a[124:127], a[92:95], v[84:87]
    v_mfma_f32_16x16x32_bf16 v[84:87], a[120:123], a[88:91], v[84:87]
    s_waitcnt lgkmcnt(4)
    v_mfma_f32_16x16x32_bf16 v[184:187], a[64:67], a[96:99], v[184:187]
    ds_read_b64_tr_b16 a[112:113], v12 offset:16384
    ds_read_b64_tr_b16 a[114:115], v12 offset:18432
    v_mfma_f32_16x16x32_bf16 v[184:187], a[68:71], a[100:103], v[184:187]
    v_mfma_f32_16x16x32_bf16 v[200:203], a[76:79], a[100:103], v[200:203]
    ds_read_b64_tr_b16 a[116:117], v12 offset:20480
    ds_read_b64_tr_b16 a[118:119], v12 offset:22528
    v_mfma_f32_16x16x32_bf16 v[200:203], a[72:75], a[96:99], v[200:203]
    v_mfma_f32_16x16x32_bf16 v[216:219], a[80:83], a[96:99], v[216:219]
    s_waitcnt vmcnt(20)
    ds_read_b128 a[32:35], v8 offset:0
    ds_read_b128 a[36:39], v9 offset:0
    v_mfma_f32_16x16x32_bf16 v[216:219], a[84:87], a[100:103], v[216:219]
    s_add_u32 s75, s86, 10240
    buffer_load_dwordx4 a[212:215], v14, s[36:39], s75 offen nt
    v_mfma_f32_16x16x32_bf16 v[232:235], a[92:95], a[100:103], v[232:235]
    v_mfma_f32_16x16x32_bf16 v[232:235], a[88:91], a[96:99], v[232:235]
    s_waitcnt lgkmcnt(6)
    v_mfma_f32_16x16x32_bf16 v[40:43], a[64:67], a[104:107], v[40:43]
    ds_read_b64_tr_b16 a[120:121], v13 offset:16384
    ds_read_b64_tr_b16 a[122:123], v13 offset:18432
    v_mfma_f32_16x16x32_bf16 v[40:43], a[68:71], a[108:111], v[40:43]
    v_mfma_f32_16x16x32_bf16 v[56:59], a[76:79], a[108:111], v[56:59]
    ds_read_b64_tr_b16 a[124:125], v13 offset:20480
    ds_read_b64_tr_b16 a[126:127], v13 offset:22528
    v_mfma_f32_16x16x32_bf16 v[56:59], a[72:75], a[104:107], v[56:59]
    v_mfma_f32_16x16x32_bf16 v[72:75], a[80:83], a[104:107], v[72:75]
    ds_read_b128 a[40:43], v8 offset:2048
    ds_read_b128 a[44:47], v9 offset:2048
    v_mfma_f32_16x16x32_bf16 v[72:75], a[84:87], a[108:111], v[72:75]
    v_mfma_f32_16x16x32_bf16 v[88:91], a[92:95], a[108:111], v[88:91]
pad0:
    s_cbranch_execz pad4
    v_mfma_f32_16x16x32_bf16 v[88:91], a[88:91], a[104:107], v[88:91]
    s_waitcnt lgkmcnt(8)
    v_mfma_f32_16x16x32_bf16 v[188:191], a[64:67], a[112:115], v[188:191]
    ds_read_b64_tr_b16 a[96:97], v10 offset:24576
    ds_read_b64_tr_b16 a[98:99], v10 offset:26624
    v_mfma_f32_16x16x32_bf16 v[188:191], a[68:71], a[116:119], v[188:191]
    v_mfma_f32_16x16x32_bf16 v[204:207], a[76:79], a[116:119], v[204:207]
    ds_read_b64_tr_b16 a[100:101], v10 offset:28672
    ds_read_b64_tr_b16 a[102:103], v10 offset:30720
    v_mfma_f32_16x16x32_bf16 v[204:207], a[72:75], a[112:115], v[204:207]
    v_mfma_f32_16x16x32_bf16 v[220:223], a[80:83], a[112:115], v[220:223]
    ds_read_b128 a[48:51], v8 offset:4096
    ds_read_b128 a[52:55], v9 offset:4096
    v_mfma_f32_16x16x32_bf16 v[220:223], a[84:87], a[116:119], v[220:223]
    v_mfma_f32_16x16x32_bf16 v[236:239], a[92:95], a[116:119], v[236:239]
    v_mfma_f32_16x16x32_bf16 v[236:239], a[88:91], a[112:115], v[236:239]
    s_waitcnt lgkmcnt(8)
    v_mfma_f32_16x16x32_bf16 v[44:47], a[64:67], a[120:123], v[44:47]
    s_add_u32 m0, s60, 0
    ds_read_b64_tr_b16 a[104:105], v11 offset:24576
    ds_read_b64_tr_b16 a[106:107], v11 offset:26624
    v_mfma_f32_16x16x32_bf16 v[44:47], a[68:71], a[124:127], v[44:47]
    s_add_u32 s77, s62, 512
    buffer_load_dwordx4 v2, s[12:15], s77 offen lds
    v_mfma_f32_16x16x32_bf16 v[60:63], a[76:79], a[124:127], v[60:63]
    ds_read_b64_tr_b16 a[108:109], v11 offset:28672
    ds_read_b64_tr_b16 a[110:111], v11 offset:30720
    v_mfma_f32_16x16x32_bf16 v[60:63], a[72:75], a[120:123], v[60:63]
    v_mfma_f32_16x16x32_bf16 v[76:79], a[80:83], a[120:123], v[76:79]
    s_add_u32 m0, s60, 1024
    ds_read_b128 a[56:59], v8 offset:6144
    ds_read_b128 a[60:63], v9 offset:6144
    v_mfma_f32_16x16x32_bf16 v[76:79], a[84:87], a[124:127], v[76:79]
    s_add_u32 s78, s62, 512
    buffer_load_dwordx4 v3, s[12:15], s78 offen lds
    v_mfma_f32_16x16x32_bf16 v[92:95], a[92:95], a[124:127], v[92:95]
    s_mov_b32 s75, 8192
    buffer_load_dword a252, v28, s[28:31], s75 offen
    v_mfma_f32_16x16x32_bf16 v[92:95], a[88:91], a[120:123], v[92:95]
    s_waitcnt lgkmcnt(8)
    v_mfma_f32_16x16x32_bf16 v[160:163], a[64:67], a[96:99], v[160:163]
    s_add_u32 m0, s60, 2048
    ds_read_b64_tr_b16 a[112:113], v12 offset:24576
    ds_read_b64_tr_b16 a[114:115], v12 offset:26624
    v_mfma_f32_16x16x32_bf16 v[160:163], a[68:71], a[100:103], v[160:163]
    s_add_u32 s79, s63, 512
    buffer_load_dwordx4 v2, s[12:15], s79 offen lds
    v_mfma_f32_16x16x32_bf16 v[164:167], a[76:79], a[100:103], v[164:167]
    ds_read_b64_tr_b16 a[116:117], v12 offset:28672
    ds_read_b64_tr_b16 a[118:119], v12 offset:30720
    v_mfma_f32_16x16x32_bf16 v[164:167], a[72:75], a[96:99], v[164:167]
    v_mfma_f32_16x16x32_bf16 v[168:171], a[80:83], a[96:99], v[168:171]
    s_add_u32 m0, s60, 3072
    v_mfma_f32_16x16x32_bf16 v[168:171], a[84:87], a[100:103], v[168:171]
    s_add_u32 s76, s63, 512
    buffer_load_dwordx4 v3, s[12:15], s76 offen lds
    v_mfma_f32_16x16x32_bf16 v[172:175], a[92:95], a[100:103], v[172:175]
    v_mfma_f32_16x16x32_bf16 v[172:175], a[88:91], a[96:99], v[172:175]
    s_waitcnt lgkmcnt(6)
    v_mfma_f32_16x16x32_bf16 v[240:243], a[64:67], a[104:107], v[240:243]
    s_add_u32 m0, s60, 4096
    ds_read_b64_tr_b16 a[120:121], v13 offset:24576
    ds_read_b64_tr_b16 a[122:123], v13 offset:26624
    v_mfma_f32_16x16x32_bf16 v[240:243], a[68:71], a[108:111], v[240:243]
    s_add_u32 s77, s64, 512
    buffer_load_dwordx4 v2, s[12:15], s77 offen lds
    v_mfma_f32_16x16x32_bf16 v[244:247], a[76:79], a[108:111], v[244:247]
    ds_read_b64_tr_b16 a[124:125], v13 offset:28672
    ds_read_b64_tr_b16 a[126:127], v13 offset:30720
    v_mfma_f32_16x16x32_bf16 v[244:247], a[72:75], a[104:107], v[244:247]
    v_mfma_f32_16x16x32_bf16 v[248:251], a[80:83], a[104:107], v[248:251]
    s_add_u32 m0, s60, 5120
    v_add_u32 v10, 32768, v10
    v_add_u32 v11, 32768, v11
    v_mfma_f32_16x16x32_bf16 v[248:251], a[84:87], a[108:111], v[248:251]
    s_add_u32 s78, s64, 512
    buffer_load_dwordx4 v3, s[12:15], s78 offen lds
    v_mfma_f32_16x16x32_bf16 v[252:255], a[92:95], a[108:111], v[252:255]
    v_add_u32 v12, 32768, v12
    v_add_u32 v13, 32768, v13
    v_mfma_f32_16x16x32_bf16 v[252:255], a[88:91], a[104:107], v[252:255]
    s_waitcnt vmcnt(36) lgkmcnt(0)
    s_barrier
    v_mfma_f32_16x16x32_bf16 a[0:3], a[64:67], a[112:115], a[0:3]
    s_add_u32 m0, s60, 6144
    ds_read_b64_tr_b16 a[96:97], v10 offset:0
    ds_read_b64_tr_b16 a[98:99], v10 offset:2048
    v_mfma_f32_16x16x32_bf16 a[0:3], a[68:71], a[116:119], a[0:3]
    s_add_u32 s79, s65, 512
    buffer_load_dwordx4 v2, s[12:15], s79 offen lds
    v_mfma_f32_16x16x32_bf16 a[4:7], a[76:79], a[116:119], a[4:7]
    ds_read_b64_tr_b16 a[100:101], v10 offset:4096
    ds_read_b64_tr_b16 a[102:103], v10 offset:6144
    v_mfma_f32_16x16x32_bf16 a[4:7], a[72:75], a[112:115], a[4:7]
    v_mfma_f32_16x16x32_bf16 a[8:11], a[80:83], a[112:115], a[8:11]
    s_add_u32 m0, s60, 7168
    v_mfma_f32_16x16x32_bf16 a[8:11], a[84:87], a[116:119], a[8:11]
    s_add_u32 s76, s65, 512
    buffer_load_dwordx4 v3, s[12:15], s76 offen lds
    v_mfma_f32_16x16x32_bf16 a[12:15], a[92:95], a[116:119], a[12:15]
    v_mfma_f32_16x16x32_bf16 a[12:15], a[88:91], a[112:115], a[12:15]
    s_waitcnt lgkmcnt(4)
    v_mfma_f32_16x16x32_bf16 a[16:19], a[64:67], a[120:123], a[16:19]
    s_add_u32 m0, s61, 32768
    ds_read_b64_tr_b16 a[104:105], v11 offset:0
    ds_read_b64_tr_b16 a[106:107], v11 offset:2048
    v_mfma_f32_16x16x32_bf16 a[16:19], a[68:71], a[124:127], a[16:19]
    s_add_u32 s77, s98, 2097152
    buffer_load_dwordx4 v6, s[16:19], s77 offen nt lds
    v_mfma_f32_16x16x32_bf16 a[20:23], a[76:79], a[124:127], a[20:23]
    ds_read_b64_tr_b16 a[108:109], v11 offset:4096
    ds_read_b64_tr_b16 a[110:111], v11 offset:6144
    v_mfma_f32_16x16x32_bf16 a[20:23], a[72:75], a[120:123], a[20:23]
    v_mfma_f32_16x16x32_bf16 a[24:27], a[80:83], a[120:123], a[24:27]
    s_add_u32 m0, s61, 40960
    v_mfma_f32_16x16x32_bf16 a[24:27], a[84:87], a[124:127], a[24:27]
    s_add_u32 s79, s99, 2097280
    buffer_load_dwordx4 v6, s[16:19], s79 offen nt lds
    v_mfma_f32_16x16x32_bf16 a[28:31], a[92:95], a[124:127], a[28:31]
    v_mfma_f32_16x16x32_bf16 a[28:31], a[88:91], a[120:123], a[28:31]
    s_waitcnt lgkmcnt(4)
    v_mfma_f32_16x16x32_bf16 v[96:99], a[96:99], a[32:35], v[96:99]
    s_add_u32 m0, s61, 49152
    ds_read_b64_tr_b16 a[112:113], v12 offset:0
    ds_read_b64_tr_b16 a[114:115], v12 offset:2048
    v_mfma_f32_16x16x32_bf16 v[96:99], a[100:103], a[36:39], v[96:99]
    s_add_u32 s77, s100, 2097152
    buffer_load_dwordx4 v6, s[20:23], s77 offen nt lds
    v_mfma_f32_16x16x32_bf16 v[100:103], a[100:103], a[44:47], v[100:103]
    ds_read_b64_tr_b16 a[116:117], v12 offset:4096
    ds_read_b64_tr_b16 a[118:119], v12 offset:6144
    v_mfma_f32_16x16x32_bf16 v[100:103], a[96:99], a[40:43], v[100:103]
    v_mfma_f32_16x16x32_bf16 v[104:107], a[96:99], a[48:51], v[104:107]
    s_add_u32 m0, s61, 57344
    v_mfma_f32_16x16x32_bf16 v[104:107], a[100:103], a[52:55], v[104:107]
    s_add_u32 s79, s101, 2097280
    buffer_load_dwordx4 v6, s[20:23], s79 offen nt lds
    v_mfma_f32_16x16x32_bf16 v[108:111], a[100:103], a[60:63], v[108:111]
    v_mfma_f32_16x16x32_bf16 v[108:111], a[96:99], a[56:59], v[108:111]
    s_waitcnt lgkmcnt(4)
    v_mfma_f32_16x16x32_bf16 v[112:115], a[104:107], a[32:35], v[112:115]
    s_add_u32 m0, s61, 34816
    ds_read_b64_tr_b16 a[120:121], v13 offset:0
    ds_read_b64_tr_b16 a[122:123], v13 offset:2048
    v_mfma_f32_16x16x32_bf16 v[112:115], a[108:111], a[36:39], v[112:115]
    s_add_u32 s78, s98, 2129920
    buffer_load_dwordx4 v6, s[16:19], s78 offen nt lds
    v_mfma_f32_16x16x32_bf16 v[116:119], a[108:111], a[44:47], v[116:119]
    ds_read_b64_tr_b16 a[124:125], v13 offset:4096
    ds_read_b64_tr_b16 a[126:127], v13 offset:6144
    v_mfma_f32_16x16x32_bf16 v[116:119], a[104:107], a[40:43], v[116:119]
    v_mfma_f32_16x16x32_bf16 v[120:123], a[104:107], a[48:51], v[120:123]
    s_add_u32 m0, s61, 43008
    v_mfma_f32_16x16x32_bf16 v[120:123], a[108:111], a[52:55], v[120:123]
    s_add_u32 s76, s99, 2130048
    buffer_load_dwordx4 v6, s[16:19], s76 offen nt lds
    v_mfma_f32_16x16x32_bf16 v[124:127], a[108:111], a[60:63], v[124:127]
    v_mfma_f32_16x16x32_bf16 v[124:127], a[104:107], a[56:59], v[124:127]
    s_waitcnt lgkmcnt(4)
    v_mfma_f32_16x16x32_bf16 v[128:131], a[112:115], a[32:35], v[128:131]
    s_add_u32 m0, s61, 51200
    ds_read_b64_tr_b16 a[96:97], v10 offset:8192
    ds_read_b64_tr_b16 a[98:99], v10 offset:10240
    v_mfma_f32_16x16x32_bf16 v[128:131], a[116:119], a[36:39], v[128:131]
    s_add_u32 s78, s100, 2129920
    buffer_load_dwordx4 v6, s[20:23], s78 offen nt lds
    v_mfma_f32_16x16x32_bf16 v[132:135], a[116:119], a[44:47], v[132:135]
    ds_read_b64_tr_b16 a[100:101], v10 offset:12288
    ds_read_b64_tr_b16 a[102:103], v10 offset:14336
    v_mfma_f32_16x16x32_bf16 v[132:135], a[112:115], a[40:43], v[132:135]
    v_mfma_f32_16x16x32_bf16 v[136:139], a[112:115], a[48:51], v[136:139]
    s_add_u32 m0, s61, 59392
    v_mfma_f32_16x16x32_bf16 v[136:139], a[116:119], a[52:55], v[136:139]
    s_add_u32 s76, s101, 2130048
    buffer_load_dwordx4 v6, s[20:23], s76 offen nt lds
    v_mfma_f32_16x16x32_bf16 v[140:143], a[116:119], a[60:63], v[140:143]
    v_mfma_f32_16x16x32_bf16 v[140:143], a[112:115], a[56:59], v[140:143]
    s_waitcnt lgkmcnt(4)
    v_mfma_f32_16x16x32_bf16 v[144:147], a[120:123], a[32:35], v[144:147]
    ds_read_b64_tr_b16 a[104:105], v11 offset:8192
    ds_read_b64_tr_b16 a[106:107], v11 offset:10240
    v_mfma_f32_16x16x32_bf16 v[144:147], a[124:127], a[36:39], v[144:147]
    v_mfma_f32_16x16x32_bf16 v[148:151], a[124:127], a[44:47], v[148:151]
    ds_read_b64_tr_b16 a[108:109], v11 offset:12288
    ds_read_b64_tr_b16 a[110:111], v11 offset:14336
    v_mfma_f32_16x16x32_bf16 v[148:151], a[120:123], a[40:43], v[148:151]
    v_mfma_f32_16x16x32_bf16 v[152:155], a[120:123], a[48:51], v[152:155]
    v_mfma_f32_16x16x32_bf16 v[152:155], a[124:127], a[52:55], v[152:155]
    v_mfma_f32_16x16x32_bf16 v[156:159], a[124:127], a[60:63], v[156:159]
    v_mfma_f32_16x16x32_bf16 v[156:159], a[120:123], a[56:59], v[156:159]
    s_waitcnt lgkmcnt(4)
    v_mfma_f32_16x16x32_bf16 v[176:179], a[96:99], a[32:35], v[176:179]
    ds_read_b64_tr_b16 a[112:113], v12 offset:8192
    ds_read_b64_tr_b16 a[114:115], v12 offset:10240
    v_mfma_f32_16x16x32_bf16 v[176:179], a[100:103], a[36:39], v[176:179]
    v_mfma_f32_16x16x32_bf16 v[192:195], a[100:103], a[44:47], v[192:195]
    ds_read_b64_tr_b16 a[116:117], v12 offset:12288
    ds_read_b64_tr_b16 a[118:119], v12 offset:14336
    v_mfma_f32_16x16x32_bf16 v[192:195], a[96:99], a[40:43], v[192:195]
    v_mfma_f32_16x16x32_bf16 v[208:211], a[96:99], a[48:51], v[208:211]
    s_add_u32 s75, s86, 20480
    buffer_load_dwordx4 a[216:219], v14, s[36:39], s75 offen nt
    v_mfma_f32_16x16x32_bf16 v[208:211], a[100:103], a[52:55], v[208:211]
    v_mfma_f32_16x16x32_bf16 v[224:227], a[100:103], a[60:63], v[224:227]
    v_mfma_f32_16x16x32_bf16 v[224:227], a[96:99], a[56:59], v[224:227]
    s_waitcnt lgkmcnt(4)
    v_mfma_f32_16x16x32_bf16 v[32:35], a[104:107], a[32:35], v[32:35]
    ds_read_b64_tr_b16 a[120:121], v13 offset:8192
    ds_read_b64_tr_b16 a[122:123], v13 offset:10240
    v_mfma_f32_16x16x32_bf16 v[32:35], a[108:111], a[36:39], v[32:35]
    v_mfma_f32_16x16x32_bf16 v[48:51], a[108:111], a[44:47], v[48:51]
    ds_read_b64_tr_b16 a[124:125], v13 offset:12288
    ds_read_b64_tr_b16 a[126:127], v13 offset:14336
    v_mfma_f32_16x16x32_bf16 v[48:51], a[104:107], a[40:43], v[48:51]
    v_mfma_f32_16x16x32_bf16 v[64:67], a[104:107], a[48:51], v[64:67]
    s_waitcnt vmcnt(30)
    ds_read_b128 a[64:67], v8 offset:32768
    ds_read_b128 a[68:71], v9 offset:32768
    v_mfma_f32_16x16x32_bf16 v[64:67], a[108:111], a[52:55], v[64:67]
    s_mov_b32 s75, 0
    buffer_load_dword a252, v27, s[56:59], s75 offen
    v_mfma_f32_16x16x32_bf16 v[80:83], a[108:111], a[60:63], v[80:83]
    v_mfma_f32_16x16x32_bf16 v[80:83], a[104:107], a[56:59], v[80:83]
    s_waitcnt lgkmcnt(6)
    v_mfma_f32_16x16x32_bf16 v[180:183], a[112:115], a[32:35], v[180:183]
    ds_read_b64_tr_b16 a[96:97], v10 offset:16384
    ds_read_b64_tr_b16 a[98:99], v10 offset:18432
    v_mfma_f32_16x16x32_bf16 v[180:183], a[116:119], a[36:39], v[180:183]
    v_mfma_f32_16x16x32_bf16 v[196:199], a[116:119], a[44:47], v[196:199]
    ds_read_b64_tr_b16 a[100:101], v10 offset:20480
    ds_read_b64_tr_b16 a[102:103], v10 offset:22528
    v_mfma_f32_16x16x32_bf16 v[196:199], a[112:115], a[40:43], v[196:199]
    v_mfma_f32_16x16x32_bf16 v[212:215], a[112:115], a[48:51], v[212:215]
    ds_read_b128 a[72:75], v8 offset:34816
    ds_read_b128 a[76:79], v9 offset:34816
    v_mfma_f32_16x16x32_bf16 v[212:215], a[116:119], a[52:55], v[212:215]
    v_mfma_f32_16x16x32_bf16 v[228:231], a[116:119], a[60:63], v[228:231]
    v_mfma_f32_16x16x32_bf16 v[228:231], a[112:115], a[56:59], v[228:231]
    s_waitcnt lgkmcnt(8)
    v_mfma_f32_16x16x32_bf16 v[36:39], a[120:123], a[32:35], v[36:39]
    ds_read_b64_tr_b16 a[104:105], v11 offset:16384
    ds_read_b64_tr_b16 a[106:107], v11 offset:18432
    v_mfma_f32_16x16x32_bf16 v[36:39], a[124:127], a[36:39], v[36:39]
    v_mfma_f32_16x16x32_bf16 v[52:55], a[124:127], a[44:47], v[52:55]
    ds_read_b64_tr_b16 a[108:109], v11 offset:20480
    ds_read_b64_tr_b16 a[110:111], v11 offset:22528
    v_mfma_f32_16x16x32_bf16 v[52:55], a[120:123], a[40:43], v[52:55]
    v_mfma_f32_16x16x32_bf16 v[68:71], a[120:123], a[48:51], v[68:71]
    ds_read_b128 a[80:83], v8 offset:36864
    ds_read_b128 a[84:87], v9 offset:36864
    v_mfma_f32_16x16x32_bf16 v[68:71], a[124:127], a[52:55], v[68:71]
    v_mfma_f32_16x16x32_bf16 v[84:87], a[124:127], a[60:63], v[84:87]
    v_mfma_f32_16x16x32_bf16 v[84:87], a[120:123], a[56:59], v[84:87]
    s_waitcnt lgkmcnt(8)
    v_mfma_f32_16x16x32_bf16 v[184:187], a[32:35], a[96:99], v[184:187]
    s_add_u32 m0, s60, 32768
    ds_read_b64_tr_b16 a[112:113], v12 offset:16384
    ds_read_b64_tr_b16 a[114:115], v12 offset:18432
    v_mfma_f32_16x16x32_bf16 v[184:187], a[36:39], a[100:103], v[184:187]
    s_add_u32 s77, s62, 640
    buffer_load_dwordx4 v2, s[12:15], s77 offen lds
    v_mfma_f32_16x16x32_bf16 v[200:203], a[44:47], a[100:103], v[200:203]
    ds_read_b64_tr_b16 a[116:117], v12 offset:20480
    ds_read_b64_tr_b16 a[118:119], v12 offset:22528
    v_mfma_f32_16x16x32_bf16 v[200:203], a[40:43], a[96:99], v[200:203]
    v_mfma_f32_16x16x32_bf16 v[216:219], a[48:51], a[96:99], v[216:219]
    s_add_u32 m0, s60, 33792
    ds_read_b128 a[88:91], v8 offset:38912
    ds_read_b128 a[92:95], v9 offset:38912
    v_mfma_f32_16x16x32_bf16 v[216:219], a[52:55], a[100:103], v[216:219]
    s_add_u32 s78, s62, 640
    buffer_load_dwordx4 v3, s[12:15], s78 offen lds
    v_mfma_f32_16x16x32_bf16 v[232:235], a[60:63], a[100:103], v[232:235]
    v_mfma_f32_16x16x32_bf16 v[232:235], a[56:59], a[96:99], v[232:235]
    s_waitcnt lgkmcnt(8)
    v_mfma_f32_16x16x32_bf16 v[40:43], a[32:35], a[104:107], v[40:43]
    s_add_u32 m0, s60, 34816
    ds_read_b64_tr_b16 a[120:121], v13 offset:16384
    ds_read_b64_tr_b16 a[122:123], v13 offset:18432
    v_mfma_f32_16x16x32_bf16 v[40:43], a[36:39], a[108:111], v[40:43]
    s_add_u32 s79, s63, 640
    buffer_load_dwordx4 v2, s[12:15], s79 offen lds
    v_mfma_f32_16x16x32_bf16 v[56:59], a[44:47], a[108:111], v[56:59]
    ds_read_b64_tr_b16 a[124:125], v13 offset:20480
    ds_read_b64_tr_b16 a[126:127], v13 offset:22528
    v_mfma_f32_16x16x32_bf16 v[56:59], a[40:43], a[104:107], v[56:59]
    v_mfma_f32_16x16x32_bf16 v[72:75], a[48:51], a[104:107], v[72:75]
    s_add_u32 m0, s60, 35840
    v_mfma_f32_16x16x32_bf16 v[72:75], a[52:55], a[108:111], v[72:75]
    s_add_u32 s76, s63, 640
    buffer_load_dwordx4 v3, s[12:15], s76 offen lds
    v_mfma_f32_16x16x32_bf16 v[88:91], a[60:63], a[108:111], v[88:91]
    v_mfma_f32_16x16x32_bf16 v[88:91], a[56:59], a[104:107], v[88:91]
    s_waitcnt lgkmcnt(6)
    v_mfma_f32_16x16x32_bf16 v[188:191], a[32:35], a[112:115], v[188:191]
    s_add_u32 m0, s60, 36864
    ds_read_b64_tr_b16 a[96:97], v10 offset:24576
    ds_read_b64_tr_b16 a[98:99], v10 offset:26624
    v_mfma_f32_16x16x32_bf16 v[188:191], a[36:39], a[116:119], v[188:191]
    s_add_u32 s77, s64, 640
    buffer_load_dwordx4 v2, s[12:15], s77 offen lds
    v_mfma_f32_16x16x32_bf16 v[204:207], a[44:47], a[116:119], v[204:207]
    ds_read_b64_tr_b16 a[100:101], v10 offset:28672
    ds_read_b64_tr_b16 a[102:103], v10 offset:30720
    v_mfma_f32_16x16x32_bf16 v[204:207], a[40:43], a[112:115], v[204:207]
    v_mfma_f32_16x16x32_bf16 v[220:223], a[48:51], a[112:115], v[220:223]
    s_add_u32 m0, s60, 37888
    v_mfma_f32_16x16x32_bf16 v[220:223], a[52:55], a[116:119], v[220:223]
    s_add_u32 s78, s64, 640
    buffer_load_dwordx4 v3, s[12:15], s78 offen lds
    v_mfma_f32_16x16x32_bf16 v[236:239], a[60:63], a[116:119], v[236:239]
    v_mfma_f32_16x16x32_bf16 v[236:239], a[56:59], a[112:115], v[236:239]
    s_waitcnt lgkmcnt(4)
    v_mfma_f32_16x16x32_bf16 v[44:47], a[32:35], a[120:123], v[44:47]
    s_add_u32 m0, s60, 38912
    ds_read_b64_tr_b16 a[104:105], v11 offset:24576
    ds_read_b64_tr_b16 a[106:107], v11 offset:26624
    v_mfma_f32_16x16x32_bf16 v[44:47], a[36:39], a[124:127], v[44:47]
    s_add_u32 s79, s65, 640
    buffer_load_dwordx4 v2, s[12:15], s79 offen lds
    v_mfma_f32_16x16x32_bf16 v[60:63], a[44:47], a[124:127], v[60:63]
    ds_read_b64_tr_b16 a[108:109], v11 offset:28672
    ds_read_b64_tr_b16 a[110:111], v11 offset:30720
    v_mfma_f32_16x16x32_bf16 v[60:63], a[40:43], a[120:123], v[60:63]
    v_mfma_f32_16x16x32_bf16 v[76:79], a[48:51], a[120:123], v[76:79]
    s_add_u32 m0, s60, 39936
    v_mfma_f32_16x16x32_bf16 v[76:79], a[52:55], a[124:127], v[76:79]
    s_add_u32 s76, s65, 640
    buffer_load_dwordx4 v3, s[12:15], s76 offen lds
    v_mfma_f32_16x16x32_bf16 v[92:95], a[60:63], a[124:127], v[92:95]
    v_mfma_f32_16x16x32_bf16 v[92:95], a[56:59], a[120:123], v[92:95]
    s_waitcnt lgkmcnt(4)
    v_mfma_f32_16x16x32_bf16 v[160:163], a[32:35], a[96:99], v[160:163]
    ds_read_b64_tr_b16 a[112:113], v12 offset:24576
    ds_read_b64_tr_b16 a[114:115], v12 offset:26624
    v_mfma_f32_16x16x32_bf16 v[160:163], a[36:39], a[100:103], v[160:163]
    v_mfma_f32_16x16x32_bf16 v[164:167], a[44:47], a[100:103], v[164:167]
    ds_read_b64_tr_b16 a[116:117], v12 offset:28672
    ds_read_b64_tr_b16 a[118:119], v12 offset:30720
    v_mfma_f32_16x16x32_bf16 v[164:167], a[40:43], a[96:99], v[164:167]
    v_mfma_f32_16x16x32_bf16 v[168:171], a[48:51], a[96:99], v[168:171]
    v_mfma_f32_16x16x32_bf16 v[168:171], a[52:55], a[100:103], v[168:171]
    v_mfma_f32_16x16x32_bf16 v[172:175], a[60:63], a[100:103], v[172:175]
    v_mfma_f32_16x16x32_bf16 v[172:175], a[56:59], a[96:99], v[172:175]
    s_waitcnt lgkmcnt(4)
    v_mfma_f32_16x16x32_bf16 v[240:243], a[32:35], a[104:107], v[240:243]
    ds_read_b64_tr_b16 a[120:121], v13 offset:24576
    ds_read_b64_tr_b16 a[122:123], v13 offset:26624
    v_mfma_f32_16x16x32_bf16 v[240:243], a[36:39], a[108:111], v[240:243]
    v_mfma_f32_16x16x32_bf16 v[244:247], a[44:47], a[108:111], v[244:247]
    ds_read_b64_tr_b16 a[124:125], v13 offset:28672
    ds_read_b64_tr_b16 a[126:127], v13 offset:30720
    v_mfma_f32_16x16x32_bf16 v[244:247], a[40:43], a[104:107], v[244:247]
    v_mfma_f32_16x16x32_bf16 v[248:251], a[48:51], a[104:107], v[248:251]
    v_add_u32 v10, 4294901760, v10
    v_add_u32 v11, 4294901760, v11
    v_mfma_f32_16x16x32_bf16 v[248:251], a[52:55], a[108:111], v[248:251]
    v_mfma_f32_16x16x32_bf16 v[252:255], a[60:63], a[108:111], v[252:255]
    v_add_u32 v12, 4294901760, v12
    v_add_u32 v13, 4294901760, v13
    v_mfma_f32_16x16x32_bf16 v[252:255], a[56:59], a[104:107], v[252:255]
    s_waitcnt vmcnt(30) lgkmcnt(0)
    s_barrier
    v_mfma_f32_16x16x32_bf16 a[0:3], a[32:35], a[112:115], a[0:3]
    s_add_u32 m0, s61, 65536
    ds_read_b64_tr_b16 a[96:97], v10 offset:0
    ds_read_b64_tr_b16 a[98:99], v10 offset:2048
    v_mfma_f32_16x16x32_bf16 a[0:3], a[36:39], a[116:119], a[0:3]
    s_add_u32 s77, s98, 2621440
    buffer_load_dwordx4 v6, s[16:19], s77 offen nt lds
    v_mfma_f32_16x16x32_bf16 a[4:7], a[44:47], a[116:119], a[4:7]
    ds_read_b64_tr_b16 a[100:101], v10 offset:4096
    ds_read_b64_tr_b16 a[102:103], v10 offset:6144
    v_mfma_f32_16x16x32_bf16 a[4:7], a[40:43], a[112:115], a[4:7]
    v_mfma_f32_16x16x32_bf16 a[8:11], a[48:51], a[112:115], a[8:11]
    v_mfma_f32_16x16x32_bf16 a[8:11], a[52:55], a[116:119], a[8:11]
    v_mfma_f32_16x16x32_bf16 a[12:15], a[60:63], a[116:119], a[12:15]
    v_mfma_f32_16x16x32_bf16 a[12:15], a[56:59], a[112:115], a[12:15]
    s_waitcnt lgkmcnt(4)
    v_mfma_f32_16x16x32_bf16 a[16:19], a[32:35], a[120:123], a[16:19]
    s_add_u32 m0, s61, 73728
    ds_read_b64_tr_b16 a[104:105], v11 offset:0
    ds_read_b64_tr_b16 a[106:107], v11 offset:2048
    v_mfma_f32_16x16x32_bf16 a[16:19], a[36:39], a[124:127], a[16:19]
    s_add_u32 s79, s99, 2621568
    buffer_load_dwordx4 v6, s[16:19], s79 offen nt lds
    v_mfma_f32_16x16x32_bf16 a[20:23], a[44:47], a[124:127], a[20:23]
    ds_read_b64_tr_b16 a[108:109], v11 offset:4096
    ds_read_b64_tr_b16 a[110:111], v11 offset:6144
    v_mfma_f32_16x16x32_bf16 a[20:23], a[40:43], a[120:123], a[20:23]
    v_mfma_f32_16x16x32_bf16 a[24:27], a[48:51], a[120:123], a[24:27]
    s_mov_b32 s75, 16384
    buffer_load_dword a252, v28, s[28:31], s75 offen
    v_mfma_f32_16x16x32_bf16 a[24:27], a[52:55], a[124:127], a[24:27]
    v_mfma_f32_16x16x32_bf16 a[28:31], a[60:63], a[124:127], a[28:31]
    v_mfma_f32_16x16x32_bf16 a[28:31], a[56:59], a[120:123], a[28:31]
    s_waitcnt lgkmcnt(4)
    v_mfma_f32_16x16x32_bf16 v[96:99], a[96:99], a[64:67], v[96:99]
    s_add_u32 m0, s61, 81920
    ds_read_b64_tr_b16 a[112:113], v12 offset:0
    ds_read_b64_tr_b16 a[114:115], v12 offset:2048
    v_mfma_f32_16x16x32_bf16 v[96:99], a[100:103], a[68:71], v[96:99]
    s_add_u32 s77, s100, 2621440
    buffer_load_dwordx4 v6, s[20:23], s77 offen nt lds
    v_mfma_f32_16x16x32_bf16 v[100:103], a[100:103], a[76:79], v[100:103]
    ds_read_b64_tr_b16 a[116:117], v12 offset:4096
    ds_read_b64_tr_b16 a[118:119], v12 offset:6144
    v_mfma_f32_16x16x32_bf16 v[100:103], a[96:99], a[72:75], v[100:103]
    v_mfma_f32_16x16x32_bf16 v[104:107], a[96:99], a[80:83], v[104:107]
    s_add_u32 s75, s86, 30720
    buffer_load_dwordx4 a[220:223], v14, s[36:39], s75 offen nt
    v_mfma_f32_16x16x32_bf16 v[104:107], a[100:103], a[84:87], v[104:107]
    v_mfma_f32_16x16x32_bf16 v[108:111], a[100:103], a[92:95], v[108:111]
    v_mfma_f32_16x16x32_bf16 v[108:111], a[96:99], a[88:91], v[108:111]
    s_waitcnt lgkmcnt(4)
    v_mfma_f32_16x16x32_bf16 v[112:115], a[104:107], a[64:67], v[112:115]
    s_add_u32 m0, s61, 90112
    ds_read_b64_tr_b16 a[120:121], v13 offset:0
    ds_read_b64_tr_b16 a[122:123], v13 offset:2048
    v_mfma_f32_16x16x32_bf16 v[112:115], a[108:111], a[68:71], v[112:115]
    s_add_u32 s79, s101, 2621568
    buffer_load_dwordx4 v6, s[20:23], s79 offen nt lds
    v_mfma_f32_16x16x32_bf16 v[116:119], a[108:111], a[76:79], v[116:119]
    ds_read_b64_tr_b16 a[124:125], v13 offset:4096
    ds_read_b64_tr_b16 a[126:127], v13 offset:6144
    v_mfma_f32_16x16x32_bf16 v[116:119], a[104:107], a[72:75], v[116:119]
    v_mfma_f32_16x16x32_bf16 v[120:123], a[104:107], a[80:83], v[120:123]
    v_mfma_f32_16x16x32_bf16 v[120:123], a[108:111], a[84:87], v[120:123]
    v_mfma_f32_16x16x32_bf16 v[124:127], a[108:111], a[92:95], v[124:127]
    v_mfma_f32_16x16x32_bf16 v[124:127], a[104:107], a[88:91], v[124:127]
    s_waitcnt lgkmcnt(4)
    v_mfma_f32_16x16x32_bf16 v[128:131], a[112:115], a[64:67], v[128:131]
    s_add_u32 m0, s61, 67584
    ds_read_b64_tr_b16 a[96:97], v10 offset:8192
    ds_read_b64_tr_b16 a[98:99], v10 offset:10240
    v_mfma_f32_16x16x32_bf16 v[128:131], a[116:119], a[68:71], v[128:131]
    s_add_u32 s78, s98, 2654208
    buffer_load_dwordx4 v6, s[16:19], s78 offen nt lds
    v_mfma_f32_16x16x32_bf16 v[132:135], a[116:119], a[76:79], v[132:135]
    ds_read_b64_tr_b16 a[100:101], v10 offset:12288
    ds_read_b64_tr_b16 a[102:103], v10 offset:14336
    v_mfma_f32_16x16x32_bf16 v[132:135], a[112:115], a[72:75], v[132:135]
    v_mfma_f32_16x16x32_bf16 v[136:139], a[112:115], a[80:83], v[136:139]
    s_waitcnt vmcnt(25)
    ds_read_b128 a[32:35], v8 offset:0
    ds_read_b128 a[36:39], v9 offset:0
    v_mfma_f32_16x16x32_bf16 v[136:139], a[116:119], a[84:87], v[136:139]
    v_mfma_f32_16x16x32_bf16 v[140:143], a[116:119], a[92:95], v[140:143]
    v_mfma_f32_16x16x32_bf16 v[140:143], a[112:115], a[88:91], v[140:143]
    s_waitcnt lgkmcnt(6)
    v_mfma_f32_16x16x32_bf16 v[144:147], a[120:123], a[64:67], v[144:147]
    s_add_u32 m0, s61, 75776
    ds_read_b64_tr_b16 a[104:105], v11 offset:8192
    ds_read_b64_tr_b16 a[106:107], v11 offset:10240
    v_mfma_f32_16x16x32_bf16 v[144:147], a[124:127], a[68:71], v[144:147]
    s_add_u32 s76, s99, 2654336
    buffer_load_dwordx4 v6, s[16:19], s76 offen nt lds
    v_mfma_f32_16x16x32_bf16 v[148:151], a[124:127], a[76:79], v[148:151]
    ds_read_b64_tr_b16 a[108:109], v11 offset:12288
    ds_read_b64_tr_b16 a[110:111], v11 offset:14336
    v_mfma_f32_16x16x32_bf16 v[148:151], a[120:123], a[72:75], v[148:151]
    v_mfma_f32_16x16x32_bf16 v[152:155], a[120:123], a[80:83], v[152:155]
    ds_read_b128 a[40:43], v8 offset:2048
    ds_read_b128 a[44:47], v9 offset:2048
    v_mfma_f32_16x16x32_bf16 v[152:155], a[124:127], a[84:87], v[152:155]
    v_mfma_f32_16x16x32_bf16 v[156:159], a[124:127], a[92:95], v[156:159]
    v_mfma_f32_16x16x32_bf16 v[156:159], a[120:123], a[88:91], v[156:159]
    s_waitcnt lgkmcnt(8)
    v_mfma_f32_16x16x32_bf16 v[176:179], a[96:99], a[64:67], v[176:179]
    s_add_u32 m0, s61, 83968
    ds_read_b64_tr_b16 a[112:113], v12 offset:8192
    ds_read_b64_tr_b16 a[114:115], v12 offset:10240
    v_mfma_f32_16x16x32_bf16 v[176:179], a[100:103], a[68:71], v[176:179]
    s_add_u32 s78, s100, 2654208
    buffer_load_dwordx4 v6, s[20:23], s78 offen nt lds
    v_mfma_f32_16x16x32_bf16 v[192:195], a[100:103], a[76:79], v[192:195]
    ds_read_b64_tr_b16 a[116:117], v12 offset:12288
    ds_read_b64_tr_b16 a[118:119], v12 offset:14336
    v_mfma_f32_16x16x32_bf16 v[192:195], a[96:99], a[72:75], v[192:195]
    v_mfma_f32_16x16x32_bf16 v[208:211], a[96:99], a[80:83], v[208:211]
    ds_read_b128 a[48:51], v8 offset:4096
    ds_read_b128 a[52:55], v9 offset:4096
    v_mfma_f32_16x16x32_bf16 v[208:211], a[100:103], a[84:87], v[208:211]
    v_mfma_f32_16x16x32_bf16 v[224:227], a[100:103], a[92:95], v[224:227]
    v_mfma_f32_16x16x32_bf16 v[224:227], a[96:99], a[88:91], v[224:227]
    s_waitcnt lgkmcnt(8)
    v_mfma_f32_16x16x32_bf16 v[32:35], a[104:107], a[64:67], v[32:35]
    s_add_u32 m0, s61, 92160
    ds_read_b64_tr_b16 a[120:121], v13 offset:8192
    ds_read_b64_tr_b16 a[122:123], v13 offset:10240
    v_mfma_f32_16x16x32_bf16 v[32:35], a[108:111], a[68:71], v[32:35]
    s_add_u32 s76, s101, 2654336
    buffer_load_dwordx4 v6, s[20:23], s76 offen nt lds
    v_mfma_f32_16x16x32_bf16 v[48:51], a[108:111], a[76:79], v[48:51]
    ds_read_b64_tr_b16 a[124:125], v13 offset:12288
    ds_read_b64_tr_b16 a[126:127], v13 offset:14336
    v_mfma_f32_16x16x32_bf16 v[48:51], a[104:107], a[72:75], v[48:51]
    v_mfma_f32_16x16x32_bf16 v[64:67], a[104:107], a[80:83], v[64:67]
    ds_read_b128 a[56:59], v8 offset:6144
    ds_read_b128 a[60:63], v9 offset:6144
    v_mfma_f32_16x16x32_bf16 v[64:67], a[108:111], a[84:87], v[64:67]
    v_mfma_f32_16x16x32_bf16 v[80:83], a[108:111], a[92:95], v[80:83]
    v_mfma_f32_16x16x32_bf16 v[80:83], a[104:107], a[88:91], v[80:83]
    s_waitcnt lgkmcnt(8)
    v_mfma_f32_16x16x32_bf16 v[180:183], a[112:115], a[64:67], v[180:183]
    s_add_u32 m0, s60, 0
    ds_read_b64_tr_b16 a[96:97], v10 offset:16384
    ds_read_b64_tr_b16 a[98:99], v10 offset:18432
    v_mfma_f32_16x16x32_bf16 v[180:183], a[116:119], a[68:71], v[180:183]
    s_add_u32 s77, s62, 768
    buffer_load_dwordx4 v2, s[12:15], s77 offen lds
    v_mfma_f32_16x16x32_bf16 v[196:199], a[116:119], a[76:79], v[196:199]
    ds_read_b64_tr_b16 a[100:101], v10 offset:20480
    ds_read_b64_tr_b16 a[102:103], v10 offset:22528
    v_mfma_f32_16x16x32_bf16 v[196:199], a[112:115], a[72:75], v[196:199]
    v_mfma_f32_16x16x32_bf16 v[212:215], a[112:115], a[80:83], v[212:215]
    v_mfma_f32_16x16x32_bf16 v[212:215], a[116:119], a[84:87], v[212:215]
    v_mfma_f32_16x16x32_bf16 v[228:231], a[116:119], a[92:95], v[228:231]
    v_mfma_f32_16x16x32_bf16 v[228:231], a[112:115], a[88:91], v[228:231]
    s_waitcnt lgkmcnt(6)
    v_mfma_f32_16x16x32_bf16 v[36:39], a[120:123], a[64:67], v[36:39]
    s_add_u32 m0, s60, 1024
    ds_read_b64_tr_b16 a[104:105], v11 offset:16384
    ds_read_b64_tr_b16 a[106:107], v11 offset:18432
    v_mfma_f32_16x16x32_bf16 v[36:39], a[124:127], a[68:71], v[36:39]
    s_add_u32 s78, s62, 768
    buffer_load_dwordx4 v3, s[12:15], s78 offen lds
    v_mfma_f32_16x16x32_bf16 v[52:55], a[124:127], a[76:79], v[52:55]
    ds_read_b64_tr_b16 a[108:109], v11 offset:20480
    ds_read_b64_tr_b16 a[110:111], v11 offset:22528
    v_mfma_f32_16x16x32_bf16 v[52:55], a[120:123], a[72:75], v[52:55]
pad1:
    s_cbranch_execz pad5
    v_mfma_f32_16x16x32_bf16 v[68:71], a[120:123], a[80:83], v[68:71]
    v_mfma_f32_16x16x32_bf16 v[68:71], a[124:127], a[84:87], v[68:71]
    v_mfma_f32_16x16x32_bf16 v[84:87], a[124:127], a[92:95], v[84:87]
    v_mfma_f32_16x16x32_bf16 v[84:87], a[120:123], a[88:91], v[84:87]
    s_waitcnt lgkmcnt(4)
    v_mfma_f32_16x16x32_bf16 v[184:187], a[64:67], a[96:99], v[184:187]
    s_add_u32 m0, s60, 2048
    ds_read_b64_tr_b16 a[112:113], v12 offset:16384
    ds_read_b64_tr_b16 a[114:115], v12 offset:18432
    v_mfma_f32_16x16x32_bf16 v[184:187], a[68:71], a[100:103], v[184:187]
    s_add_u32 s79, s63, 768
    buffer_load_dwordx4 v2, s[12:15], s79 offen lds
    v_mfma_f32_16x16x32_bf16 v[200:203], a[76:79], a[100:103], v[200:203]
    ds_read_b64_tr_b16 a[116:117], v12 offset:20480
    ds_read_b64_tr_b16 a[118:119], v12 offset:22528
    v_mfma_f32_16x16x32_bf16 v[200:203], a[72:75], a[96:99], v[200:203]
    v_mfma_f32_16x16x32_bf16 v[216:219], a[80:83], a[96:99], v[216:219]
    v_mfma_f32_16x16x32_bf16 v[216:219], a[84:87], a[100:103], v[216:219]
    v_mfma_f32_16x16x32_bf16 v[232:235], a[92:95], a[100:103], v[232:235]
    v_mfma_f32_16x16x32_bf16 v[232:235], a[88:91], a[96:99], v[232:235]
    s_waitcnt lgkmcnt(4)
    v_mfma_f32_16x16x32_bf16 v[40:43], a[64:67], a[104:107], v[40:43]
    s_add_u32 m0, s60, 3072
    ds_read_b64_tr_b16 a[120:121], v13 offset:16384
    ds_read_b64_tr_b16 a[122:123], v13 offset:18432
    v_mfma_f32_16x16x32_bf16 v[40:43], a[68:71], a[108:111], v[40:43]
    s_add_u32 s76, s63, 768
    buffer_load_dwordx4 v3, s[12:15], s76 offen lds
    v_mfma_f32_16x16x32_bf16 v[56:59], a[76:79], a[108:111], v[56:59]
    ds_read_b64_tr_b16 a[124:125], v13 offset:20480
    ds_read_b64_tr_b16 a[126:127], v13 offset:22528
    v_mfma_f32_16x16x32_bf16 v[56:59], a[72:75], a[104:107], v[56:59]
    v_mfma_f32_16x16x32_bf16 v[72:75], a[80:83], a[104:107], v[72:75]
    s_mov_b32 s75, 1280
    buffer_load_dword a252, v26, s[24:27], s75 offen
    v_mfma_f32_16x16x32_bf16 v[72:75], a[84:87], a[108:111], v[72:75]
    v_mfma_f32_16x16x32_bf16 v[88:91], a[92:95], a[108:111], v[88:91]
    v_mfma_f32_16x16x32_bf16 v[88:91], a[88:91], a[104:107], v[88:91]
    s_waitcnt lgkmcnt(4)
    v_mfma_f32_16x16x32_bf16 v[188:191], a[64:67], a[112:115], v[188:191]
    s_add_u32 m0, s60, 4096
    ds_read_b64_tr_b16 a[96:97], v10 offset:24576
    ds_read_b64_tr_b16 a[98:99], v10 offset:26624
    v_mfma_f32_16x16x32_bf16 v[188:191], a[68:71], a[116:119], v[188:191]
    s_add_u32 s77, s64, 768
    buffer_load_dwordx4 v2, s[12:15], s77 offen lds
    v_mfma_f32_16x16x32_bf16 v[204:207], a[76:79], a[116:119], v[204:207]
    ds_read_b64_tr_b16 a[100:101], v10 offset:28672
    ds_read_b64_tr_b16 a[102:103], v10 offset:30720
    v_mfma_f32_16x16x32_bf16 v[204:207], a[72:75], a[112:115], v[204:207]
    v_mfma_f32_16x16x32_bf16 v[220:223], a[80:83], a[112:115], v[220:223]
    v_mfma_f32_16x16x32_bf16 v[220:223], a[84:87], a[116:119], v[220:223]
    v_mfma_f32_16x16x32_bf16 v[236:239], a[92:95], a[116:119], v[236:239]
    v_mfma_f32_16x16x32_bf16 v[236:239], a[88:91], a[112:115], v[236:239]
    s_waitcnt lgkmcnt(4)
    v_mfma_f32_16x16x32_bf16 v[44:47], a[64:67], a[120:123], v[44:47]
    s_add_u32 m0, s60, 5120
    ds_read_b64_tr_b16 a[104:105], v11 offset:24576
    ds_read_b64_tr_b16 a[106:107], v11 offset:26624
    v_mfma_f32_16x16x32_bf16 v[44:47], a[68:71], a[124:127], v[44:47]
    s_add_u32 s78, s64, 768
    buffer_load_dwordx4 v3, s[12:15], s78 offen lds
    v_mfma_f32_16x16x32_bf16 v[60:63], a[76:79], a[124:127], v[60:63]
    ds_read_b64_tr_b16 a[108:109], v11 offset:28672
    ds_read_b64_tr_b16 a[110:111], v11 offset:30720
    v_mfma_f32_16x16x32_bf16 v[60:63], a[72:75], a[120:123], v[60:63]
    v_mfma_f32_16x16x32_bf16 v[76:79], a[80:83], a[120:123], v[76:79]
    v_mfma_f32_16x16x32_bf16 v[76:79], a[84:87], a[124:127], v[76:79]
    v_mfma_f32_16x16x32_bf16 v[92:95], a[92:95], a[124:127], v[92:95]
    v_mfma_f32_16x16x32_bf16 v[92:95], a[88:91], a[120:123], v[92:95]
    s_waitcnt lgkmcnt(4)
    v_mfma_f32_16x16x32_bf16 v[160:163], a[64:67], a[96:99], v[160:163]
    s_add_u32 m0, s60, 6144
    ds_read_b64_tr_b16 a[112:113], v12 offset:24576
    ds_read_b64_tr_b16 a[114:115], v12 offset:26624
    v_mfma_f32_16x16x32_bf16 v[160:163], a[68:71], a[100:103], v[160:163]
    s_add_u32 s79, s65, 768
    buffer_load_dwordx4 v2, s[12:15], s79 offen lds
    v_mfma_f32_16x16x32_bf16 v[164:167], a[76:79], a[100:103], v[164:167]
    ds_read_b64_tr_b16 a[116:117], v12 offset:28672
    ds_read_b64_tr_b16 a[118:119], v12 offset:30720
    v_mfma_f32_16x16x32_bf16 v[164:167], a[72:75], a[96:99], v[164:167]
    v_mfma_f32_16x16x32_bf16 v[168:171], a[80:83], a[96:99], v[168:171]
    s_add_u32 s75, s87, 0
    buffer_load_dwordx4 a[224:227], v14, s[40:43], s75 offen nt
    v_mfma_f32_16x16x32_bf16 v[168:171], a[84:87], a[100:103], v[168:171]
    v_mfma_f32_16x16x32_bf16 v[172:175], a[92:95], a[100:103], v[172:175]
    v_mfma_f32_16x16x32_bf16 v[172:175], a[88:91], a[96:99], v[172:175]
    s_waitcnt lgkmcnt(4)
    v_mfma_f32_16x16x32_bf16 v[240:243], a[64:67], a[104:107], v[240:243]
    s_add_u32 m0, s60, 7168
    ds_read_b64_tr_b16 a[120:121], v13 offset:24576
    ds_read_b64_tr_b16 a[122:123], v13 offset:26624
    v_mfma_f32_16x16x32_bf16 v[240:243], a[68:71], a[108:111], v[240:243]
    s_add_u32 s76, s65, 768
    buffer_load_dwordx4 v3, s[12:15], s76 offen lds
    v_mfma_f32_16x16x32_bf16 v[244:247], a[76:79], a[108:111], v[244:247]
    ds_read_b64_tr_b16 a[124:125], v13 offset:28672
    ds_read_b64_tr_b16 a[126:127], v13 offset:30720
    v_mfma_f32_16x16x32_bf16 v[244:247], a[72:75], a[104:107], v[244:247]
    v_mfma_f32_16x16x32_bf16 v[248:251], a[80:83], a[104:107], v[248:251]
    v_add_u32 v10, 32768, v10
    v_add_u32 v11, 32768, v11
    v_mfma_f32_16x16x32_bf16 v[248:251], a[84:87], a[108:111], v[248:251]
    v_mfma_f32_16x16x32_bf16 v[252:255], a[92:95], a[108:111], v[252:255]
    v_add_u32 v12, 32768, v12
    v_add_u32 v13, 32768, v13
    v_mfma_f32_16x16x32_bf16 v[252:255], a[88:91], a[104:107], v[252:255]
    s_waitcnt vmcnt(30) lgkmcnt(0)
    s_barrier
    v_mfma_f32_16x16x32_bf16 a[0:3], a[64:67], a[112:115], a[0:3]
    s_add_u32 m0, s61, 0
    ds_read_b64_tr_b16 a[96:97], v10 offset:0
    ds_read_b64_tr_b16 a[98:99], v10 offset:2048
    v_mfma_f32_16x16x32_bf16 a[0:3], a[68:71], a[116:119], a[0:3]
    s_add_u32 s77, s98, 3145728
    buffer_load_dwordx4 v6, s[16:19], s77 offen nt lds
    v_mfma_f32_16x16x32_bf16 a[4:7], a[76:79], a[116:119], a[4:7]
    ds_read_b64_tr_b16 a[100:101], v10 offset:4096
    ds_read_b64_tr_b16 a[102:103], v10 offset:6144
    v_mfma_f32_16x16x32_bf16 a[4:7], a[72:75], a[112:115], a[4:7]
    v_mfma_f32_16x16x32_bf16 a[8:11], a[80:83], a[112:115], a[8:11]
    v_mfma_f32_16x16x32_bf16 a[8:11], a[84:87], a[116:119], a[8:11]
    v_mfma_f32_16x16x32_bf16 a[12:15], a[92:95], a[116:119], a[12:15]
    v_mfma_f32_16x16x32_bf16 a[12:15], a[88:91], a[112:115], a[12:15]
    s_waitcnt lgkmcnt(4)
    v_mfma_f32_16x16x32_bf16 a[16:19], a[64:67], a[120:123], a[16:19]
    s_add_u32 m0, s61, 8192
    ds_read_b64_tr_b16 a[104:105], v11 offset:0
    ds_read_b64_tr_b16 a[106:107], v11 offset:2048
    v_mfma_f32_16x16x32_bf16 a[16:19], a[68:71], a[124:127], a[16:19]
    s_add_u32 s79, s99, 3145856
    buffer_load_dwordx4 v6, s[16:19], s79 offen nt lds
    v_mfma_f32_16x16x32_bf16 a[20:23], a[76:79], a[124:127], a[20:23]
    ds_read_b64_tr_b16 a[108:109], v11 offset:4096
    ds_read_b64_tr_b16 a[110:111], v11 offset:6144
    v_mfma_f32_16x16x32_bf16 a[20:23], a[72:75], a[120:123], a[20:23]
    v_mfma_f32_16x16x32_bf16 a[24:27], a[80:83], a[120:123], a[24:27]
    v_mfma_f32_16x16x32_bf16 a[24:27], a[84:87], a[124:127], a[24:27]
    v_mfma_f32_16x16x32_bf16 a[28:31], a[92:95], a[124:127], a[28:31]
    v_mfma_f32_16x16x32_bf16 a[28:31], a[88:91], a[120:123], a[28:31]
    s_waitcnt lgkmcnt(4)
    v_mfma_f32_16x16x32_bf16 v[96:99], a[96:99], a[32:35], v[96:99]
    s_add_u32 m0, s61, 16384
    ds_read_b64_tr_b16 a[112:113], v12 offset:0
    ds_read_b64_tr_b16 a[114:115], v12 offset:2048
    v_mfma_f32_16x16x32_bf16 v[96:99], a[100:103], a[36:39], v[96:99]
    s_add_u32 s77, s100, 3145728
    buffer_load_dwordx4 v6, s[20:23], s77 offen nt lds
    v_mfma_f32_16x16x32_bf16 v[100:103], a[100:103], a[44:47], v[100:103]
    ds_read_b64_tr_b16 a[116:117], v12 offset:4096
    ds_read_b64_tr_b16 a[118:119], v12 offset:6144
    v_mfma_f32_16x16x32_bf16 v[100:103], a[96:99], a[40:43], v[100:103]
    v_mfma_f32_16x16x32_bf16 v[104:107], a[96:99], a[48:51], v[104:107]
    v_mfma_f32_16x16x32_bf16 v[104:107], a[100:103], a[52:55], v[104:107]
    v_mfma_f32_16x16x32_bf16 v[108:111], a[100:103], a[60:63], v[108:111]
    v_mfma_f32_16x16x32_bf16 v[108:111], a[96:99], a[56:59], v[108:111]
    s_waitcnt lgkmcnt(4)
    v_mfma_f32_16x16x32_bf16 v[112:115], a[104:107], a[32:35], v[112:115]
    s_add_u32 m0, s61, 24576
    ds_read_b64_tr_b16 a[120:121], v13 offset:0
    ds_read_b64_tr_b16 a[122:123], v13 offset:2048
    v_mfma_f32_16x16x32_bf16 v[112:115], a[108:111], a[36:39], v[112:115]
    s_add_u32 s79, s101, 3145856
    buffer_load_dwordx4 v6, s[20:23], s79 offen nt lds
    v_mfma_f32_16x16x32_bf16 v[116:119], a[108:111], a[44:47], v[116:119]
    ds_read_b64_tr_b16 a[124:125], v13 offset:4096
    ds_read_b64_tr_b16 a[126:127], v13 offset:6144
    v_mfma_f32_16x16x32_bf16 v[116:119], a[104:107], a[40:43], v[116:119]
    v_mfma_f32_16x16x32_bf16 v[120:123], a[104:107], a[48:51], v[120:123]
    v_mfma_f32_16x16x32_bf16 v[120:123], a[108:111], a[52:55], v[120:123]
    v_mfma_f32_16x16x32_bf16 v[124:127], a[108:111], a[60:63], v[124:127]
    v_mfma_f32_16x16x32_bf16 v[124:127], a[104:107], a[56:59], v[124:127]
    s_waitcnt lgkmcnt(4)
    v_mfma_f32_16x16x32_bf16 v[128:131], a[112:115], a[32:35], v[128:131]
    s_add_u32 m0, s61, 2048
    ds_read_b64_tr_b16 a[96:97], v10 offset:8192
    ds_read_b64_tr_b16 a[98:99], v10 offset:10240
    v_mfma_f32_16x16x32_bf16 v[128:131], a[116:119], a[36:39], v[128:131]
    s_add_u32 s78, s98, 3178496
    buffer_load_dwordx4 v6, s[16:19], s78 offen nt lds
    v_mfma_f32_16x16x32_bf16 v[132:135], a[116:119], a[44:47], v[132:135]
    ds_read_b64_tr_b16 a[100:101], v10 offset:12288
    ds_read_b64_tr_b16 a[102:103], v10 offset:14336
    v_mfma_f32_16x16x32_bf16 v[132:135], a[112:115], a[40:43], v[132:135]
    v_mfma_f32_16x16x32_bf16 v[136:139], a[112:115], a[48:51], v[136:139]
    s_waitcnt vmcnt(25)
    ds_read_b128 a[64:67], v8 offset:32768
    ds_read_b128 a[68:71], v9 offset:32768
    v_mfma_f32_16x16x32_bf16 v[136:139], a[116:119], a[52:55], v[136:139]
    v_mfma_f32_16x16x32_bf16 v[140:143], a[116:119], a[60:63], v[140:143]
    v_mfma_f32_16x16x32_bf16 v[140:143], a[112:115], a[56:59], v[140:143]
    s_waitcnt lgkmcnt(6)
    v_mfma_f32_16x16x32_bf16 v[144:147], a[120:123], a[32:35], v[144:147]
    s_add_u32 m0, s61, 10240
    ds_read_b64_tr_b16 a[104:105], v11 offset:8192
    ds_read_b64_tr_b16 a[106:107], v11 offset:10240
    v_mfma_f32_16x16x32_bf16 v[144:147], a[124:127], a[36:39], v[144:147]
    s_add_u32 s76, s99, 3178624
    buffer_load_dwordx4 v6, s[16:19], s76 offen nt lds
    v_mfma_f32_16x16x32_bf16 v[148:151], a[124:127], a[44:47], v[148:151]
    ds_read_b64_tr_b16 a[108:109], v11 offset:12288
    ds_read_b64_tr_b16 a[110:111], v11 offset:14336
    v_mfma_f32_16x16x32_bf16 v[148:151], a[120:123], a[40:43], v[148:151]
    v_mfma_f32_16x16x32_bf16 v[152:155], a[120:123], a[48:51], v[152:155]
    ds_read_b128 a[72:75], v8 offset:34816
    ds_read_b128 a[76:79], v9 offset:34816
    v_mfma_f32_16x16x32_bf16 v[152:155], a[124:127], a[52:55], v[152:155]
    s_mov_b32 s75, 24576
    buffer_load_dword a252, v28, s[28:31], s75 offen
    v_mfma_f32_16x16x32_bf16 v[156:159], a[124:127], a[60:63], v[156:159]
    v_mfma_f32_16x16x32_bf16 v[156:159], a[120:123], a[56:59], v[156:159]
    s_waitcnt lgkmcnt(8)
    v_mfma_f32_16x16x32_bf16 v[176:179], a[96:99], a[32:35], v[176:179]
    s_add_u32 m0, s61, 18432
    ds_read_b64_tr_b16 a[112:113], v12 offset:8192
    ds_read_b64_tr_b16 a[114:115], v12 offset:10240
    v_mfma_f32_16x16x32_bf16 v[176:179], a[100:103], a[36:39], v[176:179]
    s_add_u32 s78, s100, 3178496
    buffer_load_dwordx4 v6, s[20:23], s78 offen nt lds
    v_mfma_f32_16x16x32_bf16 v[192:195], a[100:103], a[44:47], v[192:195]
    ds_read_b64_tr_b16 a[116:117], v12 offset:12288
    ds_read_b64_tr_b16 a[118:119], v12 offset:14336
    v_mfma_f32_16x16x32_bf16 v[192:195], a[96:99], a[40:43], v[192:195]
    v_mfma_f32_16x16x32_bf16 v[208:211], a[96:99], a[48:51], v[208:211]
    ds_read_b128 a[80:83], v8 offset:36864
    ds_read_b128 a[84:87], v9 offset:36864
    v_mfma_f32_16x16x32_bf16 v[208:211], a[100:103], a[52:55], v[208:211]
    v_mfma_f32_16x16x32_bf16 v[224:227], a[100:103], a[60:63], v[224:227]
    v_mfma_f32_16x16x32_bf16 v[224:227], a[96:99], a[56:59], v[224:227]
    s_waitcnt lgkmcnt(8)
    v_mfma_f32_16x16x32_bf16 v[32:35], a[104:107], a[32:35], v[32:35]
    s_add_u32 m0, s61, 26624
    ds_read_b64_tr_b16 a[120:121], v13 offset:8192
    ds_read_b64_tr_b16 a[122:123], v13 offset:10240
    v_mfma_f32_16x16x32_bf16 v[32:35], a[108:111], a[36:39], v[32:35]
    s_add_u32 s76, s101, 3178624
    buffer_load_dwordx4 v6, s[20:23], s76 offen nt lds
    v_mfma_f32_16x16x32_bf16 v[48:51], a[108:111], a[44:47], v[48:51]
    ds_read_b64_tr_b16 a[124:125], v13 offset:12288
    ds_read_b64_tr_b16 a[126:127], v13 offset:14336
    v_mfma_f32_16x16x32_bf16 v[48:51], a[104:107], a[40:43], v[48:51]
    v_mfma_f32_16x16x32_bf16 v[64:67], a[104:107], a[48:51], v[64:67]
    ds_read_b128 a[88:91], v8 offset:38912
    ds_read_b128 a[92:95], v9 offset:38912
    v_mfma_f32_16x16x32_bf16 v[64:67], a[108:111], a[52:55], v[64:67]
    v_mfma_f32_16x16x32_bf16 v[80:83], a[108:111], a[60:63], v[80:83]
    v_mfma_f32_16x16x32_bf16 v[80:83], a[104:107], a[56:59], v[80:83]
    s_waitcnt lgkmcnt(8)
    v_mfma_f32_16x16x32_bf16 v[180:183], a[112:115], a[32:35], v[180:183]
    s_add_u32 m0, s60, 32768
    ds_read_b64_tr_b16 a[96:97], v10 offset:16384
    ds_read_b64_tr_b16 a[98:99], v10 offset:18432
    v_mfma_f32_16x16x32_bf16 v[180:183], a[116:119], a[36:39], v[180:183]
    s_add_u32 s77, s62, 896
    buffer_load_dwordx4 v2, s[12:15], s77 offen lds
    v_mfma_f32_16x16x32_bf16 v[196:199], a[116:119], a[44:47], v[196:199]
    ds_read_b64_tr_b16 a[100:101], v10 offset:20480
    ds_read_b64_tr_b16 a[102:103], v10 offset:22528
    v_mfma_f32_16x16x32_bf16 v[196:199], a[112:115], a[40:43], v[196:199]
    v_mfma_f32_16x16x32_bf16 v[212:215], a[112:115], a[48:51], v[212:215]
    v_mfma_f32_16x16x32_bf16 v[212:215], a[116:119], a[52:55], v[212:215]
    v_mfma_f32_16x16x32_bf16 v[228:231], a[116:119], a[60:63], v[228:231]
    v_mfma_f32_16x16x32_bf16 v[228:231], a[112:115], a[56:59], v[228:231]
    s_waitcnt lgkmcnt(6)
    v_mfma_f32_16x16x32_bf16 v[36:39], a[120:123], a[32:35], v[36:39]
    s_add_u32 m0, s60, 33792
    ds_read_b64_tr_b16 a[104:105], v11 offset:16384
    ds_read_b64_tr_b16 a[106:107], v11 offset:18432
    v_mfma_f32_16x16x32_bf16 v[36:39], a[124:127], a[36:39], v[36:39]
    s_add_u32 s78, s62, 896
    buffer_load_dwordx4 v3, s[12:15], s78 offen lds
    v_mfma_f32_16x16x32_bf16 v[52:55], a[124:127], a[44:47], v[52:55]
    ds_read_b64_tr_b16 a[108:109], v11 offset:20480
    ds_read_b64_tr_b16 a[110:111], v11 offset:22528
    v_mfma_f32_16x16x32_bf16 v[52:55], a[120:123], a[40:43], v[52:55]
    v_mfma_f32_16x16x32_bf16 v[68:71], a[120:123], a[48:51], v[68:71]
    v_mfma_f32_16x16x32_bf16 v[68:71], a[124:127], a[52:55], v[68:71]
    v_mfma_f32_16x16x32_bf16 v[84:87], a[124:127], a[60:63], v[84:87]
    v_mfma_f32_16x16x32_bf16 v[84:87], a[120:123], a[56:59], v[84:87]
    s_waitcnt lgkmcnt(4)
    v_mfma_f32_16x16x32_bf16 v[184:187], a[32:35], a[96:99], v[184:187]
    s_add_u32 m0, s60, 34816
    ds_read_b64_tr_b16 a[112:113], v12 offset:16384
    ds_read_b64_tr_b16 a[114:115], v12 offset:18432
    v_mfma_f32_16x16x32_bf16 v[184:187], a[36:39], a[100:103], v[184:187]
    s_add_u32 s79, s63, 896
    buffer_load_dwordx4 v2, s[12:15], s79 offen lds
    v_mfma_f32_16x16x32_bf16 v[200:203], a[44:47], a[100:103], v[200:203]
    ds_read_b64_tr_b16 a[116:117], v12 offset:20480
    ds_read_b64_tr_b16 a[118:119], v12 offset:22528
    v_mfma_f32_16x16x32_bf16 v[200:203], a[40:43], a[96:99], v[200:203]
    v_mfma_f32_16x16x32_bf16 v[216:219], a[48:51], a[96:99], v[216:219]
    s_add_u32 s75, s87, 10240
    buffer_load_dwordx4 a[228:231], v14, s[40:43], s75 offen nt
    v_mfma_f32_16x16x32_bf16 v[216:219], a[52:55], a[100:103], v[216:219]
    v_mfma_f32_16x16x32_bf16 v[232:235], a[60:63], a[100:103], v[232:235]
    v_mfma_f32_16x16x32_bf16 v[232:235], a[56:59], a[96:99], v[232:235]
    s_waitcnt lgkmcnt(4)
    v_mfma_f32_16x16x32_bf16 v[40:43], a[32:35], a[104:107], v[40:43]
    s_add_u32 m0, s60, 35840
    ds_read_b64_tr_b16 a[120:121], v13 offset:16384
    ds_read_b64_tr_b16 a[122:123], v13 offset:18432
    v_mfma_f32_16x16x32_bf16 v[40:43], a[36:39], a[108:111], v[40:43]
    s_add_u32 s76, s63, 896
    buffer_load_dwordx4 v3, s[12:15], s76 offen lds
    v_mfma_f32_16x16x32_bf16 v[56:59], a[44:47], a[108:111], v[56:59]
    ds_read_b64_tr_b16 a[124:125], v13 offset:20480
    ds_read_b64_tr_b16 a[126:127], v13 offset:22528
    v_mfma_f32_16x16x32_bf16 v[56:59], a[40:43], a[104:107], v[56:59]
    v_mfma_f32_16x16x32_bf16 v[72:75], a[48:51], a[104:107], v[72:75]
    v_mfma_f32_16x16x32_bf16 v[72:75], a[52:55], a[108:111], v[72:75]
    v_mfma_f32_16x16x32_bf16 v[88:91], a[60:63], a[108:111], v[88:91]
    v_mfma_f32_16x16x32_bf16 v[88:91], a[56:59], a[104:107], v[88:91]
    s_waitcnt lgkmcnt(4)
    v_mfma_f32_16x16x32_bf16 v[188:191], a[32:35], a[112:115], v[188:191]
    s_add_u32 m0, s60, 36864
    ds_read_b64_tr_b16 a[96:97], v10 offset:24576
    ds_read_b64_tr_b16 a[98:99], v10 offset:26624
    v_mfma_f32_16x16x32_bf16 v[188:191], a[36:39], a[116:119], v[188:191]
    s_add_u32 s77, s64, 896
    buffer_load_dwordx4 v2, s[12:15], s77 offen lds
    v_mfma_f32_16x16x32_bf16 v[204:207], a[44:47], a[116:119], v[204:207]
    ds_read_b64_tr_b16 a[100:101], v10 offset:28672
    ds_read_b64_tr_b16 a[102:103], v10 offset:30720
    v_mfma_f32_16x16x32_bf16 v[204:207], a[40:43], a[112:115], v[204:207]
    v_mfma_f32_16x16x32_bf16 v[220:223], a[48:51], a[112:115], v[220:223]
    v_mfma_f32_16x16x32_bf16 v[220:223], a[52:55], a[116:119], v[220:223]
    v_mfma_f32_16x16x32_bf16 v[236:239], a[60:63], a[116:119], v[236:239]
    v_mfma_f32_16x16x32_bf16 v[236:239], a[56:59], a[112:115], v[236:239]
    s_waitcnt lgkmcnt(4)
    v_mfma_f32_16x16x32_bf16 v[44:47], a[32:35], a[120:123], v[44:47]
    s_add_u32 m0, s60, 37888
    ds_read_b64_tr_b16 a[104:105], v11 offset:24576
    ds_read_b64_tr_b16 a[106:107], v11 offset:26624
    v_mfma_f32_16x16x32_bf16 v[44:47], a[36:39], a[124:127], v[44:47]
    s_add_u32 s78, s64, 896
    buffer_load_dwordx4 v3, s[12:15], s78 offen lds
    v_mfma_f32_16x16x32_bf16 v[60:63], a[44:47], a[124:127], v[60:63]
    ds_read_b64_tr_b16 a[108:109], v11 offset:28672
    ds_read_b64_tr_b16 a[110:111], v11 offset:30720
    v_mfma_f32_16x16x32_bf16 v[60:63], a[40:43], a[120:123], v[60:63]
    v_mfma_f32_16x16x32_bf16 v[76:79], a[48:51], a[120:123], v[76:79]
    v_mfma_f32_16x16x32_bf16 v[76:79], a[52:55], a[124:127], v[76:79]
    v_mfma_f32_16x16x32_bf16 v[92:95], a[60:63], a[124:127], v[92:95]
    v_mfma_f32_16x16x32_bf16 v[92:95], a[56:59], a[120:123], v[92:95]
    s_waitcnt lgkmcnt(4)
    v_mfma_f32_16x16x32_bf16 v[160:163], a[32:35], a[96:99], v[160:163]
    s_add_u32 m0, s60, 38912
    ds_read_b64_tr_b16 a[112:113], v12 offset:24576
    ds_read_b64_tr_b16 a[114:115], v12 offset:26624
    v_mfma_f32_16x16x32_bf16 v[160:163], a[36:39], a[100:103], v[160:163]
    s_add_u32 s79, s65, 896
    buffer_load_dwordx4 v2, s[12:15], s79 offen lds
    v_mfma_f32_16x16x32_bf16 v[164:167], a[44:47], a[100:103], v[164:167]
    ds_read_b64_tr_b16 a[116:117], v12 offset:28672
    ds_read_b64_tr_b16 a[118:119], v12 offset:30720
    v_mfma_f32_16x16x32_bf16 v[164:167], a[40:43], a[96:99], v[164:167]
    v_mfma_f32_16x16x32_bf16 v[168:171], a[48:51], a[96:99], v[168:171]
    v_mfma_f32_16x16x32_bf16 v[168:171], a[52:55], a[100:103], v[168:171]
    v_mfma_f32_16x16x32_bf16 v[172:175], a[60:63], a[100:103], v[172:175]
    v_mfma_f32_16x16x32_bf16 v[172:175], a[56:59], a[96:99], v[172:175]
    s_waitcnt lgkmcnt(4)
    v_mfma_f32_16x16x32_bf16 v[240:243], a[32:35], a[104:107], v[240:243]
    s_add_u32 m0, s60, 39936
    ds_read_b64_tr_b16 a[120:121], v13 offset:24576
    ds_read_b64_tr_b16 a[122:123], v13 offset:26624
    v_mfma_f32_16x16x32_bf16 v[240:243], a[36:39], a[108:111], v[240:243]
    s_add_u32 s76, s65, 896
    buffer_load_dwordx4 v3, s[12:15], s76 offen lds
    v_mfma_f32_16x16x32_bf16 v[244:247], a[44:47], a[108:111], v[244:247]
    ds_read_b64_tr_b16 a[124:125], v13 offset:28672
    ds_read_b64_tr_b16 a[126:127], v13 offset:30720
    v_mfma_f32_16x16x32_bf16 v[244:247], a[40:43], a[104:107], v[244:247]
    v_mfma_f32_16x16x32_bf16 v[248:251], a[48:51], a[104:107], v[248:251]
    v_add_u32 v10, 32768, v10
    v_add_u32 v11, 32768, v11
    v_mfma_f32_16x16x32_bf16 v[248:251], a[52:55], a[108:111], v[248:251]
    s_mov_b32 s75, 1152
    buffer_load_dword a252, v27, s[56:59], s75 offen
    v_mfma_f32_16x16x32_bf16 v[252:255], a[60:63], a[108:111], v[252:255]
    v_add_u32 v12, 32768, v12
    v_add_u32 v13, 32768, v13
    v_mfma_f32_16x16x32_bf16 v[252:255], a[56:59], a[104:107], v[252:255]
    s_waitcnt vmcnt(29) lgkmcnt(0)
    s_barrier
    v_mfma_f32_16x16x32_bf16 a[0:3], a[32:35], a[112:115], a[0:3]
    s_add_u32 m0, s61, 32768
    ds_read_b64_tr_b16 a[96:97], v10 offset:0
    ds_read_b64_tr_b16 a[98:99], v10 offset:2048
    v_mfma_f32_16x16x32_bf16 a[0:3], a[36:39], a[116:119], a[0:3]
    s_add_u32 s77, s98, 3670016
    buffer_load_dwordx4 v6, s[16:19], s77 offen nt lds
    v_mfma_f32_16x16x32_bf16 a[4:7], a[44:47], a[116:119], a[4:7]
    ds_read_b64_tr_b16 a[100:101], v10 offset:4096
    ds_read_b64_tr_b16 a[102:103], v10 offset:6144
    v_mfma_f32_16x16x32_bf16 a[4:7], a[40:43], a[112:115], a[4:7]
    v_mfma_f32_16x16x32_bf16 a[8:11], a[48:51], a[112:115], a[8:11]
    v_mfma_f32_16x16x32_bf16 a[8:11], a[52:55], a[116:119], a[8:11]
    v_mfma_f32_16x16x32_bf16 a[12:15], a[60:63], a[116:119], a[12:15]
    v_mfma_f32_16x16x32_bf16 a[12:15], a[56:59], a[112:115], a[12:15]
    s_waitcnt lgkmcnt(4)
    v_mfma_f32_16x16x32_bf16 a[16:19], a[32:35], a[120:123], a[16:19]
    s_add_u32 m0, s61, 40960
    ds_read_b64_tr_b16 a[104:105], v11 offset:0
    ds_read_b64_tr_b16 a[106:107], v11 offset:2048
    v_mfma_f32_16x16x32_bf16 a[16:19], a[36:39], a[124:127], a[16:19]
    s_add_u32 s79, s99, 3670144
    buffer_load_dwordx4 v6, s[16:19], s79 offen nt lds
    v_mfma_f32_16x16x32_bf16 a[20:23], a[44:47], a[124:127], a[20:23]
    ds_read_b64_tr_b16 a[108:109], v11 offset:4096
    ds_read_b64_tr_b16 a[110:111], v11 offset:6144
    v_mfma_f32_16x16x32_bf16 a[20:23], a[40:43], a[120:123], a[20:23]
    v_mfma_f32_16x16x32_bf16 a[24:27], a[48:51], a[120:123], a[24:27]
    v_mfma_f32_16x16x32_bf16 a[24:27], a[52:55], a[124:127], a[24:27]
    v_mfma_f32_16x16x32_bf16 a[28:31], a[60:63], a[124:127], a[28:31]
    v_mfma_f32_16x16x32_bf16 a[28:31], a[56:59], a[120:123], a[28:31]
    s_waitcnt lgkmcnt(4)
    v_mfma_f32_16x16x32_bf16 v[96:99], a[96:99], a[64:67], v[96:99]
    s_add_u32 m0, s61, 49152
    ds_read_b64_tr_b16 a[112:113], v12 offset:0
    ds_read_b64_tr_b16 a[114:115], v12 offset:2048
    v_mfma_f32_16x16x32_bf16 v[96:99], a[100:103], a[68:71], v[96:99]
    s_add_u32 s77, s100, 3670016
    buffer_load_dwordx4 v6, s[20:23], s77 offen nt lds
    v_mfma_f32_16x16x32_bf16 v[100:103], a[100:103], a[76:79], v[100:103]
    ds_read_b64_tr_b16 a[116:117], v12 offset:4096
    ds_read_b64_tr_b16 a[118:119], v12 offset:6144
    v_mfma_f32_16x16x32_bf16 v[100:103], a[96:99], a[72:75], v[100:103]
    v_mfma_f32_16x16x32_bf16 v[104:107], a[96:99], a[80:83], v[104:107]
    v_mfma_f32_16x16x32_bf16 v[104:107], a[100:103], a[84:87], v[104:107]
    v_mfma_f32_16x16x32_bf16 v[108:111], a[100:103], a[92:95], v[108:111]
    v_mfma_f32_16x16x32_bf16 v[108:111], a[96:99], a[88:91], v[108:111]
    s_waitcnt lgkmcnt(4)
    v_mfma_f32_16x16x32_bf16 v[112:115], a[104:107], a[64:67], v[112:115]
    s_add_u32 m0, s61, 57344
    ds_read_b64_tr_b16 a[120:121], v13 offset:0
    ds_read_b64_tr_b16 a[122:123], v13 offset:2048
    v_mfma_f32_16x16x32_bf16 v[112:115], a[108:111], a[68:71], v[112:115]
    s_add_u32 s79, s101, 3670144
    buffer_load_dwordx4 v6, s[20:23], s79 offen nt lds
    v_mfma_f32_16x16x32_bf16 v[116:119], a[108:111], a[76:79], v[116:119]
    ds_read_b64_tr_b16 a[124:125], v13 offset:4096
    ds_read_b64_tr_b16 a[126:127], v13 offset:6144
    v_mfma_f32_16x16x32_bf16 v[116:119], a[104:107], a[72:75], v[116:119]
    v_mfma_f32_16x16x32_bf16 v[120:123], a[104:107], a[80:83], v[120:123]
    v_mfma_f32_16x16x32_bf16 v[120:123], a[108:111], a[84:87], v[120:123]
    v_mfma_f32_16x16x32_bf16 v[124:127], a[108:111], a[92:95], v[124:127]
    v_mfma_f32_16x16x32_bf16 v[124:127], a[104:107], a[88:91], v[124:127]
    s_waitcnt lgkmcnt(4)
    v_mfma_f32_16x16x32_bf16 v[128:131], a[112:115], a[64:67], v[128:131]
    s_add_u32 m0, s61, 34816
    ds_read_b64_tr_b16 a[96:97], v10 offset:8192
    ds_read_b64_tr_b16 a[98:99], v10 offset:10240
    v_mfma_f32_16x16x32_bf16 v[128:131], a[116:119], a[68:71], v[128:131]
    s_add_u32 s78, s98, 3702784
    buffer_load_dwordx4 v6, s[16:19], s78 offen nt lds
    v_mfma_f32_16x16x32_bf16 v[132:135], a[116:119], a[76:79], v[132:135]
    ds_read_b64_tr_b16 a[100:101], v10 offset:12288
    ds_read_b64_tr_b16 a[102:103], v10 offset:14336
    v_mfma_f32_16x16x32_bf16 v[132:135], a[112:115], a[72:75], v[132:135]
    v_mfma_f32_16x16x32_bf16 v[136:139], a[112:115], a[80:83], v[136:139]
    s_waitcnt vmcnt(24)
    ds_read_b128 a[32:35], v8 offset:0
    ds_read_b128 a[36:39], v9 offset:0
    v_mfma_f32_16x16x32_bf16 v[136:139], a[116:119], a[84:87], v[136:139]
    v_mfma_f32_16x16x32_bf16 v[140:143], a[116:119], a[92:95], v[140:143]
    v_mfma_f32_16x16x32_bf16 v[140:143], a[112:115], a[88:91], v[140:143]
    s_waitcnt lgkmcnt(6)
    v_mfma_f32_16x16x32_bf16 v[144:147], a[120:123], a[64:67], v[144:147]
    s_add_u32 m0, s61, 43008
    ds_read_b64_tr_b16 a[104:105], v11 offset:8192
    ds_read_b64_tr_b16 a[106:107], v11 offset:10240
    v_mfma_f32_16x16x32_bf16 v[144:147], a[124:127], a[68:71], v[144:147]
    s_add_u32 s76, s99, 3702912
    buffer_load_dwordx4 v6, s[16:19], s76 offen nt lds
    v_mfma_f32_16x16x32_bf16 v[148:151], a[124:127], a[76:79], v[148:151]
    ds_read_b64_tr_b16 a[108:109], v11 offset:12288
    ds_read_b64_tr_b16 a[110:111], v11 offset:14336
    v_mfma_f32_16x16x32_bf16 v[148:151], a[120:123], a[72:75], v[148:151]
    v_mfma_f32_16x16x32_bf16 v[152:155], a[120:123], a[80:83], v[152:155]
    ds_read_b128 a[40:43], v8 offset:2048
    ds_read_b128 a[44:47], v9 offset:2048
    v_mfma_f32_16x16x32_bf16 v[152:155], a[124:127], a[84:87], v[152:155]
    v_mfma_f32_16x16x32_bf16 v[156:159], a[124:127], a[92:95], v[156:159]
    v_mfma_f32_16x16x32_bf16 v[156:159], a[120:123], a[88:91], v[156:159]
    s_waitcnt lgkmcnt(8)
    v_mfma_f32_16x16x32_bf16 v[176:179], a[96:99], a[64:67], v[176:179]
    s_add_u32 m0, s61, 51200
    ds_read_b64_tr_b16 a[112:113], v12 offset:8192
    ds_read_b64_tr_b16 a[114:115], v12 offset:10240
    v_mfma_f32_16x16x32_bf16 v[176:179], a[100:103], a[68:71], v[176:179]
    s_add_u32 s78, s100, 3702784
    buffer_load_dwordx4 v6, s[20:23], s78 offen nt lds
    v_mfma_f32_16x16x32_bf16 v[192:195], a[100:103], a[76:79], v[192:195]
    ds_read_b64_tr_b16 a[116:117], v12 offset:12288
    ds_read_b64_tr_b16 a[118:119], v12 offset:14336
    v_mfma_f32_16x16x32_bf16 v[192:195], a[96:99], a[72:75], v[192:195]
    v_mfma_f32_16x16x32_bf16 v[208:211], a[96:99], a[80:83], v[208:211]
    ds_read_b128 a[48:51], v8 offset:4096
    ds_read_b128 a[52:55], v9 offset:4096
    v_mfma_f32_16x16x32_bf16 v[208:211], a[100:103], a[84:87], v[208:211]
    s_add_u32 s75, s87, 20480
    buffer_load_dwordx4 a[232:235], v14, s[40:43], s75 offen nt
    v_mfma_f32_16x16x32_bf16 v[224:227], a[100:103], a[92:95], v[224:227]
    v_mfma_f32_16x16x32_bf16 v[224:227], a[96:99], a[88:91], v[224:227]
    s_waitcnt lgkmcnt(8)
    v_mfma_f32_16x16x32_bf16 v[32:35], a[104:107], a[64:67], v[32:35]
    s_add_u32 m0, s61, 59392
    ds_read_b64_tr_b16 a[120:121], v13 offset:8192
    ds_read_b64_tr_b16 a[122:123], v13 offset:10240
    v_mfma_f32_16x16x32_bf16 v[32:35], a[108:111], a[68:71], v[32:35]
    s_add_u32 s76, s101, 3702912
    buffer_load_dwordx4 v6, s[20:23], s76 offen nt lds
    v_mfma_f32_16x16x32_bf16 v[48:51], a[108:111], a[76:79], v[48:51]
    ds_read_b64_tr_b16 a[124:125], v13 offset:12288
    ds_read_b64_tr_b16 a[126:127], v13 offset:14336
    v_mfma_f32_16x16x32_bf16 v[48:51], a[104:107], a[72:75], v[48:51]
    v_mfma_f32_16x16x32_bf16 v[64:67], a[104:107], a[80:83], v[64:67]
    ds_read_b128 a[56:59], v8 offset:6144
    ds_read_b128 a[60:63], v9 offset:6144
    v_mfma_f32_16x16x32_bf16 v[64:67], a[108:111], a[84:87], v[64:67]
    v_mfma_f32_16x16x32_bf16 v[80:83], a[108:111], a[92:95], v[80:83]
    v_mfma_f32_16x16x32_bf16 v[80:83], a[104:107], a[88:91], v[80:83]
    s_waitcnt lgkmcnt(8)
    v_mfma_f32_16x16x32_bf16 v[180:183], a[112:115], a[64:67], v[180:183]
    s_add_u32 m0, s60, 0
    ds_read_b64_tr_b16 a[96:97], v10 offset:16384
    ds_read_b64_tr_b16 a[98:99], v10 offset:18432
    v_mfma_f32_16x16x32_bf16 v[180:183], a[116:119], a[68:71], v[180:183]
pad2:
    s_cbranch_execz pad6
    s_add_u32 s77, s66, 0
    buffer_load_dwordx4 v4, s[24:27], s77 offen lds
    v_mfma_f32_16x16x32_bf16 v[196:199], a[116:119], a[76:79], v[196:199]
    ds_read_b64_tr_b16 a[100:101], v10 offset:20480
    ds_read_b64_tr_b16 a[102:103], v10 offset:22528
    v_mfma_f32_16x16x32_bf16 v[196:199], a[112:115], a[72:75], v[196:199]
    v_mfma_f32_16x16x32_bf16 v[212:215], a[112:115], a[80:83], v[212:215]
    v_mfma_f32_16x16x32_bf16 v[212:215], a[116:119], a[84:87], v[212:215]
    v_mfma_f32_16x16x32_bf16 v[228:231], a[116:119], a[92:95], v[228:231]
    v_mfma_f32_16x16x32_bf16 v[228:231], a[112:115], a[88:91], v[228:231]
    s_waitcnt lgkmcnt(6)
    v_mfma_f32_16x16x32_bf16 v[36:39], a[120:123], a[64:67], v[36:39]
    s_add_u32 m0, s60, 1024
    ds_read_b64_tr_b16 a[104:105], v11 offset:16384
    ds_read_b64_tr_b16 a[106:107], v11 offset:18432
    v_mfma_f32_16x16x32_bf16 v[36:39], a[124:127], a[68:71], v[36:39]
    s_add_u32 s78, s66, 0
    buffer_load_dwordx4 v5, s[24:27], s78 offen lds
    v_mfma_f32_16x16x32_bf16 v[52:55], a[124:127], a[76:79], v[52:55]
    ds_read_b64_tr_b16 a[108:109], v11 offset:20480
    ds_read_b64_tr_b16 a[110:111], v11 offset:22528
    v_mfma_f32_16x16x32_bf16 v[52:55], a[120:123], a[72:75], v[52:55]
    v_mfma_f32_16x16x32_bf16 v[68:71], a[120:123], a[80:83], v[68:71]
    s_mov_b32 s75, 32768
    buffer_load_dword a252, v28, s[28:31], s75 offen
    v_mfma_f32_16x16x32_bf16 v[68:71], a[124:127], a[84:87], v[68:71]
    v_mfma_f32_16x16x32_bf16 v[84:87], a[124:127], a[92:95], v[84:87]
    v_mfma_f32_16x16x32_bf16 v[84:87], a[120:123], a[88:91], v[84:87]
    s_waitcnt lgkmcnt(4)
    v_mfma_f32_16x16x32_bf16 v[184:187], a[64:67], a[96:99], v[184:187]
    s_add_u32 m0, s60, 2048
    ds_read_b64_tr_b16 a[112:113], v12 offset:16384
    ds_read_b64_tr_b16 a[114:115], v12 offset:18432
    v_mfma_f32_16x16x32_bf16 v[184:187], a[68:71], a[100:103], v[184:187]
    s_add_u32 s79, s67, 0
    buffer_load_dwordx4 v4, s[24:27], s79 offen lds
    v_mfma_f32_16x16x32_bf16 v[200:203], a[76:79], a[100:103], v[200:203]
    ds_read_b64_tr_b16 a[116:117], v12 offset:20480
    ds_read_b64_tr_b16 a[118:119], v12 offset:22528
    v_mfma_f32_16x16x32_bf16 v[200:203], a[72:75], a[96:99], v[200:203]
    v_mfma_f32_16x16x32_bf16 v[216:219], a[80:83], a[96:99], v[216:219]
    v_mfma_f32_16x16x32_bf16 v[216:219], a[84:87], a[100:103], v[216:219]
    v_mfma_f32_16x16x32_bf16 v[232:235], a[92:95], a[100:103], v[232:235]
    v_mfma_f32_16x16x32_bf16 v[232:235], a[88:91], a[96:99], v[232:235]
    s_waitcnt lgkmcnt(4)
    v_mfma_f32_16x16x32_bf16 v[40:43], a[64:67], a[104:107], v[40:43]
    s_add_u32 m0, s60, 3072
    ds_read_b64_tr_b16 a[120:121], v13 offset:16384
    ds_read_b64_tr_b16 a[122:123], v13 offset:18432
    v_mfma_f32_16x16x32_bf16 v[40:43], a[68:71], a[108:111], v[40:43]
    s_add_u32 s76, s67, 0
    buffer_load_dwordx4 v5, s[24:27], s76 offen lds
    v_mfma_f32_16x16x32_bf16 v[56:59], a[76:79], a[108:111], v[56:59]
    ds_read_b64_tr_b16 a[124:125], v13 offset:20480
    ds_read_b64_tr_b16 a[126:127], v13 offset:22528
    v_mfma_f32_16x16x32_bf16 v[56:59], a[72:75], a[104:107], v[56:59]
    v_mfma_f32_16x16x32_bf16 v[72:75], a[80:83], a[104:107], v[72:75]
    v_mfma_f32_16x16x32_bf16 v[72:75], a[84:87], a[108:111], v[72:75]
    v_mfma_f32_16x16x32_bf16 v[88:91], a[92:95], a[108:111], v[88:91]
    v_mfma_f32_16x16x32_bf16 v[88:91], a[88:91], a[104:107], v[88:91]
    s_waitcnt lgkmcnt(4)
    v_mfma_f32_16x16x32_bf16 v[188:191], a[64:67], a[112:115], v[188:191]
    s_add_u32 m0, s60, 4096
    ds_read_b64_tr_b16 a[96:97], v10 offset:24576
    ds_read_b64_tr_b16 a[98:99], v10 offset:26624
    v_mfma_f32_16x16x32_bf16 v[188:191], a[68:71], a[116:119], v[188:191]
    s_add_u32 s77, s68, 0
    buffer_load_dwordx4 v4, s[24:27], s77 offen lds
    v_mfma_f32_16x16x32_bf16 v[204:207], a[76:79], a[116:119], v[204:207]
    ds_read_b64_tr_b16 a[100:101], v10 offset:28672
    ds_read_b64_tr_b16 a[102:103], v10 offset:30720
    v_mfma_f32_16x16x32_bf16 v[204:207], a[72:75], a[112:115], v[204:207]
    v_mfma_f32_16x16x32_bf16 v[220:223], a[80:83], a[112:115], v[220:223]
    v_mfma_f32_16x16x32_bf16 v[220:223], a[84:87], a[116:119], v[220:223]
    v_mfma_f32_16x16x32_bf16 v[236:239], a[92:95], a[116:119], v[236:239]
    v_mfma_f32_16x16x32_bf16 v[236:239], a[88:91], a[112:115], v[236:239]
    s_waitcnt lgkmcnt(4)
    v_mfma_f32_16x16x32_bf16 v[44:47], a[64:67], a[120:123], v[44:47]
    s_add_u32 m0, s60, 5120
    ds_read_b64_tr_b16 a[104:105], v11 offset:24576
    ds_read_b64_tr_b16 a[106:107], v11 offset:26624
    v_mfma_f32_16x16x32_bf16 v[44:47], a[68:71], a[124:127], v[44:47]
    s_add_u32 s78, s68, 0
    buffer_load_dwordx4 v5, s[24:27], s78 offen lds
    v_mfma_f32_16x16x32_bf16 v[60:63], a[76:79], a[124:127], v[60:63]
    ds_read_b64_tr_b16 a[108:109], v11 offset:28672
    ds_read_b64_tr_b16 a[110:111], v11 offset:30720
    v_mfma_f32_16x16x32_bf16 v[60:63], a[72:75], a[120:123], v[60:63]
    v_mfma_f32_16x16x32_bf16 v[76:79], a[80:83], a[120:123], v[76:79]
    v_mfma_f32_16x16x32_bf16 v[76:79], a[84:87], a[124:127], v[76:79]
    v_mfma_f32_16x16x32_bf16 v[92:95], a[92:95], a[124:127], v[92:95]
    v_mfma_f32_16x16x32_bf16 v[92:95], a[88:91], a[120:123], v[92:95]
    s_waitcnt lgkmcnt(4)
    v_mfma_f32_16x16x32_bf16 v[160:163], a[64:67], a[96:99], v[160:163]
    s_add_u32 m0, s60, 6144
    ds_read_b64_tr_b16 a[112:113], v12 offset:24576
    ds_read_b64_tr_b16 a[114:115], v12 offset:26624
    v_mfma_f32_16x16x32_bf16 v[160:163], a[68:71], a[100:103], v[160:163]
    s_add_u32 s79, s69, 0
    buffer_load_dwordx4 v4, s[24:27], s79 offen lds
    v_mfma_f32_16x16x32_bf16 v[164:167], a[76:79], a[100:103], v[164:167]
    ds_read_b64_tr_b16 a[116:117], v12 offset:28672
    ds_read_b64_tr_b16 a[118:119], v12 offset:30720
    v_mfma_f32_16x16x32_bf16 v[164:167], a[72:75], a[96:99], v[164:167]
    v_mfma_f32_16x16x32_bf16 v[168:171], a[80:83], a[96:99], v[168:171]
    v_mfma_f32_16x16x32_bf16 v[168:171], a[84:87], a[100:103], v[168:171]
    v_mfma_f32_16x16x32_bf16 v[172:175], a[92:95], a[100:103], v[172:175]
    v_mfma_f32_16x16x32_bf16 v[172:175], a[88:91], a[96:99], v[172:175]
    s_waitcnt lgkmcnt(4)
    v_mfma_f32_16x16x32_bf16 v[240:243], a[64:67], a[104:107], v[240:243]
    s_add_u32 m0, s60, 7168
    ds_read_b64_tr_b16 a[120:121], v13 offset:24576
    ds_read_b64_tr_b16 a[122:123], v13 offset:26624
    v_mfma_f32_16x16x32_bf16 v[240:243], a[68:71], a[108:111], v[240:243]
    s_add_u32 s76, s69, 0
    buffer_load_dwordx4 v5, s[24:27], s76 offen lds
    v_mfma_f32_16x16x32_bf16 v[244:247], a[76:79], a[108:111], v[244:247]
    ds_read_b64_tr_b16 a[124:125], v13 offset:28672
    ds_read_b64_tr_b16 a[126:127], v13 offset:30720
    v_mfma_f32_16x16x32_bf16 v[244:247], a[72:75], a[104:107], v[244:247]
    v_mfma_f32_16x16x32_bf16 v[248:251], a[80:83], a[104:107], v[248:251]
    v_add_u32 v10, 4294901760, v10
    v_add_u32 v11, 4294901760, v11
    v_mfma_f32_16x16x32_bf16 v[248:251], a[84:87], a[108:111], v[248:251]
    v_mfma_f32_16x16x32_bf16 v[252:255], a[92:95], a[108:111], v[252:255]
    v_add_u32 v12, 4294901760, v12
    v_add_u32 v13, 4294901760, v13
    v_mfma_f32_16x16x32_bf16 v[252:255], a[88:91], a[104:107], v[252:255]
    s_waitcnt vmcnt(28) lgkmcnt(0)
    s_barrier
    v_mfma_f32_16x16x32_bf16 a[0:3], a[64:67], a[112:115], a[0:3]
    s_add_u32 m0, s61, 65536
    ds_read_b64_tr_b16 a[96:97], v10 offset:0
    ds_read_b64_tr_b16 a[98:99], v10 offset:2048
    v_mfma_f32_16x16x32_bf16 a[0:3], a[68:71], a[116:119], a[0:3]
    s_add_u32 s71, s71, s73
    buffer_load_dwordx4 v7, s[32:35], s71 offen lds
    v_mfma_f32_16x16x32_bf16 a[4:7], a[76:79], a[116:119], a[4:7]
    ds_read_b64_tr_b16 a[100:101], v10 offset:4096
    ds_read_b64_tr_b16 a[102:103], v10 offset:6144
    v_mfma_f32_16x16x32_bf16 a[4:7], a[72:75], a[112:115], a[4:7]
    v_mfma_f32_16x16x32_bf16 a[8:11], a[80:83], a[112:115], a[8:11]
    v_mfma_f32_16x16x32_bf16 a[8:11], a[84:87], a[116:119], a[8:11]
    v_mfma_f32_16x16x32_bf16 a[12:15], a[92:95], a[116:119], a[12:15]
    v_mfma_f32_16x16x32_bf16 a[12:15], a[88:91], a[112:115], a[12:15]
    s_waitcnt lgkmcnt(4)
    v_mfma_f32_16x16x32_bf16 a[16:19], a[64:67], a[120:123], a[16:19]
    s_add_u32 m0, s61, 73728
    ds_read_b64_tr_b16 a[104:105], v11 offset:0
    ds_read_b64_tr_b16 a[106:107], v11 offset:2048
    v_mfma_f32_16x16x32_bf16 a[16:19], a[68:71], a[124:127], a[16:19]
    s_add_u32 s77, s70, 0
    buffer_load_dwordx4 v6, s[28:31], s77 offen lds
    v_mfma_f32_16x16x32_bf16 a[20:23], a[76:79], a[124:127], a[20:23]
    ds_read_b64_tr_b16 a[108:109], v11 offset:4096
    ds_read_b64_tr_b16 a[110:111], v11 offset:6144
    v_mfma_f32_16x16x32_bf16 a[20:23], a[72:75], a[120:123], a[20:23]
    v_mfma_f32_16x16x32_bf16 a[24:27], a[80:83], a[120:123], a[24:27]
    v_mfma_f32_16x16x32_bf16 a[24:27], a[84:87], a[124:127], a[24:27]
    v_mfma_f32_16x16x32_bf16 a[28:31], a[92:95], a[124:127], a[28:31]
    v_mfma_f32_16x16x32_bf16 a[28:31], a[88:91], a[120:123], a[28:31]
    s_waitcnt lgkmcnt(4)
    v_mfma_f32_16x16x32_bf16 v[96:99], a[96:99], a[32:35], v[96:99]
    ds_read_b64_tr_b16 a[112:113], v12 offset:0
    ds_read_b64_tr_b16 a[114:115], v12 offset:2048
    v_mfma_f32_16x16x32_bf16 v[96:99], a[100:103], a[36:39], v[96:99]
    v_mfma_f32_16x16x32_bf16 v[100:103], a[100:103], a[44:47], v[100:103]
    s_add_u32 m0, s61, 81920
    ds_read_b64_tr_b16 a[116:117], v12 offset:4096
    ds_read_b64_tr_b16 a[118:119], v12 offset:6144
    v_mfma_f32_16x16x32_bf16 v[100:103], a[96:99], a[40:43], v[100:103]
    s_add_u32 s79, s70, 128
    buffer_load_dwordx4 v6, s[28:31], s79 offen lds
    v_mfma_f32_16x16x32_bf16 v[104:107], a[96:99], a[48:51], v[104:107]
    s_add_u32 s75, s87, 30720
    buffer_load_dwordx4 a[236:239], v14, s[40:43], s75 offen nt
    v_mfma_f32_16x16x32_bf16 v[104:107], a[100:103], a[52:55], v[104:107]
    v_mfma_f32_16x16x32_bf16 v[108:111], a[100:103], a[60:63], v[108:111]
    v_mfma_f32_16x16x32_bf16 v[108:111], a[96:99], a[56:59], v[108:111]
    s_waitcnt lgkmcnt(4)
    v_mfma_f32_16x16x32_bf16 v[112:115], a[104:107], a[32:35], v[112:115]
    ds_read_b64_tr_b16 a[120:121], v13 offset:0
    ds_read_b64_tr_b16 a[122:123], v13 offset:2048
    v_mfma_f32_16x16x32_bf16 v[112:115], a[108:111], a[36:39], v[112:115]
    v_mfma_f32_16x16x32_bf16 v[116:119], a[108:111], a[44:47], v[116:119]
    s_add_u32 m0, s61, 67584
    ds_read_b64_tr_b16 a[124:125], v13 offset:4096
    ds_read_b64_tr_b16 a[126:127], v13 offset:6144
    v_mfma_f32_16x16x32_bf16 v[116:119], a[104:107], a[40:43], v[116:119]
    s_add_u32 s71, s71, s72
    buffer_load_dwordx4 v7, s[32:35], s71 offen lds
    v_mfma_f32_16x16x32_bf16 v[120:123], a[104:107], a[48:51], v[120:123]
    v_mfma_f32_16x16x32_bf16 v[120:123], a[108:111], a[52:55], v[120:123]
    v_mfma_f32_16x16x32_bf16 v[124:127], a[108:111], a[60:63], v[124:127]
    v_mfma_f32_16x16x32_bf16 v[124:127], a[104:107], a[56:59], v[124:127]
    s_waitcnt lgkmcnt(4)
    v_mfma_f32_16x16x32_bf16 v[128:131], a[112:115], a[32:35], v[128:131]
    ds_read_b64_tr_b16 a[96:97], v10 offset:8192
    ds_read_b64_tr_b16 a[98:99], v10 offset:10240
    v_mfma_f32_16x16x32_bf16 v[128:131], a[116:119], a[36:39], v[128:131]
    v_mfma_f32_16x16x32_bf16 v[132:135], a[116:119], a[44:47], v[132:135]
    ds_read_b64_tr_b16 a[100:101], v10 offset:12288
    ds_read_b64_tr_b16 a[102:103], v10 offset:14336
    v_mfma_f32_16x16x32_bf16 v[132:135], a[112:115], a[40:43], v[132:135]
    v_mfma_f32_16x16x32_bf16 v[136:139], a[112:115], a[48:51], v[136:139]
    s_waitcnt vmcnt(24)
    ds_read_b128 a[64:67], v8 offset:32768
    ds_read_b128 a[68:71], v9 offset:32768
    v_mfma_f32_16x16x32_bf16 v[136:139], a[116:119], a[52:55], v[136:139]
    s_add_u32 m0, s61, 75776
    v_mfma_f32_16x16x32_bf16 v[140:143], a[116:119], a[60:63], v[140:143]
    s_add_u32 s78, s70, 32768
    buffer_load_dwordx4 v6, s[28:31], s78 offen lds
    v_mfma_f32_16x16x32_bf16 v[140:143], a[112:115], a[56:59], v[140:143]
    s_waitcnt lgkmcnt(6)
    v_mfma_f32_16x16x32_bf16 v[144:147], a[120:123], a[32:35], v[144:147]
    ds_read_b64_tr_b16 a[104:105], v11 offset:8192
    ds_read_b64_tr_b16 a[106:107], v11 offset:10240
    v_mfma_f32_16x16x32_bf16 v[144:147], a[124:127], a[36:39], v[144:147]
    v_mfma_f32_16x16x32_bf16 v[148:151], a[124:127], a[44:47], v[148:151]
    ds_read_b64_tr_b16 a[108:109], v11 offset:12288
    ds_read_b64_tr_b16 a[110:111], v11 offset:14336
    v_mfma_f32_16x16x32_bf16 v[148:151], a[120:123], a[40:43], v[148:151]
    v_mfma_f32_16x16x32_bf16 v[152:155], a[120:123], a[48:51], v[152:155]
    s_add_u32 m0, s61, 83968
    ds_read_b128 a[72:75], v8 offset:34816
    ds_read_b128 a[76:79], v9 offset:34816
    v_mfma_f32_16x16x32_bf16 v[152:155], a[124:127], a[52:55], v[152:155]
    s_add_u32 s76, s70, 32896
    buffer_load_dwordx4 v6, s[28:31], s76 offen lds
    v_mfma_f32_16x16x32_bf16 v[156:159], a[124:127], a[60:63], v[156:159]
    v_mfma_f32_16x16x32_bf16 v[156:159], a[120:123], a[56:59], v[156:159]
    s_waitcnt lgkmcnt(8)
    v_mfma_f32_16x16x32_bf16 v[176:179], a[96:99], a[32:35], v[176:179]
    s_and_b32 s74, s74, 0xfffff
    ds_read_b64_tr_b16 a[112:113], v12 offset:8192
    ds_read_b64_tr_b16 a[114:115], v12 offset:10240
    v_mfma_f32_16x16x32_bf16 v[176:179], a[100:103], a[36:39], v[176:179]
    s_lshr_b32 s98, s98, 8
    v_mfma_f32_16x16x32_bf16 v[192:195], a[100:103], a[44:47], v[192:195]
    s_lshl_b32 s98, s98, 20
    ds_read_b64_tr_b16 a[116:117], v12 offset:12288
    ds_read_b64_tr_b16 a[118:119], v12 offset:14336
    v_mfma_f32_16x16x32_bf16 v[192:195], a[96:99], a[40:43], v[192:195]
    s_add_u32 s98, s98, s74
    v_mfma_f32_16x16x32_bf16 v[208:211], a[96:99], a[48:51], v[208:211]
    s_lshr_b32 s99, s99, 8
    ds_read_b128 a[80:83], v8 offset:36864
    ds_read_b128 a[84:87], v9 offset:36864
    v_mfma_f32_16x16x32_bf16 v[208:211], a[100:103], a[52:55], v[208:211]
    s_lshl_b32 s99, s99, 20
    v_mfma_f32_16x16x32_bf16 v[224:227], a[100:103], a[60:63], v[224:227]
    s_add_u32 s99, s99, s74
    v_mfma_f32_16x16x32_bf16 v[224:227], a[96:99], a[56:59], v[224:227]
    s_waitcnt lgkmcnt(8)
    v_mfma_f32_16x16x32_bf16 v[32:35], a[104:107], a[32:35], v[32:35]
    s_add_u32 m0, s60, 32768
    ds_read_b64_tr_b16 a[120:121], v13 offset:8192
    ds_read_b64_tr_b16 a[122:123], v13 offset:10240
    v_mfma_f32_16x16x32_bf16 v[32:35], a[108:111], a[36:39], v[32:35]
    s_add_u32 s77, s66, 128
    buffer_load_dwordx4 v4, s[24:27], s77 offen lds
    v_mfma_f32_16x16x32_bf16 v[48:51], a[108:111], a[44:47], v[48:51]
    s_lshr_b32 s100, s100, 8
    ds_read_b64_tr_b16 a[124:125], v13 offset:12288
    ds_read_b64_tr_b16 a[126:127], v13 offset:14336
    v_mfma_f32_16x16x32_bf16 v[48:51], a[104:107], a[40:43], v[48:51]
    s_lshl_b32 s100, s100, 20
    v_mfma_f32_16x16x32_bf16 v[64:67], a[104:107], a[48:51], v[64:67]
    s_add_u32 s100, s100, s74
    ds_read_b128 a[88:91], v8 offset:38912
    ds_read_b128 a[92:95], v9 offset:38912
    v_mfma_f32_16x16x32_bf16 v[64:67], a[108:111], a[52:55], v[64:67]
    s_lshr_b32 s101, s101, 8
    v_mfma_f32_16x16x32_bf16 v[80:83], a[108:111], a[60:63], v[80:83]
    s_lshl_b32 s101, s101, 20
    v_mfma_f32_16x16x32_bf16 v[80:83], a[104:107], a[56:59], v[80:83]
    s_waitcnt lgkmcnt(8)
    v_mfma_f32_16x16x32_bf16 v[180:183], a[112:115], a[32:35], v[180:183]
    s_add_u32 m0, s60, 33792
    ds_read_b64_tr_b16 a[96:97], v10 offset:16384
    ds_read_b64_tr_b16 a[98:99], v10 offset:18432
    v_mfma_f32_16x16x32_bf16 v[180:183], a[116:119], a[36:39], v[180:183]
    s_add_u32 s78, s66, 128
    buffer_load_dwordx4 v5, s[24:27], s78 offen lds
    v_mfma_f32_16x16x32_bf16 v[196:199], a[116:119], a[44:47], v[196:199]
    s_add_u32 s101, s101, s74
    ds_read_b64_tr_b16 a[100:101], v10 offset:20480
    ds_read_b64_tr_b16 a[102:103], v10 offset:22528
    v_mfma_f32_16x16x32_bf16 v[196:199], a[112:115], a[40:43], v[196:199]
    v_mfma_f32_16x16x32_bf16 v[212:215], a[112:115], a[48:51], v[212:215]
    v_mfma_f32_16x16x32_bf16 v[212:215], a[116:119], a[52:55], v[212:215]
    v_mfma_f32_16x16x32_bf16 v[228:231], a[116:119], a[60:63], v[228:231]
    v_mfma_f32_16x16x32_bf16 v[228:231], a[112:115], a[56:59], v[228:231]
    s_waitcnt lgkmcnt(6)
    v_mfma_f32_16x16x32_bf16 v[36:39], a[120:123], a[32:35], v[36:39]
    s_add_u32 m0, s60, 34816
    ds_read_b64_tr_b16 a[104:105], v11 offset:16384
    ds_read_b64_tr_b16 a[106:107], v11 offset:18432
    v_mfma_f32_16x16x32_bf16 v[36:39], a[124:127], a[36:39], v[36:39]
    s_add_u32 s79, s67, 128
    buffer_load_dwordx4 v4, s[24:27], s79 offen lds
    v_mfma_f32_16x16x32_bf16 v[52:55], a[124:127], a[44:47], v[52:55]
    ds_read_b64_tr_b16 a[108:109], v11 offset:20480
    ds_read_b64_tr_b16 a[110:111], v11 offset:22528
    v_mfma_f32_16x16x32_bf16 v[52:55], a[120:123], a[40:43], v[52:55]
    v_mfma_f32_16x16x32_bf16 v[68:71], a[120:123], a[48:51], v[68:71]
    v_mfma_f32_16x16x32_bf16 v[68:71], a[124:127], a[52:55], v[68:71]
    v_mfma_f32_16x16x32_bf16 v[84:87], a[124:127], a[60:63], v[84:87]
    v_mfma_f32_16x16x32_bf16 v[84:87], a[120:123], a[56:59], v[84:87]
    s_waitcnt lgkmcnt(4)
    v_mfma_f32_16x16x32_bf16 v[184:187], a[32:35], a[96:99], v[184:187]
    ds_read_b64_tr_b16 a[112:113], v12 offset:16384
    ds_read_b64_tr_b16 a[114:115], v12 offset:18432
    v_mfma_f32_16x16x32_bf16 v[184:187], a[36:39], a[100:103], v[184:187]
    v_mfma_f32_16x16x32_bf16 v[200:203], a[44:47], a[100:103], v[200:203]
    s_add_u32 m0, s60, 35840
    ds_read_b64_tr_b16 a[116:117], v12 offset:20480
    ds_read_b64_tr_b16 a[118:119], v12 offset:22528
    v_mfma_f32_16x16x32_bf16 v[200:203], a[40:43], a[96:99], v[200:203]
    s_add_u32 s76, s67, 128
    buffer_load_dwordx4 v5, s[24:27], s76 offen lds
    v_mfma_f32_16x16x32_bf16 v[216:219], a[48:51], a[96:99], v[216:219]
    v_mfma_f32_16x16x32_bf16 v[216:219], a[52:55], a[100:103], v[216:219]
    v_mfma_f32_16x16x32_bf16 v[232:235], a[60:63], a[100:103], v[232:235]
    v_mfma_f32_16x16x32_bf16 v[232:235], a[56:59], a[96:99], v[232:235]
    s_waitcnt lgkmcnt(4)
    v_mfma_f32_16x16x32_bf16 v[40:43], a[32:35], a[104:107], v[40:43]
    ds_read_b64_tr_b16 a[120:121], v13 offset:16384
    ds_read_b64_tr_b16 a[122:123], v13 offset:18432
    v_mfma_f32_16x16x32_bf16 v[40:43], a[36:39], a[108:111], v[40:43]
    v_mfma_f32_16x16x32_bf16 v[56:59], a[44:47], a[108:111], v[56:59]
    s_add_u32 m0, s60, 36864
    ds_read_b64_tr_b16 a[124:125], v13 offset:20480
    ds_read_b64_tr_b16 a[126:127], v13 offset:22528
    v_mfma_f32_16x16x32_bf16 v[56:59], a[40:43], a[104:107], v[56:59]
    s_add_u32 s77, s68, 128
    buffer_load_dwordx4 v4, s[24:27], s77 offen lds
    v_mfma_f32_16x16x32_bf16 v[72:75], a[48:51], a[104:107], v[72:75]
    v_mfma_f32_16x16x32_bf16 v[72:75], a[52:55], a[108:111], v[72:75]
    v_mfma_f32_16x16x32_bf16 v[88:91], a[60:63], a[108:111], v[88:91]
    v_mfma_f32_16x16x32_bf16 v[88:91], a[56:59], a[104:107], v[88:91]
    s_waitcnt lgkmcnt(4)
    v_mfma_f32_16x16x32_bf16 v[188:191], a[32:35], a[112:115], v[188:191]
    ds_read_b64_tr_b16 a[96:97], v10 offset:24576
    ds_read_b64_tr_b16 a[98:99], v10 offset:26624
    v_mfma_f32_16x16x32_bf16 v[188:191], a[36:39], a[116:119], v[188:191]
    v_mfma_f32_16x16x32_bf16 v[204:207], a[44:47], a[116:119], v[204:207]
    ds_read_b64_tr_b16 a[100:101], v10 offset:28672
    ds_read_b64_tr_b16 a[102:103], v10 offset:30720
    v_mfma_f32_16x16x32_bf16 v[204:207], a[40:43], a[112:115], v[204:207]
    s_add_u32 m0, s60, 37888
    v_mfma_f32_16x16x32_bf16 v[220:223], a[48:51], a[112:115], v[220:223]
    s_add_u32 s78, s68, 128
    buffer_load_dwordx4 v5, s[24:27], s78 offen lds
    v_mfma_f32_16x16x32_bf16 v[220:223], a[52:55], a[116:119], v[220:223]
    v_mfma_f32_16x16x32_bf16 v[236:239], a[60:63], a[116:119], v[236:239]
    v_mfma_f32_16x16x32_bf16 v[236:239], a[56:59], a[112:115], v[236:239]
    s_waitcnt lgkmcnt(4)
    v_mfma_f32_16x16x32_bf16 v[44:47], a[32:35], a[120:123], v[44:47]
    ds_read_b64_tr_b16 a[104:105], v11 offset:24576
    ds_read_b64_tr_b16 a[106:107], v11 offset:26624
    v_mfma_f32_16x16x32_bf16 v[44:47], a[36:39], a[124:127], v[44:47]
    v_mfma_f32_16x16x32_bf16 v[60:63], a[44:47], a[124:127], v[60:63]
    ds_read_b64_tr_b16 a[108:109], v11 offset:28672
    ds_read_b64_tr_b16 a[110:111], v11 offset:30720
    v_mfma_f32_16x16x32_bf16 v[60:63], a[40:43], a[120:123], v[60:63]
    v_mfma_f32_16x16x32_bf16 v[76:79], a[48:51], a[120:123], v[76:79]
    s_add_u32 m0, s60, 38912
    v_mfma_f32_16x16x32_bf16 v[76:79], a[52:55], a[124:127], v[76:79]
    s_add_u32 s79, s69, 128
    buffer_load_dwordx4 v4, s[24:27], s79 offen lds
    v_mfma_f32_16x16x32_bf16 v[92:95], a[60:63], a[124:127], v[92:95]
    v_mfma_f32_16x16x32_bf16 v[92:95], a[56:59], a[120:123], v[92:95]
    s_waitcnt lgkmcnt(4)
    v_mfma_f32_16x16x32_bf16 v[160:163], a[32:35], a[96:99], v[160:163]
    ds_read_b64_tr_b16 a[112:113], v12 offset:24576
    ds_read_b64_tr_b16 a[114:115], v12 offset:26624
    v_mfma_f32_16x16x32_bf16 v[160:163], a[36:39], a[100:103], v[160:163]
    v_mfma_f32_16x16x32_bf16 v[164:167], a[44:47], a[100:103], v[164:167]
    ds_read_b64_tr_b16 a[116:117], v12 offset:28672
    ds_read_b64_tr_b16 a[118:119], v12 offset:30720
    v_mfma_f32_16x16x32_bf16 v[164:167], a[40:43], a[96:99], v[164:167]
    v_mfma_f32_16x16x32_bf16 v[168:171], a[48:51], a[96:99], v[168:171]
    v_mfma_f32_16x16x32_bf16 v[168:171], a[52:55], a[100:103], v[168:171]
    s_add_u32 m0, s60, 39936
    v_mfma_f32_16x16x32_bf16 v[172:175], a[60:63], a[100:103], v[172:175]
    s_add_u32 s76, s69, 128
    buffer_load_dwordx4 v5, s[24:27], s76 offen lds
    v_mfma_f32_16x16x32_bf16 v[172:175], a[56:59], a[96:99], v[172:175]
    s_waitcnt lgkmcnt(4)
    v_mfma_f32_16x16x32_bf16 v[240:243], a[32:35], a[104:107], v[240:243]
    ds_read_b64_tr_b16 a[120:121], v13 offset:24576
    ds_read_b64_tr_b16 a[122:123], v13 offset:26624
    v_mfma_f32_16x16x32_bf16 v[240:243], a[36:39], a[108:111], v[240:243]
    v_mfma_f32_16x16x32_bf16 v[244:247], a[44:47], a[108:111], v[244:247]
    ds_read_b64_tr_b16 a[124:125], v13 offset:28672
    ds_read_b64_tr_b16 a[126:127], v13 offset:30720
    v_mfma_f32_16x16x32_bf16 v[244:247], a[40:43], a[104:107], v[244:247]
    v_mfma_f32_16x16x32_bf16 v[248:251], a[48:51], a[104:107], v[248:251]
    v_add_u32 v10, 32768, v10
    v_add_u32 v11, 32768, v11
    v_mfma_f32_16x16x32_bf16 v[248:251], a[52:55], a[108:111], v[248:251]
    v_mfma_f32_16x16x32_bf16 v[252:255], a[60:63], a[108:111], v[252:255]
    v_add_u32 v12, 32768, v12
    v_add_u32 v13, 32768, v13
    v_mfma_f32_16x16x32_bf16 v[252:255], a[56:59], a[104:107], v[252:255]
    s_waitcnt vmcnt(24) lgkmcnt(0)
    s_barrier
    v_mfma_f32_16x16x32_bf16 a[0:3], a[32:35], a[112:115], a[0:3]
    s_add_u32 m0, s61, 0
    ds_read_b64_tr_b16 a[96:97], v10 offset:0
    ds_read_b64_tr_b16 a[98:99], v10 offset:2048
    v_mfma_f32_16x16x32_bf16 a[0:3], a[36:39], a[116:119], a[0:3]
    s_add_u32 s71, s71, s73
    buffer_load_dwordx4 v7, s[32:35], s71 offen lds
    v_mfma_f32_16x16x32_bf16 a[4:7], a[44:47], a[116:119], a[4:7]
    ds_read_b64_tr_b16 a[100:101], v10 offset:4096
    ds_read_b64_tr_b16 a[102:103], v10 offset:6144
    v_mfma_f32_16x16x32_bf16 a[4:7], a[40:43], a[112:115], a[4:7]
    v_mfma_f32_16x16x32_bf16 a[8:11], a[48:51], a[112:115], a[8:11]
    v_mfma_f32_16x16x32_bf16 a[8:11], a[52:55], a[116:119], a[8:11]
    v_mfma_f32_16x16x32_bf16 a[12:15], a[60:63], a[116:119], a[12:15]
    v_mfma_f32_16x16x32_bf16 a[12:15], a[56:59], a[112:115], a[12:15]
    s_waitcnt lgkmcnt(4)
    v_mfma_f32_16x16x32_bf16 a[16:19], a[32:35], a[120:123], a[16:19]
    s_add_u32 m0, s61, 8192
    ds_read_b64_tr_b16 a[104:105], v11 offset:0
    ds_read_b64_tr_b16 a[106:107], v11 offset:2048
    v_mfma_f32_16x16x32_bf16 a[16:19], a[36:39], a[124:127], a[16:19]
    s_add_u32 s77, s70, 524288
    buffer_load_dwordx4 v6, s[28:31], s77 offen lds
    v_mfma_f32_16x16x32_bf16 a[20:23], a[44:47], a[124:127], a[20:23]
    ds_read_b64_tr_b16 a[108:109], v11 offset:4096
    ds_read_b64_tr_b16 a[110:111], v11 offset:6144
    v_mfma_f32_16x16x32_bf16 a[20:23], a[40:43], a[120:123], a[20:23]
    v_mfma_f32_16x16x32_bf16 a[24:27], a[48:51], a[120:123], a[24:27]
    v_mfma_f32_16x16x32_bf16 a[24:27], a[52:55], a[124:127], a[24:27]
    v_mfma_f32_16x16x32_bf16 a[28:31], a[60:63], a[124:127], a[28:31]
    v_mfma_f32_16x16x32_bf16 a[28:31], a[56:59], a[120:123], a[28:31]
    s_waitcnt lgkmcnt(4)
    v_mfma_f32_16x16x32_bf16 v[96:99], a[96:99], a[64:67], v[96:99]
    ds_read_b64_tr_b16 a[112:113], v12 offset:0
    ds_read_b64_tr_b16 a[114:115], v12 offset:2048
    v_mfma_f32_16x16x32_bf16 v[96:99], a[100:103], a[68:71], v[96:99]
    v_mfma_f32_16x16x32_bf16 v[100:103], a[100:103], a[76:79], v[100:103]
    s_add_u32 m0, s61, 16384
    ds_read_b64_tr_b16 a[116:117], v12 offset:4096
    ds_read_b64_tr_b16 a[118:119], v12 offset:6144
    v_mfma_f32_16x16x32_bf16 v[100:103], a[96:99], a[72:75], v[100:103]
    s_add_u32 s79, s70, 524416
    buffer_load_dwordx4 v6, s[28:31], s79 offen lds
    v_mfma_f32_16x16x32_bf16 v[104:107], a[96:99], a[80:83], v[104:107]
    v_mfma_f32_16x16x32_bf16 v[104:107], a[100:103], a[84:87], v[104:107]
    v_mfma_f32_16x16x32_bf16 v[108:111], a[100:103], a[92:95], v[108:111]
    v_mfma_f32_16x16x32_bf16 v[108:111], a[96:99], a[88:91], v[108:111]
    s_waitcnt lgkmcnt(4)
    v_mfma_f32_16x16x32_bf16 v[112:115], a[104:107], a[64:67], v[112:115]
    ds_read_b64_tr_b16 a[120:121], v13 offset:0
    ds_read_b64_tr_b16 a[122:123], v13 offset:2048
    v_mfma_f32_16x16x32_bf16 v[112:115], a[108:111], a[68:71], v[112:115]
    v_mfma_f32_16x16x32_bf16 v[116:119], a[108:111], a[76:79], v[116:119]
    s_add_u32 m0, s61, 2048
    ds_read_b64_tr_b16 a[124:125], v13 offset:4096
    ds_read_b64_tr_b16 a[126:127], v13 offset:6144
    v_mfma_f32_16x16x32_bf16 v[116:119], a[104:107], a[72:75], v[116:119]
    s_add_u32 s71, s71, s72
    buffer_load_dwordx4 v7, s[32:35], s71 offen lds
    v_mfma_f32_16x16x32_bf16 v[120:123], a[104:107], a[80:83], v[120:123]
    v_mfma_f32_16x16x32_bf16 v[120:123], a[108:111], a[84:87], v[120:123]
    v_mfma_f32_16x16x32_bf16 v[124:127], a[108:111], a[92:95], v[124:127]
    v_mfma_f32_16x16x32_bf16 v[124:127], a[104:107], a[88:91], v[124:127]
    s_waitcnt lgkmcnt(4)
    v_mfma_f32_16x16x32_bf16 v[128:131], a[112:115], a[64:67], v[128:131]
    ds_read_b64_tr_b16 a[96:97], v10 offset:8192
    ds_read_b64_tr_b16 a[98:99], v10 offset:10240
    v_mfma_f32_16x16x32_bf16 v[128:131], a[116:119], a[68:71], v[128:131]
    v_cvt_pk_bf16_f32 v96, v96, v97
    v_cvt_pk_bf16_f32 v97, v98, v99
    v_mfma_f32_16x16x32_bf16 v[132:135], a[116:119], a[76:79], v[132:135]
    ds_read_b64_tr_b16 a[100:101], v10 offset:12288
    ds_read_b64_tr_b16 a[102:103], v10 offset:14336
    v_mfma_f32_16x16x32_bf16 v[132:135], a[112:115], a[72:75], v[132:135]
    v_cvt_pk_bf16_f32 v98, v112, v113
    v_cvt_pk_bf16_f32 v99, v114, v115
    v_mfma_f32_16x16x32_bf16 v[136:139], a[112:115], a[80:83], v[136:139]
    s_waitcnt vmcnt(19)
    ds_read_b128 a[32:35], v8 offset:0
    ds_read_b128 a[36:39], v9 offset:0
    v_mfma_f32_16x16x32_bf16 v[136:139], a[116:119], a[84:87], v[136:139]
    s_add_u32 m0, s61, 10240
    v_cvt_pk_bf16_f32 v100, v100, v101
    v_cvt_pk_bf16_f32 v101, v102, v103
    v_mfma_f32_16x16x32_bf16 v[140:143], a[116:119], a[92:95], v[140:143]
    s_add_u32 s78, s70, 557056
    buffer_load_dwordx4 v6, s[28:31], s78 offen lds
    v_mfma_f32_16x16x32_bf16 v[140:143], a[112:115], a[88:91], v[140:143]
    s_waitcnt lgkmcnt(6)
    v_cvt_pk_bf16_f32 v102, v116, v117
    v_cvt_pk_bf16_f32 v103, v118, v119
    v_mfma_f32_16x16x32_bf16 v[144:147], a[120:123], a[64:67], v[144:147]
    ds_read_b64_tr_b16 a[104:105], v11 offset:8192
    ds_read_b64_tr_b16 a[106:107], v11 offset:10240
    v_mfma_f32_16x16x32_bf16 v[144:147], a[124:127], a[68:71], v[144:147]
    v_cvt_pk_bf16_f32 v104, v104, v105
    v_cvt_pk_bf16_f32 v105, v106, v107
    v_mfma_f32_16x16x32_bf16 v[148:151], a[124:127], a[76:79], v[148:151]
    ds_read_b64_tr_b16 a[108:109], v11 offset:12288
    ds_read_b64_tr_b16 a[110:111], v11 offset:14336
    v_mfma_f32_16x16x32_bf16 v[148:151], a[120:123], a[72:75], v[148:151]
    s_add_u32 s75, s98, 0
    buffer_store_dwordx4 v[96:99], v1, s[8:11], s75 offen sc1
    v_mfma_f32_16x16x32_bf16 v[152:155], a[120:123], a[80:83], v[152:155]
    s_add_u32 m0, s61, 18432
    ds_read_b128 a[40:43], v8 offset:2048
    ds_read_b128 a[44:47], v9 offset:2048
    v_mfma_f32_16x16x32_bf16 v[152:155], a[124:127], a[84:87], v[152:155]
    s_add_u32 s76, s70, 557184
    buffer_load_dwordx4 v6, s[28:31], s76 offen lds
    v_mfma_f32_16x16x32_bf16 v[156:159], a[124:127], a[92:95], v[156:159]
    v_cvt_pk_bf16_f32 v106, v120, v121
    v_cvt_pk_bf16_f32 v107, v122, v123
    v_mfma_f32_16x16x32_bf16 v[156:159], a[120:123], a[88:91], v[156:159]
    s_waitcnt lgkmcnt(8)
    v_cvt_pk_bf16_f32 v108, v108, v109
    v_cvt_pk_bf16_f32 v109, v110, v111
    v_mfma_f32_16x16x32_bf16 v[176:179], a[96:99], a[64:67], v[176:179]
    ds_read_b64_tr_b16 a[112:113], v12 offset:8192
    ds_read_b64_tr_b16 a[114:115], v12 offset:10240
    v_mfma_f32_16x16x32_bf16 v[176:179], a[100:103], a[68:71], v[176:179]
    v_cvt_pk_bf16_f32 v110, v124, v125
    v_cvt_pk_bf16_f32 v111, v126, v127
    v_mfma_f32_16x16x32_bf16 v[192:195], a[100:103], a[76:79], v[192:195]
    ds_read_b64_tr_b16 a[116:117], v12 offset:12288
    ds_read_b64_tr_b16 a[118:119], v12 offset:14336
    v_mfma_f32_16x16x32_bf16 v[192:195], a[96:99], a[72:75], v[192:195]
    v_cvt_pk_bf16_f32 v128, v128, v129
    v_cvt_pk_bf16_f32 v129, v130, v131
    v_mfma_f32_16x16x32_bf16 v[208:211], a[96:99], a[80:83], v[208:211]
    ds_read_b128 a[48:51], v8 offset:4096
    ds_read_b128 a[52:55], v9 offset:4096
    v_mfma_f32_16x16x32_bf16 v[208:211], a[100:103], a[84:87], v[208:211]
pad3:
    s_cbranch_execz pad7
    v_cvt_pk_bf16_f32 v130, v144, v145
    v_cvt_pk_bf16_f32 v131, v146, v147
    v_mfma_f32_16x16x32_bf16 v[224:227], a[100:103], a[92:95], v[224:227]
    v_accvgpr_write_b32 a128, v128
    v_accvgpr_write_b32 a129, v129
    v_mfma_f32_16x16x32_bf16 v[224:227], a[96:99], a[88:91], v[224:227]
    s_waitcnt lgkmcnt(8)
    v_accvgpr_write_b32 a130, v130
    v_accvgpr_write_b32 a131, v131
    v_mfma_f32_16x16x32_bf16 v[32:35], a[104:107], a[64:67], v[32:35]
    s_add_u32 m0, s60, 0
    ds_read_b64_tr_b16 a[120:121], v13 offset:8192
    ds_read_b64_tr_b16 a[122:123], v13 offset:10240
    v_mfma_f32_16x16x32_bf16 v[32:35], a[108:111], a[68:71], v[32:35]
    s_add_u32 s77, s66, 256
    buffer_load_dwordx4 v4, s[24:27], s77 offen lds
    v_mfma_f32_16x16x32_bf16 v[48:51], a[108:111], a[76:79], v[48:51]
    ds_read_b64_tr_b16 a[124:125], v13 offset:12288
    ds_read_b64_tr_b16 a[126:127], v13 offset:14336
    v_mfma_f32_16x16x32_bf16 v[48:51], a[104:107], a[72:75], v[48:51]
    v_cvt_pk_bf16_f32 v132, v132, v133
    v_cvt_pk_bf16_f32 v133, v134, v135
    v_mfma_f32_16x16x32_bf16 v[64:67], a[104:107], a[80:83], v[64:67]
    ds_read_b128 a[56:59], v8 offset:6144
    ds_read_b128 a[60:63], v9 offset:6144
    v_mfma_f32_16x16x32_bf16 v[64:67], a[108:111], a[84:87], v[64:67]
    v_cvt_pk_bf16_f32 v134, v148, v149
    v_cvt_pk_bf16_f32 v135, v150, v151
    v_mfma_f32_16x16x32_bf16 v[80:83], a[108:111], a[92:95], v[80:83]
    v_accvgpr_write_b32 a132, v132
    v_accvgpr_write_b32 a133, v133
    v_mfma_f32_16x16x32_bf16 v[80:83], a[104:107], a[88:91], v[80:83]
    s_waitcnt lgkmcnt(8)
    v_accvgpr_write_b32 a134, v134
    v_accvgpr_write_b32 a135, v135
    v_mfma_f32_16x16x32_bf16 v[180:183], a[112:115], a[64:67], v[180:183]
    s_add_u32 m0, s60, 1024
    ds_read_b64_tr_b16 a[96:97], v10 offset:16384
    ds_read_b64_tr_b16 a[98:99], v10 offset:18432
    v_mfma_f32_16x16x32_bf16 v[180:183], a[116:119], a[68:71], v[180:183]
    s_add_u32 s78, s66, 256
    buffer_load_dwordx4 v5, s[24:27], s78 offen lds
    v_mfma_f32_16x16x32_bf16 v[196:199], a[116:119], a[76:79], v[196:199]
    ds_read_b64_tr_b16 a[100:101], v10 offset:20480
    ds_read_b64_tr_b16 a[102:103], v10 offset:22528
    v_mfma_f32_16x16x32_bf16 v[196:199], a[112:115], a[72:75], v[196:199]
    s_add_u32 s75, s98, 4096
    buffer_store_dwordx4 v[100:103], v1, s[8:11], s75 offen sc1
    v_mfma_f32_16x16x32_bf16 v[212:215], a[112:115], a[80:83], v[212:215]
    v_cvt_pk_bf16_f32 v136, v136, v137
    v_cvt_pk_bf16_f32 v137, v138, v139
    v_mfma_f32_16x16x32_bf16 v[212:215], a[116:119], a[84:87], v[212:215]
    v_cvt_pk_bf16_f32 v138, v152, v153
    v_cvt_pk_bf16_f32 v139, v154, v155
    v_mfma_f32_16x16x32_bf16 v[228:231], a[116:119], a[92:95], v[228:231]
    v_accvgpr_write_b32 a136, v136
    v_accvgpr_write_b32 a137, v137
    v_mfma_f32_16x16x32_bf16 v[228:231], a[112:115], a[88:91], v[228:231]
    s_waitcnt lgkmcnt(6)
    v_accvgpr_write_b32 a138, v138
    v_accvgpr_write_b32 a139, v139
    v_mfma_f32_16x16x32_bf16 v[36:39], a[120:123], a[64:67], v[36:39]
    s_add_u32 m0, s60, 2048
    ds_read_b64_tr_b16 a[104:105], v11 offset:16384
    ds_read_b64_tr_b16 a[106:107], v11 offset:18432
    v_mfma_f32_16x16x32_bf16 v[36:39], a[124:127], a[68:71], v[36:39]
    s_add_u32 s79, s67, 256
    buffer_load_dwordx4 v4, s[24:27], s79 offen lds
    v_mfma_f32_16x16x32_bf16 v[52:55], a[124:127], a[76:79], v[52:55]
    ds_read_b64_tr_b16 a[108:109], v11 offset:20480
    ds_read_b64_tr_b16 a[110:111], v11 offset:22528
    v_mfma_f32_16x16x32_bf16 v[52:55], a[120:123], a[72:75], v[52:55]
    v_cvt_pk_bf16_f32 v140, v140, v141
    v_cvt_pk_bf16_f32 v141, v142, v143
    v_mfma_f32_16x16x32_bf16 v[68:71], a[120:123], a[80:83], v[68:71]
    v_cvt_pk_bf16_f32 v142, v156, v157
    v_cvt_pk_bf16_f32 v143, v158, v159
    v_mfma_f32_16x16x32_bf16 v[68:71], a[124:127], a[84:87], v[68:71]
    v_accvgpr_write_b32 a140, v140
    v_accvgpr_write_b32 a141, v141
    v_mfma_f32_16x16x32_bf16 v[84:87], a[124:127], a[92:95], v[84:87]
    v_accvgpr_write_b32 a142, v142
    v_accvgpr_write_b32 a143, v143
    v_mfma_f32_16x16x32_bf16 v[84:87], a[120:123], a[88:91], v[84:87]
    s_waitcnt lgkmcnt(4)
    v_cvt_pk_bf16_f32 v176, v176, v177
    v_cvt_pk_bf16_f32 v177, v178, v179
    v_mfma_f32_16x16x32_bf16 v[184:187], a[64:67], a[96:99], v[184:187]
    ds_read_b64_tr_b16 a[112:113], v12 offset:16384
    ds_read_b64_tr_b16 a[114:115], v12 offset:18432
    v_mfma_f32_16x16x32_bf16 v[184:187], a[68:71], a[100:103], v[184:187]
    v_cvt_pk_bf16_f32 v178, v32, v33
    v_cvt_pk_bf16_f32 v179, v34, v35
    v_mfma_f32_16x16x32_bf16 v[200:203], a[76:79], a[100:103], v[200:203]
    s_add_u32 m0, s60, 3072
    ds_read_b64_tr_b16 a[116:117], v12 offset:20480
    ds_read_b64_tr_b16 a[118:119], v12 offset:22528
    v_mfma_f32_16x16x32_bf16 v[200:203], a[72:75], a[96:99], v[200:203]
    s_add_u32 s76, s67, 256
    buffer_load_dwordx4 v5, s[24:27], s76 offen lds
    v_mfma_f32_16x16x32_bf16 v[216:219], a[80:83], a[96:99], v[216:219]
    v_accvgpr_write_b32 a144, v176
    v_accvgpr_write_b32 a145, v177
    v_mfma_f32_16x16x32_bf16 v[216:219], a[84:87], a[100:103], v[216:219]
    v_accvgpr_write_b32 a146, v178
    v_accvgpr_write_b32 a147, v179
    v_mfma_f32_16x16x32_bf16 v[232:235], a[92:95], a[100:103], v[232:235]
    s_add_u32 s75, s98, 8192
    buffer_store_dwordx4 v[104:107], v1, s[8:11], s75 offen sc1
    v_mfma_f32_16x16x32_bf16 v[232:235], a[88:91], a[96:99], v[232:235]
    s_waitcnt lgkmcnt(4)
    v_cvt_pk_bf16_f32 v192, v192, v193
    v_cvt_pk_bf16_f32 v193, v194, v195
    v_mfma_f32_16x16x32_bf16 v[40:43], a[64:67], a[104:107], v[40:43]
    ds_read_b64_tr_b16 a[120:121], v13 offset:16384
    ds_read_b64_tr_b16 a[122:123], v13 offset:18432
    v_mfma_f32_16x16x32_bf16 v[40:43], a[68:71], a[108:111], v[40:43]
    v_cvt_pk_bf16_f32 v194, v48, v49
    v_cvt_pk_bf16_f32 v195, v50, v51
    v_mfma_f32_16x16x32_bf16 v[56:59], a[76:79], a[108:111], v[56:59]
    s_add_u32 m0, s60, 4096
    ds_read_b64_tr_b16 a[124:125], v13 offset:20480
    ds_read_b64_tr_b16 a[126:127], v13 offset:22528
    v_mfma_f32_16x16x32_bf16 v[56:59], a[72:75], a[104:107], v[56:59]
    s_add_u32 s77, s68, 256
    buffer_load_dwordx4 v4, s[24:27], s77 offen lds
    v_mfma_f32_16x16x32_bf16 v[72:75], a[80:83], a[104:107], v[72:75]
    v_accvgpr_write_b32 a148, v192
    v_accvgpr_write_b32 a149, v193
    v_mfma_f32_16x16x32_bf16 v[72:75], a[84:87], a[108:111], v[72:75]
    v_accvgpr_write_b32 a150, v194
    v_accvgpr_write_b32 a151, v195
    v_mfma_f32_16x16x32_bf16 v[88:91], a[92:95], a[108:111], v[88:91]
    v_cvt_pk_bf16_f32 v208, v208, v209
    v_cvt_pk_bf16_f32 v209, v210, v211
    v_mfma_f32_16x16x32_bf16 v[88:91], a[88:91], a[104:107], v[88:91]
    s_waitcnt lgkmcnt(4)
    v_cvt_pk_bf16_f32 v210, v64, v65
    v_cvt_pk_bf16_f32 v211, v66, v67
    v_mfma_f32_16x16x32_bf16 v[188:191], a[64:67], a[112:115], v[188:191]
    ds_read_b64_tr_b16 a[96:97], v10 offset:24576
    ds_read_b64_tr_b16 a[98:99], v10 offset:26624
    v_mfma_f32_16x16x32_bf16 v[188:191], a[68:71], a[116:119], v[188:191]
    v_accvgpr_write_b32 a152, v208
    v_accvgpr_write_b32 a153, v209
    v_mfma_f32_16x16x32_bf16 v[204:207], a[76:79], a[116:119], v[204:207]
    ds_read_b64_tr_b16 a[100:101], v10 offset:28672
    ds_read_b64_tr_b16 a[102:103], v10 offset:30720
    v_mfma_f32_16x16x32_bf16 v[204:207], a[72:75], a[112:115], v[204:207]
    s_add_u32 m0, s60, 5120
    v_accvgpr_write_b32 a154, v210
    v_accvgpr_write_b32 a155, v211
    v_mfma_f32_16x16x32_bf16 v[220:223], a[80:83], a[112:115], v[220:223]
    s_add_u32 s78, s68, 256
    buffer_load_dwordx4 v5, s[24:27], s78 offen lds
    v_mfma_f32_16x16x32_bf16 v[220:223], a[84:87], a[116:119], v[220:223]
    v_cvt_pk_bf16_f32 v224, v224, v225
    v_cvt_pk_bf16_f32 v225, v226, v227
    v_mfma_f32_16x16x32_bf16 v[236:239], a[92:95], a[116:119], v[236:239]
    v_cvt_pk_bf16_f32 v226, v80, v81
    v_cvt_pk_bf16_f32 v227, v82, v83
    v_mfma_f32_16x16x32_bf16 v[236:239], a[88:91], a[112:115], v[236:239]
    s_waitcnt lgkmcnt(4)
    v_accvgpr_write_b32 a156, v224
    v_accvgpr_write_b32 a157, v225
    v_mfma_f32_16x16x32_bf16 v[44:47], a[64:67], a[120:123], v[44:47]
    ds_read_b64_tr_b16 a[104:105], v11 offset:24576
    ds_read_b64_tr_b16 a[106:107], v11 offset:26624
    v_mfma_f32_16x16x32_bf16 v[44:47], a[68:71], a[124:127], v[44:47]
    v_accvgpr_write_b32 a158, v226
    v_accvgpr_write_b32 a159, v227
    v_mfma_f32_16x16x32_bf16 v[60:63], a[76:79], a[124:127], v[60:63]
    ds_read_b64_tr_b16 a[108:109], v11 offset:28672
    ds_read_b64_tr_b16 a[110:111], v11 offset:30720
    v_mfma_f32_16x16x32_bf16 v[60:63], a[72:75], a[120:123], v[60:63]
    v_cvt_pk_bf16_f32 v180, v180, v181
    v_cvt_pk_bf16_f32 v181, v182, v183
    v_mfma_f32_16x16x32_bf16 v[76:79], a[80:83], a[120:123], v[76:79]
    s_add_u32 m0, s60, 6144
    v_cvt_pk_bf16_f32 v182, v36, v37
    v_cvt_pk_bf16_f32 v183, v38, v39
    v_mfma_f32_16x16x32_bf16 v[76:79], a[84:87], a[124:127], v[76:79]
    s_add_u32 s79, s69, 256
    buffer_load_dwordx4 v4, s[24:27], s79 offen lds
    v_mfma_f32_16x16x32_bf16 v[92:95], a[92:95], a[124:127], v[92:95]
    s_add_u32 s75, s98, 12288
    buffer_store_dwordx4 v[108:111], v1, s[8:11], s75 offen sc1
    v_mfma_f32_16x16x32_bf16 v[92:95], a[88:91], a[120:123], v[92:95]
    s_waitcnt lgkmcnt(4)
    v_accvgpr_write_b32 a160, v180
    v_accvgpr_write_b32 a161, v181
    v_mfma_f32_16x16x32_bf16 v[160:163], a[64:67], a[96:99], v[160:163]
    ds_read_b64_tr_b16 a[112:113], v12 offset:24576
    ds_read_b64_tr_b16 a[114:115], v12 offset:26624
    v_mfma_f32_16x16x32_bf16 v[160:163], a[68:71], a[100:103], v[160:163]
    v_accvgpr_write_b32 a162, v182
    v_accvgpr_write_b32 a163, v183
    v_mfma_f32_16x16x32_bf16 v[164:167], a[76:79], a[100:103], v[164:167]
    ds_read_b64_tr_b16 a[116:117], v12 offset:28672
    ds_read_b64_tr_b16 a[118:119], v12 offset:30720
    v_mfma_f32_16x16x32_bf16 v[164:167], a[72:75], a[96:99], v[164:167]
    v_cvt_pk_bf16_f32 v196, v196, v197
    v_cvt_pk_bf16_f32 v197, v198, v199
    v_mfma_f32_16x16x32_bf16 v[168:171], a[80:83], a[96:99], v[168:171]
    v_cvt_pk_bf16_f32 v198, v52, v53
    v_cvt_pk_bf16_f32 v199, v54, v55
    v_mfma_f32_16x16x32_bf16 v[168:171], a[84:87], a[100:103], v[168:171]
    s_add_u32 m0, s60, 7168
    v_accvgpr_write_b32 a164, v196
    v_accvgpr_write_b32 a165, v197
    v_mfma_f32_16x16x32_bf16 v[172:175], a[92:95], a[100:103], v[172:175]
    s_add_u32 s76, s69, 256
    buffer_load_dwordx4 v5, s[24:27], s76 offen lds
    v_mfma_f32_16x16x32_bf16 v[172:175], a[88:91], a[96:99], v[172:175]
    s_waitcnt lgkmcnt(4)
    v_accvgpr_write_b32 a166, v198
    v_accvgpr_write_b32 a167, v199
    v_mfma_f32_16x16x32_bf16 v[240:243], a[64:67], a[104:107], v[240:243]
    ds_read_b64_tr_b16 a[120:121], v13 offset:24576
    ds_read_b64_tr_b16 a[122:123], v13 offset:26624
    v_mfma_f32_16x16x32_bf16 v[240:243], a[68:71], a[108:111], v[240:243]
    v_cvt_pk_bf16_f32 v212, v212, v213
    v_cvt_pk_bf16_f32 v213, v214, v215
    v_mfma_f32_16x16x32_bf16 v[244:247], a[76:79], a[108:111], v[244:247]
    ds_read_b64_tr_b16 a[124:125], v13 offset:28672
    ds_read_b64_tr_b16 a[126:127], v13 offset:30720
    v_mfma_f32_16x16x32_bf16 v[244:247], a[72:75], a[104:107], v[244:247]
    v_cvt_pk_bf16_f32 v214, v68, v69
    v_cvt_pk_bf16_f32 v215, v70, v71
    v_mfma_f32_16x16x32_bf16 v[248:251], a[80:83], a[104:107], v[248:251]
    v_add_u32 v10, 32768, v10
    v_add_u32 v11, 32768, v11
    v_mfma_f32_16x16x32_bf16 v[248:251], a[84:87], a[108:111], v[248:251]
    v_accvgpr_write_b32 a168, v212
    v_accvgpr_write_b32 a169, v213
    v_mfma_f32_16x16x32_bf16 v[252:255], a[92:95], a[108:111], v[252:255]
    v_add_u32 v12, 32768, v12
    v_add_u32 v13, 32768, v13
    v_mfma_f32_16x16x32_bf16 v[252:255], a[88:91], a[104:107], v[252:255]
    s_waitcnt vmcnt(26) lgkmcnt(0)
    s_barrier
    v_accvgpr_write_b32 a170, v214
    v_mfma_f32_16x16x32_bf16 a[0:3], a[64:67], a[112:115], a[0:3]
    s_add_u32 m0, s61, 32768
    ds_read_b64_tr_b16 a[96:97], v10 offset:0
    ds_read_b64_tr_b16 a[98:99], v10 offset:2048
    v_mfma_f32_16x16x32_bf16 a[0:3], a[68:71], a[116:119], a[0:3]
    s_add_u32 s71, s71, s73
    buffer_load_dwordx4 v7, s[32:35], s71 offen lds
    v_mfma_f32_16x16x32_bf16 a[4:7], a[76:79], a[116:119], a[4:7]
    ds_read_b64_tr_b16 a[100:101], v10 offset:4096
    ds_read_b64_tr_b16 a[102:103], v10 offset:6144
    v_mfma_f32_16x16x32_bf16 a[4:7], a[72:75], a[112:115], a[4:7]
    s_add_u32 s75, s98, 1024
    buffer_store_dwordx4 a[128:131], v1, s[8:11], s75 offen sc1
    v_mfma_f32_16x16x32_bf16 a[8:11], a[80:83], a[112:115], a[8:11]
    v_accvgpr_write_b32 a171, v215
    v_cvt_pk_bf16_f32 v228, v228, v229
    v_mfma_f32_16x16x32_bf16 a[8:11], a[84:87], a[116:119], a[8:11]
    s_add_u32 m0, s61, 40960
    v_cvt_pk_bf16_f32 v229, v230, v231
    v_cvt_pk_bf16_f32 v230, v84, v85
    v_mfma_f32_16x16x32_bf16 a[12:15], a[92:95], a[116:119], a[12:15]
    s_add_u32 s77, s70, 1048576
    buffer_load_dwordx4 v6, s[28:31], s77 offen lds
    v_mfma_f32_16x16x32_bf16 a[12:15], a[88:91], a[112:115], a[12:15]
    s_waitcnt lgkmcnt(4)
    v_cvt_pk_bf16_f32 v231, v86, v87
    v_accvgpr_write_b32 a172, v228
    v_mfma_f32_16x16x32_bf16 a[16:19], a[64:67], a[120:123], a[16:19]
    ds_read_b64_tr_b16 a[104:105], v11 offset:0
    ds_read_b64_tr_b16 a[106:107], v11 offset:2048
    v_mfma_f32_16x16x32_bf16 a[16:19], a[68:71], a[124:127], a[16:19]
    v_accvgpr_write_b32 a173, v229
    v_accvgpr_write_b32 a174, v230
    v_mfma_f32_16x16x32_bf16 a[20:23], a[76:79], a[124:127], a[20:23]
    ds_read_b64_tr_b16 a[108:109], v11 offset:4096
    ds_read_b64_tr_b16 a[110:111], v11 offset:6144
    v_mfma_f32_16x16x32_bf16 a[20:23], a[72:75], a[120:123], a[20:23]
    v_accvgpr_write_b32 a175, v231
    v_cvt_pk_bf16_f32 v184, v184, v185
    v_mfma_f32_16x16x32_bf16 a[24:27], a[80:83], a[120:123], a[24:27]
    s_add_u32 m0, s61, 49152
    v_cvt_pk_bf16_f32 v185, v186, v187
    v_cvt_pk_bf16_f32 v186, v200, v201
    v_mfma_f32_16x16x32_bf16 a[24:27], a[84:87], a[124:127], a[24:27]
    s_add_u32 s79, s70, 1048704
    buffer_load_dwordx4 v6, s[28:31], s79 offen lds
    v_mfma_f32_16x16x32_bf16 a[28:31], a[92:95], a[124:127], a[28:31]
    v_cvt_pk_bf16_f32 v187, v202, v203
    v_accvgpr_write_b32 a176, v184
    v_mfma_f32_16x16x32_bf16 a[28:31], a[88:91], a[120:123], a[28:31]
    s_waitcnt lgkmcnt(4)
    v_accvgpr_write_b32 a177, v185
    v_accvgpr_write_b32 a178, v186
    v_mfma_f32_16x16x32_bf16 v[96:99], a[96:99], a[32:35], 0
    ds_read_b64_tr_b16 a[112:113], v12 offset:0
    ds_read_b64_tr_b16 a[114:115], v12 offset:2048
    v_mfma_f32_16x16x32_bf16 v[96:99], a[100:103], a[36:39], v[96:99]
    v_accvgpr_write_b32 a179, v187
    v_cvt_pk_bf16_f32 v216, v216, v217
    v_mfma_f32_16x16x32_bf16 v[100:103], a[100:103], a[44:47], 0
    ds_read_b64_tr_b16 a[116:117], v12 offset:4096
    ds_read_b64_tr_b16 a[118:119], v12 offset:6144
    v_mfma_f32_16x16x32_bf16 v[100:103], a[96:99], a[40:43], v[100:103]
    v_cvt_pk_bf16_f32 v217, v218, v219
    v_cvt_pk_bf16_f32 v218, v232, v233
    v_mfma_f32_16x16x32_bf16 v[104:107], a[96:99], a[48:51], 0
    s_waitcnt vmcnt(22)
    ds_read_b128 a[64:67], v8 offset:32768
    ds_read_b128 a[68:71], v9 offset:32768
    v_mfma_f32_16x16x32_bf16 v[104:107], a[100:103], a[52:55], v[104:107]
    s_add_u32 m0, s61, 34816
    v_cvt_pk_bf16_f32 v219, v234, v235
    v_accvgpr_write_b32 a180, v216
    v_mfma_f32_16x16x32_bf16 v[108:111], a[100:103], a[60:63], 0
    s_add_u32 s71, s71, s72
    buffer_load_dwordx4 v7, s[32:35], s71 offen lds
    v_mfma_f32_16x16x32_bf16 v[108:111], a[96:99], a[56:59], v[108:111]
    s_waitcnt lgkmcnt(6)
    v_accvgpr_write_b32 a181, v217
    v_accvgpr_write_b32 a182, v218
    v_mfma_f32_16x16x32_bf16 v[112:115], a[104:107], a[32:35], 0
    ds_read_b64_tr_b16 a[120:121], v13 offset:0
    ds_read_b64_tr_b16 a[122:123], v13 offset:2048
    v_mfma_f32_16x16x32_bf16 v[112:115], a[108:111], a[36:39], v[112:115]
    s_add_u32 s75, s98, 5120
    buffer_store_dwordx4 a[132:135], v1, s[8:11], s75 offen sc1
    v_mfma_f32_16x16x32_bf16 v[116:119], a[108:111], a[44:47], 0
    s_add_u32 m0, s61, 43008
    ds_read_b64_tr_b16 a[124:125], v13 offset:4096
    ds_read_b64_tr_b16 a[126:127], v13 offset:6144
    v_mfma_f32_16x16x32_bf16 v[116:119], a[104:107], a[40:43], v[116:119]
    s_add_u32 s78, s70, 1081344
    buffer_load_dwordx4 v6, s[28:31], s78 offen lds
    v_mfma_f32_16x16x32_bf16 v[120:123], a[104:107], a[48:51], 0
    ds_read_b128 a[72:75], v8 offset:34816
    ds_read_b128 a[76:79], v9 offset:34816
    v_mfma_f32_16x16x32_bf16 v[120:123], a[108:111], a[52:55], v[120:123]
    v_accvgpr_write_b32 a183, v219
    v_cvt_pk_bf16_f32 v40, v40, v41
    v_mfma_f32_16x16x32_bf16 v[124:127], a[108:111], a[60:63], 0
    v_cvt_pk_bf16_f32 v41, v42, v43
    v_cvt_pk_bf16_f32 v42, v56, v57
    v_mfma_f32_16x16x32_bf16 v[124:127], a[104:107], a[56:59], v[124:127]
    s_waitcnt lgkmcnt(8)
    v_cvt_pk_bf16_f32 v43, v58, v59
    v_accvgpr_write_b32 a184, v40
    v_mfma_f32_16x16x32_bf16 v[128:131], a[112:115], a[32:35], 0
    ds_read_b64_tr_b16 a[96:97], v10 offset:8192
    ds_read_b64_tr_b16 a[98:99], v10 offset:10240
    v_mfma_f32_16x16x32_bf16 v[128:131], a[116:119], a[36:39], v[128:131]
    v_accvgpr_write_b32 a185, v41
    v_accvgpr_write_b32 a186, v42
    v_mfma_f32_16x16x32_bf16 v[132:135], a[116:119], a[44:47], 0
    s_add_u32 m0, s61, 51200
    ds_read_b64_tr_b16 a[100:101], v10 offset:12288
    ds_read_b64_tr_b16 a[102:103], v10 offset:14336
    v_mfma_f32_16x16x32_bf16 v[132:135], a[112:115], a[40:43], v[132:135]
    s_add_u32 s76, s70, 1081472
    buffer_load_dwordx4 v6, s[28:31], s76 offen lds
    v_mfma_f32_16x16x32_bf16 v[136:139], a[112:115], a[48:51], 0
    ds_read_b128 a[80:83], v8 offset:36864
    ds_read_b128 a[84:87], v9 offset:36864
    v_mfma_f32_16x16x32_bf16 v[136:139], a[116:119], a[52:55], v[136:139]
    v_accvgpr_write_b32 a187, v43
    v_cvt_pk_bf16_f32 v72, v72, v73
    v_mfma_f32_16x16x32_bf16 v[140:143], a[116:119], a[60:63], 0
    v_cvt_pk_bf16_f32 v73, v74, v75
    v_cvt_pk_bf16_f32 v74, v88, v89
    v_mfma_f32_16x16x32_bf16 v[140:143], a[112:115], a[56:59], v[140:143]
    s_waitcnt lgkmcnt(8)
    v_cvt_pk_bf16_f32 v75, v90, v91
    v_accvgpr_write_b32 a188, v72
    v_mfma_f32_16x16x32_bf16 v[144:147], a[120:123], a[32:35], 0
    s_add_u32 m0, s60, 32768
    ds_read_b64_tr_b16 a[104:105], v11 offset:8192
    ds_read_b64_tr_b16 a[106:107], v11 offset:10240
    v_mfma_f32_16x16x32_bf16 v[144:147], a[124:127], a[36:39], v[144:147]
    s_add_u32 s77, s66, 384
    buffer_load_dwordx4 v4, s[24:27], s77 offen lds
    v_mfma_f32_16x16x32_bf16 v[148:151], a[124:127], a[44:47], 0
    ds_read_b64_tr_b16 a[108:109], v11 offset:12288
    ds_read_b64_tr_b16 a[110:111], v11 offset:14336
    v_mfma_f32_16x16x32_bf16 v[148:151], a[120:123], a[40:43], v[148:151]
    v_accvgpr_write_b32 a189, v73
    v_accvgpr_write_b32 a190, v74
    v_mfma_f32_16x16x32_bf16 v[152:155], a[120:123], a[48:51], 0
    ds_read_b128 a[88:91], v8 offset:38912
    ds_read_b128 a[92:95], v9 offset:38912
    v_mfma_f32_16x16x32_bf16 v[152:155], a[124:127], a[52:55], v[152:155]
    v_accvgpr_write_b32 a191, v75
    v_cvt_pk_bf16_f32 v188, v188, v189
    v_mfma_f32_16x16x32_bf16 v[156:159], a[124:127], a[60:63], 0
    s_add_u32 s75, s98, 9216
    buffer_store_dwordx4 a[136:139], v1, s[8:11], s75 offen sc1
    v_mfma_f32_16x16x32_bf16 v[156:159], a[120:123], a[56:59], v[156:159]
    s_waitcnt lgkmcnt(8)
    v_cvt_pk_bf16_f32 v189, v190, v191
    v_cvt_pk_bf16_f32 v190, v204, v205
    v_mfma_f32_16x16x32_bf16 v[176:179], a[96:99], a[32:35], 0
    s_add_u32 m0, s60, 33792
    ds_read_b64_tr_b16 a[112:113], v12 offset:8192
    ds_read_b64_tr_b16 a[114:115], v12 offset:10240
    v_mfma_f32_16x16x32_bf16 v[176:179], a[100:103], a[36:39], v[176:179]
    s_add_u32 s78, s66, 384
    buffer_load_dwordx4 v5, s[24:27], s78 offen lds
    v_mfma_f32_16x16x32_bf16 v[192:195], a[100:103], a[44:47], 0
    ds_read_b64_tr_b16 a[116:117], v12 offset:12288
    ds_read_b64_tr_b16 a[118:119], v12 offset:14336
    v_mfma_f32_16x16x32_bf16 v[192:195], a[96:99], a[40:43], v[192:195]
    v_cvt_pk_bf16_f32 v191, v206, v207
    v_accvgpr_write_b32 a192, v188
    v_mfma_f32_16x16x32_bf16 v[208:211], a[96:99], a[48:51], 0
    v_accvgpr_write_b32 a193, v189
    v_accvgpr_write_b32 a194, v190
    v_mfma_f32_16x16x32_bf16 v[208:211], a[100:103], a[52:55], v[208:211]
    s_add_u32 m0, s60, 34816
    v_accvgpr_write_b32 a195, v191
    v_cvt_pk_bf16_f32 v220, v220, v221
    v_mfma_f32_16x16x32_bf16 v[224:227], a[100:103], a[60:63], 0
    s_add_u32 s79, s67, 384
    buffer_load_dwordx4 v4, s[24:27], s79 offen lds
    v_mfma_f32_16x16x32_bf16 v[224:227], a[96:99], a[56:59], v[224:227]
    s_waitcnt lgkmcnt(6)
    v_cvt_pk_bf16_f32 v221, v222, v223
    v_cvt_pk_bf16_f32 v222, v236, v237
    v_mfma_f32_16x16x32_bf16 v[32:35], a[104:107], a[32:35], 0
    ds_read_b64_tr_b16 a[120:121], v13 offset:8192
    ds_read_b64_tr_b16 a[122:123], v13 offset:10240
    v_mfma_f32_16x16x32_bf16 v[32:35], a[108:111], a[36:39], v[32:35]
    v_cvt_pk_bf16_f32 v223, v238, v239
    v_accvgpr_write_b32 a196, v220
    v_mfma_f32_16x16x32_bf16 v[48:51], a[108:111], a[44:47], 0
    ds_read_b64_tr_b16 a[124:125], v13 offset:12288
    ds_read_b64_tr_b16 a[126:127], v13 offset:14336
    v_mfma_f32_16x16x32_bf16 v[48:51], a[104:107], a[40:43], v[48:51]
    v_accvgpr_write_b32 a197, v221
    v_accvgpr_write_b32 a198, v222
    v_mfma_f32_16x16x32_bf16 v[64:67], a[104:107], a[48:51], 0
    s_add_u32 m0, s60, 35840
    v_accvgpr_write_b32 a199, v223
    v_cvt_pk_bf16_f32 v44, v44, v45
    v_mfma_f32_16x16x32_bf16 v[64:67], a[108:111], a[52:55], v[64:67]
    s_add_u32 s76, s67, 384
    buffer_load_dwordx4 v5, s[24:27], s76 offen lds
    v_mfma_f32_16x16x32_bf16 v[80:83], a[108:111], a[60:63], 0
    v_cvt_pk_bf16_f32 v45, v46, v47
    v_cvt_pk_bf16_f32 v46, v60, v61
    v_mfma_f32_16x16x32_bf16 v[80:83], a[104:107], a[56:59], v[80:83]
    s_waitcnt lgkmcnt(4)
    v_cvt_pk_bf16_f32 v47, v62, v63
    v_accvgpr_write_b32 a200, v44
    v_mfma_f32_16x16x32_bf16 v[180:183], a[112:115], a[32:35], 0
    ds_read_b64_tr_b16 a[96:97], v10 offset:16384
    ds_read_b64_tr_b16 a[98:99], v10 offset:18432
    v_mfma_f32_16x16x32_bf16 v[180:183], a[116:119], a[36:39], v[180:183]
    v_accvgpr_write_b32 a201, v45
    v_accvgpr_write_b32 a202, v46
    v_mfma_f32_16x16x32_bf16 v[196:199], a[116:119], a[44:47], 0
    ds_read_b64_tr_b16 a[100:101], v10 offset:20480
    ds_read_b64_tr_b16 a[102:103], v10 offset:22528
    v_mfma_f32_16x16x32_bf16 v[196:199], a[112:115], a[40:43], v[196:199]
    s_add_u32 m0, s60, 36864
    v_accvgpr_write_b32 a203, v47
    v_cvt_pk_bf16_f32 v76, v76, v77
    v_mfma_f32_16x16x32_bf16 v[212:215], a[112:115], a[48:51], 0
    s_add_u32 s77, s68, 384
    buffer_load_dwordx4 v4, s[24:27], s77 offen lds
    v_mfma_f32_16x16x32_bf16 v[212:215], a[116:119], a[52:55], v[212:215]
    s_add_u32 s75, s98, 13312
    buffer_store_dwordx4 a[140:143], v1, s[8:11], s75 offen sc1
    v_mfma_f32_16x16x32_bf16 v[228:231], a[116:119], a[60:63], 0
    v_cvt_pk_bf16_f32 v77, v78, v79
    v_cvt_pk_bf16_f32 v78, v92, v93
    v_mfma_f32_16x16x32_bf16 v[228:231], a[112:115], a[56:59], v[228:231]
    s_waitcnt lgkmcnt(4)
    v_cvt_pk_bf16_f32 v79, v94, v95
    v_accvgpr_write_b32 a204, v76
    v_mfma_f32_16x16x32_bf16 v[36:39], a[120:123], a[32:35], 0
    ds_read_b64_tr_b16 a[104:105], v11 offset:16384
    ds_read_b64_tr_b16 a[106:107], v11 offset:18432
    v_mfma_f32_16x16x32_bf16 v[36:39], a[124:127], a[36:39], v[36:39]
    v_accvgpr_write_b32 a205, v77
    v_accvgpr_write_b32 a206, v78
    v_mfma_f32_16x16x32_bf16 v[52:55], a[124:127], a[44:47], 0
    s_add_u32 m0, s60, 37888
    ds_read_b64_tr_b16 a[108:109], v11 offset:20480
    ds_read_b64_tr_b16 a[110:111], v11 offset:22528
    v_mfma_f32_16x16x32_bf16 v[52:55], a[120:123], a[40:43], v[52:55]
    s_add_u32 s78, s68, 384
    buffer_load_dwordx4 v5, s[24:27], s78 offen lds
    v_mfma_f32_16x16x32_bf16 v[68:71], a[120:123], a[48:51], 0
    v_accvgpr_write_b32 a207, v79
    v_cvt_pk_bf16_f32 v160, v160, v161
    v_mfma_f32_16x16x32_bf16 v[68:71], a[124:127], a[52:55], v[68:71]
    v_cvt_pk_bf16_f32 v161, v162, v163
    v_cvt_pk_bf16_f32 v162, v164, v165
    v_mfma_f32_16x16x32_bf16 v[84:87], a[124:127], a[60:63], 0
    v_cvt_pk_bf16_f32 v163, v166, v167
    v_cvt_pk_bf16_f32 v168, v168, v169
    v_mfma_f32_16x16x32_bf16 v[84:87], a[120:123], a[56:59], v[84:87]
    s_waitcnt lgkmcnt(4)
    v_cvt_pk_bf16_f32 v169, v170, v171
    v_cvt_pk_bf16_f32 v170, v172, v173
    v_mfma_f32_16x16x32_bf16 v[184:187], a[96:99], a[32:35], 0
    ds_read_b64_tr_b16 a[112:113], v12 offset:16384
    ds_read_b64_tr_b16 a[114:115], v12 offset:18432
    v_mfma_f32_16x16x32_bf16 v[184:187], a[100:103], a[36:39], v[184:187]
    v_cvt_pk_bf16_f32 v171, v174, v175
    v_cvt_pk_bf16_f32 v240, v240, v241
    v_mfma_f32_16x16x32_bf16 v[200:203], a[100:103], a[44:47], 0
    s_add_u32 m0, s60, 38912
    ds_read_b64_tr_b16 a[116:117], v12 offset:20480
    ds_read_b64_tr_b16 a[118:119], v12 offset:22528
    v_mfma_f32_16x16x32_bf16 v[200:203], a[96:99], a[40:43], v[200:203]
    s_add_u32 s79, s69, 384
    buffer_load_dwordx4 v4, s[24:27], s79 offen lds
    v_mfma_f32_16x16x32_bf16 v[216:219], a[96:99], a[48:51], 0
    v_cvt_pk_bf16_f32 v241, v242, v243
    v_cvt_pk_bf16_f32 v242, v244, v245
    v_mfma_f32_16x16x32_bf16 v[216:219], a[100:103], a[52:55], v[216:219]
    v_cvt_pk_bf16_f32 v243, v246, v247
    v_cvt_pk_bf16_f32 v248, v248, v249
    v_mfma_f32_16x16x32_bf16 v[232:235], a[100:103], a[60:63], 0
pad4:
    s_cbranch_execz pad8
    v_cvt_pk_bf16_f32 v249, v250, v251
    v_cvt_pk_bf16_f32 v250, v252, v253
    v_mfma_f32_16x16x32_bf16 v[232:235], a[96:99], a[56:59], v[232:235]
    s_waitcnt lgkmcnt(4)
    v_cvt_pk_bf16_f32 v251, v254, v255
    v_accvgpr_read_b32 v16, a0
    v_mfma_f32_16x16x32_bf16 v[40:43], a[104:107], a[32:35], 0
    s_add_u32 m0, s60, 39936
    ds_read_b64_tr_b16 a[120:121], v13 offset:16384
    ds_read_b64_tr_b16 a[122:123], v13 offset:18432
    v_mfma_f32_16x16x32_bf16 v[40:43], a[108:111], a[36:39], v[40:43]
    s_add_u32 s76, s69, 384
    buffer_load_dwordx4 v5, s[24:27], s76 offen lds
    v_mfma_f32_16x16x32_bf16 v[56:59], a[108:111], a[44:47], 0
    ds_read_b64_tr_b16 a[124:125], v13 offset:20480
    ds_read_b64_tr_b16 a[126:127], v13 offset:22528
    v_mfma_f32_16x16x32_bf16 v[56:59], a[104:107], a[40:43], v[56:59]
    s_add_u32 s75, s99, 2048
    buffer_store_dwordx4 a[144:147], v1, s[8:11], s75 offen sc1
    v_mfma_f32_16x16x32_bf16 v[72:75], a[104:107], a[48:51], 0
    v_add_u32 v10, 4294901760, v10
    v_add_u32 v11, 4294901760, v11
    v_mfma_f32_16x16x32_bf16 v[72:75], a[108:111], a[52:55], v[72:75]
    v_accvgpr_read_b32 v17, a1
    v_accvgpr_read_b32 v18, a2
    v_mfma_f32_16x16x32_bf16 v[88:91], a[108:111], a[60:63], 0
    v_add_u32 v12, 4294901760, v12
    v_add_u32 v13, 4294901760, v13
    v_mfma_f32_16x16x32_bf16 v[88:91], a[104:107], a[56:59], v[88:91]
    s_waitcnt vmcnt(30) lgkmcnt(0)
    s_barrier
    v_accvgpr_read_b32 v19, a3
    v_mfma_f32_16x16x32_bf16 v[188:191], a[112:115], a[32:35], 0
    s_add_u32 m0, s61, 65536
    ds_read_b64_tr_b16 a[96:97], v10 offset:0
    ds_read_b64_tr_b16 a[98:99], v10 offset:2048
    v_mfma_f32_16x16x32_bf16 v[188:191], a[116:119], a[36:39], v[188:191]
    s_add_u32 s71, s71, s73
    buffer_load_dwordx4 v7, s[32:35], s71 offen lds
    v_mfma_f32_16x16x32_bf16 v[204:207], a[116:119], a[44:47], 0
    ds_read_b64_tr_b16 a[100:101], v10 offset:4096
    ds_read_b64_tr_b16 a[102:103], v10 offset:6144
    v_mfma_f32_16x16x32_bf16 v[204:207], a[112:115], a[40:43], v[204:207]
    v_accvgpr_read_b32 v20, a4
    v_accvgpr_read_b32 v21, a5
    v_mfma_f32_16x16x32_bf16 v[220:223], a[112:115], a[48:51], 0
    v_accvgpr_read_b32 v22, a6
    v_accvgpr_read_b32 v23, a7
    v_mfma_f32_16x16x32_bf16 v[220:223], a[116:119], a[52:55], v[220:223]
    s_add_u32 m0, s61, 73728
    v_cvt_pk_bf16_f32 v164, v16, v17
    v_cvt_pk_bf16_f32 v165, v18, v19
    v_mfma_f32_16x16x32_bf16 v[236:239], a[116:119], a[60:63], 0
    s_add_u32 s77, s70, 1572864
    buffer_load_dwordx4 v6, s[28:31], s77 offen lds
    v_mfma_f32_16x16x32_bf16 v[236:239], a[112:115], a[56:59], v[236:239]
    s_waitcnt lgkmcnt(4)
    v_cvt_pk_bf16_f32 v166, v20, v21
    v_cvt_pk_bf16_f32 v167, v22, v23
    v_mfma_f32_16x16x32_bf16 v[44:47], a[120:123], a[32:35], 0
    ds_read_b64_tr_b16 a[104:105], v11 offset:0
    ds_read_b64_tr_b16 a[106:107], v11 offset:2048
    v_mfma_f32_16x16x32_bf16 v[44:47], a[124:127], a[36:39], v[44:47]
    v_accvgpr_read_b32 v24, a8
    v_accvgpr_read_b32 v25, a9
    v_mfma_f32_16x16x32_bf16 v[60:63], a[124:127], a[44:47], 0
    ds_read_b64_tr_b16 a[108:109], v11 offset:4096
    ds_read_b64_tr_b16 a[110:111], v11 offset:6144
    v_mfma_f32_16x16x32_bf16 v[60:63], a[120:123], a[40:43], v[60:63]
    v_accvgpr_read_b32 v26, a10
    v_accvgpr_read_b32 v27, a11
    v_mfma_f32_16x16x32_bf16 v[76:79], a[120:123], a[48:51], 0
    s_add_u32 m0, s61, 81920
    v_accvgpr_read_b32 v28, a12
    v_accvgpr_read_b32 v29, a13
    v_mfma_f32_16x16x32_bf16 v[76:79], a[124:127], a[52:55], v[76:79]
    s_add_u32 s79, s70, 1572992
    buffer_load_dwordx4 v6, s[28:31], s79 offen lds
    v_mfma_f32_16x16x32_bf16 v[92:95], a[124:127], a[60:63], 0
    v_accvgpr_read_b32 v30, a14
    v_accvgpr_read_b32 v31, a15
    v_mfma_f32_16x16x32_bf16 v[92:95], a[120:123], a[56:59], v[92:95]
    s_waitcnt lgkmcnt(4)
    v_cvt_pk_bf16_f32 v172, v24, v25
    v_cvt_pk_bf16_f32 v173, v26, v27
L_st9:
    v_mfma_f32_16x16x32_bf16 v[96:99], a[96:99], a[64:67], v[96:99]
    ds_read_b64_tr_b16 a[112:113], v12 offset:0
    ds_read_b64_tr_b16 a[114:115], v12 offset:2048
    v_mfma_f32_16x16x32_bf16 v[96:99], a[100:103], a[68:71], v[96:99]
    s_add_u32 s75, s99, 6144
    buffer_store_dwordx4 a[148:151], v1, s[8:11], s75 offen sc1
    v_mfma_f32_16x16x32_bf16 v[100:103], a[100:103], a[76:79], v[100:103]
    ds_read_b64_tr_b16 a[116:117], v12 offset:4096
    ds_read_b64_tr_b16 a[118:119], v12 offset:6144
    v_mfma_f32_16x16x32_bf16 v[100:103], a[96:99], a[72:75], v[100:103]
    v_cvt_pk_bf16_f32 v174, v28, v29
    v_cvt_pk_bf16_f32 v175, v30, v31
    v_mfma_f32_16x16x32_bf16 v[104:107], a[96:99], a[80:83], v[104:107]
    s_waitcnt vmcnt(23)
    ds_read_b128 a[32:35], v8 offset:0
    ds_read_b128 a[36:39], v9 offset:0
    v_mfma_f32_16x16x32_bf16 v[104:107], a[100:103], a[84:87], v[104:107]
    s_add_u32 m0, s61, 67584
    v_accvgpr_read_b32 v16, a16
    v_accvgpr_read_b32 v17, a17
    v_mfma_f32_16x16x32_bf16 v[108:111], a[100:103], a[92:95], v[108:111]
    s_add_u32 s71, s71, s72
    buffer_load_dwordx4 v7, s[32:35], s71 offen lds
    v_mfma_f32_16x16x32_bf16 v[108:111], a[96:99], a[88:91], v[108:111]
    s_waitcnt lgkmcnt(6)
    v_accvgpr_read_b32 v18, a18
    v_accvgpr_read_b32 v19, a19
    v_mfma_f32_16x16x32_bf16 v[112:115], a[104:107], a[64:67], v[112:115]
    ds_read_b64_tr_b16 a[120:121], v13 offset:0
    ds_read_b64_tr_b16 a[122:123], v13 offset:2048
    v_mfma_f32_16x16x32_bf16 v[112:115], a[108:111], a[68:71], v[112:115]
    v_accvgpr_read_b32 v20, a20
    v_accvgpr_read_b32 v21, a21
    v_mfma_f32_16x16x32_bf16 v[116:119], a[108:111], a[76:79], v[116:119]
    s_add_u32 m0, s61, 75776
    ds_read_b64_tr_b16 a[124:125], v13 offset:4096
    ds_read_b64_tr_b16 a[126:127], v13 offset:6144
    v_mfma_f32_16x16x32_bf16 v[116:119], a[104:107], a[72:75], v[116:119]
    s_add_u32 s78, s70, 1605632
    buffer_load_dwordx4 v6, s[28:31], s78 offen lds
    v_mfma_f32_16x16x32_bf16 v[120:123], a[104:107], a[80:83], v[120:123]
    ds_read_b128 a[40:43], v8 offset:2048
    ds_read_b128 a[44:47], v9 offset:2048
    v_mfma_f32_16x16x32_bf16 v[120:123], a[108:111], a[84:87], v[120:123]
    v_accvgpr_read_b32 v22, a22
    v_accvgpr_read_b32 v23, a23
    v_mfma_f32_16x16x32_bf16 v[124:127], a[108:111], a[92:95], v[124:127]
    v_cvt_pk_bf16_f32 v244, v16, v17
    v_cvt_pk_bf16_f32 v245, v18, v19
    v_mfma_f32_16x16x32_bf16 v[124:127], a[104:107], a[88:91], v[124:127]
    s_waitcnt lgkmcnt(8)
    v_cvt_pk_bf16_f32 v246, v20, v21
    v_cvt_pk_bf16_f32 v247, v22, v23
    v_mfma_f32_16x16x32_bf16 v[128:131], a[112:115], a[64:67], v[128:131]
    ds_read_b64_tr_b16 a[96:97], v10 offset:8192
    ds_read_b64_tr_b16 a[98:99], v10 offset:10240
    v_mfma_f32_16x16x32_bf16 v[128:131], a[116:119], a[68:71], v[128:131]
    v_accvgpr_read_b32 v24, a24
    v_accvgpr_read_b32 v25, a25
    v_mfma_f32_16x16x32_bf16 v[132:135], a[116:119], a[76:79], v[132:135]
    s_add_u32 m0, s61, 83968
    ds_read_b64_tr_b16 a[100:101], v10 offset:12288
    ds_read_b64_tr_b16 a[102:103], v10 offset:14336
    v_mfma_f32_16x16x32_bf16 v[132:135], a[112:115], a[72:75], v[132:135]
    s_add_u32 s76, s70, 1605760
    buffer_load_dwordx4 v6, s[28:31], s76 offen lds
    v_mfma_f32_16x16x32_bf16 v[136:139], a[112:115], a[80:83], v[136:139]
    ds_read_b128 a[48:51], v8 offset:4096
    ds_read_b128 a[52:55], v9 offset:4096
    v_mfma_f32_16x16x32_bf16 v[136:139], a[116:119], a[84:87], v[136:139]
    v_accvgpr_read_b32 v26, a26
    v_accvgpr_read_b32 v27, a27
    v_mfma_f32_16x16x32_bf16 v[140:143], a[116:119], a[92:95], v[140:143]
    s_add_u32 s75, s99, 10240
    buffer_store_dwordx4 a[152:155], v1, s[8:11], s75 offen sc1
    v_mfma_f32_16x16x32_bf16 v[140:143], a[112:115], a[88:91], v[140:143]
    s_waitcnt lgkmcnt(8)
    v_accvgpr_read_b32 v28, a28
    v_accvgpr_read_b32 v29, a29
    v_mfma_f32_16x16x32_bf16 v[144:147], a[120:123], a[64:67], v[144:147]
    s_add_u32 m0, s60, 0
    ds_read_b64_tr_b16 a[104:105], v11 offset:8192
    ds_read_b64_tr_b16 a[106:107], v11 offset:10240
    v_mfma_f32_16x16x32_bf16 v[144:147], a[124:127], a[68:71], v[144:147]
    s_add_u32 s77, s66, 512
    buffer_load_dwordx4 v4, s[24:27], s77 offen lds
    v_mfma_f32_16x16x32_bf16 v[148:151], a[124:127], a[76:79], v[148:151]
    ds_read_b64_tr_b16 a[108:109], v11 offset:12288
    ds_read_b64_tr_b16 a[110:111], v11 offset:14336
    v_mfma_f32_16x16x32_bf16 v[148:151], a[120:123], a[72:75], v[148:151]
    v_accvgpr_read_b32 v30, a30
    v_accvgpr_read_b32 v31, a31
    v_mfma_f32_16x16x32_bf16 v[152:155], a[120:123], a[80:83], v[152:155]
    ds_read_b128 a[56:59], v8 offset:6144
    ds_read_b128 a[60:63], v9 offset:6144
    v_mfma_f32_16x16x32_bf16 v[152:155], a[124:127], a[84:87], v[152:155]
    v_cvt_pk_bf16_f32 v252, v24, v25
    v_cvt_pk_bf16_f32 v253, v26, v27
    v_mfma_f32_16x16x32_bf16 v[156:159], a[124:127], a[92:95], v[156:159]
    v_cvt_pk_bf16_f32 v254, v28, v29
    v_cvt_pk_bf16_f32 v255, v30, v31
    v_mfma_f32_16x16x32_bf16 v[156:159], a[120:123], a[88:91], v[156:159]
    s_waitcnt lgkmcnt(8)
    v_mfma_f32_16x16x32_bf16 v[176:179], a[96:99], a[64:67], v[176:179]
    s_add_u32 m0, s60, 1024
    ds_read_b64_tr_b16 a[112:113], v12 offset:8192
    ds_read_b64_tr_b16 a[114:115], v12 offset:10240
    v_mfma_f32_16x16x32_bf16 v[176:179], a[100:103], a[68:71], v[176:179]
    s_add_u32 s78, s66, 512
    buffer_load_dwordx4 v5, s[24:27], s78 offen lds
    v_mfma_f32_16x16x32_bf16 v[192:195], a[100:103], a[76:79], v[192:195]
    ds_read_b64_tr_b16 a[116:117], v12 offset:12288
    ds_read_b64_tr_b16 a[118:119], v12 offset:14336
    v_mfma_f32_16x16x32_bf16 v[192:195], a[96:99], a[72:75], v[192:195]
    v_mfma_f32_16x16x32_bf16 v[208:211], a[96:99], a[80:83], v[208:211]
    v_mfma_f32_16x16x32_bf16 v[208:211], a[100:103], a[84:87], v[208:211]
    s_add_u32 m0, s60, 2048
    v_mfma_f32_16x16x32_bf16 v[224:227], a[100:103], a[92:95], v[224:227]
    s_add_u32 s79, s67, 512
    buffer_load_dwordx4 v4, s[24:27], s79 offen lds
    v_mfma_f32_16x16x32_bf16 v[224:227], a[96:99], a[88:91], v[224:227]
    s_waitcnt lgkmcnt(6)
    v_mfma_f32_16x16x32_bf16 v[32:35], a[104:107], a[64:67], v[32:35]
    ds_read_b64_tr_b16 a[120:121], v13 offset:8192
    ds_read_b64_tr_b16 a[122:123], v13 offset:10240
    v_mfma_f32_16x16x32_bf16 v[32:35], a[108:111], a[68:71], v[32:35]
    v_mfma_f32_16x16x32_bf16 v[48:51], a[108:111], a[76:79], v[48:51]
    ds_read_b64_tr_b16 a[124:125], v13 offset:12288
    ds_read_b64_tr_b16 a[126:127], v13 offset:14336
    v_mfma_f32_16x16x32_bf16 v[48:51], a[104:107], a[72:75], v[48:51]
    v_mfma_f32_16x16x32_bf16 v[64:67], a[104:107], a[80:83], v[64:67]
    s_add_u32 m0, s60, 3072
    v_mfma_f32_16x16x32_bf16 v[64:67], a[108:111], a[84:87], v[64:67]
    s_add_u32 s76, s67, 512
    buffer_load_dwordx4 v5, s[24:27], s76 offen lds
    v_mfma_f32_16x16x32_bf16 v[80:83], a[108:111], a[92:95], v[80:83]
    s_add_u32 s75, s99, 14336
    buffer_store_dwordx4 a[156:159], v1, s[8:11], s75 offen sc1
    v_mfma_f32_16x16x32_bf16 v[80:83], a[104:107], a[88:91], v[80:83]
    s_waitcnt lgkmcnt(4)
    v_mfma_f32_16x16x32_bf16 v[180:183], a[112:115], a[64:67], v[180:183]
    ds_read_b64_tr_b16 a[96:97], v10 offset:16384
    ds_read_b64_tr_b16 a[98:99], v10 offset:18432
    v_mfma_f32_16x16x32_bf16 v[180:183], a[116:119], a[68:71], v[180:183]
    v_mfma_f32_16x16x32_bf16 v[196:199], a[116:119], a[76:79], v[196:199]
    ds_read_b64_tr_b16 a[100:101], v10 offset:20480
    ds_read_b64_tr_b16 a[102:103], v10 offset:22528
    v_mfma_f32_16x16x32_bf16 v[196:199], a[112:115], a[72:75], v[196:199]
    s_add_u32 m0, s60, 4096
    v_mfma_f32_16x16x32_bf16 v[212:215], a[112:115], a[80:83], v[212:215]
    s_add_u32 s77, s68, 512
    buffer_load_dwordx4 v4, s[24:27], s77 offen lds
    v_mfma_f32_16x16x32_bf16 v[212:215], a[116:119], a[84:87], v[212:215]
    v_mfma_f32_16x16x32_bf16 v[228:231], a[116:119], a[92:95], v[228:231]
    v_mfma_f32_16x16x32_bf16 v[228:231], a[112:115], a[88:91], v[228:231]
    s_waitcnt lgkmcnt(4)
    v_mfma_f32_16x16x32_bf16 v[36:39], a[120:123], a[64:67], v[36:39]
    ds_read_b64_tr_b16 a[104:105], v11 offset:16384
    ds_read_b64_tr_b16 a[106:107], v11 offset:18432
    v_mfma_f32_16x16x32_bf16 v[36:39], a[124:127], a[68:71], v[36:39]
    v_mfma_f32_16x16x32_bf16 v[52:55], a[124:127], a[76:79], v[52:55]
    s_add_u32 m0, s60, 5120
    ds_read_b64_tr_b16 a[108:109], v11 offset:20480
    ds_read_b64_tr_b16 a[110:111], v11 offset:22528
    v_mfma_f32_16x16x32_bf16 v[52:55], a[120:123], a[72:75], v[52:55]
    s_add_u32 s78, s68, 512
    buffer_load_dwordx4 v5, s[24:27], s78 offen lds
    v_mfma_f32_16x16x32_bf16 v[68:71], a[120:123], a[80:83], v[68:71]
    v_mfma_f32_16x16x32_bf16 v[68:71], a[124:127], a[84:87], v[68:71]
    v_mfma_f32_16x16x32_bf16 v[84:87], a[124:127], a[92:95], v[84:87]
    v_mfma_f32_16x16x32_bf16 v[84:87], a[120:123], a[88:91], v[84:87]
    s_waitcnt lgkmcnt(4)
    v_mfma_f32_16x16x32_bf16 v[184:187], a[96:99], a[64:67], v[184:187]
    ds_read_b64_tr_b16 a[112:113], v12 offset:16384
    ds_read_b64_tr_b16 a[114:115], v12 offset:18432
    v_mfma_f32_16x16x32_bf16 v[184:187], a[100:103], a[68:71], v[184:187]
    v_mfma_f32_16x16x32_bf16 v[200:203], a[100:103], a[76:79], v[200:203]
    s_add_u32 m0, s60, 6144
    ds_read_b64_tr_b16 a[116:117], v12 offset:20480
    ds_read_b64_tr_b16 a[118:119], v12 offset:22528
    v_mfma_f32_16x16x32_bf16 v[200:203], a[96:99], a[72:75], v[200:203]
    s_add_u32 s79, s69, 512
    buffer_load_dwordx4 v4, s[24:27], s79 offen lds
    v_mfma_f32_16x16x32_bf16 v[216:219], a[96:99], a[80:83], v[216:219]
    s_add_u32 s75, s99, 3072
    buffer_store_dwordx4 a[160:163], v1, s[8:11], s75 offen sc1
    v_mfma_f32_16x16x32_bf16 v[216:219], a[100:103], a[84:87], v[216:219]
    v_mfma_f32_16x16x32_bf16 v[232:235], a[100:103], a[92:95], v[232:235]
    v_mfma_f32_16x16x32_bf16 v[232:235], a[96:99], a[88:91], v[232:235]
    s_waitcnt lgkmcnt(4)
    v_mfma_f32_16x16x32_bf16 v[40:43], a[104:107], a[64:67], v[40:43]
    s_add_u32 m0, s60, 7168
    ds_read_b64_tr_b16 a[120:121], v13 offset:16384
    ds_read_b64_tr_b16 a[122:123], v13 offset:18432
    v_mfma_f32_16x16x32_bf16 v[40:43], a[108:111], a[68:71], v[40:43]
    s_add_u32 s76, s69, 512
    buffer_load_dwordx4 v5, s[24:27], s76 offen lds
    v_mfma_f32_16x16x32_bf16 v[56:59], a[108:111], a[76:79], v[56:59]
    ds_read_b64_tr_b16 a[124:125], v13 offset:20480
    ds_read_b64_tr_b16 a[126:127], v13 offset:22528
    v_mfma_f32_16x16x32_bf16 v[56:59], a[104:107], a[72:75], v[56:59]
    v_mfma_f32_16x16x32_bf16 v[72:75], a[104:107], a[80:83], v[72:75]
    v_add_u32 v10, 32768, v10
    v_add_u32 v11, 32768, v11
    v_mfma_f32_16x16x32_bf16 v[72:75], a[108:111], a[84:87], v[72:75]
    v_mfma_f32_16x16x32_bf16 v[88:91], a[108:111], a[92:95], v[88:91]
    v_add_u32 v12, 32768, v12
    v_add_u32 v13, 32768, v13
    v_mfma_f32_16x16x32_bf16 v[88:91], a[104:107], a[88:91], v[88:91]
    s_waitcnt vmcnt(29) lgkmcnt(0)
    s_barrier
    v_mfma_f32_16x16x32_bf16 v[188:191], a[112:115], a[64:67], v[188:191]
    s_add_u32 m0, s61, 0
    ds_read_b64_tr_b16 a[96:97], v10 offset:0
    ds_read_b64_tr_b16 a[98:99], v10 offset:2048
    v_mfma_f32_16x16x32_bf16 v[188:191], a[116:119], a[68:71], v[188:191]
    s_add_u32 s71, s71, s73
    buffer_load_dwordx4 v7, s[32:35], s71 offen lds
    v_mfma_f32_16x16x32_bf16 v[204:207], a[116:119], a[76:79], v[204:207]
    ds_read_b64_tr_b16 a[100:101], v10 offset:4096
    ds_read_b64_tr_b16 a[102:103], v10 offset:6144
    v_mfma_f32_16x16x32_bf16 v[204:207], a[112:115], a[72:75], v[204:207]
    v_mfma_f32_16x16x32_bf16 v[220:223], a[112:115], a[80:83], v[220:223]
    v_mfma_f32_16x16x32_bf16 v[220:223], a[116:119], a[84:87], v[220:223]
    s_add_u32 m0, s61, 8192
    v_mfma_f32_16x16x32_bf16 v[236:239], a[116:119], a[92:95], v[236:239]
    s_add_u32 s77, s70, 2097152
    buffer_load_dwordx4 v6, s[28:31], s77 offen lds
    v_mfma_f32_16x16x32_bf16 v[236:239], a[112:115], a[88:91], v[236:239]
    s_waitcnt lgkmcnt(4)
    v_mfma_f32_16x16x32_bf16 v[44:47], a[120:123], a[64:67], v[44:47]
    ds_read_b64_tr_b16 a[104:105], v11 offset:0
    ds_read_b64_tr_b16 a[106:107], v11 offset:2048
    v_mfma_f32_16x16x32_bf16 v[44:47], a[124:127], a[68:71], v[44:47]
    s_add_u32 s75, s99, 7168
    buffer_store_dwordx4 a[164:167], v1, s[8:11], s75 offen sc1
    v_mfma_f32_16x16x32_bf16 v[60:63], a[124:127], a[76:79], v[60:63]
    ds_read_b64_tr_b16 a[108:109], v11 offset:4096
    ds_read_b64_tr_b16 a[110:111], v11 offset:6144
    v_mfma_f32_16x16x32_bf16 v[60:63], a[120:123], a[72:75], v[60:63]
    v_mfma_f32_16x16x32_bf16 v[76:79], a[120:123], a[80:83], v[76:79]
    s_add_u32 m0, s61, 16384
    v_mfma_f32_16x16x32_bf16 v[76:79], a[124:127], a[84:87], v[76:79]
    s_add_u32 s79, s70, 2097280
    buffer_load_dwordx4 v6, s[28:31], s79 offen lds
    v_mfma_f32_16x16x32_bf16 v[92:95], a[124:127], a[92:95], v[92:95]
    v_mfma_f32_16x16x32_bf16 v[92:95], a[120:123], a[88:91], v[92:95]
    s_waitcnt lgkmcnt(4)
    v_mfma_f32_16x16x32_bf16 v[96:99], a[96:99], a[32:35], v[96:99]
    ds_read_b64_tr_b16 a[112:113], v12 offset:0
    ds_read_b64_tr_b16 a[114:115], v12 offset:2048
    v_mfma_f32_16x16x32_bf16 v[96:99], a[100:103], a[36:39], v[96:99]
    v_bfe_u32 v16, v0, 2, 3
    v_lshrrev_b32 v17, 5, v0
    v_mfma_f32_16x16x32_bf16 v[100:103], a[100:103], a[44:47], v[100:103]
    ds_read_b64_tr_b16 a[116:117], v12 offset:4096
    ds_read_b64_tr_b16 a[118:119], v12 offset:6144
    v_mfma_f32_16x16x32_bf16 v[100:103], a[96:99], a[40:43], v[100:103]
    v_lshlrev_b32 v17, 10, v17
    v_lshl_add_u32 v17, v16, 7, v17
    v_mfma_f32_16x16x32_bf16 v[104:107], a[96:99], a[48:51], v[104:107]
    s_waitcnt vmcnt(23)
    ds_read_b128 a[64:67], v8 offset:32768
    ds_read_b128 a[68:71], v9 offset:32768
    v_mfma_f32_16x16x32_bf16 v[104:107], a[100:103], a[52:55], v[104:107]
    s_add_u32 m0, s61, 2048
    v_add_u32 v17, s90, v17
    v_bfe_u32 v16, v0, 3, 1
    v_mfma_f32_16x16x32_bf16 v[108:111], a[100:103], a[60:63], v[108:111]
    s_add_u32 s71, s71, s72
    buffer_load_dwordx4 v7, s[32:35], s71 offen lds
    v_mfma_f32_16x16x32_bf16 v[108:111], a[96:99], a[56:59], v[108:111]
    s_waitcnt lgkmcnt(6)
    v_lshlrev_b32 v16, 2, v16
    v_and_b32 v18, 3, v0
    v_mfma_f32_16x16x32_bf16 v[112:115], a[104:107], a[32:35], v[112:115]
    ds_read_b64_tr_b16 a[120:121], v13 offset:0
    ds_read_b64_tr_b16 a[122:123], v13 offset:2048
    v_mfma_f32_16x16x32_bf16 v[112:115], a[108:111], a[36:39], v[112:115]
    v_or_b32 v16, v16, v18
    v_lshl_add_u32 v2, v16, 4, v17
    v_mfma_f32_16x16x32_bf16 v[116:119], a[108:111], a[44:47], v[116:119]
    s_add_u32 m0, s61, 10240
    ds_read_b64_tr_b16 a[124:125], v13 offset:4096
    ds_read_b64_tr_b16 a[126:127], v13 offset:6144
    v_mfma_f32_16x16x32_bf16 v[116:119], a[104:107], a[40:43], v[116:119]
    s_add_u32 s78, s70, 2129920
    buffer_load_dwordx4 v6, s[28:31], s78 offen lds
    v_mfma_f32_16x16x32_bf16 v[120:123], a[104:107], a[48:51], v[120:123]
    ds_read_b128 a[72:75], v8 offset:34816
    ds_read_b128 a[76:79], v9 offset:34816
    v_mfma_f32_16x16x32_bf16 v[120:123], a[108:111], a[52:55], v[120:123]
    v_xor_b32 v3, 64, v2
    v_add_u32 v14, s90, v1
    v_mfma_f32_16x16x32_bf16 v[124:127], a[108:111], a[60:63], v[124:127]
    s_add_u32 s75, s99, 11264
    buffer_store_dwordx4 a[168:171], v1, s[8:11], s75 offen sc1
    v_mfma_f32_16x16x32_bf16 v[124:127], a[104:107], a[56:59], v[124:127]
    s_waitcnt lgkmcnt(8)
    v_mfma_f32_16x16x32_bf16 v[128:131], a[112:115], a[32:35], v[128:131]
    ds_read_b64_tr_b16 a[96:97], v10 offset:8192
    ds_read_b64_tr_b16 a[98:99], v10 offset:10240
    v_mfma_f32_16x16x32_bf16 v[128:131], a[116:119], a[36:39], v[128:131]
    v_mfma_f32_16x16x32_bf16 v[132:135], a[116:119], a[44:47], v[132:135]
    s_add_u32 m0, s61, 18432
    ds_read_b64_tr_b16 a[100:101], v10 offset:12288
    ds_read_b64_tr_b16 a[102:103], v10 offset:14336
    v_mfma_f32_16x16x32_bf16 v[132:135], a[112:115], a[40:43], v[132:135]
    s_add_u32 s76, s70, 2130048
    buffer_load_dwordx4 v6, s[28:31], s76 offen lds
    v_mfma_f32_16x16x32_bf16 v[136:139], a[112:115], a[48:51], v[136:139]
    ds_read_b128 a[80:83], v8 offset:36864
    ds_read_b128 a[84:87], v9 offset:36864
    v_mfma_f32_16x16x32_bf16 v[136:139], a[116:119], a[52:55], v[136:139]
    v_mfma_f32_16x16x32_bf16 v[140:143], a[116:119], a[60:63], v[140:143]
    v_mfma_f32_16x16x32_bf16 v[140:143], a[112:115], a[56:59], v[140:143]
    s_waitcnt lgkmcnt(8)
    v_mfma_f32_16x16x32_bf16 v[144:147], a[120:123], a[32:35], v[144:147]
    s_add_u32 m0, s60, 32768
    ds_read_b64_tr_b16 a[104:105], v11 offset:8192
    ds_read_b64_tr_b16 a[106:107], v11 offset:10240
    v_mfma_f32_16x16x32_bf16 v[144:147], a[124:127], a[36:39], v[144:147]
    s_add_u32 s77, s66, 640
    buffer_load_dwordx4 v4, s[24:27], s77 offen lds
    v_mfma_f32_16x16x32_bf16 v[148:151], a[124:127], a[44:47], v[148:151]
    ds_read_b64_tr_b16 a[108:109], v11 offset:12288
    ds_read_b64_tr_b16 a[110:111], v11 offset:14336
    v_mfma_f32_16x16x32_bf16 v[148:151], a[120:123], a[40:43], v[148:151]
    v_mfma_f32_16x16x32_bf16 v[152:155], a[120:123], a[48:51], v[152:155]
    ds_read_b128 a[88:91], v8 offset:38912
    ds_read_b128 a[92:95], v9 offset:38912
    v_mfma_f32_16x16x32_bf16 v[152:155], a[124:127], a[52:55], v[152:155]
    v_mfma_f32_16x16x32_bf16 v[156:159], a[124:127], a[60:63], v[156:159]
    v_mfma_f32_16x16x32_bf16 v[156:159], a[120:123], a[56:59], v[156:159]
    s_waitcnt lgkmcnt(8)
    v_mfma_f32_16x16x32_bf16 v[176:179], a[96:99], a[32:35], v[176:179]
    s_add_u32 m0, s60, 33792
    ds_read_b64_tr_b16 a[112:113], v12 offset:8192
    ds_read_b64_tr_b16 a[114:115], v12 offset:10240
    v_mfma_f32_16x16x32_bf16 v[176:179], a[100:103], a[36:39], v[176:179]
    s_add_u32 s78, s66, 640
    buffer_load_dwordx4 v5, s[24:27], s78 offen lds
    v_mfma_f32_16x16x32_bf16 v[192:195], a[100:103], a[44:47], v[192:195]
    ds_read_b64_tr_b16 a[116:117], v12 offset:12288
    ds_read_b64_tr_b16 a[118:119], v12 offset:14336
    v_mfma_f32_16x16x32_bf16 v[192:195], a[96:99], a[40:43], v[192:195]
    v_mfma_f32_16x16x32_bf16 v[208:211], a[96:99], a[48:51], v[208:211]
    s_add_u32 s75, s99, 15360
    buffer_store_dwordx4 a[172:175], v1, s[8:11], s75 offen sc1
    v_mfma_f32_16x16x32_bf16 v[208:211], a[100:103], a[52:55], v[208:211]
    s_add_u32 m0, s60, 34816
    v_mfma_f32_16x16x32_bf16 v[224:227], a[100:103], a[60:63], v[224:227]
    s_add_u32 s79, s67, 640
    buffer_load_dwordx4 v4, s[24:27], s79 offen lds
    v_mfma_f32_16x16x32_bf16 v[224:227], a[96:99], a[56:59], v[224:227]
    s_waitcnt lgkmcnt(6)
    v_mfma_f32_16x16x32_bf16 v[32:35], a[104:107], a[32:35], v[32:35]
    ds_read_b64_tr_b16 a[120:121], v13 offset:8192
    ds_read_b64_tr_b16 a[122:123], v13 offset:10240
    v_mfma_f32_16x16x32_bf16 v[32:35], a[108:111], a[36:39], v[32:35]
    v_mfma_f32_16x16x32_bf16 v[48:51], a[108:111], a[44:47], v[48:51]
    ds_read_b64_tr_b16 a[124:125], v13 offset:12288
    ds_read_b64_tr_b16 a[126:127], v13 offset:14336
    v_mfma_f32_16x16x32_bf16 v[48:51], a[104:107], a[40:43], v[48:51]
    v_mfma_f32_16x16x32_bf16 v[64:67], a[104:107], a[48:51], v[64:67]
    s_add_u32 m0, s60, 35840
    v_mfma_f32_16x16x32_bf16 v[64:67], a[108:111], a[52:55], v[64:67]
    s_add_u32 s76, s67, 640
    buffer_load_dwordx4 v5, s[24:27], s76 offen lds
    v_mfma_f32_16x16x32_bf16 v[80:83], a[108:111], a[60:63], v[80:83]
    v_mfma_f32_16x16x32_bf16 v[80:83], a[104:107], a[56:59], v[80:83]
    s_waitcnt lgkmcnt(4)
    v_mfma_f32_16x16x32_bf16 v[180:183], a[112:115], a[32:35], v[180:183]
    ds_read_b64_tr_b16 a[96:97], v10 offset:16384
    ds_read_b64_tr_b16 a[98:99], v10 offset:18432
    v_mfma_f32_16x16x32_bf16 v[180:183], a[116:119], a[36:39], v[180:183]
    v_mfma_f32_16x16x32_bf16 v[196:199], a[116:119], a[44:47], v[196:199]
    ds_read_b64_tr_b16 a[100:101], v10 offset:20480
    ds_read_b64_tr_b16 a[102:103], v10 offset:22528
    v_mfma_f32_16x16x32_bf16 v[196:199], a[112:115], a[40:43], v[196:199]
    s_add_u32 m0, s60, 36864
    v_mfma_f32_16x16x32_bf16 v[212:215], a[112:115], a[48:51], v[212:215]
    s_add_u32 s77, s68, 640
    buffer_load_dwordx4 v4, s[24:27], s77 offen lds
    v_mfma_f32_16x16x32_bf16 v[212:215], a[116:119], a[52:55], v[212:215]
    v_mfma_f32_16x16x32_bf16 v[228:231], a[116:119], a[60:63], v[228:231]
    v_mfma_f32_16x16x32_bf16 v[228:231], a[112:115], a[56:59], v[228:231]
    s_waitcnt lgkmcnt(4)
    v_mfma_f32_16x16x32_bf16 v[36:39], a[120:123], a[32:35], v[36:39]
    ds_read_b64_tr_b16 a[104:105], v11 offset:16384
    ds_read_b64_tr_b16 a[106:107], v11 offset:18432
    v_mfma_f32_16x16x32_bf16 v[36:39], a[124:127], a[36:39], v[36:39]
    v_mfma_f32_16x16x32_bf16 v[52:55], a[124:127], a[44:47], v[52:55]
    s_add_u32 m0, s60, 37888
    ds_read_b64_tr_b16 a[108:109], v11 offset:20480
    ds_read_b64_tr_b16 a[110:111], v11 offset:22528
    v_mfma_f32_16x16x32_bf16 v[52:55], a[120:123], a[40:43], v[52:55]
    s_add_u32 s78, s68, 640
    buffer_load_dwordx4 v5, s[24:27], s78 offen lds
    v_mfma_f32_16x16x32_bf16 v[68:71], a[120:123], a[48:51], v[68:71]
    s_add_u32 s75, s100, 16384
    buffer_store_dwordx4 a[176:179], v1, s[8:11], s75 offen sc1
    v_mfma_f32_16x16x32_bf16 v[68:71], a[124:127], a[52:55], v[68:71]
    v_mfma_f32_16x16x32_bf16 v[84:87], a[124:127], a[60:63], v[84:87]
    v_mfma_f32_16x16x32_bf16 v[84:87], a[120:123], a[56:59], v[84:87]
    s_waitcnt lgkmcnt(4)
    v_mfma_f32_16x16x32_bf16 v[184:187], a[96:99], a[32:35], v[184:187]
    ds_read_b64_tr_b16 a[112:113], v12 offset:16384
    ds_read_b64_tr_b16 a[114:115], v12 offset:18432
    v_mfma_f32_16x16x32_bf16 v[184:187], a[100:103], a[36:39], v[184:187]
    v_mfma_f32_16x16x32_bf16 v[200:203], a[100:103], a[44:47], v[200:203]
    s_add_u32 m0, s60, 38912
    ds_read_b64_tr_b16 a[116:117], v12 offset:20480
    ds_read_b64_tr_b16 a[118:119], v12 offset:22528
    v_mfma_f32_16x16x32_bf16 v[200:203], a[96:99], a[40:43], v[200:203]
    s_add_u32 s79, s69, 640
    buffer_load_dwordx4 v4, s[24:27], s79 offen lds
    v_mfma_f32_16x16x32_bf16 v[216:219], a[96:99], a[48:51], v[216:219]
    v_mfma_f32_16x16x32_bf16 v[216:219], a[100:103], a[52:55], v[216:219]
    v_mfma_f32_16x16x32_bf16 v[232:235], a[100:103], a[60:63], v[232:235]
    v_mfma_f32_16x16x32_bf16 v[232:235], a[96:99], a[56:59], v[232:235]
    s_waitcnt lgkmcnt(4)
    v_mfma_f32_16x16x32_bf16 v[40:43], a[104:107], a[32:35], v[40:43]
    s_add_u32 m0, s60, 39936
    ds_read_b64_tr_b16 a[120:121], v13 offset:16384
    ds_read_b64_tr_b16 a[122:123], v13 offset:18432
    v_mfma_f32_16x16x32_bf16 v[40:43], a[108:111], a[36:39], v[40:43]
    s_add_u32 s76, s69, 640
    buffer_load_dwordx4 v5, s[24:27], s76 offen lds
    v_mfma_f32_16x16x32_bf16 v[56:59], a[108:111], a[44:47], v[56:59]
    ds_read_b64_tr_b16 a[124:125], v13 offset:20480
    ds_read_b64_tr_b16 a[126:127], v13 offset:22528
    v_mfma_f32_16x16x32_bf16 v[56:59], a[104:107], a[40:43], v[56:59]
    v_mfma_f32_16x16x32_bf16 v[72:75], a[104:107], a[48:51], v[72:75]
    v_add_u32 v10, 32768, v10
    v_add_u32 v11, 32768, v11
    v_mfma_f32_16x16x32_bf16 v[72:75], a[108:111], a[52:55], v[72:75]
    v_mfma_f32_16x16x32_bf16 v[88:91], a[108:111], a[60:63], v[88:91]
    v_add_u32 v12, 32768, v12
    v_add_u32 v13, 32768, v13
    v_mfma_f32_16x16x32_bf16 v[88:91], a[104:107], a[56:59], v[88:91]
    s_waitcnt vmcnt(29) lgkmcnt(0)
    s_barrier
    v_mfma_f32_16x16x32_bf16 v[188:191], a[112:115], a[32:35], v[188:191]
    s_add_u32 m0, s61, 32768
    ds_read_b64_tr_b16 a[96:97], v10 offset:0
    ds_read_b64_tr_b16 a[98:99], v10 offset:2048
    v_mfma_f32_16x16x32_bf16 v[188:191], a[116:119], a[36:39], v[188:191]
pad5:
    s_cbranch_execz pad9
    s_add_u32 s71, s71, s73
    buffer_load_dwordx4 v7, s[32:35], s71 offen lds
    v_mfma_f32_16x16x32_bf16 v[204:207], a[116:119], a[44:47], v[204:207]
    ds_read_b64_tr_b16 a[100:101], v10 offset:4096
    ds_read_b64_tr_b16 a[102:103], v10 offset:6144
    v_mfma_f32_16x16x32_bf16 v[204:207], a[112:115], a[40:43], v[204:207]
    s_add_u32 s75, s100, 24576
    buffer_store_dwordx4 a[180:183], v1, s[8:11], s75 offen sc1
    v_mfma_f32_16x16x32_bf16 v[220:223], a[112:115], a[48:51], v[220:223]
    v_mfma_f32_16x16x32_bf16 v[220:223], a[116:119], a[52:55], v[220:223]
    s_add_u32 m0, s61, 40960
    v_mfma_f32_16x16x32_bf16 v[236:239], a[116:119], a[60:63], v[236:239]
    s_add_u32 s77, s70, 2621440
    buffer_load_dwordx4 v6, s[28:31], s77 offen lds
    v_mfma_f32_16x16x32_bf16 v[236:239], a[112:115], a[56:59], v[236:239]
    s_waitcnt lgkmcnt(4)
    v_mfma_f32_16x16x32_bf16 v[44:47], a[120:123], a[32:35], v[44:47]
    ds_read_b64_tr_b16 a[104:105], v11 offset:0
    ds_read_b64_tr_b16 a[106:107], v11 offset:2048
    v_mfma_f32_16x16x32_bf16 v[44:47], a[124:127], a[36:39], v[44:47]
    v_mfma_f32_16x16x32_bf16 v[60:63], a[124:127], a[44:47], v[60:63]
    ds_read_b64_tr_b16 a[108:109], v11 offset:4096
    ds_read_b64_tr_b16 a[110:111], v11 offset:6144
    v_mfma_f32_16x16x32_bf16 v[60:63], a[120:123], a[40:43], v[60:63]
    v_mfma_f32_16x16x32_bf16 v[76:79], a[120:123], a[48:51], v[76:79]
    s_add_u32 m0, s61, 49152
    v_mfma_f32_16x16x32_bf16 v[76:79], a[124:127], a[52:55], v[76:79]
    s_add_u32 s79, s70, 2621568
    buffer_load_dwordx4 v6, s[28:31], s79 offen lds
    v_mfma_f32_16x16x32_bf16 v[92:95], a[124:127], a[60:63], v[92:95]
    v_mfma_f32_16x16x32_bf16 v[92:95], a[120:123], a[56:59], v[92:95]
    s_waitcnt lgkmcnt(4)
    v_mfma_f32_16x16x32_bf16 v[96:99], a[96:99], a[64:67], v[96:99]
    ds_read_b64_tr_b16 a[112:113], v12 offset:0
    ds_read_b64_tr_b16 a[114:115], v12 offset:2048
    v_mfma_f32_16x16x32_bf16 v[96:99], a[100:103], a[68:71], v[96:99]
    v_mfma_f32_16x16x32_bf16 v[100:103], a[100:103], a[76:79], v[100:103]
    ds_read_b64_tr_b16 a[116:117], v12 offset:4096
    ds_read_b64_tr_b16 a[118:119], v12 offset:6144
    v_mfma_f32_16x16x32_bf16 v[100:103], a[96:99], a[72:75], v[100:103]
    ds_write_b128 v14, a[208:211] offset:0
    v_mfma_f32_16x16x32_bf16 v[104:107], a[96:99], a[80:83], v[104:107]
    s_waitcnt vmcnt(22)
    ds_read_b128 a[32:35], v8 offset:0
    ds_read_b128 a[36:39], v9 offset:0
    v_mfma_f32_16x16x32_bf16 v[104:107], a[100:103], a[84:87], v[104:107]
    s_add_u32 m0, s61, 34816
    v_mfma_f32_16x16x32_bf16 v[108:111], a[100:103], a[92:95], v[108:111]
    s_add_u32 s71, s71, s72
    buffer_load_dwordx4 v7, s[32:35], s71 offen lds
    v_mfma_f32_16x16x32_bf16 v[108:111], a[96:99], a[88:91], v[108:111]
    s_waitcnt lgkmcnt(7)
    v_mfma_f32_16x16x32_bf16 v[112:115], a[104:107], a[64:67], v[112:115]
    ds_read_b64_tr_b16 a[120:121], v13 offset:0
    ds_read_b64_tr_b16 a[122:123], v13 offset:2048
    v_mfma_f32_16x16x32_bf16 v[112:115], a[108:111], a[68:71], v[112:115]
    s_add_u32 s75, s100, 17408
    buffer_store_dwordx4 a[184:187], v1, s[8:11], s75 offen sc1
    v_mfma_f32_16x16x32_bf16 v[116:119], a[108:111], a[76:79], v[116:119]
    s_add_u32 m0, s61, 43008
    ds_read_b64_tr_b16 a[124:125], v13 offset:4096
    ds_read_b64_tr_b16 a[126:127], v13 offset:6144
    v_mfma_f32_16x16x32_bf16 v[116:119], a[104:107], a[72:75], v[116:119]
    s_add_u32 s78, s70, 2654208
    buffer_load_dwordx4 v6, s[28:31], s78 offen lds
    v_mfma_f32_16x16x32_bf16 v[120:123], a[104:107], a[80:83], v[120:123]
    ds_read_b128 a[40:43], v8 offset:2048
    ds_read_b128 a[44:47], v9 offset:2048
    v_mfma_f32_16x16x32_bf16 v[120:123], a[108:111], a[84:87], v[120:123]
    ds_write_b128 v14, a[212:215] offset:1024
    v_mfma_f32_16x16x32_bf16 v[124:127], a[108:111], a[92:95], v[124:127]
    v_mfma_f32_16x16x32_bf16 v[124:127], a[104:107], a[88:91], v[124:127]
    s_waitcnt lgkmcnt(10)
    v_mfma_f32_16x16x32_bf16 v[128:131], a[112:115], a[64:67], v[128:131]
    ds_read_b64_tr_b16 a[96:97], v10 offset:8192
    ds_read_b64_tr_b16 a[98:99], v10 offset:10240
    v_mfma_f32_16x16x32_bf16 v[128:131], a[116:119], a[68:71], v[128:131]
    ds_write_b128 v14, a[216:219] offset:2048
    v_mfma_f32_16x16x32_bf16 v[132:135], a[116:119], a[76:79], v[132:135]
    s_add_u32 m0, s61, 51200
    ds_read_b64_tr_b16 a[100:101], v10 offset:12288
    ds_read_b64_tr_b16 a[102:103], v10 offset:14336
    v_mfma_f32_16x16x32_bf16 v[132:135], a[112:115], a[72:75], v[132:135]
    s_add_u32 s76, s70, 2654336
    buffer_load_dwordx4 v6, s[28:31], s76 offen lds
    v_mfma_f32_16x16x32_bf16 v[136:139], a[112:115], a[80:83], v[136:139]
    ds_read_b128 a[48:51], v8 offset:4096
    ds_read_b128 a[52:55], v9 offset:4096
    v_mfma_f32_16x16x32_bf16 v[136:139], a[116:119], a[84:87], v[136:139]
    ds_write_b128 v14, a[220:223] offset:3072
    v_mfma_f32_16x16x32_bf16 v[140:143], a[116:119], a[92:95], v[140:143]
    v_mfma_f32_16x16x32_bf16 v[140:143], a[112:115], a[88:91], v[140:143]
    s_waitcnt lgkmcnt(11)
    v_mfma_f32_16x16x32_bf16 v[144:147], a[120:123], a[64:67], v[144:147]
    s_add_u32 m0, s60, 0
    ds_read_b64_tr_b16 a[104:105], v11 offset:8192
    ds_read_b64_tr_b16 a[106:107], v11 offset:10240
    v_mfma_f32_16x16x32_bf16 v[144:147], a[124:127], a[68:71], v[144:147]
    s_add_u32 s77, s66, 768
    buffer_load_dwordx4 v4, s[24:27], s77 offen lds
    v_mfma_f32_16x16x32_bf16 v[148:151], a[124:127], a[76:79], v[148:151]
    ds_read_b64_tr_b16 a[108:109], v11 offset:12288
    ds_read_b64_tr_b16 a[110:111], v11 offset:14336
    v_mfma_f32_16x16x32_bf16 v[148:151], a[120:123], a[72:75], v[148:151]
    v_mfma_f32_16x16x32_bf16 v[152:155], a[120:123], a[80:83], v[152:155]
    ds_read_b128 a[56:59], v8 offset:6144
    ds_read_b128 a[60:63], v9 offset:6144
    v_mfma_f32_16x16x32_bf16 v[152:155], a[124:127], a[84:87], v[152:155]
    s_add_u32 s75, s100, 25600
    buffer_store_dwordx4 a[188:191], v1, s[8:11], s75 offen sc1
    v_mfma_f32_16x16x32_bf16 v[156:159], a[124:127], a[92:95], v[156:159]
    v_mfma_f32_16x16x32_bf16 v[156:159], a[120:123], a[88:91], v[156:159]
    s_waitcnt lgkmcnt(9)
    v_mfma_f32_16x16x32_bf16 v[176:179], a[96:99], a[64:67], v[176:179]
    s_add_u32 m0, s60, 1024
    ds_read_b64_tr_b16 a[112:113], v12 offset:8192
    ds_read_b64_tr_b16 a[114:115], v12 offset:10240
    v_mfma_f32_16x16x32_bf16 v[176:179], a[100:103], a[68:71], v[176:179]
    s_add_u32 s78, s66, 768
    buffer_load_dwordx4 v5, s[24:27], s78 offen lds
    v_mfma_f32_16x16x32_bf16 v[192:195], a[100:103], a[76:79], v[192:195]
    ds_read_b64_tr_b16 a[116:117], v12 offset:12288
    ds_read_b64_tr_b16 a[118:119], v12 offset:14336
    v_mfma_f32_16x16x32_bf16 v[192:195], a[96:99], a[72:75], v[192:195]
    ds_read_b64_tr_b16 a[208:209], v2 offset:0
    ds_read_b64_tr_b16 a[210:211], v2 offset:2048
    v_mfma_f32_16x16x32_bf16 v[208:211], a[96:99], a[80:83], v[208:211]
    v_mfma_f32_16x16x32_bf16 v[208:211], a[100:103], a[84:87], v[208:211]
    s_add_u32 m0, s60, 2048
    v_mfma_f32_16x16x32_bf16 v[224:227], a[100:103], a[92:95], v[224:227]
    s_add_u32 s79, s67, 768
    buffer_load_dwordx4 v4, s[24:27], s79 offen lds
    v_mfma_f32_16x16x32_bf16 v[224:227], a[96:99], a[88:91], v[224:227]
    s_waitcnt lgkmcnt(8)
    v_mfma_f32_16x16x32_bf16 v[32:35], a[104:107], a[64:67], v[32:35]
    ds_read_b64_tr_b16 a[120:121], v13 offset:8192
    ds_read_b64_tr_b16 a[122:123], v13 offset:10240
    v_mfma_f32_16x16x32_bf16 v[32:35], a[108:111], a[68:71], v[32:35]
    ds_read_b64_tr_b16 a[212:213], v2 offset:8
    ds_read_b64_tr_b16 a[214:215], v2 offset:2056
    v_mfma_f32_16x16x32_bf16 v[48:51], a[108:111], a[76:79], v[48:51]
    ds_read_b64_tr_b16 a[124:125], v13 offset:12288
    ds_read_b64_tr_b16 a[126:127], v13 offset:14336
    v_mfma_f32_16x16x32_bf16 v[48:51], a[104:107], a[72:75], v[48:51]
    ds_read_b64_tr_b16 a[216:217], v3 offset:0
    ds_read_b64_tr_b16 a[218:219], v3 offset:2048
    v_mfma_f32_16x16x32_bf16 v[64:67], a[104:107], a[80:83], v[64:67]
    s_add_u32 m0, s60, 3072
    v_mfma_f32_16x16x32_bf16 v[64:67], a[108:111], a[84:87], v[64:67]
    s_add_u32 s76, s67, 768
    buffer_load_dwordx4 v5, s[24:27], s76 offen lds
    v_mfma_f32_16x16x32_bf16 v[80:83], a[108:111], a[92:95], v[80:83]
    ds_read_b64_tr_b16 a[220:221], v3 offset:8
    ds_read_b64_tr_b16 a[222:223], v3 offset:2056
    v_mfma_f32_16x16x32_bf16 v[80:83], a[104:107], a[88:91], v[80:83]
    s_waitcnt lgkmcnt(12)
    v_mfma_f32_16x16x32_bf16 v[180:183], a[112:115], a[64:67], v[180:183]
    ds_read_b64_tr_b16 a[96:97], v10 offset:16384
    ds_read_b64_tr_b16 a[98:99], v10 offset:18432
    v_mfma_f32_16x16x32_bf16 v[180:183], a[116:119], a[68:71], v[180:183]
    v_mfma_f32_16x16x32_bf16 v[196:199], a[116:119], a[76:79], v[196:199]
    ds_read_b64_tr_b16 a[100:101], v10 offset:20480
    ds_read_b64_tr_b16 a[102:103], v10 offset:22528
    v_mfma_f32_16x16x32_bf16 v[196:199], a[112:115], a[72:75], v[196:199]
    s_add_u32 m0, s60, 4096
    v_mfma_f32_16x16x32_bf16 v[212:215], a[112:115], a[80:83], v[212:215]
    s_add_u32 s77, s68, 768
    buffer_load_dwordx4 v4, s[24:27], s77 offen lds
    v_mfma_f32_16x16x32_bf16 v[212:215], a[116:119], a[84:87], v[212:215]
    s_add_u32 s75, s100, 18432
    buffer_store_dwordx4 a[192:195], v1, s[8:11], s75 offen sc1
    v_mfma_f32_16x16x32_bf16 v[228:231], a[116:119], a[92:95], v[228:231]
    v_mfma_f32_16x16x32_bf16 v[228:231], a[112:115], a[88:91], v[228:231]
    s_waitcnt lgkmcnt(8)
    v_mfma_f32_16x16x32_bf16 v[36:39], a[120:123], a[64:67], v[36:39]
    ds_read_b64_tr_b16 a[104:105], v11 offset:16384
    ds_read_b64_tr_b16 a[106:107], v11 offset:18432
    v_mfma_f32_16x16x32_bf16 v[36:39], a[124:127], a[68:71], v[36:39]
    ds_write_b128 v14, a[224:227] offset:0
    v_mfma_f32_16x16x32_bf16 v[52:55], a[124:127], a[76:79], v[52:55]
    s_add_u32 m0, s60, 5120
    ds_read_b64_tr_b16 a[108:109], v11 offset:20480
    ds_read_b64_tr_b16 a[110:111], v11 offset:22528
    v_mfma_f32_16x16x32_bf16 v[52:55], a[120:123], a[72:75], v[52:55]
    s_add_u32 s78, s68, 768
    buffer_load_dwordx4 v5, s[24:27], s78 offen lds
    v_mfma_f32_16x16x32_bf16 v[68:71], a[120:123], a[80:83], v[68:71]
    ds_write_b128 v14, a[228:231] offset:1024
    v_mfma_f32_16x16x32_bf16 v[68:71], a[124:127], a[84:87], v[68:71]
    v_mfma_f32_16x16x32_bf16 v[84:87], a[124:127], a[92:95], v[84:87]
    v_mfma_f32_16x16x32_bf16 v[84:87], a[120:123], a[88:91], v[84:87]
    s_waitcnt lgkmcnt(6)
    v_mfma_f32_16x16x32_bf16 v[184:187], a[96:99], a[64:67], v[184:187]
    ds_read_b64_tr_b16 a[112:113], v12 offset:16384
    ds_read_b64_tr_b16 a[114:115], v12 offset:18432
    v_mfma_f32_16x16x32_bf16 v[184:187], a[100:103], a[68:71], v[184:187]
    ds_write_b128 v14, a[232:235] offset:2048
    v_mfma_f32_16x16x32_bf16 v[200:203], a[100:103], a[76:79], v[200:203]
    s_add_u32 m0, s60, 6144
    ds_read_b64_tr_b16 a[116:117], v12 offset:20480
    ds_read_b64_tr_b16 a[118:119], v12 offset:22528
    v_mfma_f32_16x16x32_bf16 v[200:203], a[96:99], a[72:75], v[200:203]
    s_add_u32 s79, s69, 768
    buffer_load_dwordx4 v4, s[24:27], s79 offen lds
    v_mfma_f32_16x16x32_bf16 v[216:219], a[96:99], a[80:83], v[216:219]
    ds_write_b128 v14, a[236:239] offset:3072
    v_mfma_f32_16x16x32_bf16 v[216:219], a[100:103], a[84:87], v[216:219]
    v_mfma_f32_16x16x32_bf16 v[232:235], a[100:103], a[92:95], v[232:235]
    v_mfma_f32_16x16x32_bf16 v[232:235], a[96:99], a[88:91], v[232:235]
    s_waitcnt lgkmcnt(7)
    v_mfma_f32_16x16x32_bf16 v[40:43], a[104:107], a[64:67], v[40:43]
    s_add_u32 m0, s60, 7168
    ds_read_b64_tr_b16 a[120:121], v13 offset:16384
    ds_read_b64_tr_b16 a[122:123], v13 offset:18432
    v_mfma_f32_16x16x32_bf16 v[40:43], a[108:111], a[68:71], v[40:43]
    s_add_u32 s76, s69, 768
    buffer_load_dwordx4 v5, s[24:27], s76 offen lds
    v_mfma_f32_16x16x32_bf16 v[56:59], a[108:111], a[76:79], v[56:59]
    ds_read_b64_tr_b16 a[124:125], v13 offset:20480
    ds_read_b64_tr_b16 a[126:127], v13 offset:22528
    v_mfma_f32_16x16x32_bf16 v[56:59], a[104:107], a[72:75], v[56:59]
    s_add_u32 s75, s100, 26624
    buffer_store_dwordx4 a[196:199], v1, s[8:11], s75 offen sc1
    v_mfma_f32_16x16x32_bf16 v[72:75], a[104:107], a[80:83], v[72:75]
    v_add_u32 v10, 4294901760, v10
    v_add_u32 v11, 4294901760, v11
    v_mfma_f32_16x16x32_bf16 v[72:75], a[108:111], a[84:87], v[72:75]
    v_mfma_f32_16x16x32_bf16 v[88:91], a[108:111], a[92:95], v[88:91]
    v_add_u32 v12, 4294901760, v12
    v_add_u32 v13, 4294901760, v13
    v_mfma_f32_16x16x32_bf16 v[88:91], a[104:107], a[88:91], v[88:91]
    s_waitcnt vmcnt(29) lgkmcnt(0)
    s_barrier
    v_mfma_f32_16x16x32_bf16 v[188:191], a[112:115], a[64:67], v[188:191]
    s_add_u32 m0, s61, 65536
    ds_read_b64_tr_b16 a[96:97], v10 offset:0
    ds_read_b64_tr_b16 a[98:99], v10 offset:2048
    v_mfma_f32_16x16x32_bf16 v[188:191], a[116:119], a[68:71], v[188:191]
    s_add_u32 s71, s71, s73
    buffer_load_dwordx4 v7, s[32:35], s71 offen lds
    v_mfma_f32_16x16x32_bf16 v[204:207], a[116:119], a[76:79], v[204:207]
    ds_read_b64_tr_b16 a[100:101], v10 offset:4096
    ds_read_b64_tr_b16 a[102:103], v10 offset:6144
    v_mfma_f32_16x16x32_bf16 v[204:207], a[112:115], a[72:75], v[204:207]
    ds_read_b64_tr_b16 a[224:225], v2 offset:0
    ds_read_b64_tr_b16 a[226:227], v2 offset:2048
    v_mfma_f32_16x16x32_bf16 v[220:223], a[112:115], a[80:83], v[220:223]
    v_mfma_f32_16x16x32_bf16 v[220:223], a[116:119], a[84:87], v[220:223]
    s_add_u32 m0, s61, 73728
    v_mfma_f32_16x16x32_bf16 v[236:239], a[116:119], a[92:95], v[236:239]
    s_add_u32 s77, s70, 3145728
    buffer_load_dwordx4 v6, s[28:31], s77 offen lds
    v_mfma_f32_16x16x32_bf16 v[236:239], a[112:115], a[88:91], v[236:239]
    s_waitcnt lgkmcnt(6)
    v_mfma_f32_16x16x32_bf16 v[44:47], a[120:123], a[64:67], v[44:47]
    ds_read_b64_tr_b16 a[104:105], v11 offset:0
    ds_read_b64_tr_b16 a[106:107], v11 offset:2048
    v_mfma_f32_16x16x32_bf16 v[44:47], a[124:127], a[68:71], v[44:47]
    ds_read_b64_tr_b16 a[228:229], v2 offset:8
    ds_read_b64_tr_b16 a[230:231], v2 offset:2056
    v_mfma_f32_16x16x32_bf16 v[60:63], a[124:127], a[76:79], v[60:63]
    ds_read_b64_tr_b16 a[108:109], v11 offset:4096
    ds_read_b64_tr_b16 a[110:111], v11 offset:6144
    v_mfma_f32_16x16x32_bf16 v[60:63], a[120:123], a[72:75], v[60:63]
    ds_read_b64_tr_b16 a[232:233], v3 offset:0
    ds_read_b64_tr_b16 a[234:235], v3 offset:2048
    v_mfma_f32_16x16x32_bf16 v[76:79], a[120:123], a[80:83], v[76:79]
    s_add_u32 m0, s61, 81920
    v_mfma_f32_16x16x32_bf16 v[76:79], a[124:127], a[84:87], v[76:79]
    s_add_u32 s79, s70, 3145856
    buffer_load_dwordx4 v6, s[28:31], s79 offen lds
    v_mfma_f32_16x16x32_bf16 v[92:95], a[124:127], a[92:95], v[92:95]
    s_add_u32 s75, s100, 19456
    buffer_store_dwordx4 a[200:203], v1, s[8:11], s75 offen sc1
    v_mfma_f32_16x16x32_bf16 v[92:95], a[120:123], a[88:91], v[92:95]
    s_waitcnt lgkmcnt(10)
    v_mfma_f32_16x16x32_bf16 v[96:99], a[96:99], a[32:35], v[96:99]
    s_lshr_b32 s96, s2, 3
    ds_read_b64_tr_b16 a[112:113], v12 offset:0
    ds_read_b64_tr_b16 a[114:115], v12 offset:2048
    v_mfma_f32_16x16x32_bf16 v[96:99], a[100:103], a[36:39], v[96:99]
    s_lshl_b32 s94, s4, 5
    ds_read_b64_tr_b16 a[236:237], v3 offset:8
    ds_read_b64_tr_b16 a[238:239], v3 offset:2056
    v_mfma_f32_16x16x32_bf16 v[100:103], a[100:103], a[44:47], v[100:103]
    s_add_u32 s96, s96, s94
    ds_read_b64_tr_b16 a[116:117], v12 offset:4096
    ds_read_b64_tr_b16 a[118:119], v12 offset:6144
    v_mfma_f32_16x16x32_bf16 v[100:103], a[96:99], a[40:43], v[100:103]
    s_lshl_b32 s96, s96, 2
    v_mov_b32 v20, s97
    v_and_b32 v21, 31, v0
    v_mfma_f32_16x16x32_bf16 v[104:107], a[96:99], a[48:51], v[104:107]
    s_waitcnt vmcnt(23)
    ds_read_b128 a[64:67], v8 offset:32768
    ds_read_b128 a[68:71], v9 offset:32768
    v_mfma_f32_16x16x32_bf16 v[104:107], a[100:103], a[52:55], v[104:107]
    s_add_u32 m0, s61, 67584
    v_lshlrev_b32 v21, 2, v21
    v_mfma_f32_16x16x32_bf16 v[108:111], a[100:103], a[60:63], v[108:111]
    s_add_u32 s71, s71, s72
    buffer_load_dwordx4 v7, s[32:35], s71 offen lds
    v_mfma_f32_16x16x32_bf16 v[108:111], a[96:99], a[56:59], v[108:111]
    s_waitcnt lgkmcnt(10)
    v_mfma_f32_16x16x32_bf16 v[112:115], a[104:107], a[32:35], v[112:115]
    s_add_u32 s96, s96, 84017152
    ds_read_b64_tr_b16 a[120:121], v13 offset:0
    ds_read_b64_tr_b16 a[122:123], v13 offset:2048
    v_mfma_f32_16x16x32_bf16 v[112:115], a[108:111], a[36:39], v[112:115]
    s_cmp_eq_u32 s3, 0
    s_cselect_b32 s96, s96, 536870912
    s_cselect_b64 s[86:87], 0, -1
    v_mfma_f32_16x16x32_bf16 v[116:119], a[108:111], a[44:47], v[116:119]
    s_add_u32 m0, s61, 75776
    ds_read_b64_tr_b16 a[124:125], v13 offset:4096
    ds_read_b64_tr_b16 a[126:127], v13 offset:6144
    v_mfma_f32_16x16x32_bf16 v[116:119], a[104:107], a[40:43], v[116:119]
    s_add_u32 s78, s70, 3178496
    buffer_load_dwordx4 v6, s[28:31], s78 offen lds
    v_mfma_f32_16x16x32_bf16 v[120:123], a[104:107], a[48:51], v[120:123]
    ds_read_b128 a[72:75], v8 offset:34816
    ds_read_b128 a[76:79], v9 offset:34816
    v_mfma_f32_16x16x32_bf16 v[120:123], a[108:111], a[52:55], v[120:123]
    v_mfma_f32_16x16x32_bf16 v[124:127], a[108:111], a[60:63], v[124:127]
    v_mfma_f32_16x16x32_bf16 v[124:127], a[104:107], a[56:59], v[124:127]
    s_waitcnt lgkmcnt(8)
    v_mfma_f32_16x16x32_bf16 v[128:131], a[112:115], a[32:35], v[128:131]
    ds_read_b64_tr_b16 a[96:97], v10 offset:8192
    ds_read_b64_tr_b16 a[98:99], v10 offset:10240
    v_mfma_f32_16x16x32_bf16 v[128:131], a[116:119], a[36:39], v[128:131]
    v_mfma_f32_16x16x32_bf16 v[132:135], a[116:119], a[44:47], v[132:135]
    s_add_u32 m0, s61, 83968
    ds_read_b64_tr_b16 a[100:101], v10 offset:12288
    ds_read_b64_tr_b16 a[102:103], v10 offset:14336
    v_mfma_f32_16x16x32_bf16 v[132:135], a[112:115], a[40:43], v[132:135]
    s_add_u32 s76, s70, 3178624
    buffer_load_dwordx4 v6, s[28:31], s76 offen lds
    v_mfma_f32_16x16x32_bf16 v[136:139], a[112:115], a[48:51], v[136:139]
    ds_read_b128 a[80:83], v8 offset:36864
    ds_read_b128 a[84:87], v9 offset:36864
    v_mfma_f32_16x16x32_bf16 v[136:139], a[116:119], a[52:55], v[136:139]
    s_add_u32 s75, s100, 27648
    buffer_store_dwordx4 a[204:207], v1, s[8:11], s75 offen sc1
    v_mfma_f32_16x16x32_bf16 v[140:143], a[116:119], a[60:63], v[140:143]
    v_mfma_f32_16x16x32_bf16 v[140:143], a[112:115], a[56:59], v[140:143]
    s_waitcnt lgkmcnt(8)
    v_mfma_f32_16x16x32_bf16 v[144:147], a[120:123], a[32:35], v[144:147]
    s_add_u32 m0, s60, 32768
    ds_read_b64_tr_b16 a[104:105], v11 offset:8192
    ds_read_b64_tr_b16 a[106:107], v11 offset:10240
    v_mfma_f32_16x16x32_bf16 v[144:147], a[124:127], a[36:39], v[144:147]
    s_add_u32 s77, s66, 896
    buffer_load_dwordx4 v4, s[24:27], s77 offen lds
    v_mfma_f32_16x16x32_bf16 v[148:151], a[124:127], a[44:47], v[148:151]
    ds_read_b64_tr_b16 a[108:109], v11 offset:12288
    ds_read_b64_tr_b16 a[110:111], v11 offset:14336
    v_mfma_f32_16x16x32_bf16 v[148:151], a[120:123], a[40:43], v[148:151]
    v_mfma_f32_16x16x32_bf16 v[152:155], a[120:123], a[48:51], v[152:155]
    ds_read_b128 a[88:91], v8 offset:38912
    ds_read_b128 a[92:95], v9 offset:38912
    v_mfma_f32_16x16x32_bf16 v[152:155], a[124:127], a[52:55], v[152:155]
    v_mfma_f32_16x16x32_bf16 v[156:159], a[124:127], a[60:63], v[156:159]
    v_mfma_f32_16x16x32_bf16 v[156:159], a[120:123], a[56:59], v[156:159]
    s_waitcnt lgkmcnt(8)
    v_mfma_f32_16x16x32_bf16 v[176:179], a[96:99], a[32:35], v[176:179]
    s_add_u32 m0, s60, 33792
    ds_read_b64_tr_b16 a[112:113], v12 offset:8192
    ds_read_b64_tr_b16 a[114:115], v12 offset:10240
    v_mfma_f32_16x16x32_bf16 v[176:179], a[100:103], a[36:39], v[176:179]
    s_add_u32 s78, s66, 896
    buffer_load_dwordx4 v5, s[24:27], s78 offen lds
    v_mfma_f32_16x16x32_bf16 v[192:195], a[100:103], a[44:47], v[192:195]
    ds_read_b64_tr_b16 a[116:117], v12 offset:12288
    ds_read_b64_tr_b16 a[118:119], v12 offset:14336
    v_mfma_f32_16x16x32_bf16 v[192:195], a[96:99], a[40:43], v[192:195]
    v_mfma_f32_16x16x32_bf16 v[208:211], a[96:99], a[48:51], v[208:211]
    v_mfma_f32_16x16x32_bf16 v[208:211], a[100:103], a[52:55], v[208:211]
    s_add_u32 m0, s60, 34816
    v_mfma_f32_16x16x32_bf16 v[224:227], a[100:103], a[60:63], v[224:227]
    s_add_u32 s79, s67, 896
    buffer_load_dwordx4 v4, s[24:27], s79 offen lds
    v_mfma_f32_16x16x32_bf16 v[224:227], a[96:99], a[56:59], v[224:227]
    s_waitcnt lgkmcnt(6)
    v_mfma_f32_16x16x32_bf16 v[32:35], a[104:107], a[32:35], v[32:35]
    ds_read_b64_tr_b16 a[120:121], v13 offset:8192
    ds_read_b64_tr_b16 a[122:123], v13 offset:10240
    v_mfma_f32_16x16x32_bf16 v[32:35], a[108:111], a[36:39], v[32:35]
    v_mfma_f32_16x16x32_bf16 v[48:51], a[108:111], a[44:47], v[48:51]
    ds_read_b64_tr_b16 a[124:125], v13 offset:12288
    ds_read_b64_tr_b16 a[126:127], v13 offset:14336
    v_mfma_f32_16x16x32_bf16 v[48:51], a[104:107], a[40:43], v[48:51]
    s_add_u32 s75, s101, 20480
    buffer_store_dwordx4 v[160:163], v1, s[8:11], s75 offen sc1
    v_mfma_f32_16x16x32_bf16 v[64:67], a[104:107], a[48:51], v[64:67]
    s_add_u32 m0, s60, 35840
    v_mfma_f32_16x16x32_bf16 v[64:67], a[108:111], a[52:55], v[64:67]
    s_add_u32 s76, s67, 896
    buffer_load_dwordx4 v5, s[24:27], s76 offen lds
    v_mfma_f32_16x16x32_bf16 v[80:83], a[108:111], a[60:63], v[80:83]
    v_mfma_f32_16x16x32_bf16 v[80:83], a[104:107], a[56:59], v[80:83]
    s_waitcnt lgkmcnt(4)
    v_mfma_f32_16x16x32_bf16 v[180:183], a[112:115], a[32:35], v[180:183]
    ds_read_b64_tr_b16 a[96:97], v10 offset:16384
    ds_read_b64_tr_b16 a[98:99], v10 offset:18432
    v_mfma_f32_16x16x32_bf16 v[180:183], a[116:119], a[36:39], v[180:183]
    v_mfma_f32_16x16x32_bf16 v[196:199], a[116:119], a[44:47], v[196:199]
    ds_read_b64_tr_b16 a[100:101], v10 offset:20480
    ds_read_b64_tr_b16 a[102:103], v10 offset:22528
    v_mfma_f32_16x16x32_bf16 v[196:199], a[112:115], a[40:43], v[196:199]
    s_add_u32 m0, s60, 36864
    v_mfma_f32_16x16x32_bf16 v[212:215], a[112:115], a[48:51], v[212:215]
    s_add_u32 s77, s68, 896
    buffer_load_dwordx4 v4, s[24:27], s77 offen lds
    v_mfma_f32_16x16x32_bf16 v[212:215], a[116:119], a[52:55], v[212:215]
    v_mfma_f32_16x16x32_bf16 v[228:231], a[116:119], a[60:63], v[228:231]
    v_mfma_f32_16x16x32_bf16 v[228:231], a[112:115], a[56:59], v[228:231]
    s_waitcnt lgkmcnt(4)
    v_mfma_f32_16x16x32_bf16 v[36:39], a[120:123], a[32:35], v[36:39]
    ds_read_b64_tr_b16 a[104:105], v11 offset:16384
    ds_read_b64_tr_b16 a[106:107], v11 offset:18432
    v_mfma_f32_16x16x32_bf16 v[36:39], a[124:127], a[36:39], v[36:39]
    v_mfma_f32_16x16x32_bf16 v[52:55], a[124:127], a[44:47], v[52:55]
    s_add_u32 m0, s60, 37888
    ds_read_b64_tr_b16 a[108:109], v11 offset:20480
    ds_read_b64_tr_b16 a[110:111], v11 offset:22528
    v_mfma_f32_16x16x32_bf16 v[52:55], a[120:123], a[40:43], v[52:55]
    s_add_u32 s78, s68, 896
    buffer_load_dwordx4 v5, s[24:27], s78 offen lds
    v_mfma_f32_16x16x32_bf16 v[68:71], a[120:123], a[48:51], v[68:71]
    v_mfma_f32_16x16x32_bf16 v[68:71], a[124:127], a[52:55], v[68:71]
    v_mfma_f32_16x16x32_bf16 v[84:87], a[124:127], a[60:63], v[84:87]
    v_mfma_f32_16x16x32_bf16 v[84:87], a[120:123], a[56:59], v[84:87]
    s_waitcnt lgkmcnt(4)
    v_mfma_f32_16x16x32_bf16 v[184:187], a[96:99], a[32:35], v[184:187]
    ds_read_b64_tr_b16 a[112:113], v12 offset:16384
    ds_read_b64_tr_b16 a[114:115], v12 offset:18432
    v_mfma_f32_16x16x32_bf16 v[184:187], a[100:103], a[36:39], v[184:187]
    s_add_u32 s75, s101, 28672
    buffer_store_dwordx4 v[168:171], v1, s[8:11], s75 offen sc1
    v_mfma_f32_16x16x32_bf16 v[200:203], a[100:103], a[44:47], v[200:203]
    s_add_u32 m0, s60, 38912
    ds_read_b64_tr_b16 a[116:117], v12 offset:20480
    ds_read_b64_tr_b16 a[118:119], v12 offset:22528
    v_mfma_f32_16x16x32_bf16 v[200:203], a[96:99], a[40:43], v[200:203]
    s_add_u32 s79, s69, 896
    buffer_load_dwordx4 v4, s[24:27], s79 offen lds
    v_mfma_f32_16x16x32_bf16 v[216:219], a[96:99], a[48:51], v[216:219]
    v_mfma_f32_16x16x32_bf16 v[216:219], a[100:103], a[52:55], v[216:219]
    v_mfma_f32_16x16x32_bf16 v[232:235], a[100:103], a[60:63], v[232:235]
    v_mfma_f32_16x16x32_bf16 v[232:235], a[96:99], a[56:59], v[232:235]
    s_waitcnt lgkmcnt(4)
    v_mfma_f32_16x16x32_bf16 v[40:43], a[104:107], a[32:35], v[40:43]
    s_add_u32 m0, s60, 39936
    ds_read_b64_tr_b16 a[120:121], v13 offset:16384
    ds_read_b64_tr_b16 a[122:123], v13 offset:18432
    v_mfma_f32_16x16x32_bf16 v[40:43], a[108:111], a[36:39], v[40:43]
    s_add_u32 s76, s69, 896
    buffer_load_dwordx4 v5, s[24:27], s76 offen lds
    v_mfma_f32_16x16x32_bf16 v[56:59], a[108:111], a[44:47], v[56:59]
    ds_read_b64_tr_b16 a[124:125], v13 offset:20480
    ds_read_b64_tr_b16 a[126:127], v13 offset:22528
    v_mfma_f32_16x16x32_bf16 v[56:59], a[104:107], a[40:43], v[56:59]
    v_mfma_f32_16x16x32_bf16 v[72:75], a[104:107], a[48:51], v[72:75]
    v_add_u32 v10, 32768, v10
    v_add_u32 v11, 32768, v11
    v_mfma_f32_16x16x32_bf16 v[72:75], a[108:111], a[52:55], v[72:75]
    v_mfma_f32_16x16x32_bf16 v[88:91], a[108:111], a[60:63], v[88:91]
    v_add_u32 v12, 32768, v12
    v_add_u32 v13, 32768, v13
    v_mfma_f32_16x16x32_bf16 v[88:91], a[104:107], a[56:59], v[88:91]
    s_waitcnt vmcnt(29) lgkmcnt(0)
    s_barrier
    v_mfma_f32_16x16x32_bf16 v[188:191], a[112:115], a[32:35], v[188:191]
    s_add_u32 m0, s61, 0
    ds_read_b64_tr_b16 a[96:97], v10 offset:0
    ds_read_b64_tr_b16 a[98:99], v10 offset:2048
    v_mfma_f32_16x16x32_bf16 v[188:191], a[116:119], a[36:39], v[188:191]
    s_add_u32 s71, s71, s73
    buffer_load_dwordx4 v7, s[32:35], s71 offen lds
    v_mfma_f32_16x16x32_bf16 v[204:207], a[116:119], a[44:47], v[204:207]
    ds_read_b64_tr_b16 a[100:101], v10 offset:4096
    ds_read_b64_tr_b16 a[102:103], v10 offset:6144
    v_mfma_f32_16x16x32_bf16 v[204:207], a[112:115], a[40:43], v[204:207]
    v_mfma_f32_16x16x32_bf16 v[220:223], a[112:115], a[48:51], v[220:223]
    v_mfma_f32_16x16x32_bf16 v[220:223], a[116:119], a[52:55], v[220:223]
    s_add_u32 m0, s61, 8192
    v_mfma_f32_16x16x32_bf16 v[236:239], a[116:119], a[60:63], v[236:239]
    s_add_u32 s77, s70, 3670016
    buffer_load_dwordx4 v6, s[28:31], s77 offen lds
    v_mfma_f32_16x16x32_bf16 v[236:239], a[112:115], a[56:59], v[236:239]
    s_waitcnt lgkmcnt(4)
    v_mfma_f32_16x16x32_bf16 v[44:47], a[120:123], a[32:35], v[44:47]
    ds_read_b64_tr_b16 a[104:105], v11 offset:0
    ds_read_b64_tr_b16 a[106:107], v11 offset:2048
    v_mfma_f32_16x16x32_bf16 v[44:47], a[124:127], a[36:39], v[44:47]
    s_add_u32 s75, s101, 21504
    buffer_store_dwordx4 v[240:243], v1, s[8:11], s75 offen sc1
    v_mfma_f32_16x16x32_bf16 v[60:63], a[124:127], a[44:47], v[60:63]
    ds_read_b64_tr_b16 a[108:109], v11 offset:4096
    ds_read_b64_tr_b16 a[110:111], v11 offset:6144
    v_mfma_f32_16x16x32_bf16 v[60:63], a[120:123], a[40:43], v[60:63]
    v_mfma_f32_16x16x32_bf16 v[76:79], a[120:123], a[48:51], v[76:79]
    s_add_u32 m0, s61, 16384
    v_mfma_f32_16x16x32_bf16 v[76:79], a[124:127], a[52:55], v[76:79]
    s_add_u32 s79, s70, 3670144
    buffer_load_dwordx4 v6, s[28:31], s79 offen lds
    v_mfma_f32_16x16x32_bf16 v[92:95], a[124:127], a[60:63], v[92:95]
    v_mfma_f32_16x16x32_bf16 v[92:95], a[120:123], a[56:59], v[92:95]
    s_waitcnt lgkmcnt(4)
    v_mfma_f32_16x16x32_bf16 v[96:99], a[96:99], a[64:67], v[96:99]
    ds_read_b64_tr_b16 a[112:113], v12 offset:0
    ds_read_b64_tr_b16 a[114:115], v12 offset:2048
    v_mfma_f32_16x16x32_bf16 v[96:99], a[100:103], a[68:71], v[96:99]
    v_mfma_f32_16x16x32_bf16 v[100:103], a[100:103], a[76:79], v[100:103]
    ds_read_b64_tr_b16 a[116:117], v12 offset:4096
    ds_read_b64_tr_b16 a[118:119], v12 offset:6144
    v_mfma_f32_16x16x32_bf16 v[100:103], a[96:99], a[72:75], v[100:103]
    v_mfma_f32_16x16x32_bf16 v[104:107], a[96:99], a[80:83], v[104:107]
    s_waitcnt vmcnt(23)
    ds_read_b128 a[32:35], v8 offset:0
    ds_read_b128 a[36:39], v9 offset:0
    v_mfma_f32_16x16x32_bf16 v[104:107], a[100:103], a[84:87], v[104:107]
    s_add_u32 m0, s61, 2048
    v_mfma_f32_16x16x32_bf16 v[108:111], a[100:103], a[92:95], v[108:111]
    s_add_u32 s71, s71, s72
    buffer_load_dwordx4 v7, s[32:35], s71 offen lds
    v_mfma_f32_16x16x32_bf16 v[108:111], a[96:99], a[88:91], v[108:111]
    s_waitcnt lgkmcnt(6)
    v_mfma_f32_16x16x32_bf16 v[112:115], a[104:107], a[64:67], v[112:115]
    ds_read_b64_tr_b16 a[120:121], v13 offset:0
    ds_read_b64_tr_b16 a[122:123], v13 offset:2048
    v_mfma_f32_16x16x32_bf16 v[112:115], a[108:111], a[68:71], v[112:115]
    v_mfma_f32_16x16x32_bf16 v[116:119], a[108:111], a[76:79], v[116:119]
    s_add_u32 m0, s61, 10240
    ds_read_b64_tr_b16 a[124:125], v13 offset:4096
    ds_read_b64_tr_b16 a[126:127], v13 offset:6144
    v_mfma_f32_16x16x32_bf16 v[116:119], a[104:107], a[72:75], v[116:119]
pad6:
    s_cbranch_execz pad10
    s_add_u32 s78, s70, 3702784
    buffer_load_dwordx4 v6, s[28:31], s78 offen lds
    v_mfma_f32_16x16x32_bf16 v[120:123], a[104:107], a[80:83], v[120:123]
    ds_read_b128 a[40:43], v8 offset:2048
    ds_read_b128 a[44:47], v9 offset:2048
    v_mfma_f32_16x16x32_bf16 v[120:123], a[108:111], a[84:87], v[120:123]
    s_add_u32 s75, s101, 29696
    buffer_store_dwordx4 v[248:251], v1, s[8:11], s75 offen sc1
    v_mfma_f32_16x16x32_bf16 v[124:127], a[108:111], a[92:95], v[124:127]
    v_mfma_f32_16x16x32_bf16 v[124:127], a[104:107], a[88:91], v[124:127]
    s_waitcnt lgkmcnt(8)
    v_mfma_f32_16x16x32_bf16 v[128:131], a[112:115], a[64:67], v[128:131]
    ds_read_b64_tr_b16 a[96:97], v10 offset:8192
    ds_read_b64_tr_b16 a[98:99], v10 offset:10240
    v_mfma_f32_16x16x32_bf16 v[128:131], a[116:119], a[68:71], v[128:131]
    v_mfma_f32_16x16x32_bf16 v[132:135], a[116:119], a[76:79], v[132:135]
    s_add_u32 m0, s61, 18432
    ds_read_b64_tr_b16 a[100:101], v10 offset:12288
    ds_read_b64_tr_b16 a[102:103], v10 offset:14336
    v_mfma_f32_16x16x32_bf16 v[132:135], a[112:115], a[72:75], v[132:135]
    s_add_u32 s76, s70, 3702912
    buffer_load_dwordx4 v6, s[28:31], s76 offen lds
    v_mfma_f32_16x16x32_bf16 v[136:139], a[112:115], a[80:83], v[136:139]
    ds_read_b128 a[48:51], v8 offset:4096
    ds_read_b128 a[52:55], v9 offset:4096
    v_mfma_f32_16x16x32_bf16 v[136:139], a[116:119], a[84:87], v[136:139]
    v_mfma_f32_16x16x32_bf16 v[140:143], a[116:119], a[92:95], v[140:143]
    v_mfma_f32_16x16x32_bf16 v[140:143], a[112:115], a[88:91], v[140:143]
    s_waitcnt lgkmcnt(8)
    v_mfma_f32_16x16x32_bf16 v[144:147], a[120:123], a[64:67], v[144:147]
    s_add_u32 m0, s60, 0
    ds_read_b64_tr_b16 a[104:105], v11 offset:8192
    ds_read_b64_tr_b16 a[106:107], v11 offset:10240
    v_mfma_f32_16x16x32_bf16 v[144:147], a[124:127], a[68:71], v[144:147]
    s_add_u32 s77, s66, 1024
    buffer_load_dwordx4 v4, s[24:27], s77 offen lds
    v_mfma_f32_16x16x32_bf16 v[148:151], a[124:127], a[76:79], v[148:151]
    ds_read_b64_tr_b16 a[108:109], v11 offset:12288
    ds_read_b64_tr_b16 a[110:111], v11 offset:14336
    v_mfma_f32_16x16x32_bf16 v[148:151], a[120:123], a[72:75], v[148:151]
    v_mfma_f32_16x16x32_bf16 v[152:155], a[120:123], a[80:83], v[152:155]
    ds_read_b128 a[56:59], v8 offset:6144
    ds_read_b128 a[60:63], v9 offset:6144
    v_mfma_f32_16x16x32_bf16 v[152:155], a[124:127], a[84:87], v[152:155]
    v_mfma_f32_16x16x32_bf16 v[156:159], a[124:127], a[92:95], v[156:159]
    v_mfma_f32_16x16x32_bf16 v[156:159], a[120:123], a[88:91], v[156:159]
    s_waitcnt lgkmcnt(8)
    v_mfma_f32_16x16x32_bf16 v[176:179], a[96:99], a[64:67], v[176:179]
    s_add_u32 m0, s60, 1024
    ds_read_b64_tr_b16 a[112:113], v12 offset:8192
    ds_read_b64_tr_b16 a[114:115], v12 offset:10240
    v_mfma_f32_16x16x32_bf16 v[176:179], a[100:103], a[68:71], v[176:179]
    s_add_u32 s78, s66, 1024
    buffer_load_dwordx4 v5, s[24:27], s78 offen lds
    v_mfma_f32_16x16x32_bf16 v[192:195], a[100:103], a[76:79], v[192:195]
    ds_read_b64_tr_b16 a[116:117], v12 offset:12288
    ds_read_b64_tr_b16 a[118:119], v12 offset:14336
    v_mfma_f32_16x16x32_bf16 v[192:195], a[96:99], a[72:75], v[192:195]
    s_add_u32 s75, s101, 22528
    buffer_store_dwordx4 v[164:167], v1, s[8:11], s75 offen sc1
    v_mfma_f32_16x16x32_bf16 v[208:211], a[96:99], a[80:83], v[208:211]
    v_mfma_f32_16x16x32_bf16 v[208:211], a[100:103], a[84:87], v[208:211]
    s_add_u32 m0, s60, 2048
    v_mfma_f32_16x16x32_bf16 v[224:227], a[100:103], a[92:95], v[224:227]
    s_add_u32 s79, s67, 1024
    buffer_load_dwordx4 v4, s[24:27], s79 offen lds
    v_mfma_f32_16x16x32_bf16 v[224:227], a[96:99], a[88:91], v[224:227]
    s_waitcnt lgkmcnt(6)
    v_mfma_f32_16x16x32_bf16 v[32:35], a[104:107], a[64:67], v[32:35]
    ds_read_b64_tr_b16 a[120:121], v13 offset:8192
    ds_read_b64_tr_b16 a[122:123], v13 offset:10240
    v_mfma_f32_16x16x32_bf16 v[32:35], a[108:111], a[68:71], v[32:35]
    v_mfma_f32_16x16x32_bf16 v[48:51], a[108:111], a[76:79], v[48:51]
    ds_read_b64_tr_b16 a[124:125], v13 offset:12288
    ds_read_b64_tr_b16 a[126:127], v13 offset:14336
    v_mfma_f32_16x16x32_bf16 v[48:51], a[104:107], a[72:75], v[48:51]
    v_mfma_f32_16x16x32_bf16 v[64:67], a[104:107], a[80:83], v[64:67]
    s_add_u32 m0, s60, 3072
    v_mfma_f32_16x16x32_bf16 v[64:67], a[108:111], a[84:87], v[64:67]
    s_add_u32 s76, s67, 1024
    buffer_load_dwordx4 v5, s[24:27], s76 offen lds
    v_mfma_f32_16x16x32_bf16 v[80:83], a[108:111], a[92:95], v[80:83]
    v_mfma_f32_16x16x32_bf16 v[80:83], a[104:107], a[88:91], v[80:83]
    s_waitcnt lgkmcnt(4)
    v_mfma_f32_16x16x32_bf16 v[180:183], a[112:115], a[64:67], v[180:183]
    ds_read_b64_tr_b16 a[96:97], v10 offset:16384
    ds_read_b64_tr_b16 a[98:99], v10 offset:18432
    v_mfma_f32_16x16x32_bf16 v[180:183], a[116:119], a[68:71], v[180:183]
    v_mfma_f32_16x16x32_bf16 v[196:199], a[116:119], a[76:79], v[196:199]
    ds_read_b64_tr_b16 a[100:101], v10 offset:20480
    ds_read_b64_tr_b16 a[102:103], v10 offset:22528
    v_mfma_f32_16x16x32_bf16 v[196:199], a[112:115], a[72:75], v[196:199]
    s_add_u32 m0, s60, 4096
    v_mfma_f32_16x16x32_bf16 v[212:215], a[112:115], a[80:83], v[212:215]
    s_add_u32 s77, s68, 1024
    buffer_load_dwordx4 v4, s[24:27], s77 offen lds
    v_mfma_f32_16x16x32_bf16 v[212:215], a[116:119], a[84:87], v[212:215]
    v_mfma_f32_16x16x32_bf16 v[228:231], a[116:119], a[92:95], v[228:231]
    v_mfma_f32_16x16x32_bf16 v[228:231], a[112:115], a[88:91], v[228:231]
    s_waitcnt lgkmcnt(4)
    v_mfma_f32_16x16x32_bf16 v[36:39], a[120:123], a[64:67], v[36:39]
    ds_read_b64_tr_b16 a[104:105], v11 offset:16384
    ds_read_b64_tr_b16 a[106:107], v11 offset:18432
    v_mfma_f32_16x16x32_bf16 v[36:39], a[124:127], a[68:71], v[36:39]
    s_add_u32 s75, s101, 30720
    buffer_store_dwordx4 v[172:175], v1, s[8:11], s75 offen sc1
    v_mfma_f32_16x16x32_bf16 v[52:55], a[124:127], a[76:79], v[52:55]
    s_add_u32 m0, s60, 5120
    ds_read_b64_tr_b16 a[108:109], v11 offset:20480
    ds_read_b64_tr_b16 a[110:111], v11 offset:22528
    v_mfma_f32_16x16x32_bf16 v[52:55], a[120:123], a[72:75], v[52:55]
    s_add_u32 s78, s68, 1024
    buffer_load_dwordx4 v5, s[24:27], s78 offen lds
    v_mfma_f32_16x16x32_bf16 v[68:71], a[120:123], a[80:83], v[68:71]
    v_mfma_f32_16x16x32_bf16 v[68:71], a[124:127], a[84:87], v[68:71]
    v_mfma_f32_16x16x32_bf16 v[84:87], a[124:127], a[92:95], v[84:87]
    v_mfma_f32_16x16x32_bf16 v[84:87], a[120:123], a[88:91], v[84:87]
    s_waitcnt lgkmcnt(4)
    v_mfma_f32_16x16x32_bf16 v[184:187], a[96:99], a[64:67], v[184:187]
    ds_read_b64_tr_b16 a[112:113], v12 offset:16384
    ds_read_b64_tr_b16 a[114:115], v12 offset:18432
    v_mfma_f32_16x16x32_bf16 v[184:187], a[100:103], a[68:71], v[184:187]
    v_mfma_f32_16x16x32_bf16 v[200:203], a[100:103], a[76:79], v[200:203]
    s_add_u32 m0, s60, 6144
    ds_read_b64_tr_b16 a[116:117], v12 offset:20480
    ds_read_b64_tr_b16 a[118:119], v12 offset:22528
    v_mfma_f32_16x16x32_bf16 v[200:203], a[96:99], a[72:75], v[200:203]
    s_add_u32 s79, s69, 1024
    buffer_load_dwordx4 v4, s[24:27], s79 offen lds
    v_mfma_f32_16x16x32_bf16 v[216:219], a[96:99], a[80:83], v[216:219]
    v_mfma_f32_16x16x32_bf16 v[216:219], a[100:103], a[84:87], v[216:219]
    v_mfma_f32_16x16x32_bf16 v[232:235], a[100:103], a[92:95], v[232:235]
    v_mfma_f32_16x16x32_bf16 v[232:235], a[96:99], a[88:91], v[232:235]
    s_waitcnt lgkmcnt(4)
    v_mfma_f32_16x16x32_bf16 v[40:43], a[104:107], a[64:67], v[40:43]
    s_add_u32 m0, s60, 7168
    ds_read_b64_tr_b16 a[120:121], v13 offset:16384
    ds_read_b64_tr_b16 a[122:123], v13 offset:18432
    v_mfma_f32_16x16x32_bf16 v[40:43], a[108:111], a[68:71], v[40:43]
    s_add_u32 s76, s69, 1024
    buffer_load_dwordx4 v5, s[24:27], s76 offen lds
    v_mfma_f32_16x16x32_bf16 v[56:59], a[108:111], a[76:79], v[56:59]
    ds_read_b64_tr_b16 a[124:125], v13 offset:20480
    ds_read_b64_tr_b16 a[126:127], v13 offset:22528
    v_mfma_f32_16x16x32_bf16 v[56:59], a[104:107], a[72:75], v[56:59]
    v_mfma_f32_16x16x32_bf16 v[72:75], a[104:107], a[80:83], v[72:75]
    v_add_u32 v10, 32768, v10
    v_add_u32 v11, 32768, v11
    v_mfma_f32_16x16x32_bf16 v[72:75], a[108:111], a[84:87], v[72:75]
    v_mfma_f32_16x16x32_bf16 v[88:91], a[108:111], a[92:95], v[88:91]
    v_add_u32 v12, 32768, v12
    v_add_u32 v13, 32768, v13
    v_mfma_f32_16x16x32_bf16 v[88:91], a[104:107], a[88:91], v[88:91]
    s_waitcnt vmcnt(29) lgkmcnt(0)
    s_barrier
    v_mfma_f32_16x16x32_bf16 v[188:191], a[112:115], a[64:67], v[188:191]
    s_add_u32 m0, s61, 32768
    ds_read_b64_tr_b16 a[96:97], v10 offset:0
    ds_read_b64_tr_b16 a[98:99], v10 offset:2048
    v_mfma_f32_16x16x32_bf16 v[188:191], a[116:119], a[68:71], v[188:191]
    s_add_u32 s71, s71, s73
    buffer_load_dwordx4 v7, s[32:35], s71 offen lds
    v_mfma_f32_16x16x32_bf16 v[204:207], a[116:119], a[76:79], v[204:207]
    ds_read_b64_tr_b16 a[100:101], v10 offset:4096
    ds_read_b64_tr_b16 a[102:103], v10 offset:6144
    v_mfma_f32_16x16x32_bf16 v[204:207], a[112:115], a[72:75], v[204:207]
    s_add_u32 s75, s101, 23552
    buffer_store_dwordx4 v[244:247], v1, s[8:11], s75 offen sc1
    v_mfma_f32_16x16x32_bf16 v[220:223], a[112:115], a[80:83], v[220:223]
    v_mfma_f32_16x16x32_bf16 v[220:223], a[116:119], a[84:87], v[220:223]
    s_add_u32 m0, s61, 40960
    v_mfma_f32_16x16x32_bf16 v[236:239], a[116:119], a[92:95], v[236:239]
    s_add_u32 s77, s70, 4194304
    buffer_load_dwordx4 v6, s[28:31], s77 offen lds
    v_mfma_f32_16x16x32_bf16 v[236:239], a[112:115], a[88:91], v[236:239]
    s_waitcnt lgkmcnt(4)
    v_mfma_f32_16x16x32_bf16 v[44:47], a[120:123], a[64:67], v[44:47]
    ds_read_b64_tr_b16 a[104:105], v11 offset:0
    ds_read_b64_tr_b16 a[106:107], v11 offset:2048
    v_mfma_f32_16x16x32_bf16 v[44:47], a[124:127], a[68:71], v[44:47]
    v_mfma_f32_16x16x32_bf16 v[60:63], a[124:127], a[76:79], v[60:63]
    ds_read_b64_tr_b16 a[108:109], v11 offset:4096
    ds_read_b64_tr_b16 a[110:111], v11 offset:6144
    v_mfma_f32_16x16x32_bf16 v[60:63], a[120:123], a[72:75], v[60:63]
    v_mfma_f32_16x16x32_bf16 v[76:79], a[120:123], a[80:83], v[76:79]
    s_add_u32 m0, s61, 49152
    v_mfma_f32_16x16x32_bf16 v[76:79], a[124:127], a[84:87], v[76:79]
    s_add_u32 s79, s70, 4194432
    buffer_load_dwordx4 v6, s[28:31], s79 offen lds
    v_mfma_f32_16x16x32_bf16 v[92:95], a[124:127], a[92:95], v[92:95]
    v_mfma_f32_16x16x32_bf16 v[92:95], a[120:123], a[88:91], v[92:95]
    s_waitcnt lgkmcnt(4)
    v_mfma_f32_16x16x32_bf16 v[96:99], a[96:99], a[32:35], v[96:99]
    ds_read_b64_tr_b16 a[112:113], v12 offset:0
    ds_read_b64_tr_b16 a[114:115], v12 offset:2048
    v_mfma_f32_16x16x32_bf16 v[96:99], a[100:103], a[36:39], v[96:99]
    v_mfma_f32_16x16x32_bf16 v[100:103], a[100:103], a[44:47], v[100:103]
    ds_read_b64_tr_b16 a[116:117], v12 offset:4096
    ds_read_b64_tr_b16 a[118:119], v12 offset:6144
    v_mfma_f32_16x16x32_bf16 v[100:103], a[96:99], a[40:43], v[100:103]
    v_mfma_f32_16x16x32_bf16 v[104:107], a[96:99], a[48:51], v[104:107]
    s_waitcnt vmcnt(22)
    ds_read_b128 a[64:67], v8 offset:32768
    ds_read_b128 a[68:71], v9 offset:32768
    v_mfma_f32_16x16x32_bf16 v[104:107], a[100:103], a[52:55], v[104:107]
    s_add_u32 m0, s61, 34816
    v_mfma_f32_16x16x32_bf16 v[108:111], a[100:103], a[60:63], v[108:111]
    s_add_u32 s71, s71, s72
    buffer_load_dwordx4 v7, s[32:35], s71 offen lds
    v_mfma_f32_16x16x32_bf16 v[108:111], a[96:99], a[56:59], v[108:111]
    s_waitcnt lgkmcnt(6)
    v_mfma_f32_16x16x32_bf16 v[112:115], a[104:107], a[32:35], v[112:115]
    ds_read_b64_tr_b16 a[120:121], v13 offset:0
    ds_read_b64_tr_b16 a[122:123], v13 offset:2048
    v_mfma_f32_16x16x32_bf16 v[112:115], a[108:111], a[36:39], v[112:115]
    s_add_u32 s75, s101, 31744
    buffer_store_dwordx4 v[252:255], v1, s[8:11], s75 offen sc1
    v_mfma_f32_16x16x32_bf16 v[116:119], a[108:111], a[44:47], v[116:119]
    s_add_u32 m0, s61, 43008
    ds_read_b64_tr_b16 a[124:125], v13 offset:4096
    ds_read_b64_tr_b16 a[126:127], v13 offset:6144
    v_mfma_f32_16x16x32_bf16 v[116:119], a[104:107], a[40:43], v[116:119]
    s_add_u32 s78, s70, 4227072
    buffer_load_dwordx4 v6, s[28:31], s78 offen lds
    v_mfma_f32_16x16x32_bf16 v[120:123], a[104:107], a[48:51], v[120:123]
    ds_read_b128 a[72:75], v8 offset:34816
    ds_read_b128 a[76:79], v9 offset:34816
    v_mfma_f32_16x16x32_bf16 v[120:123], a[108:111], a[52:55], v[120:123]
    v_lshrrev_b32 v23, 4, v0
    v_lshlrev_b32 v23, 3, v23
    v_mfma_f32_16x16x32_bf16 v[124:127], a[108:111], a[60:63], v[124:127]
    v_mfma_f32_16x16x32_bf16 v[124:127], a[104:107], a[56:59], v[124:127]
    s_waitcnt lgkmcnt(8)
    v_mfma_f32_16x16x32_bf16 v[128:131], a[112:115], a[32:35], v[128:131]
    ds_read_b64_tr_b16 a[96:97], v10 offset:8192
    ds_read_b64_tr_b16 a[98:99], v10 offset:10240
    v_mfma_f32_16x16x32_bf16 v[128:131], a[116:119], a[36:39], v[128:131]
    s_lshl_b32 s75, s85, 22
    s_add_u32 s75, s75, s84
    s_lshl_b32 s75, s75, 7
    buffer_load_dwordx2 v[240:241], v23, s[44:47], s75 offen offset:0
    v_mfma_f32_16x16x32_bf16 v[132:135], a[116:119], a[44:47], v[132:135]
    s_add_u32 m0, s61, 51200
    ds_read_b64_tr_b16 a[100:101], v10 offset:12288
    ds_read_b64_tr_b16 a[102:103], v10 offset:14336
    v_mfma_f32_16x16x32_bf16 v[132:135], a[112:115], a[40:43], v[132:135]
    s_add_u32 s76, s70, 4227200
    buffer_load_dwordx4 v6, s[28:31], s76 offen lds
    v_mfma_f32_16x16x32_bf16 v[136:139], a[112:115], a[48:51], v[136:139]
    ds_read_b128 a[80:83], v8 offset:36864
    ds_read_b128 a[84:87], v9 offset:36864
    v_mfma_f32_16x16x32_bf16 v[136:139], a[116:119], a[52:55], v[136:139]
    s_lshl_b32 s75, s85, 22
    s_add_u32 s75, s75, s84
    s_lshl_b32 s75, s75, 7
    buffer_load_dwordx2 v[242:243], v23, s[44:47], s75 offen offset:32
    v_mfma_f32_16x16x32_bf16 v[140:143], a[116:119], a[60:63], v[140:143]
    v_mfma_f32_16x16x32_bf16 v[140:143], a[112:115], a[56:59], v[140:143]
    s_waitcnt lgkmcnt(8)
    v_mfma_f32_16x16x32_bf16 v[144:147], a[120:123], a[32:35], v[144:147]
    s_add_u32 m0, s60, 32768
    ds_read_b64_tr_b16 a[104:105], v11 offset:8192
    ds_read_b64_tr_b16 a[106:107], v11 offset:10240
    v_mfma_f32_16x16x32_bf16 v[144:147], a[124:127], a[36:39], v[144:147]
    s_add_u32 s77, s66, 1152
    buffer_load_dwordx4 v4, s[24:27], s77 offen lds
    v_mfma_f32_16x16x32_bf16 v[148:151], a[124:127], a[44:47], v[148:151]
    ds_read_b64_tr_b16 a[108:109], v11 offset:12288
    ds_read_b64_tr_b16 a[110:111], v11 offset:14336
    v_mfma_f32_16x16x32_bf16 v[148:151], a[120:123], a[40:43], v[148:151]
    s_lshl_b32 s75, s85, 22
    s_add_u32 s75, s75, s84
    s_lshl_b32 s75, s75, 7
    buffer_load_dwordx2 v[244:245], v23, s[44:47], s75 offen offset:64
    v_mfma_f32_16x16x32_bf16 v[152:155], a[120:123], a[48:51], v[152:155]
    ds_read_b128 a[88:91], v8 offset:38912
    ds_read_b128 a[92:95], v9 offset:38912
    v_mfma_f32_16x16x32_bf16 v[152:155], a[124:127], a[52:55], v[152:155]
    s_lshl_b32 s75, s85, 22
    s_add_u32 s75, s75, s84
    s_lshl_b32 s75, s75, 7
    buffer_load_dwordx2 v[246:247], v23, s[44:47], s75 offen offset:96
    v_mfma_f32_16x16x32_bf16 v[156:159], a[124:127], a[60:63], v[156:159]
    v_mfma_f32_16x16x32_bf16 v[156:159], a[120:123], a[56:59], v[156:159]
    s_waitcnt lgkmcnt(8)
    v_mfma_f32_16x16x32_bf16 v[176:179], a[96:99], a[32:35], v[176:179]
    s_add_u32 m0, s60, 33792
    ds_read_b64_tr_b16 a[112:113], v12 offset:8192
    ds_read_b64_tr_b16 a[114:115], v12 offset:10240
    v_mfma_f32_16x16x32_bf16 v[176:179], a[100:103], a[36:39], v[176:179]
    s_add_u32 s78, s66, 1152
    buffer_load_dwordx4 v5, s[24:27], s78 offen lds
    v_mfma_f32_16x16x32_bf16 v[192:195], a[100:103], a[44:47], v[192:195]
    ds_read_b64_tr_b16 a[116:117], v12 offset:12288
    ds_read_b64_tr_b16 a[118:119], v12 offset:14336
    v_mfma_f32_16x16x32_bf16 v[192:195], a[96:99], a[40:43], v[192:195]
    v_mfma_f32_16x16x32_bf16 v[208:211], a[96:99], a[48:51], v[208:211]
    v_mfma_f32_16x16x32_bf16 v[208:211], a[100:103], a[52:55], v[208:211]
    s_add_u32 m0, s60, 34816
    v_mfma_f32_16x16x32_bf16 v[224:227], a[100:103], a[60:63], v[224:227]
    s_add_u32 s79, s67, 1152
    buffer_load_dwordx4 v4, s[24:27], s79 offen lds
    v_mfma_f32_16x16x32_bf16 v[224:227], a[96:99], a[56:59], v[224:227]
    s_waitcnt lgkmcnt(6)
    v_mfma_f32_16x16x32_bf16 v[32:35], a[104:107], a[32:35], v[32:35]
    ds_read_b64_tr_b16 a[120:121], v13 offset:8192
    ds_read_b64_tr_b16 a[122:123], v13 offset:10240
    v_mfma_f32_16x16x32_bf16 v[32:35], a[108:111], a[36:39], v[32:35]
    v_mfma_f32_16x16x32_bf16 v[48:51], a[108:111], a[44:47], v[48:51]
    ds_read_b64_tr_b16 a[124:125], v13 offset:12288
    ds_read_b64_tr_b16 a[126:127], v13 offset:14336
    v_mfma_f32_16x16x32_bf16 v[48:51], a[104:107], a[40:43], v[48:51]
    v_mfma_f32_16x16x32_bf16 v[64:67], a[104:107], a[48:51], v[64:67]
    s_add_u32 m0, s60, 35840
    v_mfma_f32_16x16x32_bf16 v[64:67], a[108:111], a[52:55], v[64:67]
    s_add_u32 s76, s67, 1152
    buffer_load_dwordx4 v5, s[24:27], s76 offen lds
    v_mfma_f32_16x16x32_bf16 v[80:83], a[108:111], a[60:63], v[80:83]
    v_mfma_f32_16x16x32_bf16 v[80:83], a[104:107], a[56:59], v[80:83]
    s_waitcnt lgkmcnt(4)
    v_mfma_f32_16x16x32_bf16 v[180:183], a[112:115], a[32:35], v[180:183]
    ds_read_b64_tr_b16 a[96:97], v10 offset:16384
    ds_read_b64_tr_b16 a[98:99], v10 offset:18432
    v_mfma_f32_16x16x32_bf16 v[180:183], a[116:119], a[36:39], v[180:183]
    v_mfma_f32_16x16x32_bf16 v[196:199], a[116:119], a[44:47], v[196:199]
    ds_read_b64_tr_b16 a[100:101], v10 offset:20480
    ds_read_b64_tr_b16 a[102:103], v10 offset:22528
    v_mfma_f32_16x16x32_bf16 v[196:199], a[112:115], a[40:43], v[196:199]
    s_add_u32 m0, s60, 36864
    v_mfma_f32_16x16x32_bf16 v[212:215], a[112:115], a[48:51], v[212:215]
    s_add_u32 s77, s68, 1152
    buffer_load_dwordx4 v4, s[24:27], s77 offen lds
    v_mfma_f32_16x16x32_bf16 v[212:215], a[116:119], a[52:55], v[212:215]
    v_mfma_f32_16x16x32_bf16 v[228:231], a[116:119], a[60:63], v[228:231]
    v_mfma_f32_16x16x32_bf16 v[228:231], a[112:115], a[56:59], v[228:231]
    s_waitcnt lgkmcnt(4)
    v_mfma_f32_16x16x32_bf16 v[36:39], a[120:123], a[32:35], v[36:39]
    ds_read_b64_tr_b16 a[104:105], v11 offset:16384
    ds_read_b64_tr_b16 a[106:107], v11 offset:18432
    v_mfma_f32_16x16x32_bf16 v[36:39], a[124:127], a[36:39], v[36:39]
    v_mfma_f32_16x16x32_bf16 v[52:55], a[124:127], a[44:47], v[52:55]
    s_add_u32 m0, s60, 37888
    ds_read_b64_tr_b16 a[108:109], v11 offset:20480
    ds_read_b64_tr_b16 a[110:111], v11 offset:22528
    v_mfma_f32_16x16x32_bf16 v[52:55], a[120:123], a[40:43], v[52:55]
    s_add_u32 s78, s68, 1152
    buffer_load_dwordx4 v5, s[24:27], s78 offen lds
    v_mfma_f32_16x16x32_bf16 v[68:71], a[120:123], a[48:51], v[68:71]
    v_mfma_f32_16x16x32_bf16 v[68:71], a[124:127], a[52:55], v[68:71]
    v_mfma_f32_16x16x32_bf16 v[84:87], a[124:127], a[60:63], v[84:87]
    v_mfma_f32_16x16x32_bf16 v[84:87], a[120:123], a[56:59], v[84:87]
    s_waitcnt lgkmcnt(4)
    v_mfma_f32_16x16x32_bf16 v[184:187], a[96:99], a[32:35], v[184:187]
    ds_read_b64_tr_b16 a[112:113], v12 offset:16384
    ds_read_b64_tr_b16 a[114:115], v12 offset:18432
    v_mfma_f32_16x16x32_bf16 v[184:187], a[100:103], a[36:39], v[184:187]
    v_mfma_f32_16x16x32_bf16 v[200:203], a[100:103], a[44:47], v[200:203]
    s_add_u32 m0, s60, 38912
    ds_read_b64_tr_b16 a[116:117], v12 offset:20480
    ds_read_b64_tr_b16 a[118:119], v12 offset:22528
    v_mfma_f32_16x16x32_bf16 v[200:203], a[96:99], a[40:43], v[200:203]
    s_add_u32 s79, s69, 1152
    buffer_load_dwordx4 v4, s[24:27], s79 offen lds
    v_mfma_f32_16x16x32_bf16 v[216:219], a[96:99], a[48:51], v[216:219]
    v_mfma_f32_16x16x32_bf16 v[216:219], a[100:103], a[52:55], v[216:219]
    v_mfma_f32_16x16x32_bf16 v[232:235], a[100:103], a[60:63], v[232:235]
    v_mfma_f32_16x16x32_bf16 v[232:235], a[96:99], a[56:59], v[232:235]
    s_waitcnt lgkmcnt(4)
    v_mfma_f32_16x16x32_bf16 v[40:43], a[104:107], a[32:35], v[40:43]
    s_add_u32 m0, s60, 39936
    ds_read_b64_tr_b16 a[120:121], v13 offset:16384
    ds_read_b64_tr_b16 a[122:123], v13 offset:18432
    v_mfma_f32_16x16x32_bf16 v[40:43], a[108:111], a[36:39], v[40:43]
    s_add_u32 s76, s69, 1152
    buffer_load_dwordx4 v5, s[24:27], s76 offen lds
    v_mfma_f32_16x16x32_bf16 v[56:59], a[108:111], a[44:47], v[56:59]
    ds_read_b64_tr_b16 a[124:125], v13 offset:20480
    ds_read_b64_tr_b16 a[126:127], v13 offset:22528
    v_mfma_f32_16x16x32_bf16 v[56:59], a[104:107], a[40:43], v[56:59]
    v_mfma_f32_16x16x32_bf16 v[72:75], a[104:107], a[48:51], v[72:75]
    v_add_u32 v10, 4294901760, v10
    v_add_u32 v11, 4294901760, v11
    v_mfma_f32_16x16x32_bf16 v[72:75], a[108:111], a[52:55], v[72:75]
    v_mfma_f32_16x16x32_bf16 v[88:91], a[108:111], a[60:63], v[88:91]
    v_add_u32 v12, 4294901760, v12
    v_add_u32 v13, 4294901760, v13
    v_mfma_f32_16x16x32_bf16 v[88:91], a[104:107], a[56:59], v[88:91]
    s_waitcnt vmcnt(14) lgkmcnt(0)
    s_barrier
    v_mfma_f32_16x16x32_bf16 v[188:191], a[112:115], a[32:35], v[188:191]
    s_add_u32 m0, s61, 65536
    ds_read_b64_tr_b16 a[96:97], v10 offset:0
    ds_read_b64_tr_b16 a[98:99], v10 offset:2048
    v_mfma_f32_16x16x32_bf16 v[188:191], a[116:119], a[36:39], v[188:191]
    s_add_u32 s71, s71, s73
    buffer_load_dwordx4 v7, s[32:35], s71 offen lds
    v_mfma_f32_16x16x32_bf16 v[204:207], a[116:119], a[44:47], v[204:207]
    ds_read_b64_tr_b16 a[100:101], v10 offset:4096
    ds_read_b64_tr_b16 a[102:103], v10 offset:6144
    v_mfma_f32_16x16x32_bf16 v[204:207], a[112:115], a[40:43], v[204:207]
    buffer_store_dword v20, off, s[8:11], s96 sc1
    v_mfma_f32_16x16x32_bf16 v[220:223], a[112:115], a[48:51], v[220:223]
    v_mfma_f32_16x16x32_bf16 v[220:223], a[116:119], a[52:55], v[220:223]
    s_add_u32 m0, s61, 73728
    v_mfma_f32_16x16x32_bf16 v[236:239], a[116:119], a[60:63], v[236:239]
    s_add_u32 s77, s70, 4718592
    buffer_load_dwordx4 v6, s[28:31], s77 offen lds
    v_mfma_f32_16x16x32_bf16 v[236:239], a[112:115], a[56:59], v[236:239]
    s_waitcnt lgkmcnt(4)
    v_mfma_f32_16x16x32_bf16 v[44:47], a[120:123], a[32:35], v[44:47]
    ds_read_b64_tr_b16 a[104:105], v11 offset:0
    ds_read_b64_tr_b16 a[106:107], v11 offset:2048
    v_mfma_f32_16x16x32_bf16 v[44:47], a[124:127], a[36:39], v[44:47]
    v_mfma_f32_16x16x32_bf16 v[60:63], a[124:127], a[44:47], v[60:63]
    ds_read_b64_tr_b16 a[108:109], v11 offset:4096
    ds_read_b64_tr_b16 a[110:111], v11 offset:6144
    v_mfma_f32_16x16x32_bf16 v[60:63], a[120:123], a[40:43], v[60:63]
    v_mfma_f32_16x16x32_bf16 v[76:79], a[120:123], a[48:51], v[76:79]
    s_add_u32 m0, s61, 81920
    v_mfma_f32_16x16x32_bf16 v[76:79], a[124:127], a[52:55], v[76:79]
    s_add_u32 s79, s70, 4718720
    buffer_load_dwordx4 v6, s[28:31], s79 offen lds
    v_mfma_f32_16x16x32_bf16 v[92:95], a[124:127], a[60:63], v[92:95]
    v_mfma_f32_16x16x32_bf16 v[92:95], a[120:123], a[56:59], v[92:95]
    s_waitcnt lgkmcnt(4)
    v_mfma_f32_16x16x32_bf16 v[96:99], a[96:99], a[64:67], v[96:99]
    ds_read_b64_tr_b16 a[112:113], v12 offset:0
    ds_read_b64_tr_b16 a[114:115], v12 offset:2048
    v_mfma_f32_16x16x32_bf16 v[96:99], a[100:103], a[68:71], v[96:99]
    v_mfma_f32_16x16x32_bf16 v[100:103], a[100:103], a[76:79], v[100:103]
    ds_read_b64_tr_b16 a[116:117], v12 offset:4096
    ds_read_b64_tr_b16 a[118:119], v12 offset:6144
    v_mfma_f32_16x16x32_bf16 v[100:103], a[96:99], a[72:75], v[100:103]
    v_mfma_f32_16x16x32_bf16 v[104:107], a[96:99], a[80:83], v[104:107]
    s_waitcnt vmcnt(24)
    ds_read_b128 a[32:35], v8 offset:0
    ds_read_b128 a[36:39], v9 offset:0
    v_mfma_f32_16x16x32_bf16 v[104:107], a[100:103], a[84:87], v[104:107]
    s_add_u32 m0, s61, 67584
    v_mfma_f32_16x16x32_bf16 v[108:111], a[100:103], a[92:95], v[108:111]
    s_add_u32 s71, s71, s72
    buffer_load_dwordx4 v7, s[32:35], s71 offen lds
    v_mfma_f32_16x16x32_bf16 v[108:111], a[96:99], a[88:91], v[108:111]
    s_waitcnt lgkmcnt(6)
    v_mfma_f32_16x16x32_bf16 v[112:115], a[104:107], a[64:67], v[112:115]
    ds_read_b64_tr_b16 a[120:121], v13 offset:0
    ds_read_b64_tr_b16 a[122:123], v13 offset:2048
    v_mfma_f32_16x16x32_bf16 v[112:115], a[108:111], a[68:71], v[112:115]
    v_mfma_f32_16x16x32_bf16 v[116:119], a[108:111], a[76:79], v[116:119]
    s_add_u32 m0, s61, 75776
    ds_read_b64_tr_b16 a[124:125], v13 offset:4096
    ds_read_b64_tr_b16 a[126:127], v13 offset:6144
    v_mfma_f32_16x16x32_bf16 v[116:119], a[104:107], a[72:75], v[116:119]
    s_add_u32 s78, s70, 4751360
    buffer_load_dwordx4 v6, s[28:31], s78 offen lds
    v_mfma_f32_16x16x32_bf16 v[120:123], a[104:107], a[80:83], v[120:123]
    ds_read_b128 a[40:43], v8 offset:2048
    ds_read_b128 a[44:47], v9 offset:2048
    v_mfma_f32_16x16x32_bf16 v[120:123], a[108:111], a[84:87], v[120:123]
    v_mfma_f32_16x16x32_bf16 v[124:127], a[108:111], a[92:95], v[124:127]
    v_mfma_f32_16x16x32_bf16 v[124:127], a[104:107], a[88:91], v[124:127]
    s_waitcnt lgkmcnt(8)
    v_mfma_f32_16x16x32_bf16 v[128:131], a[112:115], a[64:67], v[128:131]
    ds_read_b64_tr_b16 a[96:97], v10 offset:8192
    ds_read_b64_tr_b16 a[98:99], v10 offset:10240
    v_mfma_f32_16x16x32_bf16 v[128:131], a[116:119], a[68:71], v[128:131]
    v_mfma_f32_16x16x32_bf16 v[132:135], a[116:119], a[76:79], v[132:135]
    s_add_u32 m0, s61, 83968
    ds_read_b64_tr_b16 a[100:101], v10 offset:12288
    ds_read_b64_tr_b16 a[102:103], v10 offset:14336
    v_mfma_f32_16x16x32_bf16 v[132:135], a[112:115], a[72:75], v[132:135]
    s_add_u32 s76, s70, 4751488
    buffer_load_dwordx4 v6, s[28:31], s76 offen lds
    v_mfma_f32_16x16x32_bf16 v[136:139], a[112:115], a[80:83], v[136:139]
    s_and_b32 s96, s96, 4294967168
    ds_read_b128 a[48:51], v8 offset:4096
    ds_read_b128 a[52:55], v9 offset:4096
    v_mfma_f32_16x16x32_bf16 v[136:139], a[116:119], a[84:87], v[136:139]
    s_lshl_b32 s12, s7, 20
    v_and_b32 v26, 1, s6
    v_lshl_add_u32 v2, v26, 15, v1
    v_mfma_f32_16x16x32_bf16 v[140:143], a[116:119], a[92:95], v[140:143]
    s_lshl_b32 s17, s3, 12
    v_add_u32 v3, 65536, v2
    v_and_b32 v26, 15, v0
    v_mfma_f32_16x16x32_bf16 v[140:143], a[112:115], a[88:91], v[140:143]
    s_waitcnt lgkmcnt(8)
    v_lshrrev_b32 v27, 4, v0
    v_lshlrev_b32 v27, 2, v27
    v_mfma_f32_16x16x32_bf16 v[144:147], a[120:123], a[64:67], v[144:147]
    s_add_u32 s12, s12, s17
    ds_read_b64_tr_b16 a[104:105], v11 offset:8192
    ds_read_b64_tr_b16 a[106:107], v11 offset:10240
    v_mfma_f32_16x16x32_bf16 v[144:147], a[124:127], a[68:71], v[144:147]
    s_lshl_b32 s16, s6, 16
    v_sub_u32 v26, v26, v27
    v_lshl_add_u32 v27, s3, 4, v26
    v_mfma_f32_16x16x32_bf16 v[148:151], a[124:127], a[76:79], v[148:151]
    s_add_u32 s16, s16, s12
    ds_read_b64_tr_b16 a[108:109], v11 offset:12288
    ds_read_b64_tr_b16 a[110:111], v11 offset:14336
    v_mfma_f32_16x16x32_bf16 v[148:151], a[120:123], a[72:75], v[148:151]
    s_and_b32 s18, s6, 1
    v_mad_i32_i24 v28, s3, -16, v26
    v_add_u32 v28, 112, v28
    v_mfma_f32_16x16x32_bf16 v[152:155], a[120:123], a[80:83], v[152:155]
    s_lshl_b32 s18, s18, 15
    ds_read_b128 a[56:59], v8 offset:6144
    ds_read_b128 a[60:63], v9 offset:6144
    v_mfma_f32_16x16x32_bf16 v[152:155], a[124:127], a[84:87], v[152:155]
    s_add_u32 s17, s17, s18
    v_cvt_f32_i32 v27, v27
    v_cvt_f32_i32 v28, v28
    v_mfma_f32_16x16x32_bf16 v[156:159], a[124:127], a[92:95], v[156:159]
    s_mov_b32 s18, s17
    v_add_f32 v27, 0.5, v27
    v_add_f32 v28, 0.5, v28
    v_mfma_f32_16x16x32_bf16 v[156:159], a[120:123], a[88:91], v[156:159]
    s_waitcnt lgkmcnt(8)
    v_mul_f32 v4, 0x71800000, v27
    v_mul_f32 v5, 0x71800000, v28
    v_mfma_f32_16x16x32_bf16 v[176:179], a[96:99], a[64:67], v[176:179]
    s_mov_b32 s14, 0
    ds_read_b64_tr_b16 a[112:113], v12 offset:8192
    ds_read_b64_tr_b16 a[114:115], v12 offset:10240
    v_mfma_f32_16x16x32_bf16 v[176:179], a[100:103], a[68:71], v[176:179]
    s_lshl_b32 s15, s6, 1
    v_mov_b32 v252, s97
    v_and_b32 v26, 3, v0
    v_mfma_f32_16x16x32_bf16 v[192:195], a[100:103], a[76:79], v[192:195]
    s_add_u32 s15, s15, 2
    ds_read_b64_tr_b16 a[116:117], v12 offset:12288
    ds_read_b64_tr_b16 a[118:119], v12 offset:14336
    v_mfma_f32_16x16x32_bf16 v[192:195], a[96:99], a[72:75], v[192:195]
    s_mov_b32 s20, s6
    v_min_u32 v26, 1, v26
    v_subrev_u32 v26, 1, v26
    v_mfma_f32_16x16x32_bf16 v[208:211], a[96:99], a[80:83], v[208:211]
    s_mov_b32 s65, 84082688
    v_and_b32 v26, 0x3f803f80, v26
    v_accvgpr_write_b32 a240, v26
    v_mfma_f32_16x16x32_bf16 v[208:211], a[100:103], a[84:87], v[208:211]
    s_mov_b32 s19, s6
    v_accvgpr_write_b32 a241, v26
    v_accvgpr_write_b32 a242, v26
    v_mfma_f32_16x16x32_bf16 v[224:227], a[100:103], a[92:95], v[224:227]
    s_sub_u32 s69, s6, 1
    v_accvgpr_write_b32 a243, v26
    v_and_b32 v250, 15, v0
    v_mfma_f32_16x16x32_bf16 v[224:227], a[96:99], a[88:91], v[224:227]
pad7:
    s_cbranch_execz pad11
    s_waitcnt lgkmcnt(6)
    v_lshlrev_b32 v250, 2, v250
    v_and_b32 v251, 28, v250
    v_mfma_f32_16x16x32_bf16 v[32:35], a[104:107], a[64:67], v[32:35]
    s_add_u32 s24, s8, 58716160
    s_addc_u32 s25, s9, 0
    ds_read_b64_tr_b16 a[120:121], v13 offset:8192
    ds_read_b64_tr_b16 a[122:123], v13 offset:10240
    v_mfma_f32_16x16x32_bf16 v[32:35], a[108:111], a[68:71], v[32:35]
    s_mov_b32 s26, 7458816
    v_add_u32 v253, 61440, v1
    v_add_u32 v254, 122880, v1
    v_mfma_f32_16x16x32_bf16 v[48:51], a[108:111], a[76:79], v[48:51]
    s_mov_b32 s27, 0x20000
    ds_read_b64_tr_b16 a[124:125], v13 offset:12288
    ds_read_b64_tr_b16 a[126:127], v13 offset:14336
    v_mfma_f32_16x16x32_bf16 v[48:51], a[104:107], a[72:75], v[48:51]
    s_lshr_b32 s28, s4, 1
    v_mov_b32 v16, 0xbdd2d3e8
    v_mov_b32 v17, 0xbdd2d3e8
    v_mfma_f32_16x16x32_bf16 v[64:67], a[104:107], a[80:83], v[64:67]
    s_sub_u32 s76, 15, s6
    v_mov_b32 v18, 0xc0135761
    v_mov_b32 v19, 0xc0135761
    v_mfma_f32_16x16x32_bf16 v[64:67], a[108:111], a[84:87], v[64:67]
    s_bitcmp1_b32 s4, 0
    s_cselect_b32 s29, s76, s6
    s_cselect_b32 s58, s82, s80
    s_cselect_b32 s59, s83, s81
    v_mfma_f32_16x16x32_bf16 v[80:83], a[108:111], a[92:95], v[80:83]
    s_mul_i32 s30, s3, 5120
    v_mfma_f32_16x16x32_bf16 v[80:83], a[104:107], a[88:91], v[80:83]
    s_waitcnt lgkmcnt(4)
    v_mfma_f32_16x16x32_bf16 v[180:183], a[112:115], a[64:67], v[180:183]
    s_mul_i32 s76, s28, 14
    ds_read_b64_tr_b16 a[96:97], v10 offset:16384
    ds_read_b64_tr_b16 a[98:99], v10 offset:18432
    v_mfma_f32_16x16x32_bf16 v[180:183], a[116:119], a[68:71], v[180:183]
    s_lshr_b32 s77, s3, 1
    v_mfma_f32_16x16x32_bf16 v[196:199], a[116:119], a[76:79], v[196:199]
    s_add_u32 s76, s76, s77
    ds_read_b64_tr_b16 a[100:101], v10 offset:20480
    ds_read_b64_tr_b16 a[102:103], v10 offset:22528
    v_mfma_f32_16x16x32_bf16 v[196:199], a[112:115], a[72:75], v[196:199]
    s_lshl_b32 s76, s76, 2
    v_mfma_f32_16x16x32_bf16 v[212:215], a[112:115], a[80:83], v[212:215]
    s_add_u32 s76, s76, s5
    v_mfma_f32_16x16x32_bf16 v[212:215], a[116:119], a[84:87], v[212:215]
    s_mul_i32 s76, s76, 10240
    v_mfma_f32_16x16x32_bf16 v[228:231], a[116:119], a[92:95], v[228:231]
    s_add_u32 s76, s76, 5246976
    v_mfma_f32_16x16x32_bf16 v[228:231], a[112:115], a[88:91], v[228:231]
    s_waitcnt lgkmcnt(4)
    v_mfma_f32_16x16x32_bf16 v[36:39], a[120:123], a[64:67], v[36:39]
    s_mul_i32 s31, s28, 737280
    ds_read_b64_tr_b16 a[104:105], v11 offset:16384
    ds_read_b64_tr_b16 a[106:107], v11 offset:18432
    v_mfma_f32_16x16x32_bf16 v[36:39], a[124:127], a[68:71], v[36:39]
    s_sub_u32 s31, s31, 5242880
    v_mfma_f32_16x16x32_bf16 v[52:55], a[124:127], a[76:79], v[52:55]
    s_and_b32 s77, s3, 1
    ds_read_b64_tr_b16 a[108:109], v11 offset:20480
    ds_read_b64_tr_b16 a[110:111], v11 offset:22528
    v_mfma_f32_16x16x32_bf16 v[52:55], a[120:123], a[72:75], v[52:55]
    s_mul_i32 s77, s77, 5
    v_mfma_f32_16x16x32_bf16 v[68:71], a[120:123], a[80:83], v[68:71]
    s_add_u32 s78, s77, 0
    v_mfma_f32_16x16x32_bf16 v[68:71], a[124:127], a[84:87], v[68:71]
    s_lshl1_add_u32 s70, s28, s78
    v_mfma_f32_16x16x32_bf16 v[84:87], a[124:127], a[92:95], v[84:87]
    s_and_b32 s70, s70, 7
    v_mfma_f32_16x16x32_bf16 v[84:87], a[120:123], a[88:91], v[84:87]
    s_waitcnt lgkmcnt(4)
    v_mfma_f32_16x16x32_bf16 v[184:187], a[96:99], a[64:67], v[184:187]
    s_cmp_lt_u32 s78, 2
    s_cmov_b32 s70, 8
    ds_read_b64_tr_b16 a[112:113], v12 offset:16384
    ds_read_b64_tr_b16 a[114:115], v12 offset:18432
    v_mfma_f32_16x16x32_bf16 v[184:187], a[100:103], a[68:71], v[184:187]
    s_lshl_b32 s70, s70, 10
    v_mfma_f32_16x16x32_bf16 v[200:203], a[100:103], a[76:79], v[200:203]
    s_add_u32 s70, s70, s76
    ds_read_b64_tr_b16 a[116:117], v12 offset:20480
    ds_read_b64_tr_b16 a[118:119], v12 offset:22528
    v_mfma_f32_16x16x32_bf16 v[200:203], a[96:99], a[72:75], v[200:203]
    s_add_u32 s78, s77, 1
    v_mfma_f32_16x16x32_bf16 v[216:219], a[96:99], a[80:83], v[216:219]
    s_lshl1_add_u32 s71, s28, s78
    v_mfma_f32_16x16x32_bf16 v[216:219], a[100:103], a[84:87], v[216:219]
    s_and_b32 s71, s71, 7
    v_mfma_f32_16x16x32_bf16 v[232:235], a[100:103], a[92:95], v[232:235]
    s_cmp_lt_u32 s78, 2
    s_cmov_b32 s71, 9
    v_mfma_f32_16x16x32_bf16 v[232:235], a[96:99], a[88:91], v[232:235]
    s_waitcnt lgkmcnt(4)
    v_mfma_f32_16x16x32_bf16 v[40:43], a[104:107], a[64:67], v[40:43]
    s_lshl_b32 s71, s71, 10
    ds_read_b64_tr_b16 a[120:121], v13 offset:16384
    ds_read_b64_tr_b16 a[122:123], v13 offset:18432
    v_mfma_f32_16x16x32_bf16 v[40:43], a[108:111], a[68:71], v[40:43]
    s_add_u32 s71, s71, s76
    v_mfma_f32_16x16x32_bf16 v[56:59], a[108:111], a[76:79], v[56:59]
    s_add_u32 s78, s77, 2
    ds_read_b64_tr_b16 a[124:125], v13 offset:20480
    ds_read_b64_tr_b16 a[126:127], v13 offset:22528
    v_mfma_f32_16x16x32_bf16 v[56:59], a[104:107], a[72:75], v[56:59]
    s_lshl1_add_u32 s72, s28, s78
    v_mfma_f32_16x16x32_bf16 v[72:75], a[104:107], a[80:83], v[72:75]
    s_and_b32 s72, s72, 7
    v_add_u32 v10, 32768, v10
    v_add_u32 v11, 32768, v11
    v_mfma_f32_16x16x32_bf16 v[72:75], a[108:111], a[84:87], v[72:75]
    s_lshl_b32 s72, s72, 10
    v_mfma_f32_16x16x32_bf16 v[88:91], a[108:111], a[92:95], v[88:91]
    s_add_u32 s72, s72, s76
    v_add_u32 v12, 32768, v12
    v_add_u32 v13, 32768, v13
    v_mfma_f32_16x16x32_bf16 v[88:91], a[104:107], a[88:91], v[88:91]
    s_waitcnt vmcnt(18) lgkmcnt(0)
    s_barrier
    v_mfma_f32_16x16x32_bf16 v[188:191], a[112:115], a[64:67], v[188:191]
    s_add_u32 s78, s77, 3
    ds_read_b64_tr_b16 a[96:97], v10 offset:0
    ds_read_b64_tr_b16 a[98:99], v10 offset:2048
    v_mfma_f32_16x16x32_bf16 v[188:191], a[116:119], a[68:71], v[188:191]
    s_lshl1_add_u32 s73, s28, s78
    v_mfma_f32_16x16x32_bf16 v[204:207], a[116:119], a[76:79], v[204:207]
    s_and_b32 s73, s73, 7
    ds_read_b64_tr_b16 a[100:101], v10 offset:4096
    ds_read_b64_tr_b16 a[102:103], v10 offset:6144
    v_mfma_f32_16x16x32_bf16 v[204:207], a[112:115], a[72:75], v[204:207]
    s_lshl_b32 s73, s73, 10
    v_mfma_f32_16x16x32_bf16 v[220:223], a[112:115], a[80:83], v[220:223]
    s_add_u32 s73, s73, s76
    v_mfma_f32_16x16x32_bf16 v[220:223], a[116:119], a[84:87], v[220:223]
    s_add_u32 s78, s77, 4
    v_mfma_f32_16x16x32_bf16 v[236:239], a[116:119], a[92:95], v[236:239]
    s_lshl1_add_u32 s74, s28, s78
    v_mfma_f32_16x16x32_bf16 v[236:239], a[112:115], a[88:91], v[236:239]
    s_waitcnt lgkmcnt(4)
    v_mfma_f32_16x16x32_bf16 v[44:47], a[120:123], a[64:67], v[44:47]
    s_and_b32 s74, s74, 7
    ds_read_b64_tr_b16 a[104:105], v11 offset:0
    ds_read_b64_tr_b16 a[106:107], v11 offset:2048
    v_mfma_f32_16x16x32_bf16 v[44:47], a[124:127], a[68:71], v[44:47]
    s_lshl_b32 s74, s74, 10
    v_mfma_f32_16x16x32_bf16 v[60:63], a[124:127], a[76:79], v[60:63]
    s_add_u32 s74, s74, s76
    ds_read_b64_tr_b16 a[108:109], v11 offset:4096
    ds_read_b64_tr_b16 a[110:111], v11 offset:6144
    v_mfma_f32_16x16x32_bf16 v[60:63], a[120:123], a[72:75], v[60:63]
    s_mul_i32 s76, s28, 14336
    v_mfma_f32_16x16x32_bf16 v[76:79], a[120:123], a[80:83], v[76:79]
    s_add_u32 s76, s76, 50331648
    v_mfma_f32_16x16x32_bf16 v[76:79], a[124:127], a[84:87], v[76:79]
    s_lshl_b32 s77, s28, 15
    v_mfma_f32_16x16x32_bf16 v[92:95], a[124:127], a[92:95], v[92:95]
    s_add_u32 s77, s77, 33554432
    v_mfma_f32_16x16x32_bf16 v[92:95], a[120:123], a[88:91], v[92:95]
    s_waitcnt lgkmcnt(4)
    v_mfma_f32_16x16x32_bf16 v[96:99], a[96:99], a[32:35], v[96:99]
    s_mul_i32 s34, s58, 55296
    ds_read_b64_tr_b16 a[112:113], v12 offset:0
    ds_read_b64_tr_b16 a[114:115], v12 offset:2048
    v_mfma_f32_16x16x32_bf16 v[96:99], a[100:103], a[36:39], v[96:99]
    s_waitcnt vmcnt(14)
    v_lshlrev_b32 v160, 16, v240
    v_and_b32 v161, 0xffff0000, v240
    v_mfma_f32_16x16x32_bf16 v[100:103], a[100:103], a[44:47], v[100:103]
    s_add_u32 s34, s34, s76
    ds_read_b64_tr_b16 a[116:117], v12 offset:4096
    ds_read_b64_tr_b16 a[118:119], v12 offset:6144
    v_mfma_f32_16x16x32_bf16 v[100:103], a[96:99], a[40:43], v[100:103]
    s_lshl_b32 s44, s58, 17
    v_lshlrev_b32 v162, 16, v241
    v_and_b32 v163, 0xffff0000, v241
    v_mfma_f32_16x16x32_bf16 v[104:107], a[96:99], a[48:51], v[104:107]
    s_waitcnt vmcnt(7)
    ds_read_b128 a[64:67], v8 offset:32768
    ds_read_b128 a[68:71], v9 offset:32768
    v_mfma_f32_16x16x32_bf16 v[104:107], a[100:103], a[52:55], v[104:107]
    s_add_u32 s44, s44, s77
    v_lshlrev_b32 v164, 16, v242
    v_and_b32 v165, 0xffff0000, v242
    v_mfma_f32_16x16x32_bf16 v[108:111], a[100:103], a[60:63], v[108:111]
    s_lshl_b32 s56, s58, 6
    v_lshlrev_b32 v166, 16, v243
    v_and_b32 v167, 0xffff0000, v243
    v_mfma_f32_16x16x32_bf16 v[108:111], a[96:99], a[56:59], v[108:111]
    s_waitcnt lgkmcnt(6)
    v_lshlrev_b32 v168, 16, v244
    v_and_b32 v169, 0xffff0000, v244
    v_mfma_f32_16x16x32_bf16 v[112:115], a[104:107], a[32:35], v[112:115]
    s_add_u32 s56, s56, 67108864
    ds_read_b64_tr_b16 a[120:121], v13 offset:0
    ds_read_b64_tr_b16 a[122:123], v13 offset:2048
    v_mfma_f32_16x16x32_bf16 v[112:115], a[108:111], a[36:39], v[112:115]
    s_mul_i32 s35, s59, 55296
    v_lshlrev_b32 v170, 16, v245
    v_and_b32 v171, 0xffff0000, v245
    v_mfma_f32_16x16x32_bf16 v[116:119], a[108:111], a[44:47], v[116:119]
    s_add_u32 s35, s35, s76
    ds_read_b64_tr_b16 a[124:125], v13 offset:4096
    ds_read_b64_tr_b16 a[126:127], v13 offset:6144
    v_mfma_f32_16x16x32_bf16 v[116:119], a[104:107], a[40:43], v[116:119]
    s_lshl_b32 s45, s59, 17
    v_lshlrev_b32 v172, 16, v246
    v_and_b32 v173, 0xffff0000, v246
    v_mfma_f32_16x16x32_bf16 v[120:123], a[104:107], a[48:51], v[120:123]
    s_add_u32 s45, s45, s77
    ds_read_b128 a[72:75], v8 offset:34816
    ds_read_b128 a[76:79], v9 offset:34816
    v_mfma_f32_16x16x32_bf16 v[120:123], a[108:111], a[52:55], v[120:123]
    s_lshl_b32 s57, s59, 6
    v_lshlrev_b32 v174, 16, v247
    v_and_b32 v175, 0xffff0000, v247
    v_mfma_f32_16x16x32_bf16 v[124:127], a[108:111], a[60:63], v[124:127]
    s_add_u32 s57, s57, 67108864
    v_add_f32 v96, v96, v160
    v_add_f32 v97, v97, v161
    v_mfma_f32_16x16x32_bf16 v[124:127], a[104:107], a[56:59], v[124:127]
    s_waitcnt lgkmcnt(8)
    v_add_f32 v98, v98, v162
    v_add_f32 v99, v99, v163
    v_mfma_f32_16x16x32_bf16 v[128:131], a[112:115], a[32:35], v[128:131]
    s_cmp_eq_u32 s28, 3
    s_cselect_b32 s46, 536870912, s34
    s_cselect_b32 s47, 536870912, s35
    ds_read_b64_tr_b16 a[96:97], v10 offset:8192
    ds_read_b64_tr_b16 a[98:99], v10 offset:10240
    v_mfma_f32_16x16x32_bf16 v[128:131], a[116:119], a[36:39], v[128:131]
    s_lshl2_add_u32 s77, s29, s3
    v_add_f32 v100, v100, v160
    v_add_f32 v101, v101, v161
    v_mfma_f32_16x16x32_bf16 v[132:135], a[116:119], a[44:47], v[132:135]
    s_lshl2_add_u32 s77, s77, s28
    ds_read_b64_tr_b16 a[100:101], v10 offset:12288
    ds_read_b64_tr_b16 a[102:103], v10 offset:14336
    v_mfma_f32_16x16x32_bf16 v[132:135], a[112:115], a[40:43], v[132:135]
    s_lshl_b32 s77, s77, 5
    v_add_f32 v102, v102, v162
    v_add_f32 v103, v103, v163
    v_mfma_f32_16x16x32_bf16 v[136:139], a[112:115], a[48:51], v[136:139]
    s_add_u32 s98, s77, 83886080
    ds_read_b128 a[80:83], v8 offset:36864
    ds_read_b128 a[84:87], v9 offset:36864
    v_mfma_f32_16x16x32_bf16 v[136:139], a[116:119], a[52:55], v[136:139]
    s_lshl2_add_u32 s76, s29, s5
    v_add_f32 v104, v104, v160
    v_add_f32 v105, v105, v161
    v_mfma_f32_16x16x32_bf16 v[140:143], a[116:119], a[60:63], v[140:143]
    s_lshl2_add_u32 s76, s76, s3
    v_add_f32 v106, v106, v162
    v_add_f32 v107, v107, v163
    v_mfma_f32_16x16x32_bf16 v[140:143], a[112:115], a[56:59], v[140:143]
    s_waitcnt lgkmcnt(8)
    v_add_f32 v108, v108, v160
    v_add_f32 v109, v109, v161
    v_mfma_f32_16x16x32_bf16 v[144:147], a[120:123], a[32:35], v[144:147]
    s_mul_i32 s76, s76, 40960
    ds_read_b64_tr_b16 a[104:105], v11 offset:8192
    ds_read_b64_tr_b16 a[106:107], v11 offset:10240
    v_mfma_f32_16x16x32_bf16 v[144:147], a[124:127], a[36:39], v[144:147]
    s_add_u32 s33, s76, 68157440
    v_add_f32 v110, v110, v162
    v_add_f32 v111, v111, v163
    v_mfma_f32_16x16x32_bf16 v[148:151], a[124:127], a[44:47], v[148:151]
    ds_read_b64_tr_b16 a[108:109], v11 offset:12288
    ds_read_b64_tr_b16 a[110:111], v11 offset:14336
    v_mfma_f32_16x16x32_bf16 v[148:151], a[120:123], a[40:43], v[148:151]
    v_add_f32 v112, v112, v164
    v_add_f32 v113, v113, v165
    v_mfma_f32_16x16x32_bf16 v[152:155], a[120:123], a[48:51], v[152:155]
    ds_read_b128 a[88:91], v8 offset:38912
    ds_read_b128 a[92:95], v9 offset:38912
    v_mfma_f32_16x16x32_bf16 v[152:155], a[124:127], a[52:55], v[152:155]
    v_add_f32 v114, v114, v166
    v_add_f32 v115, v115, v167
    v_mfma_f32_16x16x32_bf16 v[156:159], a[124:127], a[60:63], v[156:159]
    v_add_f32 v116, v116, v164
    v_add_f32 v117, v117, v165
    v_mfma_f32_16x16x32_bf16 v[156:159], a[120:123], a[56:59], v[156:159]
    s_waitcnt lgkmcnt(8)
    v_add_f32 v118, v118, v166
    v_add_f32 v119, v119, v167
    v_mfma_f32_16x16x32_bf16 v[176:179], a[96:99], a[32:35], v[176:179]
    ds_read_b64_tr_b16 a[112:113], v12 offset:8192
    ds_read_b64_tr_b16 a[114:115], v12 offset:10240
    v_mfma_f32_16x16x32_bf16 v[176:179], a[100:103], a[36:39], v[176:179]
    v_add_f32 v120, v120, v164
    v_add_f32 v121, v121, v165
    v_mfma_f32_16x16x32_bf16 v[192:195], a[100:103], a[44:47], v[192:195]
    ds_read_b64_tr_b16 a[116:117], v12 offset:12288
    ds_read_b64_tr_b16 a[118:119], v12 offset:14336
    v_mfma_f32_16x16x32_bf16 v[192:195], a[96:99], a[40:43], v[192:195]
    v_add_f32 v122, v122, v166
    v_add_f32 v123, v123, v167
    v_mfma_f32_16x16x32_bf16 v[208:211], a[96:99], a[48:51], v[208:211]
    v_add_f32 v124, v124, v164
    v_add_f32 v125, v125, v165
    v_mfma_f32_16x16x32_bf16 v[208:211], a[100:103], a[52:55], v[208:211]
    v_add_f32 v126, v126, v166
    v_add_f32 v127, v127, v167
    v_mfma_f32_16x16x32_bf16 v[224:227], a[100:103], a[60:63], v[224:227]
    v_add_f32 v128, v128, v168
    v_add_f32 v129, v129, v169
    v_mfma_f32_16x16x32_bf16 v[224:227], a[96:99], a[56:59], v[224:227]
    s_waitcnt lgkmcnt(6)
    v_add_f32 v130, v130, v170
    v_add_f32 v131, v131, v171
    v_mfma_f32_16x16x32_bf16 v[32:35], a[104:107], a[32:35], v[32:35]
    ds_read_b64_tr_b16 a[120:121], v13 offset:8192
    ds_read_b64_tr_b16 a[122:123], v13 offset:10240
    v_mfma_f32_16x16x32_bf16 v[32:35], a[108:111], a[36:39], v[32:35]
    v_add_f32 v132, v132, v168
    v_add_f32 v133, v133, v169
    v_mfma_f32_16x16x32_bf16 v[48:51], a[108:111], a[44:47], v[48:51]
    ds_read_b64_tr_b16 a[124:125], v13 offset:12288
    ds_read_b64_tr_b16 a[126:127], v13 offset:14336
    v_mfma_f32_16x16x32_bf16 v[48:51], a[104:107], a[40:43], v[48:51]
    v_add_f32 v134, v134, v170
    v_add_f32 v135, v135, v171
    v_mfma_f32_16x16x32_bf16 v[64:67], a[104:107], a[48:51], v[64:67]
    v_add_f32 v136, v136, v168
    v_add_f32 v137, v137, v169
    v_mfma_f32_16x16x32_bf16 v[64:67], a[108:111], a[52:55], v[64:67]
    v_add_f32 v138, v138, v170
    v_add_f32 v139, v139, v171
    v_mfma_f32_16x16x32_bf16 v[80:83], a[108:111], a[60:63], v[80:83]
    v_add_f32 v140, v140, v168
    v_add_f32 v141, v141, v169
    v_mfma_f32_16x16x32_bf16 v[80:83], a[104:107], a[56:59], v[80:83]
    s_waitcnt lgkmcnt(4)
    v_add_f32 v142, v142, v170
    v_add_f32 v143, v143, v171
    v_mfma_f32_16x16x32_bf16 v[180:183], a[112:115], a[32:35], v[180:183]
    ds_read_b64_tr_b16 a[96:97], v10 offset:16384
    ds_read_b64_tr_b16 a[98:99], v10 offset:18432
    v_mfma_f32_16x16x32_bf16 v[180:183], a[116:119], a[36:39], v[180:183]
    v_add_f32 v144, v144, v172
    v_add_f32 v145, v145, v173
    v_mfma_f32_16x16x32_bf16 v[196:199], a[116:119], a[44:47], v[196:199]
    ds_read_b64_tr_b16 a[100:101], v10 offset:20480
    ds_read_b64_tr_b16 a[102:103], v10 offset:22528
    v_mfma_f32_16x16x32_bf16 v[196:199], a[112:115], a[40:43], v[196:199]
    v_add_f32 v146, v146, v174
    v_add_f32 v147, v147, v175
    v_mfma_f32_16x16x32_bf16 v[212:215], a[112:115], a[48:51], v[212:215]
    v_add_f32 v148, v148, v172
    v_add_f32 v149, v149, v173
    v_mfma_f32_16x16x32_bf16 v[212:215], a[116:119], a[52:55], v[212:215]
    v_add_f32 v150, v150, v174
    v_add_f32 v151, v151, v175
    v_mfma_f32_16x16x32_bf16 v[228:231], a[116:119], a[60:63], v[228:231]
    v_add_f32 v152, v152, v172
    v_add_f32 v153, v153, v173
    v_mfma_f32_16x16x32_bf16 v[228:231], a[112:115], a[56:59], v[228:231]
    s_waitcnt lgkmcnt(4)
    v_add_f32 v154, v154, v174
    v_add_f32 v155, v155, v175
    v_mfma_f32_16x16x32_bf16 v[36:39], a[120:123], a[32:35], v[36:39]
    ds_read_b64_tr_b16 a[104:105], v11 offset:16384
    ds_read_b64_tr_b16 a[106:107], v11 offset:18432
    v_mfma_f32_16x16x32_bf16 v[36:39], a[124:127], a[36:39], v[36:39]
    v_add_f32 v156, v156, v172
    v_add_f32 v157, v157, v173
    v_mfma_f32_16x16x32_bf16 v[52:55], a[124:127], a[44:47], v[52:55]
    ds_read_b64_tr_b16 a[108:109], v11 offset:20480
    ds_read_b64_tr_b16 a[110:111], v11 offset:22528
    v_mfma_f32_16x16x32_bf16 v[52:55], a[120:123], a[40:43], v[52:55]
    v_add_f32 v158, v158, v174
    v_add_f32 v159, v159, v175
    v_mfma_f32_16x16x32_bf16 v[68:71], a[120:123], a[48:51], v[68:71]
    buffer_load_dword v22, v21, s[8:11], s96 offen sc1
    v_mfma_f32_16x16x32_bf16 v[68:71], a[124:127], a[52:55], v[68:71]
    v_mfma_f32_16x16x32_bf16 v[84:87], a[124:127], a[60:63], v[84:87]
    v_mfma_f32_16x16x32_bf16 v[84:87], a[120:123], a[56:59], v[84:87]
    s_waitcnt lgkmcnt(4)
    v_mfma_f32_16x16x32_bf16 v[184:187], a[96:99], a[32:35], v[184:187]
    ds_read_b64_tr_b16 a[112:113], v12 offset:16384
    ds_read_b64_tr_b16 a[114:115], v12 offset:18432
    v_mfma_f32_16x16x32_bf16 v[184:187], a[100:103], a[36:39], v[184:187]
    v_mfma_f32_16x16x32_bf16 v[200:203], a[100:103], a[44:47], v[200:203]
    ds_read_b64_tr_b16 a[116:117], v12 offset:20480
    ds_read_b64_tr_b16 a[118:119], v12 offset:22528
    v_mfma_f32_16x16x32_bf16 v[200:203], a[96:99], a[40:43], v[200:203]
    v_mfma_f32_16x16x32_bf16 v[216:219], a[96:99], a[48:51], v[216:219]
    v_mfma_f32_16x16x32_bf16 v[216:219], a[100:103], a[52:55], v[216:219]
    v_mfma_f32_16x16x32_bf16 v[232:235], a[100:103], a[60:63], v[232:235]
    v_mfma_f32_16x16x32_bf16 v[232:235], a[96:99], a[56:59], v[232:235]
    s_waitcnt lgkmcnt(4)
    v_mfma_f32_16x16x32_bf16 v[40:43], a[104:107], a[32:35], v[40:43]
    ds_read_b64_tr_b16 a[120:121], v13 offset:16384
    ds_read_b64_tr_b16 a[122:123], v13 offset:18432
    v_mfma_f32_16x16x32_bf16 v[40:43], a[108:111], a[36:39], v[40:43]
    v_mfma_f32_16x16x32_bf16 v[56:59], a[108:111], a[44:47], v[56:59]
    ds_read_b64_tr_b16 a[124:125], v13 offset:20480
    ds_read_b64_tr_b16 a[126:127], v13 offset:22528
    v_mfma_f32_16x16x32_bf16 v[56:59], a[104:107], a[40:43], v[56:59]
    v_mfma_f32_16x16x32_bf16 v[72:75], a[104:107], a[48:51], v[72:75]
    v_add_u32 v10, 32768, v10
    v_add_u32 v11, 32768, v11
    v_mfma_f32_16x16x32_bf16 v[72:75], a[108:111], a[52:55], v[72:75]
    v_mfma_f32_16x16x32_bf16 v[88:91], a[108:111], a[60:63], v[88:91]
    v_add_u32 v12, 32768, v12
    v_add_u32 v13, 32768, v13
    v_mfma_f32_16x16x32_bf16 v[88:91], a[104:107], a[56:59], v[88:91]
    s_waitcnt vmcnt(1) lgkmcnt(0)
    s_barrier
    v_mfma_f32_16x16x32_bf16 v[188:191], a[112:115], a[32:35], v[188:191]
    ds_read_b64_tr_b16 a[96:97], v10 offset:0
    ds_read_b64_tr_b16 a[98:99], v10 offset:2048
    v_mfma_f32_16x16x32_bf16 v[188:191], a[116:119], a[36:39], v[188:191]
    v_mfma_f32_16x16x32_bf16 v[204:207], a[116:119], a[44:47], v[204:207]
    ds_read_b64_tr_b16 a[100:101], v10 offset:4096
    ds_read_b64_tr_b16 a[102:103], v10 offset:6144
    v_mfma_f32_16x16x32_bf16 v[204:207], a[112:115], a[40:43], v[204:207]
    v_mfma_f32_16x16x32_bf16 v[220:223], a[112:115], a[48:51], v[220:223]
    s_waitcnt vmcnt(0)
    v_xor_b32 v22, s97, v22
    v_cmp_eq_u32 vcc, 0, v22
    s_or_b64 vcc, vcc, s[86:87]
    s_cmp_eq_u64 vcc, -1
    s_cbranch_scc0 spin0
spin0_ok:
    s_barrier
    v_mfma_f32_16x16x32_bf16 v[220:223], a[116:119], a[52:55], v[220:223]
    v_mfma_f32_16x16x32_bf16 v[236:239], a[116:119], a[60:63], v[236:239]
    v_mfma_f32_16x16x32_bf16 v[236:239], a[112:115], a[56:59], v[236:239]
    s_waitcnt lgkmcnt(4)
    v_mfma_f32_16x16x32_bf16 v[44:47], a[120:123], a[32:35], v[44:47]
    s_mov_b32 m0, s17
    ds_read_b64_tr_b16 a[104:105], v11 offset:0
    ds_read_b64_tr_b16 a[106:107], v11 offset:2048
    v_mfma_f32_16x16x32_bf16 v[44:47], a[124:127], a[36:39], v[44:47]
    buffer_load_dwordx4 v1, s[8:11], s12 offen offset:0 sc1 lds
    v_mfma_f32_16x16x32_bf16 v[60:63], a[124:127], a[44:47], v[60:63]
    ds_read_b64_tr_b16 a[108:109], v11 offset:4096
    ds_read_b64_tr_b16 a[110:111], v11 offset:6144
    v_mfma_f32_16x16x32_bf16 v[60:63], a[120:123], a[40:43], v[60:63]
    buffer_load_dwordx4 v1, s[8:11], s12 offen offset:1024 sc1 lds
    v_mfma_f32_16x16x32_bf16 v[76:79], a[120:123], a[48:51], v[76:79]
    v_mfma_f32_16x16x32_bf16 v[76:79], a[124:127], a[52:55], v[76:79]
    buffer_load_dwordx4 v1, s[8:11], s12 offen offset:2048 sc1 lds
    v_mfma_f32_16x16x32_bf16 v[92:95], a[124:127], a[60:63], v[92:95]
    v_mfma_f32_16x16x32_bf16 v[92:95], a[120:123], a[56:59], v[92:95]
    s_waitcnt lgkmcnt(4)
    v_mfma_f32_16x16x32_bf16 v[96:99], a[96:99], a[64:67], v[96:99]
    s_lshl_b32 s75, s84, 11
    ds_read_b64_tr_b16 a[112:113], v12 offset:0
    ds_read_b64_tr_b16 a[114:115], v12 offset:2048
    v_mfma_f32_16x16x32_bf16 v[96:99], a[100:103], a[68:71], v[96:99]
    s_add_u32 s75, s75, 50331648
    buffer_load_dwordx4 v1, s[8:11], s12 offen offset:3072 sc1 lds
    v_mfma_f32_16x16x32_bf16 v[100:103], a[100:103], a[76:79], v[100:103]
    s_add_u32 s17, s17, 16384
    ds_read_b64_tr_b16 a[116:117], v12 offset:4096
    ds_read_b64_tr_b16 a[118:119], v12 offset:6144
    v_mfma_f32_16x16x32_bf16 v[100:103], a[96:99], a[72:75], v[100:103]
    s_and_b32 s17, s17, 0xffff
    v_mfma_f32_16x16x32_bf16 v[104:107], a[96:99], a[80:83], v[104:107]
    s_add_u32 s62, s12, 16384
    v_mfma_f32_16x16x32_bf16 v[104:107], a[100:103], a[84:87], v[104:107]
    s_add_u32 s12, s12, 32768
    v_mfma_f32_16x16x32_bf16 v[108:111], a[100:103], a[92:95], v[108:111]
    s_add_u32 s14, s14, 1
    v_mfma_f32_16x16x32_bf16 v[108:111], a[96:99], a[88:91], v[108:111]
    s_waitcnt lgkmcnt(4)
    v_mfma_f32_16x16x32_bf16 v[112:115], a[104:107], a[64:67], v[112:115]
    s_cmp_eq_u32 s14, s15
    s_cselect_b32 s12, s16, s12
    ds_read_b64_tr_b16 a[120:121], v13 offset:0
    ds_read_b64_tr_b16 a[122:123], v13 offset:2048
    v_mfma_f32_16x16x32_bf16 v[112:115], a[108:111], a[68:71], v[112:115]
    s_mov_b32 s13, s62
    v_mfma_f32_16x16x32_bf16 v[116:119], a[108:111], a[76:79], v[116:119]
    s_mov_b32 m0, s17
    ds_read_b64_tr_b16 a[124:125], v13 offset:4096
    ds_read_b64_tr_b16 a[126:127], v13 offset:6144
    v_mfma_f32_16x16x32_bf16 v[116:119], a[104:107], a[72:75], v[116:119]
    s_mul_i32 s76, s80, 55296
    buffer_load_dwordx4 v1, s[8:11], s12 offen offset:0 sc1 lds
    v_mfma_f32_16x16x32_bf16 v[120:123], a[104:107], a[80:83], v[120:123]
    s_add_u32 s76, s76, s75
    v_mfma_f32_16x16x32_bf16 v[120:123], a[108:111], a[84:87], v[120:123]
    s_mul_i32 s77, s81, 55296
    buffer_load_dwordx4 v1, s[8:11], s12 offen offset:1024 sc1 lds
    v_mfma_f32_16x16x32_bf16 v[124:127], a[108:111], a[92:95], v[124:127]
    s_add_u32 s77, s77, s75
    v_mfma_f32_16x16x32_bf16 v[124:127], a[104:107], a[88:91], v[124:127]
    s_waitcnt lgkmcnt(4)
    v_mfma_f32_16x16x32_bf16 v[128:131], a[112:115], a[64:67], v[128:131]
    s_mul_i32 s78, s82, 55296
    ds_read_b64_tr_b16 a[96:97], v10 offset:8192
    ds_read_b64_tr_b16 a[98:99], v10 offset:10240
    v_mfma_f32_16x16x32_bf16 v[128:131], a[116:119], a[68:71], v[128:131]
    s_add_u32 s78, s78, s75
    buffer_load_dwordx4 v1, s[8:11], s12 offen offset:2048 sc1 lds
    v_mfma_f32_16x16x32_bf16 v[132:135], a[116:119], a[76:79], v[132:135]
    s_mul_i32 s79, s83, 55296
    ds_read_b64_tr_b16 a[100:101], v10 offset:12288
    ds_read_b64_tr_b16 a[102:103], v10 offset:14336
    v_mfma_f32_16x16x32_bf16 v[132:135], a[112:115], a[72:75], v[132:135]
    s_add_u32 s79, s79, s75
    buffer_load_dwordx4 v1, s[8:11], s12 offen offset:3072 sc1 lds
    v_mfma_f32_16x16x32_bf16 v[136:139], a[112:115], a[80:83], v[136:139]
    s_add_u32 s17, s17, 16384
    v_mfma_f32_16x16x32_bf16 v[136:139], a[116:119], a[84:87], v[136:139]
    s_and_b32 s17, s17, 0xffff
    v_mfma_f32_16x16x32_bf16 v[140:143], a[116:119], a[92:95], v[140:143]
    v_mfma_f32_16x16x32_bf16 v[140:143], a[112:115], a[88:91], v[140:143]
    s_waitcnt lgkmcnt(4)
    v_mfma_f32_16x16x32_bf16 v[144:147], a[120:123], a[64:67], v[144:147]
    s_add_u32 m0, s18, 65536
    ds_read_b64_tr_b16 a[104:105], v11 offset:8192
    ds_read_b64_tr_b16 a[106:107], v11 offset:10240
    v_mfma_f32_16x16x32_bf16 v[144:147], a[124:127], a[68:71], v[144:147]
    buffer_load_dwordx4 v1, s[8:11], s13 offen offset:0 sc1 lds
    v_mfma_f32_16x16x32_bf16 v[148:151], a[124:127], a[76:79], v[148:151]
    ds_read_b64_tr_b16 a[108:109], v11 offset:12288
    ds_read_b64_tr_b16 a[110:111], v11 offset:14336
    v_mfma_f32_16x16x32_bf16 v[148:151], a[120:123], a[72:75], v[148:151]
    buffer_load_dwordx4 v1, s[8:11], s13 offen offset:1024 sc1 lds
    v_mfma_f32_16x16x32_bf16 v[152:155], a[120:123], a[80:83], v[152:155]
    v_mfma_f32_16x16x32_bf16 v[152:155], a[124:127], a[84:87], v[152:155]
    buffer_load_dwordx4 v1, s[8:11], s13 offen offset:2048 sc1 lds
    v_mfma_f32_16x16x32_bf16 v[156:159], a[124:127], a[92:95], v[156:159]
    v_mfma_f32_16x16x32_bf16 v[156:159], a[120:123], a[88:91], v[156:159]
    s_waitcnt lgkmcnt(4)
    v_mfma_f32_16x16x32_bf16 v[176:179], a[96:99], a[64:67], v[176:179]
    ds_read_b64_tr_b16 a[112:113], v12 offset:8192
    ds_read_b64_tr_b16 a[114:115], v12 offset:10240
    v_mfma_f32_16x16x32_bf16 v[176:179], a[100:103], a[68:71], v[176:179]
    buffer_load_dwordx4 v1, s[8:11], s13 offen offset:3072 sc1 lds
    v_mfma_f32_16x16x32_bf16 v[192:195], a[100:103], a[76:79], v[192:195]
    s_add_u32 s18, s18, 16384
    ds_read_b64_tr_b16 a[116:117], v12 offset:12288
    ds_read_b64_tr_b16 a[118:119], v12 offset:14336
    v_mfma_f32_16x16x32_bf16 v[192:195], a[96:99], a[72:75], v[192:195]
    s_and_b32 s18, s18, 0xffff
    v_mfma_f32_16x16x32_bf16 v[208:211], a[96:99], a[80:83], v[208:211]
    s_add_u32 s62, s12, 16384
    v_mfma_f32_16x16x32_bf16 v[208:211], a[100:103], a[84:87], v[208:211]
    s_add_u32 s12, s12, 32768
    v_mfma_f32_16x16x32_bf16 v[224:227], a[100:103], a[92:95], v[224:227]
    s_add_u32 s14, s14, 1
    v_mfma_f32_16x16x32_bf16 v[224:227], a[96:99], a[88:91], v[224:227]
    s_waitcnt lgkmcnt(4)
    v_mul_f32 v24, v140, v140
    v_mul_f32 v25, v141, v141
    v_mfma_f32_16x16x32_bf16 v[32:35], a[104:107], a[64:67], v[32:35]
    s_cmp_eq_u32 s14, s15
    s_cselect_b32 s12, s16, s12
    ds_read_b64_tr_b16 a[120:121], v13 offset:8192
    ds_read_b64_tr_b16 a[122:123], v13 offset:10240
    v_mfma_f32_16x16x32_bf16 v[32:35], a[108:111], a[68:71], v[32:35]
    s_mov_b32 s13, s62
    v_mul_f32 v26, v142, v142
    v_mul_f32 v27, v143, v143
    v_mfma_f32_16x16x32_bf16 v[48:51], a[108:111], a[76:79], v[48:51]
    s_mov_b32 m0, s17
    ds_read_b64_tr_b16 a[124:125], v13 offset:12288
    ds_read_b64_tr_b16 a[126:127], v13 offset:14336
    v_mfma_f32_16x16x32_bf16 v[48:51], a[104:107], a[72:75], v[48:51]
    buffer_load_dwordx4 v1, s[8:11], s12 offen offset:0 sc1 lds
    v_mfma_f32_16x16x32_bf16 v[64:67], a[104:107], a[80:83], v[64:67]
    v_mul_f32 v28, v156, v156
    v_mul_f32 v29, v157, v157
    v_mfma_f32_16x16x32_bf16 v[64:67], a[108:111], a[84:87], v[64:67]
    buffer_load_dwordx4 v1, s[8:11], s12 offen offset:1024 sc1 lds
    v_mfma_f32_16x16x32_bf16 v[80:83], a[108:111], a[92:95], v[80:83]
    v_mul_f32 v30, v158, v158
    v_mul_f32 v31, v159, v159
    v_mfma_f32_16x16x32_bf16 v[80:83], a[104:107], a[88:91], v[80:83]
    s_waitcnt lgkmcnt(4)
    v_fma_f32 v24, v24, v16, v18
    v_fma_f32 v25, v25, v16, v18
    v_mfma_f32_16x16x32_bf16 v[180:183], a[112:115], a[64:67], v[180:183]
    ds_read_b64_tr_b16 a[96:97], v10 offset:16384
    ds_read_b64_tr_b16 a[98:99], v10 offset:18432
    v_mfma_f32_16x16x32_bf16 v[180:183], a[116:119], a[68:71], v[180:183]
    buffer_load_dwordx4 v1, s[8:11], s12 offen offset:2048 sc1 lds
    v_mfma_f32_16x16x32_bf16 v[196:199], a[116:119], a[76:79], v[196:199]
    ds_read_b64_tr_b16 a[100:101], v10 offset:20480
    ds_read_b64_tr_b16 a[102:103], v10 offset:22528
    v_mfma_f32_16x16x32_bf16 v[196:199], a[112:115], a[72:75], v[196:199]
    buffer_load_dwordx4 v1, s[8:11], s12 offen offset:3072 sc1 lds
    v_mfma_f32_16x16x32_bf16 v[212:215], a[112:115], a[80:83], v[212:215]
    s_add_u32 s17, s17, 16384
    v_fma_f32 v26, v26, v16, v18
    v_fma_f32 v27, v27, v16, v18
    v_mfma_f32_16x16x32_bf16 v[212:215], a[116:119], a[84:87], v[212:215]
    s_and_b32 s17, s17, 0xffff
    v_fma_f32 v28, v28, v16, v18
    v_fma_f32 v29, v29, v16, v18
    v_mfma_f32_16x16x32_bf16 v[228:231], a[116:119], a[92:95], v[228:231]
    v_fma_f32 v30, v30, v16, v18
    v_fma_f32 v31, v31, v16, v18
    v_mfma_f32_16x16x32_bf16 v[228:231], a[112:115], a[88:91], v[228:231]
    s_waitcnt lgkmcnt(4)
    v_mul_f32 v24, v24, v140
    v_mul_f32 v25, v25, v141
    v_mfma_f32_16x16x32_bf16 v[36:39], a[120:123], a[64:67], v[36:39]
    s_add_u32 m0, s18, 65536
    ds_read_b64_tr_b16 a[104:105], v11 offset:16384
    ds_read_b64_tr_b16 a[106:107], v11 offset:18432
    v_mfma_f32_16x16x32_bf16 v[36:39], a[124:127], a[68:71], v[36:39]
    buffer_load_dwordx4 v1, s[8:11], s13 offen offset:0 sc1 lds
    v_mfma_f32_16x16x32_bf16 v[52:55], a[124:127], a[76:79], v[52:55]
pad8:
    s_cbranch_execz pad12
    ds_read_b64_tr_b16 a[108:109], v11 offset:20480
    ds_read_b64_tr_b16 a[110:111], v11 offset:22528
    v_mfma_f32_16x16x32_bf16 v[52:55], a[120:123], a[72:75], v[52:55]
    buffer_load_dwordx4 v1, s[8:11], s13 offen offset:1024 sc1 lds
    v_mfma_f32_16x16x32_bf16 v[68:71], a[120:123], a[80:83], v[68:71]
    v_mul_f32 v26, v26, v142
    v_mul_f32 v27, v27, v143
    v_mfma_f32_16x16x32_bf16 v[68:71], a[124:127], a[84:87], v[68:71]
    buffer_load_dwordx4 v1, s[8:11], s13 offen offset:2048 sc1 lds
    v_mfma_f32_16x16x32_bf16 v[84:87], a[124:127], a[92:95], v[84:87]
    v_mul_f32 v28, v28, v156
    v_mul_f32 v29, v29, v157
    v_mfma_f32_16x16x32_bf16 v[84:87], a[120:123], a[88:91], v[84:87]
    s_waitcnt lgkmcnt(4)
    v_mul_f32 v30, v30, v158
    v_mul_f32 v31, v31, v159
    v_mfma_f32_16x16x32_bf16 v[184:187], a[96:99], a[64:67], v[184:187]
    ds_read_b64_tr_b16 a[112:113], v12 offset:16384
    ds_read_b64_tr_b16 a[114:115], v12 offset:18432
    v_mfma_f32_16x16x32_bf16 v[184:187], a[100:103], a[68:71], v[184:187]
    buffer_load_dwordx4 v1, s[8:11], s13 offen offset:3072 sc1 lds
    v_mfma_f32_16x16x32_bf16 v[200:203], a[100:103], a[76:79], v[200:203]
    s_add_u32 s18, s18, 16384
    ds_read_b64_tr_b16 a[116:117], v12 offset:20480
    ds_read_b64_tr_b16 a[118:119], v12 offset:22528
    v_mfma_f32_16x16x32_bf16 v[200:203], a[96:99], a[72:75], v[200:203]
    s_and_b32 s18, s18, 0xffff
    v_exp_f32 v24, v24
    v_mfma_f32_16x16x32_bf16 v[216:219], a[96:99], a[80:83], v[216:219]
    s_add_u32 s62, s12, 16384
    v_exp_f32 v25, v25
    v_mfma_f32_16x16x32_bf16 v[216:219], a[100:103], a[84:87], v[216:219]
    s_add_u32 s12, s12, 32768
    v_exp_f32 v26, v26
    v_mfma_f32_16x16x32_bf16 v[232:235], a[100:103], a[92:95], v[232:235]
    s_add_u32 s14, s14, 1
    v_exp_f32 v27, v27
    v_mfma_f32_16x16x32_bf16 v[232:235], a[96:99], a[88:91], v[232:235]
    s_waitcnt lgkmcnt(4)
    v_exp_f32 v28, v28
    v_mfma_f32_16x16x32_bf16 v[40:43], a[104:107], a[64:67], v[40:43]
    s_cmp_eq_u32 s14, s15
    s_cselect_b32 s12, s16, s12
    ds_read_b64_tr_b16 a[120:121], v13 offset:16384
    ds_read_b64_tr_b16 a[122:123], v13 offset:18432
    v_mfma_f32_16x16x32_bf16 v[40:43], a[108:111], a[68:71], v[40:43]
    s_mov_b32 s13, s62
    v_exp_f32 v29, v29
    v_mfma_f32_16x16x32_bf16 v[56:59], a[108:111], a[76:79], v[56:59]
    ds_read_b64_tr_b16 a[124:125], v13 offset:20480
    ds_read_b64_tr_b16 a[126:127], v13 offset:22528
    v_mfma_f32_16x16x32_bf16 v[56:59], a[104:107], a[72:75], v[56:59]
    v_exp_f32 v30, v30
    v_mfma_f32_16x16x32_bf16 v[72:75], a[104:107], a[80:83], v[72:75]
    v_exp_f32 v31, v31
    v_mfma_f32_16x16x32_bf16 v[72:75], a[108:111], a[84:87], v[72:75]
    v_add_f32 v24, 1.0, v24
    v_add_f32 v25, 1.0, v25
    v_mfma_f32_16x16x32_bf16 v[88:91], a[108:111], a[92:95], v[88:91]
    v_add_f32 v26, 1.0, v26
    v_add_f32 v27, 1.0, v27
    v_mfma_f32_16x16x32_bf16 v[88:91], a[104:107], a[88:91], v[88:91]
    s_waitcnt lgkmcnt(4)
    v_add_f32 v28, 1.0, v28
    v_add_f32 v29, 1.0, v29
    v_mfma_f32_16x16x32_bf16 v[188:191], a[112:115], a[64:67], v[188:191]
    v_add_f32 v30, 1.0, v30
    v_add_f32 v31, 1.0, v31
    v_mfma_f32_16x16x32_bf16 v[188:191], a[116:119], a[68:71], v[188:191]
    v_rcp_f32 v24, v24
    v_mfma_f32_16x16x32_bf16 v[204:207], a[116:119], a[76:79], v[204:207]
    v_rcp_f32 v25, v25
    v_mfma_f32_16x16x32_bf16 v[204:207], a[112:115], a[72:75], v[204:207]
    v_rcp_f32 v26, v26
    v_mfma_f32_16x16x32_bf16 v[220:223], a[112:115], a[80:83], v[220:223]
    v_rcp_f32 v27, v27
    v_mfma_f32_16x16x32_bf16 v[220:223], a[116:119], a[84:87], v[220:223]
    v_rcp_f32 v28, v28
    v_mfma_f32_16x16x32_bf16 v[236:239], a[116:119], a[92:95], v[236:239]
    v_rcp_f32 v29, v29
    v_mfma_f32_16x16x32_bf16 v[236:239], a[112:115], a[88:91], v[236:239]
    s_waitcnt lgkmcnt(0)
    v_rcp_f32 v30, v30
    v_mfma_f32_16x16x32_bf16 v[44:47], a[120:123], a[64:67], v[44:47]
    v_rcp_f32 v31, v31
    v_mfma_f32_16x16x32_bf16 v[44:47], a[124:127], a[68:71], v[44:47]
    v_mul_f32 v24, v24, v140
    v_mul_f32 v25, v25, v141
    v_mfma_f32_16x16x32_bf16 v[60:63], a[124:127], a[76:79], v[60:63]
    v_mul_f32 v26, v26, v142
    v_mul_f32 v27, v27, v143
    v_mfma_f32_16x16x32_bf16 v[60:63], a[120:123], a[72:75], v[60:63]
    v_mul_f32 v28, v28, v156
    v_mul_f32 v29, v29, v157
    v_mfma_f32_16x16x32_bf16 v[76:79], a[120:123], a[80:83], v[76:79]
    v_mul_f32 v30, v30, v158
    v_mul_f32 v31, v31, v159
    v_mfma_f32_16x16x32_bf16 v[76:79], a[124:127], a[84:87], v[76:79]
    v_mfma_f32_16x16x32_bf16 v[92:95], a[124:127], a[92:95], v[92:95]
    v_mfma_f32_16x16x32_bf16 v[92:95], a[120:123], a[88:91], v[92:95]
L_qfend:
    s_cmp_lg_u32 s85, 0
    s_cbranch_scc1 L_gate
    v_cvt_pk_bf16_f32 v140, v24, v25
    v_cvt_pk_bf16_f32 v141, v26, v27
    v_cvt_pk_bf16_f32 v142, v28, v29
    v_cvt_pk_bf16_f32 v143, v30, v31
    buffer_store_dwordx4 v[140:143], v1, s[8:11], s79 offen offset:1024 sc1
    v_pk_mul_f32 v[24:25], v[96:97], v[96:97]
    v_pk_mul_f32 v[26:27], v[98:99], v[98:99]
    v_pk_mul_f32 v[28:29], v[112:113], v[112:113]
    v_pk_mul_f32 v[30:31], v[114:115], v[114:115]
    v_pk_fma_f32 v[24:25], v[24:25], v[16:17], v[18:19]
    v_pk_fma_f32 v[26:27], v[26:27], v[16:17], v[18:19]
    v_pk_fma_f32 v[28:29], v[28:29], v[16:17], v[18:19]
    v_pk_fma_f32 v[30:31], v[30:31], v[16:17], v[18:19]
    v_pk_mul_f32 v[24:25], v[24:25], v[96:97]
    v_pk_mul_f32 v[26:27], v[26:27], v[98:99]
    v_pk_mul_f32 v[28:29], v[28:29], v[112:113]
    v_pk_mul_f32 v[30:31], v[30:31], v[114:115]
    v_exp_f32 v24, v24
    v_exp_f32 v25, v25
    v_exp_f32 v26, v26
    v_exp_f32 v27, v27
    v_exp_f32 v28, v28
    v_exp_f32 v29, v29
    v_exp_f32 v30, v30
    v_exp_f32 v31, v31
    v_pk_add_f32 v[24:25], v[24:25], 1.0 op_sel_hi:[1,0]
    v_pk_add_f32 v[26:27], v[26:27], 1.0 op_sel_hi:[1,0]
    v_pk_add_f32 v[28:29], v[28:29], 1.0 op_sel_hi:[1,0]
    v_pk_add_f32 v[30:31], v[30:31], 1.0 op_sel_hi:[1,0]
    v_rcp_f32 v24, v24
    v_rcp_f32 v25, v25
    v_rcp_f32 v26, v26
    v_rcp_f32 v27, v27
    v_rcp_f32 v28, v28
    v_rcp_f32 v29, v29
    v_rcp_f32 v30, v30
    v_rcp_f32 v31, v31
    v_pk_mul_f32 v[24:25], v[24:25], v[96:97]
    v_pk_mul_f32 v[26:27], v[26:27], v[98:99]
    v_pk_mul_f32 v[28:29], v[28:29], v[112:113]
    v_pk_mul_f32 v[30:31], v[30:31], v[114:115]
    v_cvt_pk_bf16_f32 v96, v24, v25
    v_cvt_pk_bf16_f32 v97, v26, v27
    v_cvt_pk_bf16_f32 v98, v28, v29
    v_cvt_pk_bf16_f32 v99, v30, v31
    buffer_store_dwordx4 v[96:99], v1, s[8:11], s76 offen offset:0 sc1
    v_pk_mul_f32 v[24:25], v[128:129], v[128:129]
    v_pk_mul_f32 v[26:27], v[130:131], v[130:131]
    v_pk_mul_f32 v[28:29], v[144:145], v[144:145]
    v_pk_mul_f32 v[30:31], v[146:147], v[146:147]
    v_pk_fma_f32 v[24:25], v[24:25], v[16:17], v[18:19]
    v_pk_fma_f32 v[26:27], v[26:27], v[16:17], v[18:19]
    v_pk_fma_f32 v[28:29], v[28:29], v[16:17], v[18:19]
    v_pk_fma_f32 v[30:31], v[30:31], v[16:17], v[18:19]
    v_pk_mul_f32 v[24:25], v[24:25], v[128:129]
    v_pk_mul_f32 v[26:27], v[26:27], v[130:131]
    v_pk_mul_f32 v[28:29], v[28:29], v[144:145]
    v_pk_mul_f32 v[30:31], v[30:31], v[146:147]
    v_exp_f32 v24, v24
    v_exp_f32 v25, v25
    v_exp_f32 v26, v26
    v_exp_f32 v27, v27
    v_exp_f32 v28, v28
    v_exp_f32 v29, v29
    v_exp_f32 v30, v30
    v_exp_f32 v31, v31
    v_pk_add_f32 v[24:25], v[24:25], 1.0 op_sel_hi:[1,0]
    v_pk_add_f32 v[26:27], v[26:27], 1.0 op_sel_hi:[1,0]
    v_pk_add_f32 v[28:29], v[28:29], 1.0 op_sel_hi:[1,0]
    v_pk_add_f32 v[30:31], v[30:31], 1.0 op_sel_hi:[1,0]
    v_rcp_f32 v24, v24
    v_rcp_f32 v25, v25
    v_rcp_f32 v26, v26
    v_rcp_f32 v27, v27
    v_rcp_f32 v28, v28
    v_rcp_f32 v29, v29
    v_rcp_f32 v30, v30
    v_rcp_f32 v31, v31
    v_pk_mul_f32 v[24:25], v[24:25], v[128:129]
    v_pk_mul_f32 v[26:27], v[26:27], v[130:131]
    v_pk_mul_f32 v[28:29], v[28:29], v[144:145]
    v_pk_mul_f32 v[30:31], v[30:31], v[146:147]
    v_cvt_pk_bf16_f32 v128, v24, v25
    v_cvt_pk_bf16_f32 v129, v26, v27
    v_cvt_pk_bf16_f32 v130, v28, v29
    v_cvt_pk_bf16_f32 v131, v30, v31
    buffer_store_dwordx4 v[128:131], v1, s[8:11], s76 offen offset:1024 sc1
    v_pk_mul_f32 v[24:25], v[100:101], v[100:101]
    v_pk_mul_f32 v[26:27], v[102:103], v[102:103]
    v_pk_mul_f32 v[28:29], v[116:117], v[116:117]
    v_pk_mul_f32 v[30:31], v[118:119], v[118:119]
    v_pk_fma_f32 v[24:25], v[24:25], v[16:17], v[18:19]
    v_pk_fma_f32 v[26:27], v[26:27], v[16:17], v[18:19]
    v_pk_fma_f32 v[28:29], v[28:29], v[16:17], v[18:19]
    v_pk_fma_f32 v[30:31], v[30:31], v[16:17], v[18:19]
    v_pk_mul_f32 v[24:25], v[24:25], v[100:101]
    v_pk_mul_f32 v[26:27], v[26:27], v[102:103]
    v_pk_mul_f32 v[28:29], v[28:29], v[116:117]
    v_pk_mul_f32 v[30:31], v[30:31], v[118:119]
    v_exp_f32 v24, v24
    v_exp_f32 v25, v25
    v_exp_f32 v26, v26
    v_exp_f32 v27, v27
    v_exp_f32 v28, v28
    v_exp_f32 v29, v29
    v_exp_f32 v30, v30
    v_exp_f32 v31, v31
    v_pk_add_f32 v[24:25], v[24:25], 1.0 op_sel_hi:[1,0]
    v_pk_add_f32 v[26:27], v[26:27], 1.0 op_sel_hi:[1,0]
    v_pk_add_f32 v[28:29], v[28:29], 1.0 op_sel_hi:[1,0]
    v_pk_add_f32 v[30:31], v[30:31], 1.0 op_sel_hi:[1,0]
    v_rcp_f32 v24, v24
    v_rcp_f32 v25, v25
    v_rcp_f32 v26, v26
    v_rcp_f32 v27, v27
    v_rcp_f32 v28, v28
    v_rcp_f32 v29, v29
    v_rcp_f32 v30, v30
    v_rcp_f32 v31, v31
    v_pk_mul_f32 v[24:25], v[24:25], v[100:101]
    v_pk_mul_f32 v[26:27], v[26:27], v[102:103]
    v_pk_mul_f32 v[28:29], v[28:29], v[116:117]
    v_pk_mul_f32 v[30:31], v[30:31], v[118:119]
    v_cvt_pk_bf16_f32 v100, v24, v25
    v_cvt_pk_bf16_f32 v101, v26, v27
    v_cvt_pk_bf16_f32 v102, v28, v29
    v_cvt_pk_bf16_f32 v103, v30, v31
    buffer_store_dwordx4 v[100:103], v1, s[8:11], s77 offen offset:0 sc1
    v_pk_mul_f32 v[24:25], v[132:133], v[132:133]
    v_pk_mul_f32 v[26:27], v[134:135], v[134:135]
    v_pk_mul_f32 v[28:29], v[148:149], v[148:149]
    v_pk_mul_f32 v[30:31], v[150:151], v[150:151]
    v_pk_fma_f32 v[24:25], v[24:25], v[16:17], v[18:19]
    v_pk_fma_f32 v[26:27], v[26:27], v[16:17], v[18:19]
    v_pk_fma_f32 v[28:29], v[28:29], v[16:17], v[18:19]
    v_pk_fma_f32 v[30:31], v[30:31], v[16:17], v[18:19]
    v_pk_mul_f32 v[24:25], v[24:25], v[132:133]
    v_pk_mul_f32 v[26:27], v[26:27], v[134:135]
    v_pk_mul_f32 v[28:29], v[28:29], v[148:149]
    v_pk_mul_f32 v[30:31], v[30:31], v[150:151]
    v_exp_f32 v24, v24
    v_exp_f32 v25, v25
    v_exp_f32 v26, v26
    v_exp_f32 v27, v27
    v_exp_f32 v28, v28
    v_exp_f32 v29, v29
    v_exp_f32 v30, v30
    v_exp_f32 v31, v31
    v_pk_add_f32 v[24:25], v[24:25], 1.0 op_sel_hi:[1,0]
    v_pk_add_f32 v[26:27], v[26:27], 1.0 op_sel_hi:[1,0]
    v_pk_add_f32 v[28:29], v[28:29], 1.0 op_sel_hi:[1,0]
    v_pk_add_f32 v[30:31], v[30:31], 1.0 op_sel_hi:[1,0]
    v_rcp_f32 v24, v24
    v_rcp_f32 v25, v25
    v_rcp_f32 v26, v26
    v_rcp_f32 v27, v27
    v_rcp_f32 v28, v28
    v_rcp_f32 v29, v29
    v_rcp_f32 v30, v30
    v_rcp_f32 v31, v31
    v_pk_mul_f32 v[24:25], v[24:25], v[132:133]
    v_pk_mul_f32 v[26:27], v[26:27], v[134:135]
    v_pk_mul_f32 v[28:29], v[28:29], v[148:149]
    v_pk_mul_f32 v[30:31], v[30:31], v[150:151]
    v_cvt_pk_bf16_f32 v132, v24, v25
    v_cvt_pk_bf16_f32 v133, v26, v27
    v_cvt_pk_bf16_f32 v134, v28, v29
    v_cvt_pk_bf16_f32 v135, v30, v31
    buffer_store_dwordx4 v[132:135], v1, s[8:11], s77 offen offset:1024 sc1
    v_pk_mul_f32 v[24:25], v[104:105], v[104:105]
    v_pk_mul_f32 v[26:27], v[106:107], v[106:107]
    v_pk_mul_f32 v[28:29], v[120:121], v[120:121]
    v_pk_mul_f32 v[30:31], v[122:123], v[122:123]
    v_pk_fma_f32 v[24:25], v[24:25], v[16:17], v[18:19]
    v_pk_fma_f32 v[26:27], v[26:27], v[16:17], v[18:19]
    v_pk_fma_f32 v[28:29], v[28:29], v[16:17], v[18:19]
    v_pk_fma_f32 v[30:31], v[30:31], v[16:17], v[18:19]
    v_pk_mul_f32 v[24:25], v[24:25], v[104:105]
    v_pk_mul_f32 v[26:27], v[26:27], v[106:107]
    v_pk_mul_f32 v[28:29], v[28:29], v[120:121]
    v_pk_mul_f32 v[30:31], v[30:31], v[122:123]
    v_exp_f32 v24, v24
    v_exp_f32 v25, v25
    v_exp_f32 v26, v26
    v_exp_f32 v27, v27
    v_exp_f32 v28, v28
    v_exp_f32 v29, v29
    v_exp_f32 v30, v30
    v_exp_f32 v31, v31
    v_pk_add_f32 v[24:25], v[24:25], 1.0 op_sel_hi:[1,0]
    v_pk_add_f32 v[26:27], v[26:27], 1.0 op_sel_hi:[1,0]
    v_pk_add_f32 v[28:29], v[28:29], 1.0 op_sel_hi:[1,0]
    v_pk_add_f32 v[30:31], v[30:31], 1.0 op_sel_hi:[1,0]
    v_rcp_f32 v24, v24
    v_rcp_f32 v25, v25
    v_rcp_f32 v26, v26
    v_rcp_f32 v27, v27
    v_rcp_f32 v28, v28
    v_rcp_f32 v29, v29
    v_rcp_f32 v30, v30
    v_rcp_f32 v31, v31
    v_pk_mul_f32 v[24:25], v[24:25], v[104:105]
    v_pk_mul_f32 v[26:27], v[26:27], v[106:107]
    v_pk_mul_f32 v[28:29], v[28:29], v[120:121]
    v_pk_mul_f32 v[30:31], v[30:31], v[122:123]
    v_cvt_pk_bf16_f32 v104, v24, v25
    v_cvt_pk_bf16_f32 v105, v26, v27
    v_cvt_pk_bf16_f32 v106, v28, v29
    v_cvt_pk_bf16_f32 v107, v30, v31
    buffer_store_dwordx4 v[104:107], v1, s[8:11], s78 offen offset:0 sc1
    v_pk_mul_f32 v[24:25], v[136:137], v[136:137]
    v_pk_mul_f32 v[26:27], v[138:139], v[138:139]
    v_pk_mul_f32 v[28:29], v[152:153], v[152:153]
    v_pk_mul_f32 v[30:31], v[154:155], v[154:155]
    v_pk_fma_f32 v[24:25], v[24:25], v[16:17], v[18:19]
    v_pk_fma_f32 v[26:27], v[26:27], v[16:17], v[18:19]
    v_pk_fma_f32 v[28:29], v[28:29], v[16:17], v[18:19]
    v_pk_fma_f32 v[30:31], v[30:31], v[16:17], v[18:19]
    v_pk_mul_f32 v[24:25], v[24:25], v[136:137]
    v_pk_mul_f32 v[26:27], v[26:27], v[138:139]
    v_pk_mul_f32 v[28:29], v[28:29], v[152:153]
    v_pk_mul_f32 v[30:31], v[30:31], v[154:155]
    v_exp_f32 v24, v24
    v_exp_f32 v25, v25
    v_exp_f32 v26, v26
    v_exp_f32 v27, v27
    v_exp_f32 v28, v28
    v_exp_f32 v29, v29
    v_exp_f32 v30, v30
    v_exp_f32 v31, v31
    v_pk_add_f32 v[24:25], v[24:25], 1.0 op_sel_hi:[1,0]
    v_pk_add_f32 v[26:27], v[26:27], 1.0 op_sel_hi:[1,0]
    v_pk_add_f32 v[28:29], v[28:29], 1.0 op_sel_hi:[1,0]
    v_pk_add_f32 v[30:31], v[30:31], 1.0 op_sel_hi:[1,0]
    v_rcp_f32 v24, v24
    v_rcp_f32 v25, v25
    v_rcp_f32 v26, v26
    v_rcp_f32 v27, v27
    v_rcp_f32 v28, v28
    v_rcp_f32 v29, v29
    v_rcp_f32 v30, v30
    v_rcp_f32 v31, v31
    v_pk_mul_f32 v[24:25], v[24:25], v[136:137]
    v_pk_mul_f32 v[26:27], v[26:27], v[138:139]
    v_pk_mul_f32 v[28:29], v[28:29], v[152:153]
    v_pk_mul_f32 v[30:31], v[30:31], v[154:155]
    v_cvt_pk_bf16_f32 v136, v24, v25
    v_cvt_pk_bf16_f32 v137, v26, v27
    v_cvt_pk_bf16_f32 v138, v28, v29
    v_cvt_pk_bf16_f32 v139, v30, v31
    buffer_store_dwordx4 v[136:139], v1, s[8:11], s78 offen offset:1024 sc1
    v_pk_mul_f32 v[24:25], v[108:109], v[108:109]
    v_pk_mul_f32 v[26:27], v[110:111], v[110:111]
    v_pk_mul_f32 v[28:29], v[124:125], v[124:125]
    v_pk_mul_f32 v[30:31], v[126:127], v[126:127]
    v_pk_fma_f32 v[24:25], v[24:25], v[16:17], v[18:19]
    v_pk_fma_f32 v[26:27], v[26:27], v[16:17], v[18:19]
    v_pk_fma_f32 v[28:29], v[28:29], v[16:17], v[18:19]
    v_pk_fma_f32 v[30:31], v[30:31], v[16:17], v[18:19]
    v_pk_mul_f32 v[24:25], v[24:25], v[108:109]
    v_pk_mul_f32 v[26:27], v[26:27], v[110:111]
    v_pk_mul_f32 v[28:29], v[28:29], v[124:125]
    v_pk_mul_f32 v[30:31], v[30:31], v[126:127]
    v_exp_f32 v24, v24
    v_exp_f32 v25, v25
    v_exp_f32 v26, v26
    v_exp_f32 v27, v27
    v_exp_f32 v28, v28
    v_exp_f32 v29, v29
    v_exp_f32 v30, v30
    v_exp_f32 v31, v31
    v_pk_add_f32 v[24:25], v[24:25], 1.0 op_sel_hi:[1,0]
    v_pk_add_f32 v[26:27], v[26:27], 1.0 op_sel_hi:[1,0]
    v_pk_add_f32 v[28:29], v[28:29], 1.0 op_sel_hi:[1,0]
    v_pk_add_f32 v[30:31], v[30:31], 1.0 op_sel_hi:[1,0]
    v_rcp_f32 v24, v24
    v_rcp_f32 v25, v25
    v_rcp_f32 v26, v26
    v_rcp_f32 v27, v27
    v_rcp_f32 v28, v28
    v_rcp_f32 v29, v29
    v_rcp_f32 v30, v30
    v_rcp_f32 v31, v31
    v_pk_mul_f32 v[24:25], v[24:25], v[108:109]
    v_pk_mul_f32 v[26:27], v[26:27], v[110:111]
    v_pk_mul_f32 v[28:29], v[28:29], v[124:125]
    v_pk_mul_f32 v[30:31], v[30:31], v[126:127]
    v_cvt_pk_bf16_f32 v108, v24, v25
    v_cvt_pk_bf16_f32 v109, v26, v27
    v_cvt_pk_bf16_f32 v110, v28, v29
    v_cvt_pk_bf16_f32 v111, v30, v31
    buffer_store_dwordx4 v[108:111], v1, s[8:11], s79 offen offset:0 sc1
    v_mov_b32 v16, 0x3e0293ee
    v_mov_b32 v17, v16
    s_waitcnt vmcnt(16)
    s_barrier
    v_pk_mul_f32 v[176:177], v[176:177], v[16:17]
    v_pk_mul_f32 v[178:179], v[178:179], v[16:17]
    v_pk_mul_f32 v[32:33], v[32:33], v[16:17]
    v_pk_mul_f32 v[34:35], v[34:35], v[16:17]
    v_cvt_pk_bf16_f32 v176, v176, v177
    v_cvt_pk_bf16_f32 v177, v178, v179
    v_cvt_pk_bf16_f32 v178, v32, v33
    v_cvt_pk_bf16_f32 v179, v34, v35
    ds_read_b128 a[68:71], v2 offset:0
    ds_read_b128 a[72:75], v2 offset:1024
    v_pk_mul_f32 v[180:181], v[180:181], v[16:17]
    v_pk_mul_f32 v[182:183], v[182:183], v[16:17]
    v_pk_mul_f32 v[36:37], v[36:37], v[16:17]
    v_pk_mul_f32 v[38:39], v[38:39], v[16:17]
    v_cvt_pk_bf16_f32 v180, v180, v181
    v_cvt_pk_bf16_f32 v181, v182, v183
    v_cvt_pk_bf16_f32 v182, v36, v37
    v_cvt_pk_bf16_f32 v183, v38, v39
    ds_read_b128 a[76:79], v2 offset:2048
    ds_read_b128 a[80:83], v2 offset:3072
    v_pk_mul_f32 v[184:185], v[184:185], v[16:17]
    v_pk_mul_f32 v[186:187], v[186:187], v[16:17]
    v_pk_mul_f32 v[40:41], v[40:41], v[16:17]
    v_pk_mul_f32 v[42:43], v[42:43], v[16:17]
    v_cvt_pk_bf16_f32 v184, v184, v185
    v_cvt_pk_bf16_f32 v185, v186, v187
    v_cvt_pk_bf16_f32 v186, v40, v41
    v_cvt_pk_bf16_f32 v187, v42, v43
    ds_read_b128 a[84:87], v2 offset:4096
    ds_read_b128 a[88:91], v2 offset:5120
    v_pk_mul_f32 v[188:189], v[188:189], v[16:17]
    v_pk_mul_f32 v[190:191], v[190:191], v[16:17]
    v_pk_mul_f32 v[44:45], v[44:45], v[16:17]
    v_pk_mul_f32 v[46:47], v[46:47], v[16:17]
    v_cvt_pk_bf16_f32 v188, v188, v189
    v_cvt_pk_bf16_f32 v189, v190, v191
    v_cvt_pk_bf16_f32 v190, v44, v45
    v_cvt_pk_bf16_f32 v191, v46, v47
    ds_read_b128 a[92:95], v2 offset:6144
    ds_read_b128 a[96:99], v2 offset:7168
    v_pk_mul_f32 v[192:193], v[192:193], v[16:17]
    v_pk_mul_f32 v[194:195], v[194:195], v[16:17]
    v_pk_mul_f32 v[48:49], v[48:49], v[16:17]
    v_pk_mul_f32 v[50:51], v[50:51], v[16:17]
    v_cvt_pk_bf16_f32 v192, v192, v193
    v_cvt_pk_bf16_f32 v193, v194, v195
    v_cvt_pk_bf16_f32 v194, v48, v49
    v_cvt_pk_bf16_f32 v195, v50, v51
    ds_read_b128 a[0:3], v2 offset:8192
    ds_read_b128 a[4:7], v2 offset:9216
    v_pk_mul_f32 v[196:197], v[196:197], v[16:17]
    v_pk_mul_f32 v[198:199], v[198:199], v[16:17]
    v_pk_mul_f32 v[52:53], v[52:53], v[16:17]
    v_pk_mul_f32 v[54:55], v[54:55], v[16:17]
    v_cvt_pk_bf16_f32 v196, v196, v197
    v_cvt_pk_bf16_f32 v197, v198, v199
    v_cvt_pk_bf16_f32 v198, v52, v53
    v_cvt_pk_bf16_f32 v199, v54, v55
    ds_read_b128 a[8:11], v2 offset:10240
    ds_read_b128 a[12:15], v2 offset:11264
    v_pk_mul_f32 v[200:201], v[200:201], v[16:17]
    v_pk_mul_f32 v[202:203], v[202:203], v[16:17]
    v_pk_mul_f32 v[56:57], v[56:57], v[16:17]
    v_pk_mul_f32 v[58:59], v[58:59], v[16:17]
    v_cvt_pk_bf16_f32 v200, v200, v201
    v_cvt_pk_bf16_f32 v201, v202, v203
    v_cvt_pk_bf16_f32 v202, v56, v57
    v_cvt_pk_bf16_f32 v203, v58, v59
    ds_read_b128 a[16:19], v2 offset:12288
    ds_read_b128 a[20:23], v2 offset:13312
    v_pk_mul_f32 v[204:205], v[204:205], v[16:17]
    v_pk_mul_f32 v[206:207], v[206:207], v[16:17]
    v_pk_mul_f32 v[60:61], v[60:61], v[16:17]
    v_pk_mul_f32 v[62:63], v[62:63], v[16:17]
    v_cvt_pk_bf16_f32 v204, v204, v205
    v_cvt_pk_bf16_f32 v205, v206, v207
    v_cvt_pk_bf16_f32 v206, v60, v61
    v_cvt_pk_bf16_f32 v207, v62, v63
    ds_read_b128 a[24:27], v2 offset:14336
    ds_read_b128 a[28:31], v2 offset:15360
    v_pk_mul_f32 v[208:209], v[208:209], v[16:17]
    v_pk_mul_f32 v[210:211], v[210:211], v[16:17]
    v_pk_mul_f32 v[64:65], v[64:65], v[16:17]
    v_pk_mul_f32 v[66:67], v[66:67], v[16:17]
    v_cvt_pk_bf16_f32 v208, v208, v209
    v_cvt_pk_bf16_f32 v209, v210, v211
    v_cvt_pk_bf16_f32 v210, v64, v65
    v_cvt_pk_bf16_f32 v211, v66, v67
    v_pk_mul_f32 v[212:213], v[212:213], v[16:17]
    v_pk_mul_f32 v[214:215], v[214:215], v[16:17]
    v_pk_mul_f32 v[68:69], v[68:69], v[16:17]
    v_pk_mul_f32 v[70:71], v[70:71], v[16:17]
    v_cvt_pk_bf16_f32 v212, v212, v213
    v_cvt_pk_bf16_f32 v213, v214, v215
    v_cvt_pk_bf16_f32 v214, v68, v69
    v_cvt_pk_bf16_f32 v215, v70, v71
    v_pk_mul_f32 v[216:217], v[216:217], v[16:17]
    v_pk_mul_f32 v[218:219], v[218:219], v[16:17]
    v_pk_mul_f32 v[72:73], v[72:73], v[16:17]
    v_pk_mul_f32 v[74:75], v[74:75], v[16:17]
    v_cvt_pk_bf16_f32 v216, v216, v217
    v_cvt_pk_bf16_f32 v217, v218, v219
    v_cvt_pk_bf16_f32 v218, v72, v73
    v_cvt_pk_bf16_f32 v219, v74, v75
    v_pk_mul_f32 v[220:221], v[220:221], v[16:17]
    v_pk_mul_f32 v[222:223], v[222:223], v[16:17]
    v_pk_mul_f32 v[76:77], v[76:77], v[16:17]
    v_pk_mul_f32 v[78:79], v[78:79], v[16:17]
    v_cvt_pk_bf16_f32 v220, v220, v221
    v_cvt_pk_bf16_f32 v221, v222, v223
    v_cvt_pk_bf16_f32 v222, v76, v77
    v_cvt_pk_bf16_f32 v223, v78, v79
    v_pk_mul_f32 v[224:225], v[224:225], v[16:17]
    v_pk_mul_f32 v[226:227], v[226:227], v[16:17]
    v_pk_mul_f32 v[80:81], v[80:81], v[16:17]
    v_pk_mul_f32 v[82:83], v[82:83], v[16:17]
    v_cvt_pk_bf16_f32 v224, v224, v225
    v_cvt_pk_bf16_f32 v225, v226, v227
    v_cvt_pk_bf16_f32 v226, v80, v81
    v_cvt_pk_bf16_f32 v227, v82, v83
    v_pk_mul_f32 v[228:229], v[228:229], v[16:17]
    v_pk_mul_f32 v[230:231], v[230:231], v[16:17]
    v_pk_mul_f32 v[84:85], v[84:85], v[16:17]
    v_pk_mul_f32 v[86:87], v[86:87], v[16:17]
    v_cvt_pk_bf16_f32 v228, v228, v229
    v_cvt_pk_bf16_f32 v229, v230, v231
    v_cvt_pk_bf16_f32 v230, v84, v85
    v_cvt_pk_bf16_f32 v231, v86, v87
    v_pk_mul_f32 v[232:233], v[232:233], v[16:17]
    v_pk_mul_f32 v[234:235], v[234:235], v[16:17]
    v_pk_mul_f32 v[88:89], v[88:89], v[16:17]
    v_pk_mul_f32 v[90:91], v[90:91], v[16:17]
    v_cvt_pk_bf16_f32 v232, v232, v233
    v_cvt_pk_bf16_f32 v233, v234, v235
    v_cvt_pk_bf16_f32 v234, v88, v89
    v_cvt_pk_bf16_f32 v235, v90, v91
    v_pk_mul_f32 v[236:237], v[236:237], v[16:17]
    v_pk_mul_f32 v[238:239], v[238:239], v[16:17]
    v_pk_mul_f32 v[92:93], v[92:93], v[16:17]
    v_pk_mul_f32 v[94:95], v[94:95], v[16:17]
    v_cvt_pk_bf16_f32 v236, v236, v237
    v_cvt_pk_bf16_f32 v237, v238, v239
    v_cvt_pk_bf16_f32 v238, v92, v93
    v_cvt_pk_bf16_f32 v239, v94, v95
L_qepi:
    s_waitcnt lgkmcnt(0)
    s_nop 0
    v_mfma_f32_16x16x32_bf16 v[104:107], a[68:71], v[176:179], 0
    s_mov_b32 m0, s17
    v_subrev_f32 v144, 0x00000000, v4
    v_subrev_f32 v145, 0x71800000, v4
    v_mfma_f32_16x16x32_bf16 v[104:107], a[72:75], v[180:183], v[104:107]
    s_add_u32 s17, s17, 16384
    buffer_load_dwordx4 v1, s[8:11], s12 offen offset:0 sc1 lds
    v_mfma_f32_16x16x32_bf16 v[104:107], a[76:79], v[184:187], v[104:107]
    s_and_b32 s17, s17, 0xffff
    v_subrev_f32 v146, 0x72000000, v4
    v_subrev_f32 v147, 0x72400000, v4
    v_mfma_f32_16x16x32_bf16 v[104:107], a[80:83], v[188:191], v[104:107]
    v_subrev_f32 v148, 0x73800000, v4
    v_subrev_f32 v149, 0x73880000, v4
    v_mfma_f32_16x16x32_bf16 v[108:111], a[68:71], v[192:195], 0
    v_subrev_f32 v150, 0x73900000, v4
    v_subrev_f32 v151, 0x73980000, v4
    v_mfma_f32_16x16x32_bf16 v[108:111], a[72:75], v[196:199], v[108:111]
    buffer_load_dwordx4 v1, s[8:11], s12 offen offset:1024 sc1 lds
    v_mfma_f32_16x16x32_bf16 v[108:111], a[76:79], v[200:203], v[108:111]
    v_accvgpr_write_b32 a100, v176
    v_accvgpr_write_b32 a101, v177
    v_mfma_f32_16x16x32_bf16 v[108:111], a[80:83], v[204:207], v[108:111]
    v_accvgpr_write_b32 a102, v178
    v_accvgpr_write_b32 a103, v179
    v_mfma_f32_16x16x32_bf16 v[112:115], a[68:71], v[208:211], 0
    v_max3_f32 v6, v104, v105, v106
    v_max_f32 v6, v6, v107
    v_mfma_f32_16x16x32_bf16 v[112:115], a[72:75], v[212:215], v[112:115]
    buffer_load_dwordx4 v1, s[8:11], s12 offen offset:2048 sc1 lds
    v_mfma_f32_16x16x32_bf16 v[112:115], a[76:79], v[216:219], v[112:115]
    v_accvgpr_write_b32 a104, v180
    v_accvgpr_write_b32 a105, v181
    v_mfma_f32_16x16x32_bf16 v[112:115], a[80:83], v[220:223], v[112:115]
    v_accvgpr_write_b32 a106, v182
    v_accvgpr_write_b32 a107, v183
    v_mfma_f32_16x16x32_bf16 v[116:119], a[68:71], v[224:227], 0
    v_max3_f32 v7, v108, v109, v110
    v_max_f32 v7, v7, v111
    v_mfma_f32_16x16x32_bf16 v[116:119], a[72:75], v[228:231], v[116:119]
    buffer_load_dwordx4 v1, s[8:11], s12 offen offset:3072 sc1 lds
    v_mfma_f32_16x16x32_bf16 v[116:119], a[76:79], v[232:235], v[116:119]
    v_accvgpr_write_b32 a108, v184
    v_accvgpr_write_b32 a109, v185
    v_mfma_f32_16x16x32_bf16 v[116:119], a[80:83], v[236:239], v[116:119]
    v_max3_f32 v8, v112, v113, v114
    v_max_f32 v8, v8, v115
    v_accvgpr_write_b32 a110, v186
    v_accvgpr_write_b32 a111, v187
    v_accvgpr_write_b32 a112, v188
    v_accvgpr_write_b32 a113, v189
    v_accvgpr_write_b32 a114, v190
    v_accvgpr_write_b32 a115, v191
    v_max3_f32 v9, v116, v117, v118
    v_max_f32 v9, v9, v119
    v_mov_b32 v10, v6
    v_mov_b32 v11, v7
    v_mov_b32 v12, v8
    v_mov_b32 v13, v9
    v_permlane32_swap_b32 v10, v6
    v_permlane32_swap_b32 v11, v7
pad9:
    s_cbranch_execz pad13
    v_permlane32_swap_b32 v12, v8
    v_permlane32_swap_b32 v13, v9
    v_max_f32 v6, v6, v10
    v_max_f32 v7, v7, v11
    v_max_f32 v8, v8, v12
    v_max_f32 v9, v9, v13
    v_mov_b32 v10, v6
    v_mov_b32 v11, v7
    v_mov_b32 v12, v8
    v_mov_b32 v13, v9
    v_permlane16_swap_b32 v10, v6
    v_permlane16_swap_b32 v11, v7
    v_permlane16_swap_b32 v12, v8
    v_permlane16_swap_b32 v13, v9
    v_max_f32 v6, v6, v10
    v_max_f32 v7, v7, v11
    v_max_f32 v8, v8, v12
    v_max_f32 v9, v9, v13
    v_sub_f32 v136, 0, v6
    v_sub_f32 v137, 0, v6
    v_sub_f32 v138, 0, v6
    v_sub_f32 v139, 0, v6
    s_cmp_eq_u32 s6, 0
    s_cbranch_scc1 L_q0d
    v_mfma_f32_16x16x32_bf16 v[88:91], a[68:71], v[176:179], v[136:139]
    s_add_u32 m0, s18, 65536
    v_sub_f32 v140, 0, v7
    v_sub_f32 v141, 0, v7
    v_mfma_f32_16x16x32_bf16 v[88:91], a[72:75], v[180:183], v[88:91]
    s_add_u32 s18, s18, 16384
    buffer_load_dwordx4 v1, s[8:11], s13 offen offset:0 sc1 lds
    v_mfma_f32_16x16x32_bf16 v[88:91], a[76:79], v[184:187], v[88:91]
    s_and_b32 s18, s18, 0xffff
    v_sub_f32 v142, 0, v7
    v_sub_f32 v143, 0, v7
    v_mfma_f32_16x16x32_bf16 v[88:91], a[80:83], v[188:191], v[88:91]
    s_add_u32 s62, s12, 16384
    v_sub_f32 v14, 0, v8
    v_sub_f32 v255, 0, v9
    v_mfma_f32_16x16x32_bf16 v[92:95], a[84:87], v[176:179], v[136:139]
    s_add_u32 s12, s12, 32768
    v_sub_f32 v152, 0, v8
    v_sub_f32 v153, 0, v8
    v_mfma_f32_16x16x32_bf16 v[92:95], a[88:91], v[180:183], v[92:95]
    s_add_u32 s14, s14, 1
    v_sub_f32 v154, 0, v8
    v_sub_f32 v155, 0, v8
    v_mfma_f32_16x16x32_bf16 v[92:95], a[92:95], v[184:187], v[92:95]
    s_cmp_eq_u32 s14, s15
    buffer_load_dwordx4 v1, s[8:11], s13 offen offset:1024 sc1 lds
    v_mfma_f32_16x16x32_bf16 v[92:95], a[96:99], v[188:191], v[92:95]
    s_cselect_b32 s12, s16, s12
    v_sub_f32 v156, 0, v9
    v_sub_f32 v157, 0, v9
    v_mfma_f32_16x16x32_bf16 v[96:99], a[68:71], v[192:195], v[140:143]
    v_sub_f32 v158, 0, v9
    v_sub_f32 v159, 0, v9
    v_mfma_f32_16x16x32_bf16 v[96:99], a[72:75], v[196:199], v[96:99]
    v_exp_f32 v88, v88
    v_mfma_f32_16x16x32_bf16 v[96:99], a[76:79], v[200:203], v[96:99]
    v_exp_f32 v89, v89
    v_mfma_f32_16x16x32_bf16 v[96:99], a[80:83], v[204:207], v[96:99]
    buffer_load_dwordx4 v1, s[8:11], s13 offen offset:2048 sc1 lds
    v_mfma_f32_16x16x32_bf16 v[100:103], a[84:87], v[192:195], v[140:143]
    v_exp_f32 v90, v90
    v_mfma_f32_16x16x32_bf16 v[100:103], a[88:91], v[196:199], v[100:103]
    v_exp_f32 v91, v91
    v_mfma_f32_16x16x32_bf16 v[100:103], a[92:95], v[200:203], v[100:103]
    v_exp_f32 v92, v92
    v_mfma_f32_16x16x32_bf16 v[100:103], a[96:99], v[204:207], v[100:103]
    v_cvt_pk_bf16_f32 v120, v88, v89
    v_cvt_pk_bf16_f32 v121, v90, v91
    v_mfma_f32_16x16x32_bf16 v[160:163], a[68:71], v[208:211], v[152:155]
    buffer_load_dwordx4 v1, s[8:11], s13 offen offset:3072 sc1 lds
    v_mfma_f32_16x16x32_bf16 v[160:163], a[72:75], v[212:215], v[160:163]
    s_mov_b32 s13, s62
    v_exp_f32 v93, v93
    v_mfma_f32_16x16x32_bf16 v[160:163], a[76:79], v[216:219], v[160:163]
    v_exp_f32 v94, v94
    v_mfma_f32_16x16x32_bf16 v[160:163], a[80:83], v[220:223], v[160:163]
    v_exp_f32 v95, v95
    v_mfma_f32_16x16x32_bf16 v[164:167], a[84:87], v[208:211], v[152:155]
    v_accvgpr_write_b32 a116, v192
    v_cvt_pk_bf16_f32 v122, v92, v93
    v_mfma_f32_16x16x32_bf16 v[164:167], a[88:91], v[212:215], v[164:167]
    v_cvt_pk_bf16_f32 v123, v94, v95
    v_mfma_f32_16x16x32_bf16 v[164:167], a[92:95], v[216:219], v[164:167]
    v_exp_f32 v96, v96
    v_mfma_f32_16x16x32_bf16 v[164:167], a[96:99], v[220:223], v[164:167]
    v_exp_f32 v97, v97
    v_mfma_f32_16x16x32_bf16 v[168:171], a[68:71], v[224:227], v[156:159]
    v_exp_f32 v98, v98
    v_mfma_f32_16x16x32_bf16 v[168:171], a[72:75], v[228:231], v[168:171]
    v_exp_f32 v99, v99
    v_mfma_f32_16x16x32_bf16 v[168:171], a[76:79], v[232:235], v[168:171]
    v_exp_f32 v100, v100
    v_mfma_f32_16x16x32_bf16 v[168:171], a[80:83], v[236:239], v[168:171]
    v_cvt_pk_bf16_f32 v124, v96, v97
    v_cvt_pk_bf16_f32 v125, v98, v99
    v_mfma_f32_16x16x32_bf16 v[172:175], a[84:87], v[224:227], v[156:159]
    v_exp_f32 v101, v101
    v_mfma_f32_16x16x32_bf16 v[172:175], a[88:91], v[228:231], v[172:175]
    v_exp_f32 v102, v102
    v_mfma_f32_16x16x32_bf16 v[172:175], a[92:95], v[232:235], v[172:175]
    v_exp_f32 v103, v103
    v_mfma_f32_16x16x32_bf16 v[172:175], a[96:99], v[236:239], v[172:175]
    v_accvgpr_write_b32 a117, v193
    v_cvt_pk_bf16_f32 v126, v100, v101
    v_cvt_pk_bf16_f32 v127, v102, v103
    s_waitcnt vmcnt(16)
    s_barrier
    v_mfma_f32_16x16x32_bf16 v[88:91], a[0:3], v[176:179], v[136:139]
    v_exp_f32 v160, v160
    v_mfma_f32_16x16x32_bf16 v[88:91], a[4:7], v[180:183], v[88:91]
    v_exp_f32 v161, v161
    v_accvgpr_write_b32 a118, v194
    v_mfma_f32_16x16x32_bf16 v[88:91], a[8:11], v[184:187], v[88:91]
    s_mov_b32 m0, s17
    v_cvt_pk_bf16_f32 v6, v160, v161
    v_accvgpr_write_b32 a119, v195
    v_accvgpr_write_b32 a120, v196
    v_mfma_f32_16x16x32_bf16 v[88:91], a[12:15], v[188:191], v[88:91]
    s_add_u32 s17, s17, 16384
    buffer_load_dwordx4 v1, s[8:11], s12 offen offset:0 sc1 lds
    v_mfma_f32_16x16x32_bf16 v[92:95], a[16:19], v[176:179], v[136:139]
    s_and_b32 s17, s17, 0xffff
    v_exp_f32 v162, v162
    v_accvgpr_write_b32 a121, v197
    v_mfma_f32_16x16x32_bf16 v[92:95], a[20:23], v[180:183], v[92:95]
    v_exp_f32 v163, v163
    v_accvgpr_write_b32 a122, v198
    v_mfma_f32_16x16x32_bf16 v[92:95], a[24:27], v[184:187], v[92:95]
    v_cvt_pk_bf16_f32 v7, v162, v163
    v_accvgpr_write_b32 a123, v199
    v_mfma_f32_16x16x32_bf16 v[92:95], a[28:31], v[188:191], v[92:95]
    buffer_store_dwordx4 a[208:211], v1, s[8:11], s88 offen offset:0 sc1
    v_accvgpr_write_b32 a124, v200
    v_mfma_f32_16x16x32_bf16 v[96:99], a[0:3], v[192:195], v[140:143]
    v_exp_f32 v164, v164
    v_accvgpr_write_b32 a125, v201
    v_mfma_f32_16x16x32_bf16 v[96:99], a[4:7], v[196:199], v[96:99]
    v_exp_f32 v165, v165
    v_accvgpr_write_b32 a126, v202
    v_mfma_f32_16x16x32_bf16 v[96:99], a[8:11], v[200:203], v[96:99]
    v_cvt_pk_bf16_f32 v8, v164, v165
    v_accvgpr_write_b32 a127, v203
    v_mfma_f32_16x16x32_bf16 v[96:99], a[12:15], v[204:207], v[96:99]
    buffer_store_dwordx4 a[212:215], v1, s[8:11], s88 offen offset:1024 sc1
    v_accvgpr_write_b32 a128, v204
    v_mfma_f32_16x16x32_bf16 v[100:103], a[16:19], v[192:195], v[140:143]
    v_exp_f32 v166, v166
    v_accvgpr_write_b32 a129, v205
    v_mfma_f32_16x16x32_bf16 v[100:103], a[20:23], v[196:199], v[100:103]
    v_exp_f32 v167, v167
    v_mfma_f32_16x16x32_bf16 v[100:103], a[24:27], v[200:203], v[100:103]
    v_cvt_pk_bf16_f32 v9, v166, v167
    v_accvgpr_write_b32 a130, v206
    v_accvgpr_write_b32 a131, v207
    v_mfma_f32_16x16x32_bf16 v[100:103], a[28:31], v[204:207], v[100:103]
    buffer_load_dwordx4 v1, s[8:11], s12 offen offset:1024 sc1 lds
    v_accvgpr_write_b32 a180, v208
    v_mfma_f32_16x16x32_bf16 v[104:107], a[0:3], v[208:211], v[152:155]
    v_exp_f32 v168, v168
    v_accvgpr_write_b32 a181, v209
    v_mfma_f32_16x16x32_bf16 v[104:107], a[4:7], v[212:215], v[104:107]
    v_exp_f32 v169, v169
    v_mfma_f32_16x16x32_bf16 v[104:107], a[8:11], v[216:219], v[104:107]
    ds_read_b128 a[32:35], v3 offset:0
    v_cvt_pk_bf16_f32 v10, v168, v169
    v_accvgpr_write_b32 a182, v210
    v_mfma_f32_16x16x32_bf16 v[104:107], a[12:15], v[220:223], v[104:107]
    ds_read_b128 a[36:39], v3 offset:1024
    v_accvgpr_write_b32 a183, v211
    v_accvgpr_write_b32 a184, v212
    v_mfma_f32_16x16x32_bf16 v[108:111], a[16:19], v[208:211], v[152:155]
    v_exp_f32 v170, v170
    v_mfma_f32_16x16x32_bf16 v[108:111], a[20:23], v[212:215], v[108:111]
    v_exp_f32 v171, v171
    v_accvgpr_write_b32 a185, v213
    v_mfma_f32_16x16x32_bf16 v[108:111], a[24:27], v[216:219], v[108:111]
    ds_read_b128 a[40:43], v3 offset:2048
    v_cvt_pk_bf16_f32 v11, v170, v171
    v_accvgpr_write_b32 a186, v214
    v_mfma_f32_16x16x32_bf16 v[108:111], a[28:31], v[220:223], v[108:111]
    ds_read_b128 a[44:47], v3 offset:3072
    v_accvgpr_write_b32 a187, v215
    v_accvgpr_write_b32 a188, v216
    v_mfma_f32_16x16x32_bf16 v[112:115], a[0:3], v[224:227], v[156:159]
    v_exp_f32 v172, v172
    v_mfma_f32_16x16x32_bf16 v[112:115], a[4:7], v[228:231], v[112:115]
    v_exp_f32 v173, v173
    v_accvgpr_write_b32 a189, v217
    v_mfma_f32_16x16x32_bf16 v[112:115], a[8:11], v[232:235], v[112:115]
    ds_read_b128 a[48:51], v3 offset:4096
    v_cvt_pk_bf16_f32 v12, v172, v173
    v_accvgpr_write_b32 a190, v218
    v_mfma_f32_16x16x32_bf16 v[112:115], a[12:15], v[236:239], v[112:115]
    ds_read_b128 a[52:55], v3 offset:5120
    v_accvgpr_write_b32 a191, v219
    v_mfma_f32_16x16x32_bf16 v[116:119], a[16:19], v[224:227], v[156:159]
    v_exp_f32 v174, v174
    v_accvgpr_write_b32 a192, v220
    v_mfma_f32_16x16x32_bf16 v[116:119], a[20:23], v[228:231], v[116:119]
    v_exp_f32 v175, v175
    v_accvgpr_write_b32 a193, v221
    v_mfma_f32_16x16x32_bf16 v[116:119], a[24:27], v[232:235], v[116:119]
    ds_read_b128 a[56:59], v3 offset:6144
    v_cvt_pk_bf16_f32 v13, v174, v175
    v_mfma_f32_16x16x32_bf16 v[116:119], a[28:31], v[236:239], v[116:119]
    ds_read_b128 a[60:63], v3 offset:7168
    v_accvgpr_write_b32 a194, v222
    v_accvgpr_write_b32 a195, v223
    v_mfma_f32_16x16x32_bf16 v[80:83], a[240:243], v[120:123], 0
    s_waitcnt lgkmcnt(4)
    v_exp_f32 v88, v88
    v_accvgpr_write_b32 a64, v224
    v_mfma_f32_16x16x32_bf16 v[16:19], a[32:35], v[120:123], 0
    v_exp_f32 v89, v89
    v_accvgpr_write_b32 a65, v225
    v_mfma_f32_16x16x32_bf16 v[20:23], a[32:35], v[124:127], 0
    v_cvt_pk_bf16_f32 v128, v88, v89
    v_accvgpr_write_b32 a66, v226
    v_mfma_f32_16x16x32_bf16 v[28:31], a[36:39], v[124:127], 0
    buffer_load_dwordx4 v1, s[8:11], s12 offen offset:2048 sc1 lds
    v_accvgpr_write_b32 a67, v227
    v_mfma_f32_16x16x32_bf16 v[24:27], a[36:39], v[120:123], 0
    v_exp_f32 v90, v90
    v_accvgpr_write_b32 a244, v228
    v_mfma_f32_16x16x32_bf16 v[32:35], a[40:43], v[120:123], 0
    v_exp_f32 v91, v91
    v_mfma_f32_16x16x32_bf16 v[36:39], a[40:43], v[124:127], 0
    v_cvt_pk_bf16_f32 v129, v90, v91
    v_accvgpr_write_b32 a245, v229
    v_accvgpr_write_b32 a246, v230
    v_mfma_f32_16x16x32_bf16 v[44:47], a[44:47], v[124:127], 0
    buffer_store_dwordx4 a[216:219], v1, s[8:11], s88 offen offset:2048 sc1
    v_accvgpr_write_b32 a247, v231
    v_mfma_f32_16x16x32_bf16 v[40:43], a[44:47], v[120:123], 0
    s_waitcnt lgkmcnt(0)
    v_exp_f32 v92, v92
    v_accvgpr_write_b32 a248, v232
    v_mfma_f32_16x16x32_bf16 v[48:51], a[48:51], v[120:123], 0
    v_exp_f32 v93, v93
    v_mfma_f32_16x16x32_bf16 v[52:55], a[48:51], v[124:127], 0
    ds_read_b128 a[0:3], v2 offset:16384
    v_cvt_pk_bf16_f32 v130, v92, v93
    v_accvgpr_write_b32 a249, v233
    v_mfma_f32_16x16x32_bf16 v[60:63], a[52:55], v[124:127], 0
    ds_read_b128 a[4:7], v2 offset:17408
    v_accvgpr_write_b32 a250, v234
    v_accvgpr_write_b32 a251, v235
    v_mfma_f32_16x16x32_bf16 v[56:59], a[52:55], v[120:123], 0
    v_exp_f32 v94, v94
    v_mfma_f32_16x16x32_bf16 v[64:67], a[56:59], v[120:123], 0
    v_exp_f32 v95, v95
    v_accvgpr_write_b32 a252, v236
    v_mfma_f32_16x16x32_bf16 v[68:71], a[56:59], v[124:127], 0
    ds_read_b128 a[8:11], v2 offset:18432
    v_cvt_pk_bf16_f32 v131, v94, v95
    v_accvgpr_write_b32 a253, v237
    v_mfma_f32_16x16x32_bf16 v[76:79], a[60:63], v[124:127], 0
    ds_read_b128 a[12:15], v2 offset:19456
    v_accvgpr_write_b32 a254, v238
    v_accvgpr_write_b32 a255, v239
    v_mfma_f32_16x16x32_bf16 v[72:75], a[60:63], v[120:123], 0
    v_exp_f32 v96, v96
    v_mfma_f32_16x16x32_bf16 v[84:87], a[240:243], v[124:127], 0
    v_exp_f32 v97, v97
    v_mfma_f32_16x16x32_bf16 v[240:243], a[240:243], v[6:9], 0
    ds_read_b128 a[16:19], v2 offset:20480
    v_cvt_pk_bf16_f32 v132, v96, v97
    v_mfma_f32_16x16x32_bf16 v[176:179], a[32:35], v[6:9], 0
    ds_read_b128 a[20:23], v2 offset:21504
    buffer_store_dwordx4 a[220:223], v1, s[8:11], s88 offen offset:3072 sc1
    v_mfma_f32_16x16x32_bf16 v[180:183], a[32:35], v[10:13], 0
    v_exp_f32 v98, v98
    v_mfma_f32_16x16x32_bf16 v[188:191], a[36:39], v[10:13], 0
    v_exp_f32 v99, v99
    v_mfma_f32_16x16x32_bf16 v[184:187], a[36:39], v[6:9], 0
    ds_read_b128 a[24:27], v2 offset:22528
    v_cvt_pk_bf16_f32 v133, v98, v99
    v_mfma_f32_16x16x32_bf16 v[192:195], a[40:43], v[6:9], 0
    ds_read_b128 a[28:31], v2 offset:23552
    buffer_store_dwordx4 a[224:227], v1, s[8:11], s89 offen offset:0 sc1
    v_mfma_f32_16x16x32_bf16 v[196:199], a[40:43], v[10:13], 0
    v_exp_f32 v100, v100
    v_mfma_f32_16x16x32_bf16 v[204:207], a[44:47], v[10:13], 0
    v_exp_f32 v101, v101
    v_mfma_f32_16x16x32_bf16 v[200:203], a[44:47], v[6:9], 0
    v_cvt_pk_bf16_f32 v134, v100, v101
    v_min_f32 v144, v136, v144
    v_min_f32 v145, v136, v145
    v_mfma_f32_16x16x32_bf16 v[208:211], a[48:51], v[6:9], 0
    buffer_load_dwordx4 v1, s[8:11], s12 offen offset:3072 sc1 lds
    v_mfma_f32_16x16x32_bf16 v[212:215], a[48:51], v[10:13], 0
    v_exp_f32 v102, v102
    v_mfma_f32_16x16x32_bf16 v[220:223], a[52:55], v[10:13], 0
    v_exp_f32 v103, v103
    v_mfma_f32_16x16x32_bf16 v[216:219], a[52:55], v[6:9], 0
    v_cvt_pk_bf16_f32 v135, v102, v103
    v_min_f32 v146, v136, v146
    v_mfma_f32_16x16x32_bf16 v[224:227], a[56:59], v[6:9], 0
    buffer_store_dwordx4 a[228:231], v1, s[8:11], s89 offen offset:1024 sc1
    v_mfma_f32_16x16x32_bf16 v[228:231], a[56:59], v[10:13], 0
    v_min_f32 v147, v136, v147
    v_min_f32 v148, v136, v148
    v_mfma_f32_16x16x32_bf16 v[236:239], a[60:63], v[10:13], 0
    buffer_store_dwordx4 a[232:235], v1, s[8:11], s89 offen offset:2048 sc1
    v_mfma_f32_16x16x32_bf16 v[232:235], a[60:63], v[6:9], 0
    v_min_f32 v149, v136, v149
    v_min_f32 v150, v136, v150
    v_min_f32 v151, v136, v151
    v_mfma_f32_16x16x32_bf16 v[244:247], a[240:243], v[10:13], 0
    s_waitcnt lgkmcnt(0)
    buffer_store_dwordx4 a[236:239], v1, s[8:11], s89 offen offset:3072 sc1
    s_branch L_A
L_q0d:
    v_min_f32 v144, v136, v144
pad10:
    s_cbranch_execz pad14
    v_min_f32 v145, v136, v145
    v_min_f32 v146, v136, v146
    v_min_f32 v147, v136, v147
    v_min_f32 v148, v136, v148
    v_min_f32 v149, v136, v149
    v_min_f32 v150, v136, v150
    v_min_f32 v151, v136, v151
    s_nop 0
    v_mfma_f32_16x16x32_bf16 v[88:91], a[68:71], v[176:179], v[144:147]
    s_add_u32 m0, s18, 65536
    v_sub_f32 v140, 0, v7
    v_sub_f32 v141, 0, v7
    v_mfma_f32_16x16x32_bf16 v[88:91], a[72:75], v[180:183], v[88:91]
    s_add_u32 s18, s18, 16384
    buffer_load_dwordx4 v1, s[8:11], s13 offen offset:0 sc1 lds
    v_mfma_f32_16x16x32_bf16 v[88:91], a[76:79], v[184:187], v[88:91]
    s_and_b32 s18, s18, 0xffff
    v_sub_f32 v142, 0, v7
    v_sub_f32 v143, 0, v7
    v_mfma_f32_16x16x32_bf16 v[88:91], a[80:83], v[188:191], v[88:91]
    s_add_u32 s62, s12, 16384
    v_sub_f32 v14, 0, v8
    v_sub_f32 v255, 0, v9
    v_mfma_f32_16x16x32_bf16 v[92:95], a[84:87], v[176:179], v[148:151]
    s_add_u32 s12, s12, 32768
    buffer_load_dwordx4 v1, s[8:11], s13 offen offset:1024 sc1 lds
    v_mfma_f32_16x16x32_bf16 v[92:95], a[88:91], v[180:183], v[92:95]
    s_add_u32 s14, s14, 1
    v_subrev_f32 v152, 0x74000000, v4
    v_subrev_f32 v153, 0x74040000, v4
    v_mfma_f32_16x16x32_bf16 v[92:95], a[92:95], v[184:187], v[92:95]
    s_cmp_eq_u32 s14, s15
    v_subrev_f32 v154, 0x74080000, v4
    v_subrev_f32 v155, 0x740c0000, v4
    v_mfma_f32_16x16x32_bf16 v[92:95], a[96:99], v[188:191], v[92:95]
    s_cselect_b32 s12, s16, s12
    buffer_load_dwordx4 v1, s[8:11], s13 offen offset:2048 sc1 lds
    v_mfma_f32_16x16x32_bf16 v[96:99], a[68:71], v[192:195], v[140:143]
    v_subrev_f32 v156, 0x74400000, v4
    v_subrev_f32 v157, 0x74440000, v4
    v_mfma_f32_16x16x32_bf16 v[96:99], a[72:75], v[196:199], v[96:99]
    v_exp_f32 v88, v88
    v_mfma_f32_16x16x32_bf16 v[96:99], a[76:79], v[200:203], v[96:99]
    buffer_load_dwordx4 v1, s[8:11], s13 offen offset:3072 sc1 lds
    v_mfma_f32_16x16x32_bf16 v[96:99], a[80:83], v[204:207], v[96:99]
    s_mov_b32 s13, s62
    v_exp_f32 v89, v89
    v_mfma_f32_16x16x32_bf16 v[100:103], a[84:87], v[192:195], v[140:143]
    v_exp_f32 v90, v90
    v_mfma_f32_16x16x32_bf16 v[100:103], a[88:91], v[196:199], v[100:103]
    v_exp_f32 v91, v91
    v_mfma_f32_16x16x32_bf16 v[100:103], a[92:95], v[200:203], v[100:103]
    v_exp_f32 v92, v92
    v_mfma_f32_16x16x32_bf16 v[100:103], a[96:99], v[204:207], v[100:103]
    v_exp_f32 v93, v93
    v_exp_f32 v94, v94
    v_exp_f32 v95, v95
    v_subrev_f32 v158, 0x74480000, v4
    v_subrev_f32 v159, 0x744c0000, v4
    v_subrev_f32 v160, 0x74800000, v5
    v_subrev_f32 v161, 0x74820000, v5
    v_subrev_f32 v162, 0x74840000, v5
    v_subrev_f32 v163, 0x74860000, v5
    v_subrev_f32 v164, 0x74a00000, v5
    v_subrev_f32 v165, 0x74a20000, v5
    v_subrev_f32 v166, 0x74a40000, v5
    v_subrev_f32 v167, 0x74a60000, v5
    v_subrev_f32 v168, 0x74c00000, v5
    v_subrev_f32 v169, 0x74c20000, v5
    v_subrev_f32 v170, 0x74c40000, v5
    v_subrev_f32 v171, 0x74c60000, v5
    v_subrev_f32 v172, 0x74e00000, v5
    v_subrev_f32 v173, 0x74e20000, v5
    v_subrev_f32 v174, 0x74e40000, v5
    v_subrev_f32 v175, 0x74e60000, v5
    v_min_f32 v152, v136, v152
    v_min_f32 v153, v136, v153
    v_min_f32 v154, v136, v154
    v_min_f32 v155, v136, v155
    v_min_f32 v156, v136, v156
    v_min_f32 v157, v136, v157
    v_min_f32 v158, v136, v158
    v_min_f32 v159, v136, v159
    v_min_f32 v160, v140, v160
    v_min_f32 v161, v140, v161
    v_min_f32 v162, v140, v162
    v_min_f32 v163, v140, v163
    v_min_f32 v164, v140, v164
    v_min_f32 v165, v140, v165
    v_min_f32 v166, v140, v166
    v_min_f32 v167, v140, v167
    v_min_f32 v168, v140, v168
    v_min_f32 v169, v140, v169
    v_min_f32 v170, v140, v170
    v_min_f32 v171, v140, v171
    v_min_f32 v172, v140, v172
    v_min_f32 v173, v140, v173
    v_min_f32 v174, v140, v174
    v_min_f32 v175, v140, v175
    v_accvgpr_write_b32 a116, v192
    v_accvgpr_write_b32 a117, v193
    v_accvgpr_write_b32 a118, v194
    v_accvgpr_write_b32 a119, v195
    v_accvgpr_write_b32 a120, v196
    v_accvgpr_write_b32 a121, v197
    v_accvgpr_write_b32 a122, v198
    v_accvgpr_write_b32 a123, v199
    v_accvgpr_write_b32 a124, v200
    v_accvgpr_write_b32 a125, v201
    v_accvgpr_write_b32 a126, v202
    v_accvgpr_write_b32 a127, v203
    v_accvgpr_write_b32 a128, v204
    v_accvgpr_write_b32 a129, v205
    v_accvgpr_write_b32 a130, v206
    v_accvgpr_write_b32 a131, v207
    v_accvgpr_write_b32 a180, v208
    v_accvgpr_write_b32 a181, v209
    v_accvgpr_write_b32 a182, v210
    v_accvgpr_write_b32 a183, v211
    v_accvgpr_write_b32 a184, v212
    v_accvgpr_write_b32 a185, v213
    v_accvgpr_write_b32 a186, v214
    v_accvgpr_write_b32 a187, v215
    v_accvgpr_write_b32 a188, v216
    v_accvgpr_write_b32 a189, v217
    v_accvgpr_write_b32 a190, v218
    v_accvgpr_write_b32 a191, v219
    v_accvgpr_write_b32 a192, v220
    v_accvgpr_write_b32 a193, v221
    v_accvgpr_write_b32 a194, v222
    v_accvgpr_write_b32 a195, v223
    v_accvgpr_write_b32 a64, v224
    v_accvgpr_write_b32 a65, v225
    v_accvgpr_write_b32 a66, v226
    v_accvgpr_write_b32 a67, v227
    v_accvgpr_write_b32 a244, v228
    v_accvgpr_write_b32 a245, v229
    v_accvgpr_write_b32 a246, v230
    v_accvgpr_write_b32 a247, v231
    v_accvgpr_write_b32 a248, v232
    v_accvgpr_write_b32 a249, v233
    v_accvgpr_write_b32 a250, v234
    v_accvgpr_write_b32 a251, v235
    v_accvgpr_write_b32 a252, v236
    v_accvgpr_write_b32 a253, v237
    v_accvgpr_write_b32 a254, v238
    v_accvgpr_write_b32 a255, v239
    v_cvt_pk_bf16_f32 v120, v88, v89
    v_cvt_pk_bf16_f32 v121, v90, v91
    v_cvt_pk_bf16_f32 v122, v92, v93
    v_cvt_pk_bf16_f32 v123, v94, v95
    s_waitcnt vmcnt(16)
    s_barrier
    v_mfma_f32_16x16x32_bf16 v[104:107], a[0:3], a[100:103], v[152:155]
    v_exp_f32 v96, v96
    v_mfma_f32_16x16x32_bf16 v[104:107], a[4:7], a[104:107], v[104:107]
    v_exp_f32 v97, v97
    v_mfma_f32_16x16x32_bf16 v[104:107], a[8:11], a[108:111], v[104:107]
    ds_read_b128 a[32:35], v3 offset:0
    buffer_store_dwordx4 a[208:211], v1, s[8:11], s88 offen offset:0 sc1
    v_cvt_pk_bf16_f32 v124, v96, v97
    v_mfma_f32_16x16x32_bf16 v[104:107], a[12:15], a[112:115], v[104:107]
    v_exp_f32 v98, v98
    v_mfma_f32_16x16x32_bf16 v[108:111], a[16:19], a[100:103], v[156:159]
    v_exp_f32 v99, v99
    v_mfma_f32_16x16x32_bf16 v[108:111], a[20:23], a[104:107], v[108:111]
    s_mov_b32 m0, s17
    ds_read_b128 a[36:39], v3 offset:1024
    v_cvt_pk_bf16_f32 v125, v98, v99
    v_mfma_f32_16x16x32_bf16 v[108:111], a[24:27], a[108:111], v[108:111]
    s_add_u32 s17, s17, 16384
    buffer_load_dwordx4 v1, s[8:11], s12 offen offset:0 sc1 lds
    v_mfma_f32_16x16x32_bf16 v[108:111], a[28:31], a[112:115], v[108:111]
    s_and_b32 s17, s17, 0xffff
    v_exp_f32 v100, v100
    v_mfma_f32_16x16x32_bf16 v[112:115], a[0:3], a[116:119], v[140:143]
    v_exp_f32 v101, v101
    v_mfma_f32_16x16x32_bf16 v[112:115], a[4:7], a[120:123], v[112:115]
    ds_read_b128 a[40:43], v3 offset:2048
    v_cvt_pk_bf16_f32 v126, v100, v101
    v_mfma_f32_16x16x32_bf16 v[112:115], a[8:11], a[124:127], v[112:115]
    buffer_store_dwordx4 a[212:215], v1, s[8:11], s88 offen offset:1024 sc1
    v_exp_f32 v102, v102
    v_mfma_f32_16x16x32_bf16 v[112:115], a[12:15], a[128:131], v[112:115]
    v_exp_f32 v103, v103
    v_mfma_f32_16x16x32_bf16 v[116:119], a[16:19], a[116:119], v[140:143]
    ds_read_b128 a[44:47], v3 offset:3072
    v_cvt_pk_bf16_f32 v127, v102, v103
    v_mfma_f32_16x16x32_bf16 v[116:119], a[20:23], a[120:123], v[116:119]
    ds_read_b128 a[48:51], v3 offset:4096
    ds_read_b128 a[52:55], v3 offset:5120
    v_mfma_f32_16x16x32_bf16 v[116:119], a[24:27], a[124:127], v[116:119]
    ds_read_b128 a[56:59], v3 offset:6144
    ds_read_b128 a[60:63], v3 offset:7168
    v_mfma_f32_16x16x32_bf16 v[116:119], a[28:31], a[128:131], v[116:119]
    s_waitcnt lgkmcnt(4)
    buffer_load_dwordx4 v1, s[8:11], s12 offen offset:1024 sc1 lds
    v_mfma_f32_16x16x32_bf16 v[80:83], a[240:243], v[120:123], 0
    ds_read_b128 a[0:3], v2 offset:16384
    ds_read_b128 a[4:7], v2 offset:17408
    v_mfma_f32_16x16x32_bf16 v[16:19], a[32:35], v[120:123], 0
    v_exp_f32 v104, v104
    v_mfma_f32_16x16x32_bf16 v[20:23], a[32:35], v[124:127], 0
    ds_read_b128 a[8:11], v2 offset:18432
    ds_read_b128 a[12:15], v2 offset:19456
    v_mfma_f32_16x16x32_bf16 v[28:31], a[36:39], v[124:127], 0
    buffer_store_dwordx4 a[216:219], v1, s[8:11], s88 offen offset:2048 sc1
    v_exp_f32 v105, v105
    v_mfma_f32_16x16x32_bf16 v[24:27], a[36:39], v[120:123], 0
    ds_read_b128 a[16:19], v2 offset:20480
    v_cvt_pk_bf16_f32 v128, v104, v105
    v_mfma_f32_16x16x32_bf16 v[32:35], a[40:43], v[120:123], 0
    v_exp_f32 v106, v106
    v_mfma_f32_16x16x32_bf16 v[36:39], a[40:43], v[124:127], 0
    v_exp_f32 v107, v107
    v_mfma_f32_16x16x32_bf16 v[44:47], a[44:47], v[124:127], 0
    s_waitcnt lgkmcnt(5)
    ds_read_b128 a[20:23], v2 offset:21504
    buffer_store_dwordx4 a[220:223], v1, s[8:11], s88 offen offset:3072 sc1
    v_cvt_pk_bf16_f32 v129, v106, v107
    v_mfma_f32_16x16x32_bf16 v[40:43], a[44:47], v[120:123], 0
    v_exp_f32 v108, v108
    v_mfma_f32_16x16x32_bf16 v[48:51], a[48:51], v[120:123], 0
    ds_read_b128 a[24:27], v2 offset:22528
    ds_read_b128 a[28:31], v2 offset:23552
    v_mfma_f32_16x16x32_bf16 v[52:55], a[48:51], v[124:127], 0
    ds_read_b128 a[68:71], v2 offset:24576
    v_exp_f32 v109, v109
    v_mfma_f32_16x16x32_bf16 v[60:63], a[52:55], v[124:127], 0
    ds_read_b128 a[72:75], v2 offset:25600
    buffer_load_dwordx4 v1, s[8:11], s12 offen offset:2048 sc1 lds
    v_mfma_f32_16x16x32_bf16 v[56:59], a[52:55], v[120:123], 0
    ds_read_b128 a[76:79], v2 offset:26624
    v_exp_f32 v110, v110
    v_mfma_f32_16x16x32_bf16 v[64:67], a[56:59], v[120:123], 0
    ds_read_b128 a[80:83], v2 offset:27648
    v_cvt_pk_bf16_f32 v130, v108, v109
    v_mfma_f32_16x16x32_bf16 v[68:71], a[56:59], v[124:127], 0
    ds_read_b128 a[84:87], v2 offset:28672
    v_exp_f32 v111, v111
    v_mfma_f32_16x16x32_bf16 v[76:79], a[60:63], v[124:127], 0
    ds_read_b128 a[88:91], v2 offset:29696
    buffer_load_dwordx4 v1, s[8:11], s12 offen offset:3072 sc1 lds
    v_mfma_f32_16x16x32_bf16 v[72:75], a[60:63], v[120:123], 0
    ds_read_b128 a[92:95], v2 offset:30720
    v_cvt_pk_bf16_f32 v131, v110, v111
    v_mfma_f32_16x16x32_bf16 v[84:87], a[240:243], v[124:127], 0
    s_waitcnt lgkmcnt(11)
    ds_read_b128 a[96:99], v2 offset:31744
    s_branch L_X
.p2align 6
L_loop:
    v_mfma_f32_16x16x32_bf16 v[88:91], a[0:3], a[100:103], v[136:139]
pad11:
    s_cbranch_execz pad15
    v_exp_f32 v104, v104
    v_mfma_f32_16x16x32_bf16 v[88:91], a[4:7], a[104:107], v[88:91]
    v_exp_f32 v105, v105
    v_mfma_f32_16x16x32_bf16 v[88:91], a[8:11], a[108:111], v[88:91]
    s_add_u32 m0, s18, 65536
    v_cvt_pk_bf16_f32 v6, v104, v105
    v_mfma_f32_16x16x32_bf16 v[88:91], a[12:15], a[112:115], v[88:91]
    s_add_u32 s18, s18, 16384
    buffer_load_dwordx4 v1, s[8:11], s13 offen offset:0 sc1 lds
    v_mfma_f32_16x16x32_bf16 v[92:95], a[16:19], a[100:103], v[136:139]
    s_and_b32 s18, s18, 0xffff
    v_exp_f32 v106, v106
    v_mfma_f32_16x16x32_bf16 v[92:95], a[20:23], a[104:107], v[92:95]
    s_add_u32 s62, s12, 16384
    v_exp_f32 v107, v107
    v_mfma_f32_16x16x32_bf16 v[92:95], a[24:27], a[108:111], v[92:95]
    s_add_u32 s12, s12, 32768
    v_cvt_pk_bf16_f32 v7, v106, v107
    v_mfma_f32_16x16x32_bf16 v[92:95], a[28:31], a[112:115], v[92:95]
    s_add_u32 s14, s14, 1
    v_mfma_f32_16x16x32_bf16 v[96:99], a[0:3], a[116:119], v[140:143]
    s_cmp_eq_u32 s14, s15
    v_exp_f32 v108, v108
    v_mfma_f32_16x16x32_bf16 v[96:99], a[4:7], a[120:123], v[96:99]
    s_cselect_b32 s12, s16, s12
    v_exp_f32 v109, v109
    v_mfma_f32_16x16x32_bf16 v[96:99], a[8:11], a[124:127], v[96:99]
pad12:
    s_cbranch_execz pad16
    v_cvt_pk_bf16_f32 v8, v108, v109
    v_mfma_f32_16x16x32_bf16 v[96:99], a[12:15], a[128:131], v[96:99]
    v_mfma_f32_16x16x32_bf16 v[100:103], a[16:19], a[116:119], v[140:143]
    v_exp_f32 v110, v110
    v_mfma_f32_16x16x32_bf16 v[100:103], a[20:23], a[120:123], v[100:103]
    v_exp_f32 v111, v111
    v_mfma_f32_16x16x32_bf16 v[100:103], a[24:27], a[124:127], v[100:103]
    v_cvt_pk_bf16_f32 v9, v110, v111
    v_mfma_f32_16x16x32_bf16 v[100:103], a[28:31], a[128:131], v[100:103]
    buffer_load_dwordx4 v1, s[8:11], s13 offen offset:1024 sc1 lds
    v_mfma_f32_16x16x32_bf16 v[160:163], a[0:3], a[180:183], v[152:155]
    v_exp_f32 v112, v112
    v_mfma_f32_16x16x32_bf16 v[160:163], a[4:7], a[184:187], v[160:163]
    v_exp_f32 v113, v113
    v_mfma_f32_16x16x32_bf16 v[160:163], a[8:11], a[188:191], v[160:163]
    ds_read_b128 a[32:35], v3 offset:24576
    v_cvt_pk_bf16_f32 v10, v112, v113
    v_mfma_f32_16x16x32_bf16 v[160:163], a[12:15], a[192:195], v[160:163]
    ds_read_b128 a[36:39], v3 offset:25600
    v_mfma_f32_16x16x32_bf16 v[164:167], a[16:19], a[180:183], v[152:155]
    v_exp_f32 v114, v114
    v_mfma_f32_16x16x32_bf16 v[164:167], a[20:23], a[184:187], v[164:167]
    v_exp_f32 v115, v115
    v_mfma_f32_16x16x32_bf16 v[164:167], a[24:27], a[188:191], v[164:167]
    ds_read_b128 a[40:43], v3 offset:26624
    v_cvt_pk_bf16_f32 v11, v114, v115
    v_mfma_f32_16x16x32_bf16 v[164:167], a[28:31], a[192:195], v[164:167]
    ds_read_b128 a[44:47], v3 offset:27648
    v_mfma_f32_16x16x32_bf16 v[168:171], a[0:3], a[64:67], v[156:159]
    v_exp_f32 v116, v116
    v_mfma_f32_16x16x32_bf16 v[168:171], a[4:7], a[244:247], v[168:171]
    v_exp_f32 v117, v117
    v_mfma_f32_16x16x32_bf16 v[168:171], a[8:11], a[248:251], v[168:171]
    ds_read_b128 a[48:51], v3 offset:28672
    v_cvt_pk_bf16_f32 v12, v116, v117
    v_mfma_f32_16x16x32_bf16 v[168:171], a[12:15], a[252:255], v[168:171]
    ds_read_b128 a[52:55], v3 offset:29696
    v_mfma_f32_16x16x32_bf16 v[172:175], a[16:19], a[64:67], v[156:159]
    v_exp_f32 v118, v118
    v_mfma_f32_16x16x32_bf16 v[172:175], a[20:23], a[244:247], v[172:175]
    v_exp_f32 v119, v119
    v_mfma_f32_16x16x32_bf16 v[172:175], a[24:27], a[248:251], v[172:175]
    ds_read_b128 a[56:59], v3 offset:30720
    v_cvt_pk_bf16_f32 v13, v118, v119
    v_mfma_f32_16x16x32_bf16 v[172:175], a[28:31], a[252:255], v[172:175]
    ds_read_b128 a[60:63], v3 offset:31744
    v_mfma_f32_16x16x32_bf16 v[84:87], a[240:243], v[132:135], v[84:87]
    s_waitcnt lgkmcnt(4)
    v_exp_f32 v88, v88
    v_mfma_f32_16x16x32_bf16 v[80:83], a[240:243], v[128:131], v[80:83]
    v_exp_f32 v89, v89
    v_mfma_f32_16x16x32_bf16 v[16:19], a[32:35], v[128:131], v[16:19]
    v_cvt_pk_bf16_f32 v120, v88, v89
    v_mfma_f32_16x16x32_bf16 v[20:23], a[32:35], v[132:135], v[20:23]
    buffer_load_dwordx4 v1, s[8:11], s13 offen offset:2048 sc1 lds
    v_mfma_f32_16x16x32_bf16 v[180:183], a[32:35], v[10:13], v[180:183]
    v_exp_f32 v90, v90
    v_mfma_f32_16x16x32_bf16 v[176:179], a[32:35], v[6:9], v[176:179]
    v_exp_f32 v91, v91
    v_mfma_f32_16x16x32_bf16 v[184:187], a[36:39], v[6:9], v[184:187]
    v_cvt_pk_bf16_f32 v121, v90, v91
    v_mfma_f32_16x16x32_bf16 v[188:191], a[36:39], v[10:13], v[188:191]
    v_mfma_f32_16x16x32_bf16 v[28:31], a[36:39], v[132:135], v[28:31]
    v_exp_f32 v92, v92
    v_mfma_f32_16x16x32_bf16 v[24:27], a[36:39], v[128:131], v[24:27]
    s_waitcnt lgkmcnt(0)
    v_exp_f32 v93, v93
    v_mfma_f32_16x16x32_bf16 v[32:35], a[40:43], v[128:131], v[32:35]
    ds_read_b128 a[0:3], v2 offset:8192
    v_cvt_pk_bf16_f32 v122, v92, v93
    v_mfma_f32_16x16x32_bf16 v[36:39], a[40:43], v[132:135], v[36:39]
    ds_read_b128 a[4:7], v2 offset:9216
    v_mfma_f32_16x16x32_bf16 v[196:199], a[40:43], v[10:13], v[196:199]
    v_exp_f32 v94, v94
    v_mfma_f32_16x16x32_bf16 v[192:195], a[40:43], v[6:9], v[192:195]
    v_exp_f32 v95, v95
    v_mfma_f32_16x16x32_bf16 v[200:203], a[44:47], v[6:9], v[200:203]
    ds_read_b128 a[8:11], v2 offset:10240
    v_cvt_pk_bf16_f32 v123, v94, v95
    v_mfma_f32_16x16x32_bf16 v[204:207], a[44:47], v[10:13], v[204:207]
    ds_read_b128 a[12:15], v2 offset:11264
    v_mfma_f32_16x16x32_bf16 v[44:47], a[44:47], v[132:135], v[44:47]
    v_exp_f32 v96, v96
    v_mfma_f32_16x16x32_bf16 v[40:43], a[44:47], v[128:131], v[40:43]
    v_exp_f32 v97, v97
    v_mfma_f32_16x16x32_bf16 v[48:51], a[48:51], v[128:131], v[48:51]
    ds_read_b128 a[16:19], v2 offset:12288
    v_cvt_pk_bf16_f32 v124, v96, v97
    v_mfma_f32_16x16x32_bf16 v[52:55], a[48:51], v[132:135], v[52:55]
    ds_read_b128 a[20:23], v2 offset:13312
    v_mfma_f32_16x16x32_bf16 v[212:215], a[48:51], v[10:13], v[212:215]
    v_exp_f32 v98, v98
    v_mfma_f32_16x16x32_bf16 v[208:211], a[48:51], v[6:9], v[208:211]
    v_exp_f32 v99, v99
    v_mfma_f32_16x16x32_bf16 v[216:219], a[52:55], v[6:9], v[216:219]
    ds_read_b128 a[24:27], v2 offset:14336
    v_cvt_pk_bf16_f32 v125, v98, v99
    v_mfma_f32_16x16x32_bf16 v[220:223], a[52:55], v[10:13], v[220:223]
    ds_read_b128 a[28:31], v2 offset:15360
    v_mfma_f32_16x16x32_bf16 v[60:63], a[52:55], v[132:135], v[60:63]
    v_exp_f32 v100, v100
    v_mfma_f32_16x16x32_bf16 v[56:59], a[52:55], v[128:131], v[56:59]
    v_exp_f32 v101, v101
    v_mfma_f32_16x16x32_bf16 v[64:67], a[56:59], v[128:131], v[64:67]
    v_cvt_pk_bf16_f32 v126, v100, v101
    v_mfma_f32_16x16x32_bf16 v[68:71], a[56:59], v[132:135], v[68:71]
    buffer_load_dwordx4 v1, s[8:11], s13 offen offset:3072 sc1 lds
    v_mfma_f32_16x16x32_bf16 v[228:231], a[56:59], v[10:13], v[228:231]
    s_mov_b32 s13, s62
    v_exp_f32 v102, v102
    v_mfma_f32_16x16x32_bf16 v[224:227], a[56:59], v[6:9], v[224:227]
    v_exp_f32 v103, v103
    v_mfma_f32_16x16x32_bf16 v[232:235], a[60:63], v[6:9], v[232:235]
    v_cvt_pk_bf16_f32 v127, v102, v103
    v_mfma_f32_16x16x32_bf16 v[236:239], a[60:63], v[10:13], v[236:239]
    v_mfma_f32_16x16x32_bf16 v[76:79], a[60:63], v[132:135], v[76:79]
    v_xor_b32 v3, 0x8000, v3
    v_mfma_f32_16x16x32_bf16 v[72:75], a[60:63], v[128:131], v[72:75]
    v_mfma_f32_16x16x32_bf16 v[240:243], a[240:243], v[6:9], v[240:243]
    v_mfma_f32_16x16x32_bf16 v[244:247], a[240:243], v[10:13], v[244:247]
    s_waitcnt vmcnt(16) lgkmcnt(0)
    s_barrier
    v_mfma_f32_16x16x32_bf16 v[88:91], a[0:3], a[100:103], v[136:139]
    v_exp_f32 v160, v160
    v_mfma_f32_16x16x32_bf16 v[88:91], a[4:7], a[104:107], v[88:91]
    v_exp_f32 v161, v161
    v_mfma_f32_16x16x32_bf16 v[88:91], a[8:11], a[108:111], v[88:91]
    s_mov_b32 m0, s17
    v_cvt_pk_bf16_f32 v6, v160, v161
    v_mfma_f32_16x16x32_bf16 v[88:91], a[12:15], a[112:115], v[88:91]
    s_add_u32 s17, s17, 16384
    buffer_load_dwordx4 v1, s[8:11], s12 offen offset:0 sc1 lds
    v_mfma_f32_16x16x32_bf16 v[92:95], a[16:19], a[100:103], v[136:139]
    s_and_b32 s17, s17, 0xffff
    v_exp_f32 v162, v162
    v_mfma_f32_16x16x32_bf16 v[92:95], a[20:23], a[104:107], v[92:95]
    v_exp_f32 v163, v163
    v_mfma_f32_16x16x32_bf16 v[92:95], a[24:27], a[108:111], v[92:95]
    v_cvt_pk_bf16_f32 v7, v162, v163
    v_mfma_f32_16x16x32_bf16 v[92:95], a[28:31], a[112:115], v[92:95]
    v_mfma_f32_16x16x32_bf16 v[96:99], a[0:3], a[116:119], v[140:143]
    v_exp_f32 v164, v164
    v_mfma_f32_16x16x32_bf16 v[96:99], a[4:7], a[120:123], v[96:99]
    v_exp_f32 v165, v165
    v_mfma_f32_16x16x32_bf16 v[96:99], a[8:11], a[124:127], v[96:99]
    v_cvt_pk_bf16_f32 v8, v164, v165
    v_mfma_f32_16x16x32_bf16 v[96:99], a[12:15], a[128:131], v[96:99]
    v_mfma_f32_16x16x32_bf16 v[100:103], a[16:19], a[116:119], v[140:143]
    v_exp_f32 v166, v166
    v_mfma_f32_16x16x32_bf16 v[100:103], a[20:23], a[120:123], v[100:103]
    v_exp_f32 v167, v167
    v_mfma_f32_16x16x32_bf16 v[100:103], a[24:27], a[124:127], v[100:103]
    v_cvt_pk_bf16_f32 v9, v166, v167
    v_mfma_f32_16x16x32_bf16 v[100:103], a[28:31], a[128:131], v[100:103]
    buffer_load_dwordx4 v1, s[8:11], s12 offen offset:1024 sc1 lds
    v_mfma_f32_16x16x32_bf16 v[104:107], a[0:3], a[180:183], v[152:155]
    v_exp_f32 v168, v168
    v_mfma_f32_16x16x32_bf16 v[104:107], a[4:7], a[184:187], v[104:107]
    v_exp_f32 v169, v169
    v_mfma_f32_16x16x32_bf16 v[104:107], a[8:11], a[188:191], v[104:107]
    ds_read_b128 a[32:35], v3 offset:0
    v_cvt_pk_bf16_f32 v10, v168, v169
    v_mfma_f32_16x16x32_bf16 v[104:107], a[12:15], a[192:195], v[104:107]
    ds_read_b128 a[36:39], v3 offset:1024
    v_mfma_f32_16x16x32_bf16 v[108:111], a[16:19], a[180:183], v[152:155]
    v_exp_f32 v170, v170
    v_mfma_f32_16x16x32_bf16 v[108:111], a[20:23], a[184:187], v[108:111]
    v_exp_f32 v171, v171
    v_mfma_f32_16x16x32_bf16 v[108:111], a[24:27], a[188:191], v[108:111]
    ds_read_b128 a[40:43], v3 offset:2048
    v_cvt_pk_bf16_f32 v11, v170, v171
    v_mfma_f32_16x16x32_bf16 v[108:111], a[28:31], a[192:195], v[108:111]
    ds_read_b128 a[44:47], v3 offset:3072
    v_mfma_f32_16x16x32_bf16 v[112:115], a[0:3], a[64:67], v[156:159]
    v_exp_f32 v172, v172
    v_mfma_f32_16x16x32_bf16 v[112:115], a[4:7], a[244:247], v[112:115]
    v_exp_f32 v173, v173
    v_mfma_f32_16x16x32_bf16 v[112:115], a[8:11], a[248:251], v[112:115]
    ds_read_b128 a[48:51], v3 offset:4096
    v_cvt_pk_bf16_f32 v12, v172, v173
    v_mfma_f32_16x16x32_bf16 v[112:115], a[12:15], a[252:255], v[112:115]
    ds_read_b128 a[52:55], v3 offset:5120
    v_mfma_f32_16x16x32_bf16 v[116:119], a[16:19], a[64:67], v[156:159]
    v_exp_f32 v174, v174
    v_mfma_f32_16x16x32_bf16 v[116:119], a[20:23], a[244:247], v[116:119]
    v_exp_f32 v175, v175
    v_mfma_f32_16x16x32_bf16 v[116:119], a[24:27], a[248:251], v[116:119]
    ds_read_b128 a[56:59], v3 offset:6144
    v_cvt_pk_bf16_f32 v13, v174, v175
    v_mfma_f32_16x16x32_bf16 v[116:119], a[28:31], a[252:255], v[116:119]
    ds_read_b128 a[60:63], v3 offset:7168
    v_mfma_f32_16x16x32_bf16 v[84:87], a[240:243], v[124:127], v[84:87]
    s_waitcnt lgkmcnt(4)
    v_exp_f32 v88, v88
    v_mfma_f32_16x16x32_bf16 v[80:83], a[240:243], v[120:123], v[80:83]
    v_exp_f32 v89, v89
    v_mfma_f32_16x16x32_bf16 v[16:19], a[32:35], v[120:123], v[16:19]
    v_cvt_pk_bf16_f32 v128, v88, v89
    v_mfma_f32_16x16x32_bf16 v[20:23], a[32:35], v[124:127], v[20:23]
    buffer_load_dwordx4 v1, s[8:11], s12 offen offset:2048 sc1 lds
    v_mfma_f32_16x16x32_bf16 v[180:183], a[32:35], v[10:13], v[180:183]
    v_exp_f32 v90, v90
    v_mfma_f32_16x16x32_bf16 v[176:179], a[32:35], v[6:9], v[176:179]
    v_exp_f32 v91, v91
    v_mfma_f32_16x16x32_bf16 v[184:187], a[36:39], v[6:9], v[184:187]
    v_cvt_pk_bf16_f32 v129, v90, v91
    v_mfma_f32_16x16x32_bf16 v[188:191], a[36:39], v[10:13], v[188:191]
    v_mfma_f32_16x16x32_bf16 v[28:31], a[36:39], v[124:127], v[28:31]
    v_exp_f32 v92, v92
    v_mfma_f32_16x16x32_bf16 v[24:27], a[36:39], v[120:123], v[24:27]
    s_waitcnt lgkmcnt(0)
    v_exp_f32 v93, v93
    v_mfma_f32_16x16x32_bf16 v[32:35], a[40:43], v[120:123], v[32:35]
    ds_read_b128 a[0:3], v2 offset:16384
    v_cvt_pk_bf16_f32 v130, v92, v93
    v_mfma_f32_16x16x32_bf16 v[36:39], a[40:43], v[124:127], v[36:39]
    ds_read_b128 a[4:7], v2 offset:17408
    v_mfma_f32_16x16x32_bf16 v[196:199], a[40:43], v[10:13], v[196:199]
    v_exp_f32 v94, v94
    v_mfma_f32_16x16x32_bf16 v[192:195], a[40:43], v[6:9], v[192:195]
    v_exp_f32 v95, v95
    v_mfma_f32_16x16x32_bf16 v[200:203], a[44:47], v[6:9], v[200:203]
    ds_read_b128 a[8:11], v2 offset:18432
    v_cvt_pk_bf16_f32 v131, v94, v95
    v_mfma_f32_16x16x32_bf16 v[204:207], a[44:47], v[10:13], v[204:207]
    ds_read_b128 a[12:15], v2 offset:19456
    v_mfma_f32_16x16x32_bf16 v[44:47], a[44:47], v[124:127], v[44:47]
    v_exp_f32 v96, v96
    v_mfma_f32_16x16x32_bf16 v[40:43], a[44:47], v[120:123], v[40:43]
    v_exp_f32 v97, v97
    v_mfma_f32_16x16x32_bf16 v[48:51], a[48:51], v[120:123], v[48:51]
    ds_read_b128 a[16:19], v2 offset:20480
    v_cvt_pk_bf16_f32 v132, v96, v97
    v_mfma_f32_16x16x32_bf16 v[52:55], a[48:51], v[124:127], v[52:55]
    ds_read_b128 a[20:23], v2 offset:21504
    v_mfma_f32_16x16x32_bf16 v[212:215], a[48:51], v[10:13], v[212:215]
    v_exp_f32 v98, v98
    v_mfma_f32_16x16x32_bf16 v[208:211], a[48:51], v[6:9], v[208:211]
    v_exp_f32 v99, v99
    v_mfma_f32_16x16x32_bf16 v[216:219], a[52:55], v[6:9], v[216:219]
    ds_read_b128 a[24:27], v2 offset:22528
    v_cvt_pk_bf16_f32 v133, v98, v99
    v_mfma_f32_16x16x32_bf16 v[220:223], a[52:55], v[10:13], v[220:223]
    ds_read_b128 a[28:31], v2 offset:23552
    v_mfma_f32_16x16x32_bf16 v[60:63], a[52:55], v[124:127], v[60:63]
    v_exp_f32 v100, v100
    v_mfma_f32_16x16x32_bf16 v[56:59], a[52:55], v[120:123], v[56:59]
    v_exp_f32 v101, v101
    v_mfma_f32_16x16x32_bf16 v[64:67], a[56:59], v[120:123], v[64:67]
    v_cvt_pk_bf16_f32 v134, v100, v101
    v_mfma_f32_16x16x32_bf16 v[68:71], a[56:59], v[124:127], v[68:71]
    buffer_load_dwordx4 v1, s[8:11], s12 offen offset:3072 sc1 lds
    v_mfma_f32_16x16x32_bf16 v[228:231], a[56:59], v[10:13], v[228:231]
    v_exp_f32 v102, v102
    v_mfma_f32_16x16x32_bf16 v[224:227], a[56:59], v[6:9], v[224:227]
    v_exp_f32 v103, v103
    v_mfma_f32_16x16x32_bf16 v[232:235], a[60:63], v[6:9], v[232:235]
    v_cvt_pk_bf16_f32 v135, v102, v103
    v_mfma_f32_16x16x32_bf16 v[236:239], a[60:63], v[10:13], v[236:239]
    v_mfma_f32_16x16x32_bf16 v[76:79], a[60:63], v[124:127], v[76:79]
    v_mfma_f32_16x16x32_bf16 v[72:75], a[60:63], v[120:123], v[72:75]
    v_mfma_f32_16x16x32_bf16 v[240:243], a[240:243], v[6:9], v[240:243]
    v_mfma_f32_16x16x32_bf16 v[244:247], a[240:243], v[10:13], v[244:247]
    s_waitcnt lgkmcnt(0)
L_A:
pad13:
    s_cbranch_execz pad17
    v_mfma_f32_16x16x32_bf16 v[88:91], a[0:3], a[100:103], v[136:139]
    v_exp_f32 v104, v104
    v_mfma_f32_16x16x32_bf16 v[88:91], a[4:7], a[104:107], v[88:91]
    v_exp_f32 v105, v105
    v_mfma_f32_16x16x32_bf16 v[88:91], a[8:11], a[108:111], v[88:91]
    s_add_u32 m0, s18, 65536
    v_cvt_pk_bf16_f32 v6, v104, v105
    v_mfma_f32_16x16x32_bf16 v[88:91], a[12:15], a[112:115], v[88:91]
    s_add_u32 s18, s18, 16384
    buffer_load_dwordx4 v1, s[8:11], s13 offen offset:0 sc1 lds
    v_mfma_f32_16x16x32_bf16 v[92:95], a[16:19], a[100:103], v[136:139]
    s_and_b32 s18, s18, 0xffff
    v_exp_f32 v106, v106
    v_mfma_f32_16x16x32_bf16 v[92:95], a[20:23], a[104:107], v[92:95]
    s_add_u32 s62, s12, 16384
    v_exp_f32 v107, v107
    v_mfma_f32_16x16x32_bf16 v[92:95], a[24:27], a[108:111], v[92:95]
    s_add_u32 s12, s12, 32768
    v_cvt_pk_bf16_f32 v7, v106, v107
    v_mfma_f32_16x16x32_bf16 v[92:95], a[28:31], a[112:115], v[92:95]
    s_add_u32 s14, s14, 1
    v_mfma_f32_16x16x32_bf16 v[96:99], a[0:3], a[116:119], v[140:143]
    s_cmp_eq_u32 s14, s15
    v_exp_f32 v108, v108
    v_mfma_f32_16x16x32_bf16 v[96:99], a[4:7], a[120:123], v[96:99]
    s_cselect_b32 s12, s16, s12
    v_exp_f32 v109, v109
    v_mfma_f32_16x16x32_bf16 v[96:99], a[8:11], a[124:127], v[96:99]
    v_cvt_pk_bf16_f32 v8, v108, v109
    v_mfma_f32_16x16x32_bf16 v[96:99], a[12:15], a[128:131], v[96:99]
    v_mfma_f32_16x16x32_bf16 v[100:103], a[16:19], a[116:119], v[140:143]
    v_exp_f32 v110, v110
    v_mfma_f32_16x16x32_bf16 v[100:103], a[20:23], a[120:123], v[100:103]
    v_exp_f32 v111, v111
    v_mfma_f32_16x16x32_bf16 v[100:103], a[24:27], a[124:127], v[100:103]
    v_cvt_pk_bf16_f32 v9, v110, v111
    v_mfma_f32_16x16x32_bf16 v[100:103], a[28:31], a[128:131], v[100:103]
    buffer_load_dwordx4 v1, s[8:11], s13 offen offset:1024 sc1 lds
    v_mfma_f32_16x16x32_bf16 v[160:163], a[0:3], a[180:183], v[152:155]
    v_exp_f32 v112, v112
    v_mfma_f32_16x16x32_bf16 v[160:163], a[4:7], a[184:187], v[160:163]
    v_exp_f32 v113, v113
    v_mfma_f32_16x16x32_bf16 v[160:163], a[8:11], a[188:191], v[160:163]
    ds_read_b128 a[32:35], v3 offset:8192
    v_cvt_pk_bf16_f32 v10, v112, v113
    v_mfma_f32_16x16x32_bf16 v[160:163], a[12:15], a[192:195], v[160:163]
    ds_read_b128 a[36:39], v3 offset:9216
    v_mfma_f32_16x16x32_bf16 v[164:167], a[16:19], a[180:183], v[152:155]
    v_exp_f32 v114, v114
    v_mfma_f32_16x16x32_bf16 v[164:167], a[20:23], a[184:187], v[164:167]
    v_exp_f32 v115, v115
    v_mfma_f32_16x16x32_bf16 v[164:167], a[24:27], a[188:191], v[164:167]
    ds_read_b128 a[40:43], v3 offset:10240
    v_cvt_pk_bf16_f32 v11, v114, v115
    v_mfma_f32_16x16x32_bf16 v[164:167], a[28:31], a[192:195], v[164:167]
    ds_read_b128 a[44:47], v3 offset:11264
    v_mfma_f32_16x16x32_bf16 v[168:171], a[0:3], a[64:67], v[156:159]
    v_exp_f32 v116, v116
    v_mfma_f32_16x16x32_bf16 v[168:171], a[4:7], a[244:247], v[168:171]
    v_exp_f32 v117, v117
    v_mfma_f32_16x16x32_bf16 v[168:171], a[8:11], a[248:251], v[168:171]
    ds_read_b128 a[48:51], v3 offset:12288
    v_cvt_pk_bf16_f32 v12, v116, v117
    v_mfma_f32_16x16x32_bf16 v[168:171], a[12:15], a[252:255], v[168:171]
    ds_read_b128 a[52:55], v3 offset:13312
    v_mfma_f32_16x16x32_bf16 v[172:175], a[16:19], a[64:67], v[156:159]
    v_exp_f32 v118, v118
    v_mfma_f32_16x16x32_bf16 v[172:175], a[20:23], a[244:247], v[172:175]
    v_exp_f32 v119, v119
    v_mfma_f32_16x16x32_bf16 v[172:175], a[24:27], a[248:251], v[172:175]
    ds_read_b128 a[56:59], v3 offset:14336
    v_cvt_pk_bf16_f32 v13, v118, v119
    v_mfma_f32_16x16x32_bf16 v[172:175], a[28:31], a[252:255], v[172:175]
    ds_read_b128 a[60:63], v3 offset:15360
    v_mfma_f32_16x16x32_bf16 v[84:87], a[240:243], v[132:135], v[84:87]
    s_waitcnt lgkmcnt(4)
    v_exp_f32 v88, v88
    v_mfma_f32_16x16x32_bf16 v[80:83], a[240:243], v[128:131], v[80:83]
    v_exp_f32 v89, v89
    v_mfma_f32_16x16x32_bf16 v[16:19], a[32:35], v[128:131], v[16:19]
    v_cvt_pk_bf16_f32 v120, v88, v89
    v_mfma_f32_16x16x32_bf16 v[20:23], a[32:35], v[132:135], v[20:23]
    buffer_load_dwordx4 v1, s[8:11], s13 offen offset:2048 sc1 lds
    v_mfma_f32_16x16x32_bf16 v[180:183], a[32:35], v[10:13], v[180:183]
    v_exp_f32 v90, v90
    v_mfma_f32_16x16x32_bf16 v[176:179], a[32:35], v[6:9], v[176:179]
    v_exp_f32 v91, v91
    v_mfma_f32_16x16x32_bf16 v[184:187], a[36:39], v[6:9], v[184:187]
    v_cvt_pk_bf16_f32 v121, v90, v91
    v_mfma_f32_16x16x32_bf16 v[188:191], a[36:39], v[10:13], v[188:191]
    v_mfma_f32_16x16x32_bf16 v[28:31], a[36:39], v[132:135], v[28:31]
    v_exp_f32 v92, v92
    v_mfma_f32_16x16x32_bf16 v[24:27], a[36:39], v[128:131], v[24:27]
    s_waitcnt lgkmcnt(0)
    v_exp_f32 v93, v93
    v_mfma_f32_16x16x32_bf16 v[32:35], a[40:43], v[128:131], v[32:35]
    ds_read_b128 a[0:3], v2 offset:24576
    v_cvt_pk_bf16_f32 v122, v92, v93
    v_mfma_f32_16x16x32_bf16 v[36:39], a[40:43], v[132:135], v[36:39]
    ds_read_b128 a[4:7], v2 offset:25600
    v_mfma_f32_16x16x32_bf16 v[196:199], a[40:43], v[10:13], v[196:199]
    v_exp_f32 v94, v94
    v_mfma_f32_16x16x32_bf16 v[192:195], a[40:43], v[6:9], v[192:195]
    v_exp_f32 v95, v95
    v_mfma_f32_16x16x32_bf16 v[200:203], a[44:47], v[6:9], v[200:203]
    ds_read_b128 a[8:11], v2 offset:26624
    v_cvt_pk_bf16_f32 v123, v94, v95
    v_mfma_f32_16x16x32_bf16 v[204:207], a[44:47], v[10:13], v[204:207]
    ds_read_b128 a[12:15], v2 offset:27648
    v_mfma_f32_16x16x32_bf16 v[44:47], a[44:47], v[132:135], v[44:47]
    v_exp_f32 v96, v96
    v_mfma_f32_16x16x32_bf16 v[40:43], a[44:47], v[128:131], v[40:43]
    v_exp_f32 v97, v97
    v_mfma_f32_16x16x32_bf16 v[48:51], a[48:51], v[128:131], v[48:51]
    ds_read_b128 a[16:19], v2 offset:28672
    v_cvt_pk_bf16_f32 v124, v96, v97
    v_mfma_f32_16x16x32_bf16 v[52:55], a[48:51], v[132:135], v[52:55]
    ds_read_b128 a[20:23], v2 offset:29696
    v_mfma_f32_16x16x32_bf16 v[212:215], a[48:51], v[10:13], v[212:215]
    v_exp_f32 v98, v98
    v_mfma_f32_16x16x32_bf16 v[208:211], a[48:51], v[6:9], v[208:211]
    v_exp_f32 v99, v99
    v_mfma_f32_16x16x32_bf16 v[216:219], a[52:55], v[6:9], v[216:219]
    ds_read_b128 a[24:27], v2 offset:30720
    v_cvt_pk_bf16_f32 v125, v98, v99
    v_mfma_f32_16x16x32_bf16 v[220:223], a[52:55], v[10:13], v[220:223]
    ds_read_b128 a[28:31], v2 offset:31744
    v_mfma_f32_16x16x32_bf16 v[60:63], a[52:55], v[132:135], v[60:63]
    v_exp_f32 v100, v100
    v_mfma_f32_16x16x32_bf16 v[56:59], a[52:55], v[128:131], v[56:59]
    v_exp_f32 v101, v101
    v_mfma_f32_16x16x32_bf16 v[64:67], a[56:59], v[128:131], v[64:67]
    v_cvt_pk_bf16_f32 v126, v100, v101
    v_mfma_f32_16x16x32_bf16 v[68:71], a[56:59], v[132:135], v[68:71]
    buffer_load_dwordx4 v1, s[8:11], s13 offen offset:3072 sc1 lds
    v_mfma_f32_16x16x32_bf16 v[228:231], a[56:59], v[10:13], v[228:231]
    s_mov_b32 s13, s62
    v_exp_f32 v102, v102
    v_mfma_f32_16x16x32_bf16 v[224:227], a[56:59], v[6:9], v[224:227]
    v_exp_f32 v103, v103
    v_mfma_f32_16x16x32_bf16 v[232:235], a[60:63], v[6:9], v[232:235]
    v_cvt_pk_bf16_f32 v127, v102, v103
    v_mfma_f32_16x16x32_bf16 v[236:239], a[60:63], v[10:13], v[236:239]
    v_mfma_f32_16x16x32_bf16 v[76:79], a[60:63], v[132:135], v[76:79]
    v_xor_b32 v2, 0x8000, v2
    v_mfma_f32_16x16x32_bf16 v[72:75], a[60:63], v[128:131], v[72:75]
    v_mfma_f32_16x16x32_bf16 v[240:243], a[240:243], v[6:9], v[240:243]
    v_mfma_f32_16x16x32_bf16 v[244:247], a[240:243], v[10:13], v[244:247]
    s_waitcnt vmcnt(16) lgkmcnt(0)
    s_barrier
    v_mfma_f32_16x16x32_bf16 v[88:91], a[0:3], a[100:103], v[136:139]
    v_exp_f32 v160, v160
    v_mfma_f32_16x16x32_bf16 v[88:91], a[4:7], a[104:107], v[88:91]
    v_exp_f32 v161, v161
    v_mfma_f32_16x16x32_bf16 v[88:91], a[8:11], a[108:111], v[88:91]
    s_mov_b32 m0, s17
    v_cvt_pk_bf16_f32 v6, v160, v161
    v_mfma_f32_16x16x32_bf16 v[88:91], a[12:15], a[112:115], v[88:91]
    s_add_u32 s17, s17, 16384
    buffer_load_dwordx4 v1, s[8:11], s12 offen offset:0 sc1 lds
    v_mfma_f32_16x16x32_bf16 v[92:95], a[16:19], a[100:103], v[136:139]
    s_and_b32 s17, s17, 0xffff
    v_exp_f32 v162, v162
    v_mfma_f32_16x16x32_bf16 v[92:95], a[20:23], a[104:107], v[92:95]
    v_exp_f32 v163, v163
    v_mfma_f32_16x16x32_bf16 v[92:95], a[24:27], a[108:111], v[92:95]
    v_cvt_pk_bf16_f32 v7, v162, v163
    v_mfma_f32_16x16x32_bf16 v[92:95], a[28:31], a[112:115], v[92:95]
    v_mfma_f32_16x16x32_bf16 v[96:99], a[0:3], a[116:119], v[140:143]
    v_exp_f32 v164, v164
    v_mfma_f32_16x16x32_bf16 v[96:99], a[4:7], a[120:123], v[96:99]
    v_exp_f32 v165, v165
    v_mfma_f32_16x16x32_bf16 v[96:99], a[8:11], a[124:127], v[96:99]
    s_cmp_eq_u32 s19, s69
    v_cvt_pk_bf16_f32 v8, v164, v165
    v_mfma_f32_16x16x32_bf16 v[96:99], a[12:15], a[128:131], v[96:99]
    s_cselect_b32 s64, s95, 536870912
    v_mfma_f32_16x16x32_bf16 v[100:103], a[16:19], a[116:119], v[140:143]
    v_exp_f32 v166, v166
    v_mfma_f32_16x16x32_bf16 v[100:103], a[20:23], a[120:123], v[100:103]
    v_exp_f32 v167, v167
    v_mfma_f32_16x16x32_bf16 v[100:103], a[24:27], a[124:127], v[100:103]
    v_cvt_pk_bf16_f32 v9, v166, v167
    v_mfma_f32_16x16x32_bf16 v[100:103], a[28:31], a[128:131], v[100:103]
    buffer_load_dwordx4 v1, s[8:11], s12 offen offset:1024 sc1 lds
    v_mfma_f32_16x16x32_bf16 v[104:107], a[0:3], a[180:183], v[152:155]
    v_exp_f32 v168, v168
    v_mfma_f32_16x16x32_bf16 v[104:107], a[4:7], a[184:187], v[104:107]
    v_exp_f32 v169, v169
    v_mfma_f32_16x16x32_bf16 v[104:107], a[8:11], a[188:191], v[104:107]
    ds_read_b128 a[32:35], v3 offset:16384
    v_cvt_pk_bf16_f32 v10, v168, v169
    v_mfma_f32_16x16x32_bf16 v[104:107], a[12:15], a[192:195], v[104:107]
    ds_read_b128 a[36:39], v3 offset:17408
    v_mfma_f32_16x16x32_bf16 v[108:111], a[16:19], a[180:183], v[152:155]
    v_exp_f32 v170, v170
    v_mfma_f32_16x16x32_bf16 v[108:111], a[20:23], a[184:187], v[108:111]
    v_exp_f32 v171, v171
    v_mfma_f32_16x16x32_bf16 v[108:111], a[24:27], a[188:191], v[108:111]
    ds_read_b128 a[40:43], v3 offset:18432
    v_cvt_pk_bf16_f32 v11, v170, v171
    v_mfma_f32_16x16x32_bf16 v[108:111], a[28:31], a[192:195], v[108:111]
    ds_read_b128 a[44:47], v3 offset:19456
    v_mfma_f32_16x16x32_bf16 v[112:115], a[0:3], a[64:67], v[156:159]
    v_exp_f32 v172, v172
    v_mfma_f32_16x16x32_bf16 v[112:115], a[4:7], a[244:247], v[112:115]
    v_exp_f32 v173, v173
    v_mfma_f32_16x16x32_bf16 v[112:115], a[8:11], a[248:251], v[112:115]
    ds_read_b128 a[48:51], v3 offset:20480
    v_cvt_pk_bf16_f32 v12, v172, v173
    v_mfma_f32_16x16x32_bf16 v[112:115], a[12:15], a[252:255], v[112:115]
    ds_read_b128 a[52:55], v3 offset:21504
    v_mfma_f32_16x16x32_bf16 v[116:119], a[16:19], a[64:67], v[156:159]
    v_exp_f32 v174, v174
    v_mfma_f32_16x16x32_bf16 v[116:119], a[20:23], a[244:247], v[116:119]
    v_exp_f32 v175, v175
    v_mfma_f32_16x16x32_bf16 v[116:119], a[24:27], a[248:251], v[116:119]
    ds_read_b128 a[56:59], v3 offset:22528
    v_cvt_pk_bf16_f32 v13, v174, v175
    v_mfma_f32_16x16x32_bf16 v[116:119], a[28:31], a[252:255], v[116:119]
    ds_read_b128 a[60:63], v3 offset:23552
    v_mfma_f32_16x16x32_bf16 v[84:87], a[240:243], v[124:127], v[84:87]
    s_waitcnt lgkmcnt(4)
    v_exp_f32 v88, v88
    v_mfma_f32_16x16x32_bf16 v[80:83], a[240:243], v[120:123], v[80:83]
    v_exp_f32 v89, v89
    v_mfma_f32_16x16x32_bf16 v[16:19], a[32:35], v[120:123], v[16:19]
    v_cvt_pk_bf16_f32 v128, v88, v89
    v_mfma_f32_16x16x32_bf16 v[20:23], a[32:35], v[124:127], v[20:23]
    buffer_load_dwordx4 v1, s[8:11], s12 offen offset:2048 sc1 lds
    v_mfma_f32_16x16x32_bf16 v[180:183], a[32:35], v[10:13], v[180:183]
    v_exp_f32 v90, v90
    v_mfma_f32_16x16x32_bf16 v[176:179], a[32:35], v[6:9], v[176:179]
    v_exp_f32 v91, v91
    v_mfma_f32_16x16x32_bf16 v[184:187], a[36:39], v[6:9], v[184:187]
    v_cvt_pk_bf16_f32 v129, v90, v91
    v_mfma_f32_16x16x32_bf16 v[188:191], a[36:39], v[10:13], v[188:191]
    v_mfma_f32_16x16x32_bf16 v[28:31], a[36:39], v[124:127], v[28:31]
    v_exp_f32 v92, v92
    v_mfma_f32_16x16x32_bf16 v[24:27], a[36:39], v[120:123], v[24:27]
    s_waitcnt lgkmcnt(0)
    v_exp_f32 v93, v93
    v_mfma_f32_16x16x32_bf16 v[32:35], a[40:43], v[120:123], v[32:35]
    ds_read_b128 a[0:3], v2 offset:0
    v_cvt_pk_bf16_f32 v130, v92, v93
    v_mfma_f32_16x16x32_bf16 v[36:39], a[40:43], v[124:127], v[36:39]
    ds_read_b128 a[4:7], v2 offset:1024
    v_mfma_f32_16x16x32_bf16 v[196:199], a[40:43], v[10:13], v[196:199]
    v_exp_f32 v94, v94
    v_mfma_f32_16x16x32_bf16 v[192:195], a[40:43], v[6:9], v[192:195]
    v_exp_f32 v95, v95
    v_mfma_f32_16x16x32_bf16 v[200:203], a[44:47], v[6:9], v[200:203]
    ds_read_b128 a[8:11], v2 offset:2048
    v_cvt_pk_bf16_f32 v131, v94, v95
    v_mfma_f32_16x16x32_bf16 v[204:207], a[44:47], v[10:13], v[204:207]
    ds_read_b128 a[12:15], v2 offset:3072
    v_mfma_f32_16x16x32_bf16 v[44:47], a[44:47], v[124:127], v[44:47]
    v_exp_f32 v96, v96
    v_mfma_f32_16x16x32_bf16 v[40:43], a[44:47], v[120:123], v[40:43]
    v_exp_f32 v97, v97
    v_mfma_f32_16x16x32_bf16 v[48:51], a[48:51], v[120:123], v[48:51]
    ds_read_b128 a[16:19], v2 offset:4096
    v_cvt_pk_bf16_f32 v132, v96, v97
    v_mfma_f32_16x16x32_bf16 v[52:55], a[48:51], v[124:127], v[52:55]
    ds_read_b128 a[20:23], v2 offset:5120
    v_mfma_f32_16x16x32_bf16 v[212:215], a[48:51], v[10:13], v[212:215]
    v_exp_f32 v98, v98
    v_mfma_f32_16x16x32_bf16 v[208:211], a[48:51], v[6:9], v[208:211]
    v_exp_f32 v99, v99
    v_mfma_f32_16x16x32_bf16 v[216:219], a[52:55], v[6:9], v[216:219]
    ds_read_b128 a[24:27], v2 offset:6144
    v_cvt_pk_bf16_f32 v133, v98, v99
    v_mfma_f32_16x16x32_bf16 v[220:223], a[52:55], v[10:13], v[220:223]
    ds_read_b128 a[28:31], v2 offset:7168
    v_mfma_f32_16x16x32_bf16 v[60:63], a[52:55], v[124:127], v[60:63]
    v_exp_f32 v100, v100
    v_mfma_f32_16x16x32_bf16 v[56:59], a[52:55], v[120:123], v[56:59]
    v_exp_f32 v101, v101
    v_mfma_f32_16x16x32_bf16 v[64:67], a[56:59], v[120:123], v[64:67]
    v_cvt_pk_bf16_f32 v134, v100, v101
    v_mfma_f32_16x16x32_bf16 v[68:71], a[56:59], v[124:127], v[68:71]
    buffer_load_dwordx4 v1, s[8:11], s12 offen offset:3072 sc1 lds
    v_mfma_f32_16x16x32_bf16 v[228:231], a[56:59], v[10:13], v[228:231]
    v_exp_f32 v102, v102
    v_mfma_f32_16x16x32_bf16 v[224:227], a[56:59], v[6:9], v[224:227]
    v_exp_f32 v103, v103
    v_mfma_f32_16x16x32_bf16 v[232:235], a[60:63], v[6:9], v[232:235]
    s_sub_u32 s19, s19, 1
    v_cvt_pk_bf16_f32 v135, v102, v103
    v_mfma_f32_16x16x32_bf16 v[236:239], a[60:63], v[10:13], v[236:239]
    s_cmp_lg_u32 s19, 0
    v_mfma_f32_16x16x32_bf16 v[76:79], a[60:63], v[124:127], v[76:79]
    v_mfma_f32_16x16x32_bf16 v[72:75], a[60:63], v[120:123], v[72:75]
    v_mfma_f32_16x16x32_bf16 v[240:243], a[240:243], v[6:9], v[240:243]
    v_mfma_f32_16x16x32_bf16 v[244:247], a[240:243], v[10:13], v[244:247]
    s_waitcnt lgkmcnt(0)
    buffer_store_dword v252, off, s[8:11], s64 sc1
    s_cbranch_scc1 L_loop
    v_mfma_f32_16x16x32_bf16 v[88:91], a[0:3], a[100:103], v[144:147]
    v_exp_f32 v104, v104
    v_mfma_f32_16x16x32_bf16 v[88:91], a[4:7], a[104:107], v[88:91]
    v_exp_f32 v105, v105
    v_mfma_f32_16x16x32_bf16 v[88:91], a[8:11], a[108:111], v[88:91]
    ds_read_b128 a[32:35], v3 offset:24576
    v_cvt_pk_bf16_f32 v6, v104, v105
    v_mfma_f32_16x16x32_bf16 v[88:91], a[12:15], a[112:115], v[88:91]
    v_exp_f32 v106, v106
    v_mfma_f32_16x16x32_bf16 v[92:95], a[16:19], a[100:103], v[148:151]
    v_exp_f32 v107, v107
    v_mfma_f32_16x16x32_bf16 v[92:95], a[20:23], a[104:107], v[92:95]
    s_add_u32 m0, s18, 65536
    ds_read_b128 a[36:39], v3 offset:25600
    v_cvt_pk_bf16_f32 v7, v106, v107
    v_mfma_f32_16x16x32_bf16 v[92:95], a[24:27], a[108:111], v[92:95]
    s_add_u32 s18, s18, 16384
    buffer_load_dwordx4 v1, s[8:11], s13 offen offset:0 sc1 lds
    v_mfma_f32_16x16x32_bf16 v[92:95], a[28:31], a[112:115], v[92:95]
    s_and_b32 s18, s18, 0xffff
    v_exp_f32 v108, v108
    v_mfma_f32_16x16x32_bf16 v[96:99], a[0:3], a[116:119], v[140:143]
    s_add_u32 s62, s12, 16384
    v_exp_f32 v109, v109
    v_mfma_f32_16x16x32_bf16 v[96:99], a[4:7], a[120:123], v[96:99]
    s_add_u32 s12, s12, 32768
    ds_read_b128 a[40:43], v3 offset:26624
    v_cvt_pk_bf16_f32 v8, v108, v109
    v_mfma_f32_16x16x32_bf16 v[96:99], a[8:11], a[124:127], v[96:99]
pad14:
    s_cbranch_execz pad18
    s_add_u32 s14, s14, 1
    v_exp_f32 v110, v110
    v_mfma_f32_16x16x32_bf16 v[96:99], a[12:15], a[128:131], v[96:99]
    s_cmp_eq_u32 s14, s15
    v_exp_f32 v111, v111
    v_mfma_f32_16x16x32_bf16 v[100:103], a[16:19], a[116:119], v[140:143]
    s_cselect_b32 s12, s16, s12
    ds_read_b128 a[44:47], v3 offset:27648
    v_cvt_pk_bf16_f32 v9, v110, v111
    v_mfma_f32_16x16x32_bf16 v[100:103], a[20:23], a[120:123], v[100:103]
    ds_read_b128 a[48:51], v3 offset:28672
    ds_read_b128 a[52:55], v3 offset:29696
    v_mfma_f32_16x16x32_bf16 v[100:103], a[24:27], a[124:127], v[100:103]
    ds_read_b128 a[56:59], v3 offset:30720
    ds_read_b128 a[60:63], v3 offset:31744
    v_mfma_f32_16x16x32_bf16 v[100:103], a[28:31], a[128:131], v[100:103]
    s_waitcnt lgkmcnt(4)
    buffer_load_dwordx4 v1, s[8:11], s13 offen offset:1024 sc1 lds
    v_mfma_f32_16x16x32_bf16 v[80:83], a[240:243], v[128:131], v[80:83]
    ds_read_b128 a[0:3], v2 offset:8192
    ds_read_b128 a[4:7], v2 offset:9216
    v_mfma_f32_16x16x32_bf16 v[16:19], a[32:35], v[128:131], v[16:19]
    v_exp_f32 v112, v112
    v_mfma_f32_16x16x32_bf16 v[20:23], a[32:35], v[132:135], v[20:23]
    ds_read_b128 a[8:11], v2 offset:10240
    ds_read_b128 a[12:15], v2 offset:11264
    v_mfma_f32_16x16x32_bf16 v[28:31], a[36:39], v[132:135], v[28:31]
    v_exp_f32 v113, v113
    v_mfma_f32_16x16x32_bf16 v[24:27], a[36:39], v[128:131], v[24:27]
    ds_read_b128 a[16:19], v2 offset:12288
    v_cvt_pk_bf16_f32 v10, v112, v113
    v_mfma_f32_16x16x32_bf16 v[32:35], a[40:43], v[128:131], v[32:35]
    v_exp_f32 v114, v114
    v_mfma_f32_16x16x32_bf16 v[36:39], a[40:43], v[132:135], v[36:39]
    v_exp_f32 v115, v115
    v_mfma_f32_16x16x32_bf16 v[44:47], a[44:47], v[132:135], v[44:47]
    s_waitcnt lgkmcnt(5)
    ds_read_b128 a[20:23], v2 offset:13312
    v_cvt_pk_bf16_f32 v11, v114, v115
    v_mfma_f32_16x16x32_bf16 v[40:43], a[44:47], v[128:131], v[40:43]
    v_exp_f32 v116, v116
    v_mfma_f32_16x16x32_bf16 v[48:51], a[48:51], v[128:131], v[48:51]
    ds_read_b128 a[24:27], v2 offset:14336
    ds_read_b128 a[28:31], v2 offset:15360
    v_mfma_f32_16x16x32_bf16 v[52:55], a[48:51], v[132:135], v[52:55]
    v_exp_f32 v117, v117
    v_mfma_f32_16x16x32_bf16 v[60:63], a[52:55], v[132:135], v[60:63]
    buffer_load_dwordx4 v1, s[8:11], s13 offen offset:2048 sc1 lds
    v_mfma_f32_16x16x32_bf16 v[56:59], a[52:55], v[128:131], v[56:59]
    v_exp_f32 v118, v118
    v_subrev_f32 v152, 0x74000000, v4
    v_mfma_f32_16x16x32_bf16 v[64:67], a[56:59], v[128:131], v[64:67]
    v_cvt_pk_bf16_f32 v12, v116, v117
    v_xor_b32 v3, 0x8000, v3
    v_min_f32 v152, v136, v152
    v_subrev_f32 v153, 0x74040000, v4
    v_mfma_f32_16x16x32_bf16 v[68:71], a[56:59], v[132:135], v[68:71]
    v_exp_f32 v119, v119
    v_min_f32 v153, v136, v153
    v_mfma_f32_16x16x32_bf16 v[76:79], a[60:63], v[132:135], v[76:79]
    v_subrev_f32 v154, 0x74080000, v4
    v_min_f32 v154, v136, v154
    v_subrev_f32 v155, 0x740c0000, v4
    v_min_f32 v155, v136, v155
    v_mfma_f32_16x16x32_bf16 v[72:75], a[60:63], v[128:131], v[72:75]
    v_cvt_pk_bf16_f32 v13, v118, v119
    v_subrev_f32 v156, 0x74400000, v4
    v_min_f32 v156, v136, v156
    v_mfma_f32_16x16x32_bf16 v[84:87], a[240:243], v[132:135], v[84:87]
    v_subrev_f32 v157, 0x74440000, v4
    v_min_f32 v157, v136, v157
    v_subrev_f32 v158, 0x74480000, v4
    v_min_f32 v158, v136, v158
    v_mfma_f32_16x16x32_bf16 v[240:243], a[240:243], v[6:9], v[240:243]
    v_exp_f32 v88, v88
    v_subrev_f32 v159, 0x744c0000, v4
    v_mfma_f32_16x16x32_bf16 v[176:179], a[32:35], v[6:9], v[176:179]
    v_exp_f32 v89, v89
    v_min_f32 v159, v136, v159
    v_subrev_f32 v160, 0x74800000, v5
    v_mfma_f32_16x16x32_bf16 v[180:183], a[32:35], v[10:13], v[180:183]
    v_cvt_pk_bf16_f32 v120, v88, v89
    v_min_f32 v160, v140, v160
    v_subrev_f32 v161, 0x74820000, v5
    v_mfma_f32_16x16x32_bf16 v[188:191], a[36:39], v[10:13], v[188:191]
    v_min_f32 v161, v140, v161
    v_subrev_f32 v162, 0x74840000, v5
    v_min_f32 v162, v140, v162
    v_subrev_f32 v163, 0x74860000, v5
    v_mfma_f32_16x16x32_bf16 v[184:187], a[36:39], v[6:9], v[184:187]
    v_exp_f32 v90, v90
    v_min_f32 v163, v140, v163
    v_mfma_f32_16x16x32_bf16 v[192:195], a[40:43], v[6:9], v[192:195]
    v_exp_f32 v91, v91
    v_subrev_f32 v164, 0x74a00000, v5
    v_min_f32 v164, v140, v164
    v_mfma_f32_16x16x32_bf16 v[196:199], a[40:43], v[10:13], v[196:199]
    v_cvt_pk_bf16_f32 v121, v90, v91
    v_subrev_f32 v165, 0x74a20000, v5
    v_min_f32 v165, v140, v165
    v_mfma_f32_16x16x32_bf16 v[204:207], a[44:47], v[10:13], v[204:207]
    buffer_load_dwordx4 v1, s[8:11], s13 offen offset:3072 sc1 lds
    v_subrev_f32 v166, 0x74a40000, v5
    v_min_f32 v166, v140, v166
    v_mfma_f32_16x16x32_bf16 v[200:203], a[44:47], v[6:9], v[200:203]
    s_mov_b32 s13, s62
    v_exp_f32 v92, v92
    v_subrev_f32 v167, 0x74a60000, v5
    v_mfma_f32_16x16x32_bf16 v[208:211], a[48:51], v[6:9], v[208:211]
    v_exp_f32 v93, v93
    v_min_f32 v167, v140, v167
    v_subrev_f32 v168, 0x74c00000, v5
    v_mfma_f32_16x16x32_bf16 v[212:215], a[48:51], v[10:13], v[212:215]
    v_cvt_pk_bf16_f32 v122, v92, v93
    v_min_f32 v168, v140, v168
    v_subrev_f32 v169, 0x74c20000, v5
    v_mfma_f32_16x16x32_bf16 v[220:223], a[52:55], v[10:13], v[220:223]
    v_min_f32 v169, v140, v169
    v_subrev_f32 v170, 0x74c40000, v5
    v_min_f32 v170, v140, v170
    v_subrev_f32 v171, 0x74c60000, v5
    v_mfma_f32_16x16x32_bf16 v[216:219], a[52:55], v[6:9], v[216:219]
    v_exp_f32 v94, v94
    v_min_f32 v171, v140, v171
    v_mfma_f32_16x16x32_bf16 v[224:227], a[56:59], v[6:9], v[224:227]
    v_exp_f32 v95, v95
    v_subrev_f32 v172, 0x74e00000, v5
    v_min_f32 v172, v140, v172
    v_mfma_f32_16x16x32_bf16 v[228:231], a[56:59], v[10:13], v[228:231]
    v_cvt_pk_bf16_f32 v123, v94, v95
    v_subrev_f32 v173, 0x74e20000, v5
    v_min_f32 v173, v140, v173
    v_mfma_f32_16x16x32_bf16 v[236:239], a[60:63], v[10:13], v[236:239]
    v_subrev_f32 v174, 0x74e40000, v5
    v_min_f32 v174, v140, v174
    v_subrev_f32 v175, 0x74e60000, v5
    v_min_f32 v175, v140, v175
    v_mfma_f32_16x16x32_bf16 v[232:235], a[60:63], v[6:9], v[232:235]
    v_mfma_f32_16x16x32_bf16 v[244:247], a[240:243], v[10:13], v[244:247]
    s_waitcnt vmcnt(16) lgkmcnt(0)
    s_barrier
    v_mfma_f32_16x16x32_bf16 v[104:107], a[0:3], a[100:103], v[152:155]
    v_exp_f32 v96, v96
    v_mfma_f32_16x16x32_bf16 v[104:107], a[4:7], a[104:107], v[104:107]
    v_exp_f32 v97, v97
    v_mfma_f32_16x16x32_bf16 v[104:107], a[8:11], a[108:111], v[104:107]
    ds_read_b128 a[32:35], v3 offset:0
    v_cvt_pk_bf16_f32 v124, v96, v97
    v_mfma_f32_16x16x32_bf16 v[104:107], a[12:15], a[112:115], v[104:107]
    v_exp_f32 v98, v98
    v_mfma_f32_16x16x32_bf16 v[108:111], a[16:19], a[100:103], v[156:159]
    v_exp_f32 v99, v99
    v_mfma_f32_16x16x32_bf16 v[108:111], a[20:23], a[104:107], v[108:111]
    s_mov_b32 m0, s17
    ds_read_b128 a[36:39], v3 offset:1024
    v_cvt_pk_bf16_f32 v125, v98, v99
    v_mfma_f32_16x16x32_bf16 v[108:111], a[24:27], a[108:111], v[108:111]
    s_add_u32 s17, s17, 16384
    buffer_load_dwordx4 v1, s[8:11], s12 offen offset:0 sc1 lds
    v_mfma_f32_16x16x32_bf16 v[108:111], a[28:31], a[112:115], v[108:111]
    s_and_b32 s17, s17, 0xffff
    v_exp_f32 v100, v100
    v_mfma_f32_16x16x32_bf16 v[112:115], a[0:3], a[116:119], v[140:143]
    v_exp_f32 v101, v101
    v_mfma_f32_16x16x32_bf16 v[112:115], a[4:7], a[120:123], v[112:115]
    ds_read_b128 a[40:43], v3 offset:2048
    v_cvt_pk_bf16_f32 v126, v100, v101
    v_mfma_f32_16x16x32_bf16 v[112:115], a[8:11], a[124:127], v[112:115]
    v_exp_f32 v102, v102
    v_mfma_f32_16x16x32_bf16 v[112:115], a[12:15], a[128:131], v[112:115]
    v_exp_f32 v103, v103
    v_mfma_f32_16x16x32_bf16 v[116:119], a[16:19], a[116:119], v[140:143]
    ds_read_b128 a[44:47], v3 offset:3072
    v_cvt_pk_bf16_f32 v127, v102, v103
    v_mfma_f32_16x16x32_bf16 v[116:119], a[20:23], a[120:123], v[116:119]
    ds_read_b128 a[48:51], v3 offset:4096
    ds_read_b128 a[52:55], v3 offset:5120
    v_mfma_f32_16x16x32_bf16 v[116:119], a[24:27], a[124:127], v[116:119]
    ds_read_b128 a[56:59], v3 offset:6144
    ds_read_b128 a[60:63], v3 offset:7168
    v_mfma_f32_16x16x32_bf16 v[116:119], a[28:31], a[128:131], v[116:119]
    s_waitcnt lgkmcnt(4)
    buffer_load_dwordx4 v1, s[8:11], s12 offen offset:1024 sc1 lds
    v_mfma_f32_16x16x32_bf16 v[80:83], a[240:243], v[120:123], v[80:83]
    ds_read_b128 a[0:3], v2 offset:16384
    ds_read_b128 a[4:7], v2 offset:17408
    v_mfma_f32_16x16x32_bf16 v[16:19], a[32:35], v[120:123], v[16:19]
    v_exp_f32 v104, v104
    v_mfma_f32_16x16x32_bf16 v[20:23], a[32:35], v[124:127], v[20:23]
    ds_read_b128 a[8:11], v2 offset:18432
    ds_read_b128 a[12:15], v2 offset:19456
    v_mfma_f32_16x16x32_bf16 v[28:31], a[36:39], v[124:127], v[28:31]
    v_exp_f32 v105, v105
    v_mfma_f32_16x16x32_bf16 v[24:27], a[36:39], v[120:123], v[24:27]
    ds_read_b128 a[16:19], v2 offset:20480
    v_cvt_pk_bf16_f32 v128, v104, v105
    v_mfma_f32_16x16x32_bf16 v[32:35], a[40:43], v[120:123], v[32:35]
    v_exp_f32 v106, v106
    v_mfma_f32_16x16x32_bf16 v[36:39], a[40:43], v[124:127], v[36:39]
    v_exp_f32 v107, v107
    v_mfma_f32_16x16x32_bf16 v[44:47], a[44:47], v[124:127], v[44:47]
    s_waitcnt lgkmcnt(5)
    ds_read_b128 a[20:23], v2 offset:21504
    v_cvt_pk_bf16_f32 v129, v106, v107
    v_mfma_f32_16x16x32_bf16 v[40:43], a[44:47], v[120:123], v[40:43]
    v_exp_f32 v108, v108
    v_mfma_f32_16x16x32_bf16 v[48:51], a[48:51], v[120:123], v[48:51]
    ds_read_b128 a[24:27], v2 offset:22528
    ds_read_b128 a[28:31], v2 offset:23552
    v_mfma_f32_16x16x32_bf16 v[52:55], a[48:51], v[124:127], v[52:55]
    ds_read_b128 a[68:71], v2 offset:24576
    v_exp_f32 v109, v109
    v_mfma_f32_16x16x32_bf16 v[60:63], a[52:55], v[124:127], v[60:63]
    ds_read_b128 a[72:75], v2 offset:25600
    buffer_load_dwordx4 v1, s[8:11], s12 offen offset:2048 sc1 lds
    v_mfma_f32_16x16x32_bf16 v[56:59], a[52:55], v[120:123], v[56:59]
    ds_read_b128 a[76:79], v2 offset:26624
    v_exp_f32 v110, v110
    v_mfma_f32_16x16x32_bf16 v[64:67], a[56:59], v[120:123], v[64:67]
    ds_read_b128 a[80:83], v2 offset:27648
    v_cvt_pk_bf16_f32 v130, v108, v109
    v_mfma_f32_16x16x32_bf16 v[68:71], a[56:59], v[124:127], v[68:71]
    ds_read_b128 a[84:87], v2 offset:28672
    v_exp_f32 v111, v111
    v_mfma_f32_16x16x32_bf16 v[76:79], a[60:63], v[124:127], v[76:79]
    ds_read_b128 a[88:91], v2 offset:29696
    buffer_load_dwordx4 v1, s[8:11], s12 offen offset:3072 sc1 lds
    v_mfma_f32_16x16x32_bf16 v[72:75], a[60:63], v[120:123], v[72:75]
    ds_read_b128 a[92:95], v2 offset:30720
    v_cvt_pk_bf16_f32 v131, v110, v111
    v_mfma_f32_16x16x32_bf16 v[84:87], a[240:243], v[124:127], v[84:87]
    s_waitcnt lgkmcnt(11)
    ds_read_b128 a[96:99], v2 offset:31744
L_X:
    v_mfma_f32_16x16x32_bf16 v[88:91], a[0:3], a[116:119], v[160:163]
pad15:
    s_cbranch_execz pad19
    s_lshl_b32 s63, s20, 3
    ds_read_b128 a[32:35], v3 offset:8192
    ds_read_b128 a[36:39], v3 offset:9216
    v_mfma_f32_16x16x32_bf16 v[88:91], a[4:7], a[120:123], v[88:91]
    s_add_u32 s22, s63, s3
    v_exp_f32 v112, v112
    v_mfma_f32_16x16x32_bf16 v[88:91], a[8:11], a[124:127], v[88:91]
    s_sub_u32 s23, s63, s3
    ds_read_b128 a[40:43], v3 offset:10240
    ds_read_b128 a[44:47], v3 offset:11264
    v_mfma_f32_16x16x32_bf16 v[88:91], a[12:15], a[128:131], v[88:91]
    s_waitcnt lgkmcnt(12)
    v_exp_f32 v113, v113
    v_mfma_f32_16x16x32_bf16 v[92:95], a[16:19], a[116:119], v[164:167]
    s_add_u32 s23, s23, 7
    ds_read_b128 a[48:51], v3 offset:12288
    v_cvt_pk_bf16_f32 v132, v112, v113
    v_mfma_f32_16x16x32_bf16 v[92:95], a[20:23], a[120:123], v[92:95]
    s_add_u32 m0, s18, 65536
    v_exp_f32 v114, v114
    v_mfma_f32_16x16x32_bf16 v[92:95], a[24:27], a[124:127], v[92:95]
    s_add_u32 s18, s18, 16384
    buffer_load_dwordx4 v1, s[8:11], s13 offen offset:0 sc1 lds
    v_mfma_f32_16x16x32_bf16 v[92:95], a[28:31], a[128:131], v[92:95]
    s_waitcnt lgkmcnt(5)
    v_exp_f32 v115, v115
    v_mfma_f32_16x16x32_bf16 v[96:99], a[68:71], a[116:119], v[168:171]
    s_and_b32 s18, s18, 0xffff
    ds_read_b128 a[52:55], v3 offset:13312
    v_cvt_pk_bf16_f32 v133, v114, v115
    v_mfma_f32_16x16x32_bf16 v[96:99], a[72:75], a[120:123], v[96:99]
    s_add_u32 s62, s12, 16384
    v_exp_f32 v116, v116
    v_mfma_f32_16x16x32_bf16 v[96:99], a[76:79], a[124:127], v[96:99]
    s_add_u32 s12, s12, 32768
    ds_read_b128 a[56:59], v3 offset:14336
    ds_read_b128 a[60:63], v3 offset:15360
    v_mfma_f32_16x16x32_bf16 v[96:99], a[80:83], a[128:131], v[96:99]
    s_add_u32 s14, s14, 1
    buffer_load_dwordx4 v1, s[8:11], s13 offen offset:1024 sc1 lds
    v_exp_f32 v117, v117
    v_mfma_f32_16x16x32_bf16 v[100:103], a[84:87], a[116:119], v[172:175]
    s_cmp_eq_u32 s14, s15
    v_exp_f32 v118, v118
    v_mov_b32 v136, v14
    v_mfma_f32_16x16x32_bf16 v[100:103], a[88:91], a[120:123], v[100:103]
    s_cselect_b32 s12, s16, s12
    v_exp_f32 v119, v119
    v_mov_b32 v137, v14
    v_mfma_f32_16x16x32_bf16 v[100:103], a[92:95], a[124:127], v[100:103]
    s_lshl_b32 s63, s7, 12
    v_cvt_pk_bf16_f32 v134, v116, v117
    v_cvt_pk_bf16_f32 v135, v118, v119
    v_mfma_f32_16x16x32_bf16 v[100:103], a[96:99], a[128:131], v[100:103]
    s_waitcnt vmcnt(14) lgkmcnt(0)
    s_barrier
    v_xor_b32 v2, 0x8000, v2
    v_mfma_f32_16x16x32_bf16 v[80:83], a[240:243], v[128:131], v[80:83]
    s_add_u32 s63, s63, 33554432
    ds_read_b128 a[0:3], v2 offset:0
    ds_read_b128 a[4:7], v2 offset:1024
    v_mfma_f32_16x16x32_bf16 v[16:19], a[32:35], v[128:131], v[16:19]
    s_lshl_b32 s22, s22, 17
    buffer_load_dwordx4 v1, s[8:11], s13 offen offset:2048 sc1 lds
    v_exp_f32 v88, v88
    v_mfma_f32_16x16x32_bf16 v[20:23], a[32:35], v[132:135], v[20:23]
    s_add_u32 s22, s22, s63
    ds_read_b128 a[8:11], v2 offset:2048
    ds_read_b128 a[12:15], v2 offset:3072
    v_mfma_f32_16x16x32_bf16 v[28:31], a[36:39], v[132:135], v[28:31]
    s_lshl_b32 s23, s23, 17
    v_exp_f32 v89, v89
    v_mov_b32 v140, v255
    v_mfma_f32_16x16x32_bf16 v[24:27], a[36:39], v[128:131], v[24:27]
    s_add_u32 s23, s23, s63
    ds_read_b128 a[16:19], v2 offset:4096
    v_cvt_pk_bf16_f32 v120, v88, v89
    v_mfma_f32_16x16x32_bf16 v[32:35], a[40:43], v[128:131], v[32:35]
    s_mov_b32 s66, 0
    v_exp_f32 v90, v90
    v_mov_b32 v141, v255
    v_mfma_f32_16x16x32_bf16 v[36:39], a[40:43], v[132:135], v[36:39]
    s_lshl_b32 s19, s6, 1
    buffer_load_dwordx4 v1, s[8:11], s13 offen offset:3072 sc1 lds
    v_exp_f32 v91, v91
    v_mfma_f32_16x16x32_bf16 v[44:47], a[44:47], v[132:135], v[44:47]
    s_mov_b32 s13, s62
    ds_read_b128 a[20:23], v2 offset:5120
    v_cvt_pk_bf16_f32 v121, v90, v91
    v_mfma_f32_16x16x32_bf16 v[40:43], a[44:47], v[128:131], v[40:43]
    s_sub_u32 s19, 14, s19
    v_exp_f32 v92, v92
    v_mov_b32 v142, v255
    v_mfma_f32_16x16x32_bf16 v[48:51], a[48:51], v[128:131], v[48:51]
    s_sub_u32 s69, s19, 1
    ds_read_b128 a[24:27], v2 offset:6144
    ds_read_b128 a[28:31], v2 offset:7168
    v_mfma_f32_16x16x32_bf16 v[52:55], a[48:51], v[132:135], v[52:55]
    s_mov_b32 m0, s17
    v_exp_f32 v93, v93
    v_mov_b32 v143, v255
    v_mfma_f32_16x16x32_bf16 v[60:63], a[52:55], v[132:135], v[60:63]
    s_add_u32 s17, s17, 16384
    buffer_load_dwordx4 v1, s[8:11], s12 offen offset:0 sc1 lds
    v_mfma_f32_16x16x32_bf16 v[56:59], a[52:55], v[128:131], v[56:59]
    s_and_b32 s17, s17, 0xffff
    v_exp_f32 v94, v94
    v_mfma_f32_16x16x32_bf16 v[64:67], a[56:59], v[128:131], v[64:67]
    s_cmp_ge_u32 s6, 2
    s_cmov_b32 s69, -1
    v_cvt_pk_bf16_f32 v122, v92, v93
    v_mov_b32 v138, v14
    v_mfma_f32_16x16x32_bf16 v[68:71], a[56:59], v[132:135], v[68:71]
    v_exp_f32 v95, v95
    v_mfma_f32_16x16x32_bf16 v[76:79], a[60:63], v[132:135], v[76:79]
    buffer_load_dwordx4 v1, s[8:11], s12 offen offset:1024 sc1 lds
    v_mfma_f32_16x16x32_bf16 v[72:75], a[60:63], v[128:131], v[72:75]
    v_cvt_pk_bf16_f32 v123, v94, v95
    v_mov_b32 v139, v14
    v_mfma_f32_16x16x32_bf16 v[84:87], a[240:243], v[132:135], v[84:87]
    s_waitcnt lgkmcnt(4)
    buffer_load_dwordx4 v1, s[8:11], s12 offen offset:2048 sc1 lds
    v_mfma_f32_16x16x32_bf16 v[104:107], a[0:3], a[180:183], v[136:139]
    v_exp_f32 v96, v96
    v_mfma_f32_16x16x32_bf16 v[104:107], a[4:7], a[184:187], v[104:107]
    v_exp_f32 v97, v97
    v_mfma_f32_16x16x32_bf16 v[104:107], a[8:11], a[188:191], v[104:107]
    ds_read_b128 a[32:35], v3 offset:16384
    v_cvt_pk_bf16_f32 v124, v96, v97
    v_mfma_f32_16x16x32_bf16 v[104:107], a[12:15], a[192:195], v[104:107]
    s_waitcnt lgkmcnt(1)
    v_exp_f32 v98, v98
    v_mfma_f32_16x16x32_bf16 v[108:111], a[16:19], a[180:183], v[136:139]
    v_exp_f32 v99, v99
    v_mfma_f32_16x16x32_bf16 v[108:111], a[20:23], a[184:187], v[108:111]
    ds_read_b128 a[36:39], v3 offset:17408
    v_cvt_pk_bf16_f32 v125, v98, v99
    v_mfma_f32_16x16x32_bf16 v[108:111], a[24:27], a[188:191], v[108:111]
    buffer_load_dwordx4 v1, s[8:11], s12 offen offset:3072 sc1 lds
    v_mfma_f32_16x16x32_bf16 v[108:111], a[28:31], a[192:195], v[108:111]
    v_exp_f32 v100, v100
    v_mfma_f32_16x16x32_bf16 v[112:115], a[0:3], a[64:67], v[140:143]
    v_exp_f32 v101, v101
    v_mfma_f32_16x16x32_bf16 v[112:115], a[4:7], a[244:247], v[112:115]
    ds_read_b128 a[40:43], v3 offset:18432
    v_cvt_pk_bf16_f32 v126, v100, v101
    v_mfma_f32_16x16x32_bf16 v[112:115], a[8:11], a[248:251], v[112:115]
    s_add_u32 m0, s18, 65536
    v_exp_f32 v102, v102
    v_mfma_f32_16x16x32_bf16 v[112:115], a[12:15], a[252:255], v[112:115]
    s_add_u32 s18, s18, 16384
    buffer_load_dwordx4 v1, s[8:11], s13 offen offset:0 sc1 lds
    v_exp_f32 v103, v103
    v_mfma_f32_16x16x32_bf16 v[116:119], a[16:19], a[64:67], v[140:143]
    s_and_b32 s18, s18, 0xffff
    ds_read_b128 a[44:47], v3 offset:19456
    v_cvt_pk_bf16_f32 v127, v102, v103
    v_mfma_f32_16x16x32_bf16 v[116:119], a[20:23], a[244:247], v[116:119]
    s_add_u32 s62, s12, 16384
    ds_read_b128 a[48:51], v3 offset:20480
    ds_read_b128 a[52:55], v3 offset:21504
    v_mfma_f32_16x16x32_bf16 v[116:119], a[24:27], a[248:251], v[116:119]
    s_add_u32 s12, s12, 32768
    ds_read_b128 a[56:59], v3 offset:22528
    ds_read_b128 a[60:63], v3 offset:23552
    v_mfma_f32_16x16x32_bf16 v[116:119], a[28:31], a[252:255], v[116:119]
    s_waitcnt lgkmcnt(4)
    buffer_load_dwordx4 v1, s[8:11], s13 offen offset:1024 sc1 lds
    v_mfma_f32_16x16x32_bf16 v[84:87], a[240:243], v[120:123], v[84:87]
    s_add_u32 s14, s14, 1
    ds_read_b128 a[68:71], v3 offset:24576
    ds_read_b128 a[72:75], v3 offset:25600
    v_mfma_f32_16x16x32_bf16 v[20:23], a[32:35], v[120:123], v[20:23]
    s_cmp_eq_u32 s14, s15
    ds_read_b128 a[76:79], v3 offset:26624
    ds_read_b128 a[80:83], v3 offset:27648
    v_mfma_f32_16x16x32_bf16 v[28:31], a[36:39], v[120:123], v[28:31]
    s_cselect_b32 s12, s16, s12
    ds_read_b128 a[84:87], v3 offset:28672
    ds_read_b128 a[88:91], v3 offset:29696
    v_mfma_f32_16x16x32_bf16 v[36:39], a[40:43], v[120:123], v[36:39]
    ds_read_b128 a[92:95], v3 offset:30720
    ds_read_b128 a[96:99], v3 offset:31744
    v_mfma_f32_16x16x32_bf16 v[44:47], a[44:47], v[120:123], v[44:47]
    s_waitcnt lgkmcnt(8)
    v_exp_f32 v104, v104
    v_mfma_f32_16x16x32_bf16 v[52:55], a[48:51], v[120:123], v[52:55]
    v_exp_f32 v105, v105
    v_mfma_f32_16x16x32_bf16 v[60:63], a[52:55], v[120:123], v[60:63]
    ds_read_b128 a[0:3], v2 offset:8192
    buffer_load_dwordx4 v1, s[8:11], s13 offen offset:2048 sc1 lds
    v_cvt_pk_bf16_f32 v128, v104, v105
    v_mfma_f32_16x16x32_bf16 v[68:71], a[56:59], v[120:123], v[68:71]
    v_exp_f32 v106, v106
    v_mfma_f32_16x16x32_bf16 v[76:79], a[60:63], v[120:123], v[76:79]
    s_waitcnt lgkmcnt(5)
    v_exp_f32 v107, v107
    v_mfma_f32_16x16x32_bf16 v[20:23], a[68:71], v[124:127], v[20:23]
    ds_read_b128 a[4:7], v2 offset:9216
    v_cvt_pk_bf16_f32 v129, v106, v107
    v_mfma_f32_16x16x32_bf16 v[28:31], a[72:75], v[124:127], v[28:31]
    v_exp_f32 v108, v108
    v_mfma_f32_16x16x32_bf16 v[36:39], a[76:79], v[124:127], v[36:39]
    v_exp_f32 v109, v109
    v_mfma_f32_16x16x32_bf16 v[44:47], a[80:83], v[124:127], v[44:47]
    s_waitcnt lgkmcnt(2)
    ds_read_b128 a[8:11], v2 offset:10240
    buffer_load_dwordx4 v1, s[8:11], s13 offen offset:3072 sc1 lds
    v_cvt_pk_bf16_f32 v130, v108, v109
    v_mfma_f32_16x16x32_bf16 v[52:55], a[84:87], v[124:127], v[52:55]
    s_mov_b32 s13, s62
    v_exp_f32 v110, v110
    v_mfma_f32_16x16x32_bf16 v[60:63], a[88:91], v[124:127], v[60:63]
    v_exp_f32 v111, v111
    v_mfma_f32_16x16x32_bf16 v[68:71], a[92:95], v[124:127], v[68:71]
    ds_read_b128 a[12:15], v2 offset:11264
    v_cvt_pk_bf16_f32 v131, v110, v111
    v_mfma_f32_16x16x32_bf16 v[76:79], a[96:99], v[124:127], v[76:79]
    ds_read_b128 a[16:19], v2 offset:12288
    ds_read_b128 a[20:23], v2 offset:13312
    v_mfma_f32_16x16x32_bf16 v[84:87], a[240:243], v[124:127], v[84:87]
    ds_read_b128 a[24:27], v2 offset:14336
    ds_read_b128 a[28:31], v2 offset:15360
    v_xor_b32 v3, 0x8000, v3
norm1:
    v_rcp_f32 v6, v80
    v_mov_b32 v10, 0
    v_mov_b32 v7, v6
    v_pk_mul_f32 v[16:17], v[16:17], v[6:7]
    v_pk_mul_f32 v[18:19], v[18:19], v[6:7]
    v_pk_mul_f32 v[24:25], v[24:25], v[6:7]
    v_pk_mul_f32 v[26:27], v[26:27], v[6:7]
    v_cvt_pk_bf16_f32 v16, v16, v17
    v_cvt_pk_bf16_f32 v17, v18, v19
    v_cvt_pk_bf16_f32 v18, v24, v25
    v_cvt_pk_bf16_f32 v19, v26, v27
    buffer_store_dwordx4 v[16:19], v1, s[8:11], s22 offen offset:0 sc1
    v_pk_maximum3_f16 v10, v10, v16, v17
    v_pk_maximum3_f16 v10, v10, v18, v19
    v_pk_mul_f32 v[32:33], v[32:33], v[6:7]
    v_pk_mul_f32 v[34:35], v[34:35], v[6:7]
    v_pk_mul_f32 v[40:41], v[40:41], v[6:7]
    v_pk_mul_f32 v[42:43], v[42:43], v[6:7]
    v_cvt_pk_bf16_f32 v32, v32, v33
    v_cvt_pk_bf16_f32 v33, v34, v35
    v_cvt_pk_bf16_f32 v34, v40, v41
    v_cvt_pk_bf16_f32 v35, v42, v43
    v_pk_maximum3_f16 v10, v10, v32, v33
    v_pk_maximum3_f16 v10, v10, v34, v35
    v_pk_mul_f32 v[48:49], v[48:49], v[6:7]
    v_pk_mul_f32 v[50:51], v[50:51], v[6:7]
    v_pk_mul_f32 v[56:57], v[56:57], v[6:7]
    v_pk_mul_f32 v[58:59], v[58:59], v[6:7]
    v_cvt_pk_bf16_f32 v48, v48, v49
    v_cvt_pk_bf16_f32 v49, v50, v51
    v_cvt_pk_bf16_f32 v50, v56, v57
    v_cvt_pk_bf16_f32 v51, v58, v59
    buffer_store_dwordx4 v[32:35], v1, s[8:11], s22 offen offset:1024 sc1
    v_pk_maximum3_f16 v10, v10, v48, v49
    v_pk_maximum3_f16 v10, v10, v50, v51
    v_rcp_f32 v8, v84
    v_min_f32 v12, v80, v84
    v_pk_mul_f32 v[64:65], v[64:65], v[6:7]
    v_pk_mul_f32 v[66:67], v[66:67], v[6:7]
    v_pk_mul_f32 v[72:73], v[72:73], v[6:7]
    v_pk_mul_f32 v[74:75], v[74:75], v[6:7]
    v_cvt_pk_bf16_f32 v64, v64, v65
    v_cvt_pk_bf16_f32 v65, v66, v67
    v_cvt_pk_bf16_f32 v66, v72, v73
    v_cvt_pk_bf16_f32 v67, v74, v75
    v_pk_maximum3_f16 v10, v10, v64, v65
    v_pk_maximum3_f16 v10, v10, v66, v67
    v_mov_b32 v9, v8
    v_maximum3_f32 v13, v80, v84, v84
    v_pk_mul_f32 v[20:21], v[20:21], v[8:9]
    v_pk_mul_f32 v[22:23], v[22:23], v[8:9]
    v_pk_mul_f32 v[28:29], v[28:29], v[8:9]
    v_pk_mul_f32 v[30:31], v[30:31], v[8:9]
    v_cvt_pk_bf16_f32 v20, v20, v21
    v_cvt_pk_bf16_f32 v21, v22, v23
    v_cvt_pk_bf16_f32 v22, v28, v29
    v_cvt_pk_bf16_f32 v23, v30, v31
    buffer_store_dwordx4 v[48:51], v1, s[8:11], s22 offen offset:2048 sc1
    v_pk_maximum3_f16 v10, v10, v20, v21
    v_pk_maximum3_f16 v10, v10, v22, v23
    v_cmp_gt_f32 vcc, 0x1f800000, v12
    v_pk_mul_f32 v[36:37], v[36:37], v[8:9]
    v_pk_mul_f32 v[38:39], v[38:39], v[8:9]
    v_pk_mul_f32 v[44:45], v[44:45], v[8:9]
    v_pk_mul_f32 v[46:47], v[46:47], v[8:9]
    v_cvt_pk_bf16_f32 v36, v36, v37
    v_cvt_pk_bf16_f32 v37, v38, v39
    v_cvt_pk_bf16_f32 v38, v44, v45
    v_cvt_pk_bf16_f32 v39, v46, v47
    v_pk_maximum3_f16 v10, v10, v36, v37
    v_pk_maximum3_f16 v10, v10, v38, v39
    s_mov_b64 s[62:63], vcc
    v_cmp_nge_f32 vcc, 0x4b800000, v13
    v_pk_mul_f32 v[52:53], v[52:53], v[8:9]
    v_pk_mul_f32 v[54:55], v[54:55], v[8:9]
    v_pk_mul_f32 v[60:61], v[60:61], v[8:9]
    v_pk_mul_f32 v[62:63], v[62:63], v[8:9]
    v_cvt_pk_bf16_f32 v52, v52, v53
    v_cvt_pk_bf16_f32 v53, v54, v55
    v_cvt_pk_bf16_f32 v54, v60, v61
    v_cvt_pk_bf16_f32 v55, v62, v63
    buffer_store_dwordx4 v[64:67], v1, s[8:11], s22 offen offset:3072 sc1
    v_pk_maximum3_f16 v10, v10, v52, v53
    v_pk_maximum3_f16 v10, v10, v54, v55
    s_or_b64 s[62:63], s[62:63], vcc
    v_pk_mul_f32 v[68:69], v[68:69], v[8:9]
    v_pk_mul_f32 v[70:71], v[70:71], v[8:9]
    v_pk_mul_f32 v[76:77], v[76:77], v[8:9]
    v_pk_mul_f32 v[78:79], v[78:79], v[8:9]
    v_cvt_pk_bf16_f32 v68, v68, v69
    v_cvt_pk_bf16_f32 v69, v70, v71
    v_cvt_pk_bf16_f32 v70, v76, v77
    v_cvt_pk_bf16_f32 v71, v78, v79
    v_pk_maximum3_f16 v10, v10, v68, v69
    v_pk_maximum3_f16 v10, v10, v70, v71
    v_lshrrev_b32 v11, 16, v10
    v_cmp_u_f16 vcc, v10, v11
    s_or_b64 s[62:63], s[62:63], vcc
    s_cbranch_scc1 redo1
done1:
    buffer_store_dwordx4 v[20:23], v1, s[8:11], s23 offen offset:0 sc1
    v_mov_b32 v6, 0x21800000
    v_mov_b32 v7, v6
    v_pk_fma_f32 v[144:145], v[144:145], v[6:7], v[136:137]
    v_pk_fma_f32 v[146:147], v[146:147], v[6:7], v[136:137]
    v_pk_fma_f32 v[148:149], v[148:149], v[6:7], v[136:137]
    buffer_store_dwordx4 v[36:39], v1, s[8:11], s23 offen offset:1024 sc1
    v_pk_fma_f32 v[150:151], v[150:151], v[6:7], v[136:137]
    v_pk_fma_f32 v[152:153], v[152:153], v[6:7], v[136:137]
    v_pk_fma_f32 v[154:155], v[154:155], v[6:7], v[136:137]
    v_pk_fma_f32 v[156:157], v[156:157], v[6:7], v[136:137]
    v_pk_fma_f32 v[158:159], v[158:159], v[6:7], v[136:137]
    buffer_store_dwordx4 v[52:55], v1, s[8:11], s23 offen offset:2048 sc1
    v_pk_fma_f32 v[160:161], v[160:161], v[6:7], v[140:141]
    v_pk_fma_f32 v[162:163], v[162:163], v[6:7], v[140:141]
    v_pk_fma_f32 v[164:165], v[164:165], v[6:7], v[140:141]
    v_pk_fma_f32 v[166:167], v[166:167], v[6:7], v[140:141]
    v_pk_fma_f32 v[168:169], v[168:169], v[6:7], v[140:141]
    buffer_store_dwordx4 v[68:71], v1, s[8:11], s23 offen offset:3072 sc1
    v_pk_fma_f32 v[170:171], v[170:171], v[6:7], v[140:141]
    v_pk_fma_f32 v[172:173], v[172:173], v[6:7], v[140:141]
    v_pk_fma_f32 v[174:175], v[174:175], v[6:7], v[140:141]
    s_sub_u32 s20, 15, s6
    s_mov_b64 exec, 0
    s_cmp_eq_u32 s3, 0
    s_cbranch_scc1 pad20
    s_cmp_eq_u32 s3, 1
    s_cbranch_scc1 pad21
    s_cmp_eq_u32 s3, 2
    s_cbranch_scc1 pad22
    s_branch pad23
hopret1:
    s_mov_b64 exec, -1
    s_waitcnt vmcnt(24) lgkmcnt(0)
    s_barrier
    s_cmp_eq_u32 s6, 7
    s_cbranch_scc1 L_i7
    s_cmp_lg_u32 s6, 0
    s_cbranch_scc1 L_T1
    v_mfma_f32_16x16x32_bf16 v[88:91], a[0:3], a[180:183], v[136:139]
pad16:
    s_cbranch_execz hopret0
    v_exp_f32 v112, v112
    v_mfma_f32_16x16x32_bf16 v[88:91], a[4:7], a[184:187], v[88:91]
    v_exp_f32 v113, v113
    v_mfma_f32_16x16x32_bf16 v[88:91], a[8:11], a[188:191], v[88:91]
    ds_read_b128 a[32:35], v3 offset:0
    buffer_store_dwordx4 a[224:227], v1, s[8:11], s89 offen offset:0 sc1
    v_cvt_pk_bf16_f32 v132, v112, v113
    v_mfma_f32_16x16x32_bf16 v[88:91], a[12:15], a[192:195], v[88:91]
    v_exp_f32 v114, v114
    v_mfma_f32_16x16x32_bf16 v[92:95], a[16:19], a[180:183], v[136:139]
    v_exp_f32 v115, v115
    v_mfma_f32_16x16x32_bf16 v[92:95], a[20:23], a[184:187], v[92:95]
    s_mov_b32 m0, s17
    ds_read_b128 a[36:39], v3 offset:1024
    v_cvt_pk_bf16_f32 v133, v114, v115
    v_mfma_f32_16x16x32_bf16 v[92:95], a[24:27], a[188:191], v[92:95]
    s_add_u32 s17, s17, 16384
    buffer_load_dwordx4 v1, s[8:11], s12 offen offset:0 sc1 lds
    v_mfma_f32_16x16x32_bf16 v[92:95], a[28:31], a[192:195], v[92:95]
    s_and_b32 s17, s17, 0xffff
    v_exp_f32 v116, v116
    v_mfma_f32_16x16x32_bf16 v[96:99], a[0:3], a[64:67], v[140:143]
    v_exp_f32 v117, v117
    v_mfma_f32_16x16x32_bf16 v[96:99], a[4:7], a[244:247], v[96:99]
    ds_read_b128 a[40:43], v3 offset:2048
    v_cvt_pk_bf16_f32 v134, v116, v117
    v_mfma_f32_16x16x32_bf16 v[96:99], a[8:11], a[248:251], v[96:99]
    buffer_store_dwordx4 a[228:231], v1, s[8:11], s89 offen offset:1024 sc1
    v_exp_f32 v118, v118
    v_mfma_f32_16x16x32_bf16 v[96:99], a[12:15], a[252:255], v[96:99]
    v_exp_f32 v119, v119
    v_mfma_f32_16x16x32_bf16 v[100:103], a[16:19], a[64:67], v[140:143]
    ds_read_b128 a[44:47], v3 offset:3072
    v_cvt_pk_bf16_f32 v135, v118, v119
    v_mfma_f32_16x16x32_bf16 v[100:103], a[20:23], a[244:247], v[100:103]
    ds_read_b128 a[48:51], v3 offset:4096
    ds_read_b128 a[52:55], v3 offset:5120
    v_mfma_f32_16x16x32_bf16 v[100:103], a[24:27], a[248:251], v[100:103]
    ds_read_b128 a[56:59], v3 offset:6144
    ds_read_b128 a[60:63], v3 offset:7168
    v_mfma_f32_16x16x32_bf16 v[100:103], a[28:31], a[252:255], v[100:103]
    s_waitcnt lgkmcnt(4)
    buffer_load_dwordx4 v1, s[8:11], s12 offen offset:1024 sc1 lds
    v_mfma_f32_16x16x32_bf16 v[240:243], a[240:243], v[128:131], 0
    ds_read_b128 a[0:3], v2 offset:16384
    ds_read_b128 a[4:7], v2 offset:17408
    v_mfma_f32_16x16x32_bf16 v[176:179], a[32:35], v[128:131], 0
    v_exp_f32 v88, v88
    v_mfma_f32_16x16x32_bf16 v[180:183], a[32:35], v[132:135], 0
    ds_read_b128 a[8:11], v2 offset:18432
    ds_read_b128 a[12:15], v2 offset:19456
    v_mfma_f32_16x16x32_bf16 v[188:191], a[36:39], v[132:135], 0
    v_exp_f32 v89, v89
    v_mfma_f32_16x16x32_bf16 v[184:187], a[36:39], v[128:131], 0
    ds_read_b128 a[16:19], v2 offset:20480
    v_cvt_pk_bf16_f32 v120, v88, v89
    v_mfma_f32_16x16x32_bf16 v[192:195], a[40:43], v[128:131], 0
    buffer_store_dwordx4 a[232:235], v1, s[8:11], s89 offen offset:2048 sc1
    v_exp_f32 v90, v90
    v_mfma_f32_16x16x32_bf16 v[196:199], a[40:43], v[132:135], 0
    v_exp_f32 v91, v91
    v_mfma_f32_16x16x32_bf16 v[204:207], a[44:47], v[132:135], 0
    s_waitcnt lgkmcnt(5)
    ds_read_b128 a[20:23], v2 offset:21504
    v_cvt_pk_bf16_f32 v121, v90, v91
    v_mfma_f32_16x16x32_bf16 v[200:203], a[44:47], v[128:131], 0
    v_exp_f32 v92, v92
    v_mfma_f32_16x16x32_bf16 v[208:211], a[48:51], v[128:131], 0
    ds_read_b128 a[24:27], v2 offset:22528
    ds_read_b128 a[28:31], v2 offset:23552
    v_mfma_f32_16x16x32_bf16 v[212:215], a[48:51], v[132:135], 0
    v_exp_f32 v93, v93
    v_mfma_f32_16x16x32_bf16 v[220:223], a[52:55], v[132:135], 0
    buffer_load_dwordx4 v1, s[8:11], s12 offen offset:2048 sc1 lds
    v_mfma_f32_16x16x32_bf16 v[216:219], a[52:55], v[128:131], 0
    v_exp_f32 v94, v94
    v_mfma_f32_16x16x32_bf16 v[224:227], a[56:59], v[128:131], 0
    v_cvt_pk_bf16_f32 v122, v92, v93
    v_mfma_f32_16x16x32_bf16 v[228:231], a[56:59], v[132:135], 0
    v_exp_f32 v95, v95
    v_mfma_f32_16x16x32_bf16 v[236:239], a[60:63], v[132:135], 0
    buffer_load_dwordx4 v1, s[8:11], s12 offen offset:3072 sc1 lds
    v_mfma_f32_16x16x32_bf16 v[232:235], a[60:63], v[128:131], 0
    v_cvt_pk_bf16_f32 v123, v94, v95
    v_mfma_f32_16x16x32_bf16 v[244:247], a[240:243], v[132:135], 0
    s_waitcnt lgkmcnt(4)
    buffer_store_dwordx4 a[236:239], v1, s[8:11], s89 offen offset:3072 sc1
    s_branch L_T2
L_i7:
    buffer_load_dwordx4 v[6:9], v1, s[8:11], s65 offen sc1
    s_waitcnt vmcnt(0)
    s_branch L_Y1
.p2align 6
L_loop2:
    v_mfma_f32_16x16x32_bf16 v[104:107], a[0:3], a[180:183], v[136:139]
pad17:
    s_cbranch_execz hopret0
    v_exp_f32 v96, v96
    v_mfma_f32_16x16x32_bf16 v[104:107], a[4:7], a[184:187], v[104:107]
    v_exp_f32 v97, v97
    v_mfma_f32_16x16x32_bf16 v[104:107], a[8:11], a[188:191], v[104:107]
    ds_read_b128 a[32:35], v3 offset:24576
    v_cvt_pk_bf16_f32 v124, v96, v97
    v_mfma_f32_16x16x32_bf16 v[104:107], a[12:15], a[192:195], v[104:107]
    s_waitcnt lgkmcnt(1)
    v_exp_f32 v98, v98
    v_mfma_f32_16x16x32_bf16 v[108:111], a[16:19], a[180:183], v[136:139]
    v_exp_f32 v99, v99
    v_mfma_f32_16x16x32_bf16 v[108:111], a[20:23], a[184:187], v[108:111]
    s_add_u32 m0, s18, 65536
    ds_read_b128 a[36:39], v3 offset:25600
    v_cvt_pk_bf16_f32 v125, v98, v99
    v_mfma_f32_16x16x32_bf16 v[108:111], a[24:27], a[188:191], v[108:111]
    s_add_u32 s18, s18, 16384
    buffer_load_dwordx4 v1, s[8:11], s13 offen offset:0 sc1 lds
    v_mfma_f32_16x16x32_bf16 v[108:111], a[28:31], a[192:195], v[108:111]
    s_and_b32 s18, s18, 0xffff
    v_exp_f32 v100, v100
    v_mfma_f32_16x16x32_bf16 v[112:115], a[0:3], a[64:67], v[140:143]
    s_add_u32 s62, s12, 16384
    v_exp_f32 v101, v101
    v_mfma_f32_16x16x32_bf16 v[112:115], a[4:7], a[244:247], v[112:115]
    s_add_u32 s12, s12, 32768
    ds_read_b128 a[40:43], v3 offset:26624
    v_cvt_pk_bf16_f32 v126, v100, v101
    v_mfma_f32_16x16x32_bf16 v[112:115], a[8:11], a[248:251], v[112:115]
    s_add_u32 s14, s14, 1
    v_exp_f32 v102, v102
    v_mfma_f32_16x16x32_bf16 v[112:115], a[12:15], a[252:255], v[112:115]
    s_cmp_eq_u32 s14, s15
    v_exp_f32 v103, v103
    v_mfma_f32_16x16x32_bf16 v[116:119], a[16:19], a[64:67], v[140:143]
    s_cselect_b32 s12, s16, s12
    ds_read_b128 a[44:47], v3 offset:27648
    v_cvt_pk_bf16_f32 v127, v102, v103
    v_mfma_f32_16x16x32_bf16 v[116:119], a[20:23], a[244:247], v[116:119]
    ds_read_b128 a[48:51], v3 offset:28672
    ds_read_b128 a[52:55], v3 offset:29696
    v_mfma_f32_16x16x32_bf16 v[116:119], a[24:27], a[248:251], v[116:119]
    ds_read_b128 a[56:59], v3 offset:30720
    ds_read_b128 a[60:63], v3 offset:31744
    v_mfma_f32_16x16x32_bf16 v[116:119], a[28:31], a[252:255], v[116:119]
    s_waitcnt lgkmcnt(4)
    buffer_load_dwordx4 v1, s[8:11], s13 offen offset:1024 sc1 lds
    v_mfma_f32_16x16x32_bf16 v[240:243], a[240:243], v[120:123], v[240:243]
    ds_read_b128 a[0:3], v2 offset:8192
    ds_read_b128 a[4:7], v2 offset:9216
    v_mfma_f32_16x16x32_bf16 v[176:179], a[32:35], v[120:123], v[176:179]
    v_exp_f32 v104, v104
    v_mfma_f32_16x16x32_bf16 v[180:183], a[32:35], v[124:127], v[180:183]
    ds_read_b128 a[8:11], v2 offset:10240
    ds_read_b128 a[12:15], v2 offset:11264
    v_mfma_f32_16x16x32_bf16 v[188:191], a[36:39], v[124:127], v[188:191]
    v_exp_f32 v105, v105
    v_mfma_f32_16x16x32_bf16 v[184:187], a[36:39], v[120:123], v[184:187]
    ds_read_b128 a[16:19], v2 offset:12288
    v_cvt_pk_bf16_f32 v128, v104, v105
    v_mfma_f32_16x16x32_bf16 v[192:195], a[40:43], v[120:123], v[192:195]
    v_exp_f32 v106, v106
    v_mfma_f32_16x16x32_bf16 v[196:199], a[40:43], v[124:127], v[196:199]
    v_exp_f32 v107, v107
    v_mfma_f32_16x16x32_bf16 v[204:207], a[44:47], v[124:127], v[204:207]
    s_waitcnt lgkmcnt(5)
    ds_read_b128 a[20:23], v2 offset:13312
    v_cvt_pk_bf16_f32 v129, v106, v107
    v_mfma_f32_16x16x32_bf16 v[200:203], a[44:47], v[120:123], v[200:203]
    v_exp_f32 v108, v108
    v_mfma_f32_16x16x32_bf16 v[208:211], a[48:51], v[120:123], v[208:211]
    ds_read_b128 a[24:27], v2 offset:14336
    ds_read_b128 a[28:31], v2 offset:15360
    v_mfma_f32_16x16x32_bf16 v[212:215], a[48:51], v[124:127], v[212:215]
    v_exp_f32 v109, v109
    v_mfma_f32_16x16x32_bf16 v[220:223], a[52:55], v[124:127], v[220:223]
    buffer_load_dwordx4 v1, s[8:11], s13 offen offset:2048 sc1 lds
    v_mfma_f32_16x16x32_bf16 v[216:219], a[52:55], v[120:123], v[216:219]
    v_exp_f32 v110, v110
    v_mfma_f32_16x16x32_bf16 v[224:227], a[56:59], v[120:123], v[224:227]
    v_cvt_pk_bf16_f32 v130, v108, v109
    v_xor_b32 v3, 0x8000, v3
    v_mfma_f32_16x16x32_bf16 v[228:231], a[56:59], v[124:127], v[228:231]
    v_exp_f32 v111, v111
    v_mfma_f32_16x16x32_bf16 v[236:239], a[60:63], v[124:127], v[236:239]
    buffer_load_dwordx4 v1, s[8:11], s13 offen offset:3072 sc1 lds
    v_mfma_f32_16x16x32_bf16 v[232:235], a[60:63], v[120:123], v[232:235]
    s_mov_b32 s13, s62
    v_cvt_pk_bf16_f32 v131, v110, v111
    v_mfma_f32_16x16x32_bf16 v[244:247], a[240:243], v[124:127], v[244:247]
    s_waitcnt vmcnt(16) lgkmcnt(0)
    s_barrier
L_T1:
    v_mfma_f32_16x16x32_bf16 v[88:91], a[0:3], a[180:183], v[136:139]
pad18:
    s_cbranch_execz hopret0
    v_exp_f32 v112, v112
    v_mfma_f32_16x16x32_bf16 v[88:91], a[4:7], a[184:187], v[88:91]
    v_exp_f32 v113, v113
    v_mfma_f32_16x16x32_bf16 v[88:91], a[8:11], a[188:191], v[88:91]
    ds_read_b128 a[32:35], v3 offset:0
    v_cvt_pk_bf16_f32 v132, v112, v113
    v_mfma_f32_16x16x32_bf16 v[88:91], a[12:15], a[192:195], v[88:91]
    v_exp_f32 v114, v114
    v_mfma_f32_16x16x32_bf16 v[92:95], a[16:19], a[180:183], v[136:139]
    v_exp_f32 v115, v115
    v_mfma_f32_16x16x32_bf16 v[92:95], a[20:23], a[184:187], v[92:95]
    s_mov_b32 m0, s17
    ds_read_b128 a[36:39], v3 offset:1024
    v_cvt_pk_bf16_f32 v133, v114, v115
    v_mfma_f32_16x16x32_bf16 v[92:95], a[24:27], a[188:191], v[92:95]
    s_add_u32 s17, s17, 16384
    buffer_load_dwordx4 v1, s[8:11], s12 offen offset:0 sc1 lds
    v_mfma_f32_16x16x32_bf16 v[92:95], a[28:31], a[192:195], v[92:95]
    s_and_b32 s17, s17, 0xffff
    v_exp_f32 v116, v116
    v_mfma_f32_16x16x32_bf16 v[96:99], a[0:3], a[64:67], v[140:143]
    v_exp_f32 v117, v117
    v_mfma_f32_16x16x32_bf16 v[96:99], a[4:7], a[244:247], v[96:99]
    ds_read_b128 a[40:43], v3 offset:2048
    v_cvt_pk_bf16_f32 v134, v116, v117
    v_mfma_f32_16x16x32_bf16 v[96:99], a[8:11], a[248:251], v[96:99]
    v_exp_f32 v118, v118
    v_mfma_f32_16x16x32_bf16 v[96:99], a[12:15], a[252:255], v[96:99]
    v_exp_f32 v119, v119
    v_mfma_f32_16x16x32_bf16 v[100:103], a[16:19], a[64:67], v[140:143]
    ds_read_b128 a[44:47], v3 offset:3072
    v_cvt_pk_bf16_f32 v135, v118, v119
    v_mfma_f32_16x16x32_bf16 v[100:103], a[20:23], a[244:247], v[100:103]
    ds_read_b128 a[48:51], v3 offset:4096
    ds_read_b128 a[52:55], v3 offset:5120
    v_mfma_f32_16x16x32_bf16 v[100:103], a[24:27], a[248:251], v[100:103]
    ds_read_b128 a[56:59], v3 offset:6144
    ds_read_b128 a[60:63], v3 offset:7168
    v_mfma_f32_16x16x32_bf16 v[100:103], a[28:31], a[252:255], v[100:103]
    s_waitcnt lgkmcnt(4)
    buffer_load_dwordx4 v1, s[8:11], s12 offen offset:1024 sc1 lds
    v_mfma_f32_16x16x32_bf16 v[240:243], a[240:243], v[128:131], v[240:243]
    ds_read_b128 a[0:3], v2 offset:16384
    ds_read_b128 a[4:7], v2 offset:17408
    v_mfma_f32_16x16x32_bf16 v[176:179], a[32:35], v[128:131], v[176:179]
    v_exp_f32 v88, v88
    v_mfma_f32_16x16x32_bf16 v[180:183], a[32:35], v[132:135], v[180:183]
    ds_read_b128 a[8:11], v2 offset:18432
    ds_read_b128 a[12:15], v2 offset:19456
    v_mfma_f32_16x16x32_bf16 v[188:191], a[36:39], v[132:135], v[188:191]
    v_exp_f32 v89, v89
    v_mfma_f32_16x16x32_bf16 v[184:187], a[36:39], v[128:131], v[184:187]
    ds_read_b128 a[16:19], v2 offset:20480
    v_cvt_pk_bf16_f32 v120, v88, v89
    v_mfma_f32_16x16x32_bf16 v[192:195], a[40:43], v[128:131], v[192:195]
    v_exp_f32 v90, v90
    v_mfma_f32_16x16x32_bf16 v[196:199], a[40:43], v[132:135], v[196:199]
    v_exp_f32 v91, v91
    v_mfma_f32_16x16x32_bf16 v[204:207], a[44:47], v[132:135], v[204:207]
    s_waitcnt lgkmcnt(5)
    ds_read_b128 a[20:23], v2 offset:21504
    v_cvt_pk_bf16_f32 v121, v90, v91
    v_mfma_f32_16x16x32_bf16 v[200:203], a[44:47], v[128:131], v[200:203]
    v_exp_f32 v92, v92
    v_mfma_f32_16x16x32_bf16 v[208:211], a[48:51], v[128:131], v[208:211]
    ds_read_b128 a[24:27], v2 offset:22528
    ds_read_b128 a[28:31], v2 offset:23552
    v_mfma_f32_16x16x32_bf16 v[212:215], a[48:51], v[132:135], v[212:215]
    v_exp_f32 v93, v93
    v_mfma_f32_16x16x32_bf16 v[220:223], a[52:55], v[132:135], v[220:223]
    buffer_load_dwordx4 v1, s[8:11], s12 offen offset:2048 sc1 lds
    v_mfma_f32_16x16x32_bf16 v[216:219], a[52:55], v[128:131], v[216:219]
    v_exp_f32 v94, v94
    v_mfma_f32_16x16x32_bf16 v[224:227], a[56:59], v[128:131], v[224:227]
    v_cvt_pk_bf16_f32 v122, v92, v93
    v_mfma_f32_16x16x32_bf16 v[228:231], a[56:59], v[132:135], v[228:231]
    v_exp_f32 v95, v95
    v_mfma_f32_16x16x32_bf16 v[236:239], a[60:63], v[132:135], v[236:239]
    buffer_load_dwordx4 v1, s[8:11], s12 offen offset:3072 sc1 lds
    v_mfma_f32_16x16x32_bf16 v[232:235], a[60:63], v[128:131], v[232:235]
    v_cvt_pk_bf16_f32 v123, v94, v95
    v_mfma_f32_16x16x32_bf16 v[244:247], a[240:243], v[132:135], v[244:247]
    s_waitcnt lgkmcnt(4)
L_T2:
    v_mfma_f32_16x16x32_bf16 v[104:107], a[0:3], a[180:183], v[136:139]
pad19:
    s_cbranch_execz hopret0
    v_exp_f32 v96, v96
    v_mfma_f32_16x16x32_bf16 v[104:107], a[4:7], a[184:187], v[104:107]
    v_exp_f32 v97, v97
    v_mfma_f32_16x16x32_bf16 v[104:107], a[8:11], a[188:191], v[104:107]
    ds_read_b128 a[32:35], v3 offset:8192
    v_cvt_pk_bf16_f32 v124, v96, v97
    v_mfma_f32_16x16x32_bf16 v[104:107], a[12:15], a[192:195], v[104:107]
    s_waitcnt lgkmcnt(1)
    v_exp_f32 v98, v98
    v_mfma_f32_16x16x32_bf16 v[108:111], a[16:19], a[180:183], v[136:139]
    v_exp_f32 v99, v99
    v_mfma_f32_16x16x32_bf16 v[108:111], a[20:23], a[184:187], v[108:111]
    s_add_u32 m0, s18, 65536
    ds_read_b128 a[36:39], v3 offset:9216
    v_cvt_pk_bf16_f32 v125, v98, v99
    v_mfma_f32_16x16x32_bf16 v[108:111], a[24:27], a[188:191], v[108:111]
    s_add_u32 s18, s18, 16384
    buffer_load_dwordx4 v1, s[8:11], s13 offen offset:0 sc1 lds
    v_mfma_f32_16x16x32_bf16 v[108:111], a[28:31], a[192:195], v[108:111]
    s_and_b32 s18, s18, 0xffff
    v_exp_f32 v100, v100
    v_mfma_f32_16x16x32_bf16 v[112:115], a[0:3], a[64:67], v[140:143]
    s_add_u32 s62, s12, 16384
    v_exp_f32 v101, v101
    v_mfma_f32_16x16x32_bf16 v[112:115], a[4:7], a[244:247], v[112:115]
    s_add_u32 s12, s12, 32768
    ds_read_b128 a[40:43], v3 offset:10240
    v_cvt_pk_bf16_f32 v126, v100, v101
    v_mfma_f32_16x16x32_bf16 v[112:115], a[8:11], a[248:251], v[112:115]
    s_add_u32 s14, s14, 1
    v_exp_f32 v102, v102
    v_mfma_f32_16x16x32_bf16 v[112:115], a[12:15], a[252:255], v[112:115]
    s_cmp_eq_u32 s14, s15
    v_exp_f32 v103, v103
    v_mfma_f32_16x16x32_bf16 v[116:119], a[16:19], a[64:67], v[140:143]
    s_cselect_b32 s12, s16, s12
    ds_read_b128 a[44:47], v3 offset:11264
    v_cvt_pk_bf16_f32 v127, v102, v103
    v_mfma_f32_16x16x32_bf16 v[116:119], a[20:23], a[244:247], v[116:119]
    ds_read_b128 a[48:51], v3 offset:12288
    ds_read_b128 a[52:55], v3 offset:13312
    v_mfma_f32_16x16x32_bf16 v[116:119], a[24:27], a[248:251], v[116:119]
    ds_read_b128 a[56:59], v3 offset:14336
    ds_read_b128 a[60:63], v3 offset:15360
    v_mfma_f32_16x16x32_bf16 v[116:119], a[28:31], a[252:255], v[116:119]
    s_waitcnt lgkmcnt(4)
    buffer_load_dwordx4 v1, s[8:11], s13 offen offset:1024 sc1 lds
    v_mfma_f32_16x16x32_bf16 v[240:243], a[240:243], v[120:123], v[240:243]
    ds_read_b128 a[0:3], v2 offset:24576
    ds_read_b128 a[4:7], v2 offset:25600
    v_mfma_f32_16x16x32_bf16 v[176:179], a[32:35], v[120:123], v[176:179]
    v_exp_f32 v104, v104
    v_mfma_f32_16x16x32_bf16 v[180:183], a[32:35], v[124:127], v[180:183]
    ds_read_b128 a[8:11], v2 offset:26624
    ds_read_b128 a[12:15], v2 offset:27648
    v_mfma_f32_16x16x32_bf16 v[188:191], a[36:39], v[124:127], v[188:191]
    v_exp_f32 v105, v105
    v_mfma_f32_16x16x32_bf16 v[184:187], a[36:39], v[120:123], v[184:187]
    ds_read_b128 a[16:19], v2 offset:28672
    v_cvt_pk_bf16_f32 v128, v104, v105
    v_mfma_f32_16x16x32_bf16 v[192:195], a[40:43], v[120:123], v[192:195]
    v_exp_f32 v106, v106
    v_mfma_f32_16x16x32_bf16 v[196:199], a[40:43], v[124:127], v[196:199]
    v_exp_f32 v107, v107
    v_mfma_f32_16x16x32_bf16 v[204:207], a[44:47], v[124:127], v[204:207]
    s_waitcnt lgkmcnt(5)
    ds_read_b128 a[20:23], v2 offset:29696
    v_cvt_pk_bf16_f32 v129, v106, v107
    v_mfma_f32_16x16x32_bf16 v[200:203], a[44:47], v[120:123], v[200:203]
    v_exp_f32 v108, v108
    v_mfma_f32_16x16x32_bf16 v[208:211], a[48:51], v[120:123], v[208:211]
    ds_read_b128 a[24:27], v2 offset:30720
    ds_read_b128 a[28:31], v2 offset:31744
    v_mfma_f32_16x16x32_bf16 v[212:215], a[48:51], v[124:127], v[212:215]
    v_exp_f32 v109, v109
    v_mfma_f32_16x16x32_bf16 v[220:223], a[52:55], v[124:127], v[220:223]
    buffer_load_dwordx4 v1, s[8:11], s13 offen offset:2048 sc1 lds
    v_mfma_f32_16x16x32_bf16 v[216:219], a[52:55], v[120:123], v[216:219]
    v_exp_f32 v110, v110
    v_mfma_f32_16x16x32_bf16 v[224:227], a[56:59], v[120:123], v[224:227]
    v_cvt_pk_bf16_f32 v130, v108, v109
    v_xor_b32 v2, 0x8000, v2
    v_mfma_f32_16x16x32_bf16 v[228:231], a[56:59], v[124:127], v[228:231]
    v_exp_f32 v111, v111
    v_mfma_f32_16x16x32_bf16 v[236:239], a[60:63], v[124:127], v[236:239]
    buffer_load_dwordx4 v1, s[8:11], s13 offen offset:3072 sc1 lds
    v_mfma_f32_16x16x32_bf16 v[232:235], a[60:63], v[120:123], v[232:235]
    s_mov_b32 s13, s62
    v_cvt_pk_bf16_f32 v131, v110, v111
    v_mfma_f32_16x16x32_bf16 v[244:247], a[240:243], v[124:127], v[244:247]
    s_waitcnt vmcnt(16) lgkmcnt(0)
    s_barrier
    v_mfma_f32_16x16x32_bf16 v[88:91], a[0:3], a[180:183], v[136:139]
    v_exp_f32 v112, v112
    v_mfma_f32_16x16x32_bf16 v[88:91], a[4:7], a[184:187], v[88:91]
    v_exp_f32 v113, v113
    v_mfma_f32_16x16x32_bf16 v[88:91], a[8:11], a[188:191], v[88:91]
    ds_read_b128 a[32:35], v3 offset:16384
    v_cvt_pk_bf16_f32 v132, v112, v113
    v_mfma_f32_16x16x32_bf16 v[88:91], a[12:15], a[192:195], v[88:91]
    v_exp_f32 v114, v114
    v_mfma_f32_16x16x32_bf16 v[92:95], a[16:19], a[180:183], v[136:139]
    v_exp_f32 v115, v115
    v_mfma_f32_16x16x32_bf16 v[92:95], a[20:23], a[184:187], v[92:95]
    s_mov_b32 m0, s17
    ds_read_b128 a[36:39], v3 offset:17408
    v_cvt_pk_bf16_f32 v133, v114, v115
    v_mfma_f32_16x16x32_bf16 v[92:95], a[24:27], a[188:191], v[92:95]
    s_add_u32 s17, s17, 16384
    buffer_load_dwordx4 v1, s[8:11], s12 offen offset:0 sc1 lds
    v_mfma_f32_16x16x32_bf16 v[92:95], a[28:31], a[192:195], v[92:95]
    s_and_b32 s17, s17, 0xffff
    v_exp_f32 v116, v116
    v_mfma_f32_16x16x32_bf16 v[96:99], a[0:3], a[64:67], v[140:143]
    v_exp_f32 v117, v117
    v_mfma_f32_16x16x32_bf16 v[96:99], a[4:7], a[244:247], v[96:99]
    ds_read_b128 a[40:43], v3 offset:18432
    v_cvt_pk_bf16_f32 v134, v116, v117
    v_mfma_f32_16x16x32_bf16 v[96:99], a[8:11], a[248:251], v[96:99]
    s_cmp_eq_u32 s19, s69
    v_exp_f32 v118, v118
    v_mfma_f32_16x16x32_bf16 v[96:99], a[12:15], a[252:255], v[96:99]
    s_cselect_b32 s64, s95, 536870912
    v_exp_f32 v119, v119
    v_mfma_f32_16x16x32_bf16 v[100:103], a[16:19], a[64:67], v[140:143]
    ds_read_b128 a[44:47], v3 offset:19456
    v_cvt_pk_bf16_f32 v135, v118, v119
    v_mfma_f32_16x16x32_bf16 v[100:103], a[20:23], a[244:247], v[100:103]
    ds_read_b128 a[48:51], v3 offset:20480
    ds_read_b128 a[52:55], v3 offset:21504
    v_mfma_f32_16x16x32_bf16 v[100:103], a[24:27], a[248:251], v[100:103]
    ds_read_b128 a[56:59], v3 offset:22528
    ds_read_b128 a[60:63], v3 offset:23552
    v_mfma_f32_16x16x32_bf16 v[100:103], a[28:31], a[252:255], v[100:103]
    s_waitcnt lgkmcnt(4)
    buffer_load_dwordx4 v1, s[8:11], s12 offen offset:1024 sc1 lds
    v_mfma_f32_16x16x32_bf16 v[240:243], a[240:243], v[128:131], v[240:243]
    ds_read_b128 a[0:3], v2 offset:0
    ds_read_b128 a[4:7], v2 offset:1024
    v_mfma_f32_16x16x32_bf16 v[176:179], a[32:35], v[128:131], v[176:179]
    v_exp_f32 v88, v88
    v_mfma_f32_16x16x32_bf16 v[180:183], a[32:35], v[132:135], v[180:183]
    ds_read_b128 a[8:11], v2 offset:2048
    ds_read_b128 a[12:15], v2 offset:3072
    v_mfma_f32_16x16x32_bf16 v[188:191], a[36:39], v[132:135], v[188:191]
    v_exp_f32 v89, v89
    v_mfma_f32_16x16x32_bf16 v[184:187], a[36:39], v[128:131], v[184:187]
    ds_read_b128 a[16:19], v2 offset:4096
    v_cvt_pk_bf16_f32 v120, v88, v89
    v_mfma_f32_16x16x32_bf16 v[192:195], a[40:43], v[128:131], v[192:195]
    v_exp_f32 v90, v90
    v_mfma_f32_16x16x32_bf16 v[196:199], a[40:43], v[132:135], v[196:199]
    v_exp_f32 v91, v91
    v_mfma_f32_16x16x32_bf16 v[204:207], a[44:47], v[132:135], v[204:207]
    s_waitcnt lgkmcnt(5)
    ds_read_b128 a[20:23], v2 offset:5120
    v_cvt_pk_bf16_f32 v121, v90, v91
    v_mfma_f32_16x16x32_bf16 v[200:203], a[44:47], v[128:131], v[200:203]
    v_exp_f32 v92, v92
    v_mfma_f32_16x16x32_bf16 v[208:211], a[48:51], v[128:131], v[208:211]
    ds_read_b128 a[24:27], v2 offset:6144
    ds_read_b128 a[28:31], v2 offset:7168
    v_mfma_f32_16x16x32_bf16 v[212:215], a[48:51], v[132:135], v[212:215]
    v_exp_f32 v93, v93
    v_mfma_f32_16x16x32_bf16 v[220:223], a[52:55], v[132:135], v[220:223]
    buffer_load_dwordx4 v1, s[8:11], s12 offen offset:2048 sc1 lds
    v_mfma_f32_16x16x32_bf16 v[216:219], a[52:55], v[128:131], v[216:219]
    s_sub_u32 s19, s19, 1
    v_exp_f32 v94, v94
    v_mfma_f32_16x16x32_bf16 v[224:227], a[56:59], v[128:131], v[224:227]
    s_cmp_lg_u32 s19, 0
    v_cvt_pk_bf16_f32 v122, v92, v93
    v_mfma_f32_16x16x32_bf16 v[228:231], a[56:59], v[132:135], v[228:231]
    v_exp_f32 v95, v95
    v_mfma_f32_16x16x32_bf16 v[236:239], a[60:63], v[132:135], v[236:239]
    buffer_load_dwordx4 v1, s[8:11], s12 offen offset:3072 sc1 lds
    v_mfma_f32_16x16x32_bf16 v[232:235], a[60:63], v[128:131], v[232:235]
    v_cvt_pk_bf16_f32 v123, v94, v95
    v_mfma_f32_16x16x32_bf16 v[244:247], a[240:243], v[132:135], v[244:247]
    s_waitcnt lgkmcnt(4)
    buffer_store_dword v252, off, s[8:11], s64 sc1
    s_cbranch_scc1 L_loop2
L_last:
    v_mfma_f32_16x16x32_bf16 v[104:107], a[0:3], a[180:183], v[136:139]
    v_exp_f32 v96, v96
    v_mfma_f32_16x16x32_bf16 v[104:107], a[4:7], a[184:187], v[104:107]
    buffer_load_dwordx4 v[6:9], v1, s[8:11], s65 offen sc1
    v_exp_f32 v97, v97
    v_mfma_f32_16x16x32_bf16 v[104:107], a[8:11], a[188:191], v[104:107]
    ds_read_b128 a[32:35], v3 offset:24576
    v_cvt_pk_bf16_f32 v124, v96, v97
    v_mfma_f32_16x16x32_bf16 v[104:107], a[12:15], a[192:195], v[104:107]
    s_waitcnt lgkmcnt(1)
    v_exp_f32 v98, v98
    v_mfma_f32_16x16x32_bf16 v[108:111], a[16:19], a[180:183], v[136:139]
    v_exp_f32 v99, v99
    v_mfma_f32_16x16x32_bf16 v[108:111], a[20:23], a[184:187], v[108:111]
    s_add_u32 m0, s18, 65536
    ds_read_b128 a[36:39], v3 offset:25600
    v_cvt_pk_bf16_f32 v125, v98, v99
    v_mfma_f32_16x16x32_bf16 v[108:111], a[24:27], a[188:191], v[108:111]
    s_add_u32 s18, s18, 16384
    buffer_load_dwordx4 v1, s[8:11], s13 offen offset:0 sc1 lds
    v_mfma_f32_16x16x32_bf16 v[108:111], a[28:31], a[192:195], v[108:111]
    s_and_b32 s18, s18, 0xffff
    v_exp_f32 v100, v100
    v_mfma_f32_16x16x32_bf16 v[112:115], a[0:3], a[64:67], v[140:143]
    s_add_u32 s62, s12, 16384
    v_exp_f32 v101, v101
    v_mfma_f32_16x16x32_bf16 v[112:115], a[4:7], a[244:247], v[112:115]
    s_add_u32 s12, s12, 32768
    ds_read_b128 a[40:43], v3 offset:26624
    v_cvt_pk_bf16_f32 v126, v100, v101
    v_mfma_f32_16x16x32_bf16 v[112:115], a[8:11], a[248:251], v[112:115]
    s_add_u32 s14, s14, 1
    v_exp_f32 v102, v102
    v_mfma_f32_16x16x32_bf16 v[112:115], a[12:15], a[252:255], v[112:115]
    s_cmp_eq_u32 s14, s15
    v_exp_f32 v103, v103
    v_mfma_f32_16x16x32_bf16 v[116:119], a[16:19], a[64:67], v[140:143]
    s_cselect_b32 s12, s16, s12
    ds_read_b128 a[44:47], v3 offset:27648
    v_cvt_pk_bf16_f32 v127, v102, v103
    v_mfma_f32_16x16x32_bf16 v[116:119], a[20:23], a[244:247], v[116:119]
    ds_read_b128 a[48:51], v3 offset:28672
    ds_read_b128 a[52:55], v3 offset:29696
    v_mfma_f32_16x16x32_bf16 v[116:119], a[24:27], a[248:251], v[116:119]
    ds_read_b128 a[56:59], v3 offset:30720
    ds_read_b128 a[60:63], v3 offset:31744
    v_mfma_f32_16x16x32_bf16 v[116:119], a[28:31], a[252:255], v[116:119]
    s_waitcnt lgkmcnt(4)
    buffer_load_dwordx4 v1, s[8:11], s13 offen offset:1024 sc1 lds
    v_mfma_f32_16x16x32_bf16 v[240:243], a[240:243], v[120:123], v[240:243]
    ds_read_b128 a[0:3], v2 offset:8192
    ds_read_b128 a[4:7], v2 offset:9216
    v_mfma_f32_16x16x32_bf16 v[176:179], a[32:35], v[120:123], v[176:179]
    v_exp_f32 v104, v104
    v_mfma_f32_16x16x32_bf16 v[180:183], a[32:35], v[124:127], v[180:183]
    ds_read_b128 a[8:11], v2 offset:10240
    ds_read_b128 a[12:15], v2 offset:11264
    v_mfma_f32_16x16x32_bf16 v[188:191], a[36:39], v[124:127], v[188:191]
    v_exp_f32 v105, v105
    v_mfma_f32_16x16x32_bf16 v[184:187], a[36:39], v[120:123], v[184:187]
    ds_read_b128 a[16:19], v2 offset:12288
    v_cvt_pk_bf16_f32 v128, v104, v105
    v_mfma_f32_16x16x32_bf16 v[192:195], a[40:43], v[120:123], v[192:195]
    v_exp_f32 v106, v106
    v_mfma_f32_16x16x32_bf16 v[196:199], a[40:43], v[124:127], v[196:199]
    v_exp_f32 v107, v107
    v_mfma_f32_16x16x32_bf16 v[204:207], a[44:47], v[124:127], v[204:207]
    s_waitcnt lgkmcnt(5)
    ds_read_b128 a[20:23], v2 offset:13312
    v_cvt_pk_bf16_f32 v129, v106, v107
    v_mfma_f32_16x16x32_bf16 v[200:203], a[44:47], v[120:123], v[200:203]
    v_exp_f32 v108, v108
    v_mfma_f32_16x16x32_bf16 v[208:211], a[48:51], v[120:123], v[208:211]
    ds_read_b128 a[24:27], v2 offset:14336
    ds_read_b128 a[28:31], v2 offset:15360
    v_mfma_f32_16x16x32_bf16 v[212:215], a[48:51], v[124:127], v[212:215]
    v_exp_f32 v109, v109
    v_mfma_f32_16x16x32_bf16 v[220:223], a[52:55], v[124:127], v[220:223]
    buffer_load_dwordx4 v1, s[8:11], s13 offen offset:2048 sc1 lds
    v_mfma_f32_16x16x32_bf16 v[216:219], a[52:55], v[120:123], v[216:219]
    v_exp_f32 v110, v110
    v_mfma_f32_16x16x32_bf16 v[224:227], a[56:59], v[120:123], v[224:227]
    v_cvt_pk_bf16_f32 v130, v108, v109
    v_xor_b32 v3, 0x8000, v3
    v_mfma_f32_16x16x32_bf16 v[228:231], a[56:59], v[124:127], v[228:231]
    v_exp_f32 v111, v111
    v_mfma_f32_16x16x32_bf16 v[236:239], a[60:63], v[124:127], v[236:239]
    buffer_load_dwordx4 v1, s[8:11], s13 offen offset:3072 sc1 lds
    v_mfma_f32_16x16x32_bf16 v[232:235], a[60:63], v[120:123], v[232:235]
    s_mov_b32 s13, s62
    v_cvt_pk_bf16_f32 v131, v110, v111
    v_mfma_f32_16x16x32_bf16 v[244:247], a[240:243], v[124:127], v[244:247]
    s_waitcnt vmcnt(18) lgkmcnt(0)
    s_barrier
L_Y1:
    v_mfma_f32_16x16x32_bf16 v[88:91], a[0:3], a[180:183], v[136:139]
    s_waitcnt vmcnt(4)
    v_exp_f32 v112, v112
    v_xor_b32 v7, s97, v7
    v_xor_b32 v8, s97, v8
    v_xor_b32 v9, s97, v9
    v_xor_b32 v6, s97, v6
    v_or3_b32 v6, v6, v7, v8
    v_or_b32 v6, v6, v9
    v_cmp_eq_u32 vcc, 0, v6
    s_cmp_eq_u64 vcc, -1
    s_cbranch_scc0 spin1
spin1_ok:
    v_mfma_f32_16x16x32_bf16 v[88:91], a[4:7], a[184:187], v[88:91]
    s_add_u32 m0, s30, 143360
    v_exp_f32 v113, v113
    v_mfma_f32_16x16x32_bf16 v[88:91], a[8:11], a[188:191], v[88:91]
    s_add_u32 s76, s70, 0
    ds_read_b128 a[32:35], v3 offset:0
    buffer_load_dwordx4 v1, s[24:27], s76 offen offset:0 sc1 lds
    v_cvt_pk_bf16_f32 v132, v112, v113
    v_mfma_f32_16x16x32_bf16 v[88:91], a[12:15], a[192:195], v[88:91]
    v_exp_f32 v114, v114
    v_mfma_f32_16x16x32_bf16 v[92:95], a[16:19], a[180:183], v[136:139]
    v_exp_f32 v115, v115
    v_mfma_f32_16x16x32_bf16 v[92:95], a[20:23], a[184:187], v[92:95]
    ds_read_b128 a[36:39], v3 offset:1024
    v_cvt_pk_bf16_f32 v133, v114, v115
    v_mfma_f32_16x16x32_bf16 v[92:95], a[24:27], a[188:191], v[92:95]
    s_add_u32 s76, s71, 4294966272
    buffer_load_dwordx4 v1, s[24:27], s76 offen offset:1024 sc1 lds
    v_mfma_f32_16x16x32_bf16 v[92:95], a[28:31], a[192:195], v[92:95]
    v_exp_f32 v116, v116
    v_mfma_f32_16x16x32_bf16 v[96:99], a[0:3], a[64:67], v[140:143]
    v_exp_f32 v117, v117
    v_mfma_f32_16x16x32_bf16 v[96:99], a[4:7], a[244:247], v[96:99]
    ds_read_b128 a[40:43], v3 offset:2048
    v_cvt_pk_bf16_f32 v134, v116, v117
    v_mfma_f32_16x16x32_bf16 v[96:99], a[8:11], a[248:251], v[96:99]
pad20:
    s_cbranch_execz pad24
    s_add_u32 s76, s72, 4294965248
    buffer_load_dwordx4 v1, s[24:27], s76 offen offset:2048 sc1 lds
    v_exp_f32 v118, v118
    v_mfma_f32_16x16x32_bf16 v[96:99], a[12:15], a[252:255], v[96:99]
    v_exp_f32 v119, v119
    v_mfma_f32_16x16x32_bf16 v[100:103], a[16:19], a[64:67], v[140:143]
    ds_read_b128 a[44:47], v3 offset:3072
    v_cvt_pk_bf16_f32 v135, v118, v119
    v_mfma_f32_16x16x32_bf16 v[100:103], a[20:23], a[244:247], v[100:103]
    ds_read_b128 a[48:51], v3 offset:4096
    ds_read_b128 a[52:55], v3 offset:5120
    v_mfma_f32_16x16x32_bf16 v[100:103], a[24:27], a[248:251], v[100:103]
    ds_read_b128 a[56:59], v3 offset:6144
    ds_read_b128 a[60:63], v3 offset:7168
    v_mfma_f32_16x16x32_bf16 v[100:103], a[28:31], a[252:255], v[100:103]
    s_waitcnt lgkmcnt(4)
    s_add_u32 s76, s73, 4294964224
    buffer_load_dwordx4 v1, s[24:27], s76 offen offset:3072 sc1 lds
    v_mfma_f32_16x16x32_bf16 v[240:243], a[240:243], v[128:131], v[240:243]
    ds_read_b128 a[0:3], v2 offset:16384
    ds_read_b128 a[4:7], v2 offset:17408
    v_mfma_f32_16x16x32_bf16 v[176:179], a[32:35], v[128:131], v[176:179]
    v_exp_f32 v88, v88
    v_mfma_f32_16x16x32_bf16 v[180:183], a[32:35], v[132:135], v[180:183]
    s_add_u32 m0, s30, 147456
    ds_read_b128 a[8:11], v2 offset:18432
    ds_read_b128 a[12:15], v2 offset:19456
    v_mfma_f32_16x16x32_bf16 v[188:191], a[36:39], v[132:135], v[188:191]
    s_add_u32 s76, s74, 0
    buffer_load_dwordx4 v1, s[24:27], s76 offen offset:0 sc1 lds
    v_exp_f32 v89, v89
    v_mfma_f32_16x16x32_bf16 v[184:187], a[36:39], v[128:131], v[184:187]
    ds_read_b128 a[16:19], v2 offset:20480
    v_cvt_pk_bf16_f32 v120, v88, v89
    v_mfma_f32_16x16x32_bf16 v[192:195], a[40:43], v[128:131], v[192:195]
    v_exp_f32 v90, v90
    v_mfma_f32_16x16x32_bf16 v[196:199], a[40:43], v[132:135], v[196:199]
    v_exp_f32 v91, v91
    v_mfma_f32_16x16x32_bf16 v[204:207], a[44:47], v[132:135], v[204:207]
    s_waitcnt lgkmcnt(5)
    s_add_u32 s77, s34, 0
    ds_read_b128 a[20:23], v2 offset:21504
    buffer_load_dwordx4 a[100:103], v1, s[8:11], s77 offen offset:0 sc1
    v_cvt_pk_bf16_f32 v121, v90, v91
    v_mfma_f32_16x16x32_bf16 v[200:203], a[44:47], v[128:131], v[200:203]
    v_exp_f32 v92, v92
    v_mfma_f32_16x16x32_bf16 v[208:211], a[48:51], v[128:131], v[208:211]
    ds_read_b128 a[24:27], v2 offset:22528
    ds_read_b128 a[28:31], v2 offset:23552
    v_mfma_f32_16x16x32_bf16 v[212:215], a[48:51], v[132:135], v[212:215]
    v_exp_f32 v93, v93
    v_mfma_f32_16x16x32_bf16 v[220:223], a[52:55], v[132:135], v[220:223]
    buffer_load_dwordx4 a[104:107], v1, s[8:11], s77 offen offset:1024 sc1
    v_mfma_f32_16x16x32_bf16 v[216:219], a[52:55], v[128:131], v[216:219]
    v_exp_f32 v94, v94
    v_mfma_f32_16x16x32_bf16 v[224:227], a[56:59], v[128:131], v[224:227]
    v_cvt_pk_bf16_f32 v122, v92, v93
    v_mfma_f32_16x16x32_bf16 v[228:231], a[56:59], v[132:135], v[228:231]
    v_exp_f32 v95, v95
    v_mfma_f32_16x16x32_bf16 v[236:239], a[60:63], v[132:135], v[236:239]
    s_add_u32 s77, s35, 0
    buffer_load_dwordx4 a[108:111], v1, s[8:11], s77 offen offset:0 sc1
    v_mfma_f32_16x16x32_bf16 v[232:235], a[60:63], v[128:131], v[232:235]
    v_cvt_pk_bf16_f32 v123, v94, v95
    v_mfma_f32_16x16x32_bf16 v[244:247], a[240:243], v[132:135], v[244:247]
    s_waitcnt lgkmcnt(4)
    buffer_load_dwordx4 a[112:115], v1, s[8:11], s77 offen offset:1024 sc1
    v_mfma_f32_16x16x32_bf16 v[104:107], a[0:3], a[180:183], v[136:139]
    v_exp_f32 v96, v96
    v_mfma_f32_16x16x32_bf16 v[104:107], a[4:7], a[184:187], v[104:107]
    v_exp_f32 v97, v97
    v_mfma_f32_16x16x32_bf16 v[104:107], a[8:11], a[188:191], v[104:107]
    s_add_u32 s77, s34, 2048
    ds_read_b128 a[32:35], v3 offset:8192
    buffer_load_dwordx4 a[116:119], v1, s[8:11], s77 offen offset:0 sc1
    v_cvt_pk_bf16_f32 v124, v96, v97
    v_mfma_f32_16x16x32_bf16 v[104:107], a[12:15], a[192:195], v[104:107]
    s_waitcnt lgkmcnt(1)
    v_exp_f32 v98, v98
    v_mfma_f32_16x16x32_bf16 v[108:111], a[16:19], a[180:183], v[136:139]
    v_exp_f32 v99, v99
    v_mfma_f32_16x16x32_bf16 v[108:111], a[20:23], a[184:187], v[108:111]
    s_add_u32 m0, s18, 65536
    ds_read_b128 a[36:39], v3 offset:9216
    v_cvt_pk_bf16_f32 v125, v98, v99
    v_mfma_f32_16x16x32_bf16 v[108:111], a[24:27], a[188:191], v[108:111]
    s_add_u32 s18, s18, 16384
    buffer_load_dwordx4 v1, s[8:11], s13 offen offset:0 sc1 lds
    v_mfma_f32_16x16x32_bf16 v[108:111], a[28:31], a[192:195], v[108:111]
    s_and_b32 s18, s18, 0xffff
    v_exp_f32 v100, v100
    v_mfma_f32_16x16x32_bf16 v[112:115], a[0:3], a[64:67], v[140:143]
    s_add_u32 s62, s12, 16384
    v_exp_f32 v101, v101
    v_mfma_f32_16x16x32_bf16 v[112:115], a[4:7], a[244:247], v[112:115]
    s_add_u32 s12, s12, 32768
    ds_read_b128 a[40:43], v3 offset:10240
    v_cvt_pk_bf16_f32 v126, v100, v101
    v_mfma_f32_16x16x32_bf16 v[112:115], a[8:11], a[248:251], v[112:115]
    s_add_u32 s14, s14, 1
    v_exp_f32 v102, v102
    v_mfma_f32_16x16x32_bf16 v[112:115], a[12:15], a[252:255], v[112:115]
    s_cmp_eq_u32 s14, s15
    v_exp_f32 v103, v103
    v_mfma_f32_16x16x32_bf16 v[116:119], a[16:19], a[64:67], v[140:143]
    s_cselect_b32 s12, s16, s12
    ds_read_b128 a[44:47], v3 offset:11264
    v_cvt_pk_bf16_f32 v127, v102, v103
    v_mfma_f32_16x16x32_bf16 v[116:119], a[20:23], a[244:247], v[116:119]
    ds_read_b128 a[48:51], v3 offset:12288
    ds_read_b128 a[52:55], v3 offset:13312
    v_mfma_f32_16x16x32_bf16 v[116:119], a[24:27], a[248:251], v[116:119]
    ds_read_b128 a[56:59], v3 offset:14336
    ds_read_b128 a[60:63], v3 offset:15360
    v_mfma_f32_16x16x32_bf16 v[116:119], a[28:31], a[252:255], v[116:119]
    s_waitcnt lgkmcnt(4)
    buffer_load_dwordx4 v1, s[8:11], s13 offen offset:1024 sc1 lds
    v_mfma_f32_16x16x32_bf16 v[240:243], a[240:243], v[120:123], v[240:243]
    ds_read_b128 a[0:3], v2 offset:24576
    ds_read_b128 a[4:7], v2 offset:25600
    v_mfma_f32_16x16x32_bf16 v[176:179], a[32:35], v[120:123], v[176:179]
    v_exp_f32 v104, v104
    v_mfma_f32_16x16x32_bf16 v[180:183], a[32:35], v[124:127], v[180:183]
    ds_read_b128 a[8:11], v2 offset:26624
    ds_read_b128 a[12:15], v2 offset:27648
    buffer_load_dwordx4 a[120:123], v1, s[8:11], s77 offen offset:1024 sc1
    v_mfma_f32_16x16x32_bf16 v[188:191], a[36:39], v[124:127], v[188:191]
    v_exp_f32 v105, v105
    v_mfma_f32_16x16x32_bf16 v[184:187], a[36:39], v[120:123], v[184:187]
    ds_read_b128 a[16:19], v2 offset:28672
    v_cvt_pk_bf16_f32 v128, v104, v105
    v_mfma_f32_16x16x32_bf16 v[192:195], a[40:43], v[120:123], v[192:195]
    s_add_u32 s77, s35, 2048
    buffer_load_dwordx4 a[124:127], v1, s[8:11], s77 offen offset:0 sc1
    v_exp_f32 v106, v106
    v_mfma_f32_16x16x32_bf16 v[196:199], a[40:43], v[124:127], v[196:199]
    v_exp_f32 v107, v107
    v_mfma_f32_16x16x32_bf16 v[204:207], a[44:47], v[124:127], v[204:207]
    s_waitcnt lgkmcnt(5)
    ds_read_b128 a[20:23], v2 offset:29696
    v_cvt_pk_bf16_f32 v129, v106, v107
    v_mfma_f32_16x16x32_bf16 v[200:203], a[44:47], v[120:123], v[200:203]
    buffer_load_dwordx4 a[128:131], v1, s[8:11], s77 offen offset:1024 sc1
    v_exp_f32 v108, v108
    v_mfma_f32_16x16x32_bf16 v[208:211], a[48:51], v[120:123], v[208:211]
    ds_read_b128 a[24:27], v2 offset:30720
    ds_read_b128 a[28:31], v2 offset:31744
    v_mfma_f32_16x16x32_bf16 v[212:215], a[48:51], v[124:127], v[212:215]
    v_exp_f32 v109, v109
    v_mfma_f32_16x16x32_bf16 v[220:223], a[52:55], v[124:127], v[220:223]
    buffer_load_dwordx4 v1, s[8:11], s13 offen offset:2048 sc1 lds
    v_mfma_f32_16x16x32_bf16 v[216:219], a[52:55], v[120:123], v[216:219]
    v_exp_f32 v110, v110
    v_mfma_f32_16x16x32_bf16 v[224:227], a[56:59], v[120:123], v[224:227]
    v_cvt_pk_bf16_f32 v130, v108, v109
    v_xor_b32 v2, 0x8000, v2
    v_mfma_f32_16x16x32_bf16 v[228:231], a[56:59], v[124:127], v[228:231]
    v_exp_f32 v111, v111
    v_mfma_f32_16x16x32_bf16 v[236:239], a[60:63], v[124:127], v[236:239]
    buffer_load_dwordx4 v1, s[8:11], s13 offen offset:3072 sc1 lds
    v_mfma_f32_16x16x32_bf16 v[232:235], a[60:63], v[120:123], v[232:235]
    s_mov_b32 s13, s62
    v_cvt_pk_bf16_f32 v131, v110, v111
    v_mfma_f32_16x16x32_bf16 v[244:247], a[240:243], v[124:127], v[244:247]
    s_waitcnt vmcnt(27) lgkmcnt(0)
    s_barrier
    v_mfma_f32_16x16x32_bf16 v[88:91], a[0:3], a[180:183], v[136:139]
    v_exp_f32 v112, v112
    v_mfma_f32_16x16x32_bf16 v[88:91], a[4:7], a[184:187], v[88:91]
    s_add_u32 m0, s30, 40960
    v_exp_f32 v113, v113
    v_mfma_f32_16x16x32_bf16 v[88:91], a[8:11], a[188:191], v[88:91]
    s_add_u32 s76, s70, 81920
    ds_read_b128 a[32:35], v3 offset:16384
    buffer_load_dwordx4 v1, s[24:27], s76 offen offset:0 sc1 lds
    v_cvt_pk_bf16_f32 v132, v112, v113
    v_mfma_f32_16x16x32_bf16 v[88:91], a[12:15], a[192:195], v[88:91]
    v_exp_f32 v114, v114
    v_mfma_f32_16x16x32_bf16 v[92:95], a[16:19], a[180:183], v[136:139]
    v_exp_f32 v115, v115
    v_mfma_f32_16x16x32_bf16 v[92:95], a[20:23], a[184:187], v[92:95]
    ds_read_b128 a[36:39], v3 offset:17408
    v_cvt_pk_bf16_f32 v133, v114, v115
    v_mfma_f32_16x16x32_bf16 v[92:95], a[24:27], a[188:191], v[92:95]
    s_add_u32 s76, s71, 80896
    buffer_load_dwordx4 v1, s[24:27], s76 offen offset:1024 sc1 lds
    v_mfma_f32_16x16x32_bf16 v[92:95], a[28:31], a[192:195], v[92:95]
    v_exp_f32 v116, v116
    v_mfma_f32_16x16x32_bf16 v[96:99], a[0:3], a[64:67], v[140:143]
    v_exp_f32 v117, v117
    v_mfma_f32_16x16x32_bf16 v[96:99], a[4:7], a[244:247], v[96:99]
    ds_read_b128 a[40:43], v3 offset:18432
    v_cvt_pk_bf16_f32 v134, v116, v117
    v_mfma_f32_16x16x32_bf16 v[96:99], a[8:11], a[248:251], v[96:99]
    s_add_u32 s76, s72, 79872
    buffer_load_dwordx4 v1, s[24:27], s76 offen offset:2048 sc1 lds
    v_exp_f32 v118, v118
    v_mfma_f32_16x16x32_bf16 v[96:99], a[12:15], a[252:255], v[96:99]
    v_exp_f32 v119, v119
    v_mfma_f32_16x16x32_bf16 v[100:103], a[16:19], a[64:67], v[140:143]
    ds_read_b128 a[44:47], v3 offset:19456
    v_cvt_pk_bf16_f32 v135, v118, v119
    v_mfma_f32_16x16x32_bf16 v[100:103], a[20:23], a[244:247], v[100:103]
    ds_read_b128 a[48:51], v3 offset:20480
    ds_read_b128 a[52:55], v3 offset:21504
    v_mfma_f32_16x16x32_bf16 v[100:103], a[24:27], a[248:251], v[100:103]
    ds_read_b128 a[56:59], v3 offset:22528
    ds_read_b128 a[60:63], v3 offset:23552
    v_mfma_f32_16x16x32_bf16 v[100:103], a[28:31], a[252:255], v[100:103]
    s_waitcnt lgkmcnt(4)
    s_add_u32 s76, s73, 78848
    buffer_load_dwordx4 v1, s[24:27], s76 offen offset:3072 sc1 lds
    v_mfma_f32_16x16x32_bf16 v[240:243], a[240:243], v[128:131], v[240:243]
    ds_read_b128 a[0:3], v2 offset:0
    ds_read_b128 a[4:7], v2 offset:1024
    v_mfma_f32_16x16x32_bf16 v[176:179], a[32:35], v[128:131], v[176:179]
    v_exp_f32 v88, v88
    v_mfma_f32_16x16x32_bf16 v[180:183], a[32:35], v[132:135], v[180:183]
    s_add_u32 m0, s30, 45056
    ds_read_b128 a[8:11], v2 offset:2048
    ds_read_b128 a[12:15], v2 offset:3072
    v_mfma_f32_16x16x32_bf16 v[188:191], a[36:39], v[132:135], v[188:191]
    s_add_u32 s76, s74, 81920
    buffer_load_dwordx4 v1, s[24:27], s76 offen offset:0 sc1 lds
    v_exp_f32 v89, v89
    v_mfma_f32_16x16x32_bf16 v[184:187], a[36:39], v[128:131], v[184:187]
    ds_read_b128 a[16:19], v2 offset:4096
    v_cvt_pk_bf16_f32 v120, v88, v89
    v_mfma_f32_16x16x32_bf16 v[192:195], a[40:43], v[128:131], v[192:195]
    v_exp_f32 v90, v90
    v_mfma_f32_16x16x32_bf16 v[196:199], a[40:43], v[132:135], v[196:199]
    v_exp_f32 v91, v91
    v_mfma_f32_16x16x32_bf16 v[204:207], a[44:47], v[132:135], v[204:207]
    s_waitcnt lgkmcnt(5)
    s_add_u32 s77, s34, 4096
    ds_read_b128 a[20:23], v2 offset:5120
    buffer_load_dwordx4 a[132:135], v1, s[8:11], s77 offen offset:0 sc1
    v_cvt_pk_bf16_f32 v121, v90, v91
    v_mfma_f32_16x16x32_bf16 v[200:203], a[44:47], v[128:131], v[200:203]
    v_exp_f32 v92, v92
    v_mfma_f32_16x16x32_bf16 v[208:211], a[48:51], v[128:131], v[208:211]
    ds_read_b128 a[24:27], v2 offset:6144
    ds_read_b128 a[28:31], v2 offset:7168
    v_mfma_f32_16x16x32_bf16 v[212:215], a[48:51], v[132:135], v[212:215]
    v_exp_f32 v93, v93
    v_mfma_f32_16x16x32_bf16 v[220:223], a[52:55], v[132:135], v[220:223]
    buffer_load_dwordx4 a[136:139], v1, s[8:11], s77 offen offset:1024 sc1
    v_mfma_f32_16x16x32_bf16 v[216:219], a[52:55], v[128:131], v[216:219]
    v_exp_f32 v94, v94
    v_mfma_f32_16x16x32_bf16 v[224:227], a[56:59], v[128:131], v[224:227]
    v_cvt_pk_bf16_f32 v122, v92, v93
    v_mfma_f32_16x16x32_bf16 v[228:231], a[56:59], v[132:135], v[228:231]
    v_exp_f32 v95, v95
    v_mfma_f32_16x16x32_bf16 v[236:239], a[60:63], v[132:135], v[236:239]
    s_add_u32 s77, s35, 4096
    buffer_load_dwordx4 a[140:143], v1, s[8:11], s77 offen offset:0 sc1
    v_mfma_f32_16x16x32_bf16 v[232:235], a[60:63], v[128:131], v[232:235]
    v_cvt_pk_bf16_f32 v123, v94, v95
    v_mfma_f32_16x16x32_bf16 v[244:247], a[240:243], v[132:135], v[244:247]
    s_waitcnt lgkmcnt(4)
    buffer_load_dwordx4 a[144:147], v1, s[8:11], s77 offen offset:1024 sc1
    v_mfma_f32_16x16x32_bf16 v[104:107], a[0:3], a[180:183], v[144:147]
    v_exp_f32 v96, v96
    v_mfma_f32_16x16x32_bf16 v[104:107], a[4:7], a[184:187], v[104:107]
    v_exp_f32 v97, v97
    v_mfma_f32_16x16x32_bf16 v[104:107], a[8:11], a[188:191], v[104:107]
    s_add_u32 s77, s34, 6144
    ds_read_b128 a[32:35], v3 offset:24576
    buffer_load_dwordx4 a[148:151], v1, s[8:11], s77 offen offset:0 sc1
    v_cvt_pk_bf16_f32 v124, v96, v97
    v_mfma_f32_16x16x32_bf16 v[104:107], a[12:15], a[192:195], v[104:107]
    s_waitcnt lgkmcnt(1)
    v_exp_f32 v98, v98
    v_mfma_f32_16x16x32_bf16 v[108:111], a[16:19], a[180:183], v[148:151]
    v_exp_f32 v99, v99
    v_mfma_f32_16x16x32_bf16 v[108:111], a[20:23], a[184:187], v[108:111]
    s_lshl_b32 s63, s20, 3
    ds_read_b128 a[36:39], v3 offset:25600
    v_cvt_pk_bf16_f32 v125, v98, v99
    v_mfma_f32_16x16x32_bf16 v[108:111], a[24:27], a[188:191], v[108:111]
    s_add_u32 s22, s63, s3
    buffer_load_dwordx4 a[152:155], v1, s[8:11], s77 offen offset:1024 sc1
    v_mfma_f32_16x16x32_bf16 v[108:111], a[28:31], a[192:195], v[108:111]
    s_sub_u32 s23, s63, s3
    v_exp_f32 v100, v100
    v_mfma_f32_16x16x32_bf16 v[112:115], a[0:3], a[64:67], v[140:143]
    s_add_u32 s23, s23, 7
    v_exp_f32 v101, v101
    v_mfma_f32_16x16x32_bf16 v[112:115], a[4:7], a[244:247], v[112:115]
    s_lshl_b32 s63, s7, 12
    ds_read_b128 a[40:43], v3 offset:26624
    v_cvt_pk_bf16_f32 v126, v100, v101
    v_mfma_f32_16x16x32_bf16 v[112:115], a[8:11], a[248:251], v[112:115]
    s_add_u32 s77, s35, 6144
    buffer_load_dwordx4 a[156:159], v1, s[8:11], s77 offen offset:0 sc1
    v_exp_f32 v102, v102
    v_mfma_f32_16x16x32_bf16 v[112:115], a[12:15], a[252:255], v[112:115]
    s_add_u32 s63, s63, 33554432
    v_exp_f32 v103, v103
    v_mfma_f32_16x16x32_bf16 v[116:119], a[16:19], a[64:67], v[140:143]
    s_lshl_b32 s22, s22, 17
    ds_read_b128 a[44:47], v3 offset:27648
    v_cvt_pk_bf16_f32 v127, v102, v103
    v_mfma_f32_16x16x32_bf16 v[116:119], a[20:23], a[244:247], v[116:119]
    s_add_u32 s22, s22, s63
    ds_read_b128 a[48:51], v3 offset:28672
    ds_read_b128 a[52:55], v3 offset:29696
    v_mfma_f32_16x16x32_bf16 v[116:119], a[24:27], a[248:251], v[116:119]
    s_lshl_b32 s23, s23, 17
    ds_read_b128 a[56:59], v3 offset:30720
    ds_read_b128 a[60:63], v3 offset:31744
    v_mfma_f32_16x16x32_bf16 v[116:119], a[28:31], a[252:255], v[116:119]
    s_waitcnt lgkmcnt(4)
    buffer_load_dwordx4 a[160:163], v1, s[8:11], s77 offen offset:1024 sc1
    v_mfma_f32_16x16x32_bf16 v[240:243], a[240:243], v[120:123], v[240:243]
    s_add_u32 s23, s23, s63
    ds_read_b128 a[0:3], v2 offset:8192
    ds_read_b128 a[4:7], v2 offset:9216
    v_mfma_f32_16x16x32_bf16 v[176:179], a[32:35], v[120:123], v[176:179]
    s_mov_b32 s66, 0
    v_exp_f32 v104, v104
    v_mfma_f32_16x16x32_bf16 v[180:183], a[32:35], v[124:127], v[180:183]
    ds_read_b128 a[8:11], v2 offset:10240
    ds_read_b128 a[12:15], v2 offset:11264
    v_mfma_f32_16x16x32_bf16 v[188:191], a[36:39], v[124:127], v[188:191]
    s_add_u32 s77, s34, 8192
    buffer_load_dwordx4 a[164:167], v1, s[8:11], s77 offen offset:0 sc1
    v_exp_f32 v105, v105
    v_mfma_f32_16x16x32_bf16 v[184:187], a[36:39], v[120:123], v[184:187]
    ds_read_b128 a[16:19], v2 offset:12288
    v_cvt_pk_bf16_f32 v128, v104, v105
    v_mfma_f32_16x16x32_bf16 v[192:195], a[40:43], v[120:123], v[192:195]
    v_exp_f32 v106, v106
    v_mfma_f32_16x16x32_bf16 v[196:199], a[40:43], v[124:127], v[196:199]
    v_exp_f32 v107, v107
    v_mfma_f32_16x16x32_bf16 v[204:207], a[44:47], v[124:127], v[204:207]
    s_waitcnt lgkmcnt(5)
    ds_read_b128 a[20:23], v2 offset:13312
    buffer_load_dwordx4 a[168:171], v1, s[8:11], s77 offen offset:1024 sc1
    v_cvt_pk_bf16_f32 v129, v106, v107
    v_mfma_f32_16x16x32_bf16 v[200:203], a[44:47], v[120:123], v[200:203]
    v_exp_f32 v108, v108
    v_mfma_f32_16x16x32_bf16 v[208:211], a[48:51], v[120:123], v[208:211]
    ds_read_b128 a[24:27], v2 offset:14336
    ds_read_b128 a[28:31], v2 offset:15360
    v_mfma_f32_16x16x32_bf16 v[212:215], a[48:51], v[124:127], v[212:215]
    v_exp_f32 v109, v109
    v_mfma_f32_16x16x32_bf16 v[220:223], a[52:55], v[124:127], v[220:223]
    s_add_u32 s77, s35, 8192
    buffer_load_dwordx4 a[172:175], v1, s[8:11], s77 offen offset:0 sc1
    v_mfma_f32_16x16x32_bf16 v[216:219], a[52:55], v[120:123], v[216:219]
    v_exp_f32 v110, v110
    v_mfma_f32_16x16x32_bf16 v[224:227], a[56:59], v[120:123], v[224:227]
    v_cvt_pk_bf16_f32 v130, v108, v109
    v_xor_b32 v3, 0x8000, v3
    v_mfma_f32_16x16x32_bf16 v[228:231], a[56:59], v[124:127], v[228:231]
    v_exp_f32 v111, v111
    v_mfma_f32_16x16x32_bf16 v[236:239], a[60:63], v[124:127], v[236:239]
    buffer_load_dwordx4 a[176:179], v1, s[8:11], s77 offen offset:1024 sc1
    v_mfma_f32_16x16x32_bf16 v[232:235], a[60:63], v[120:123], v[232:235]
    buffer_store_dword v252, off, s[8:11], s91 sc1
    v_cvt_pk_bf16_f32 v131, v110, v111
    v_mfma_f32_16x16x32_bf16 v[244:247], a[240:243], v[124:127], v[244:247]
    s_waitcnt vmcnt(35) lgkmcnt(0)
    s_barrier
    v_mfma_f32_16x16x32_bf16 v[88:91], a[0:3], a[180:183], v[152:155]
    v_exp_f32 v112, v112
    v_mfma_f32_16x16x32_bf16 v[88:91], a[4:7], a[184:187], v[88:91]
    s_add_u32 m0, s30, 102400
    v_exp_f32 v113, v113
    v_mfma_f32_16x16x32_bf16 v[88:91], a[8:11], a[188:191], v[88:91]
    s_add_u32 s76, s70, 163840
    ds_read_b128 a[32:35], v3 offset:0
    buffer_load_dwordx4 v1, s[24:27], s76 offen offset:0 sc1 lds
    v_cvt_pk_bf16_f32 v132, v112, v113
    v_mfma_f32_16x16x32_bf16 v[88:91], a[12:15], a[192:195], v[88:91]
    v_exp_f32 v114, v114
    v_mfma_f32_16x16x32_bf16 v[92:95], a[16:19], a[180:183], v[156:159]
    v_exp_f32 v115, v115
    v_mfma_f32_16x16x32_bf16 v[92:95], a[20:23], a[184:187], v[92:95]
    ds_read_b128 a[36:39], v3 offset:1024
    v_cvt_pk_bf16_f32 v133, v114, v115
    v_mfma_f32_16x16x32_bf16 v[92:95], a[24:27], a[188:191], v[92:95]
    s_add_u32 s76, s71, 162816
    buffer_load_dwordx4 v1, s[24:27], s76 offen offset:1024 sc1 lds
    v_mfma_f32_16x16x32_bf16 v[92:95], a[28:31], a[192:195], v[92:95]
    v_exp_f32 v116, v116
    v_mfma_f32_16x16x32_bf16 v[96:99], a[0:3], a[64:67], v[140:143]
    v_exp_f32 v117, v117
    v_mfma_f32_16x16x32_bf16 v[96:99], a[4:7], a[244:247], v[96:99]
    ds_read_b128 a[40:43], v3 offset:2048
    v_cvt_pk_bf16_f32 v134, v116, v117
    v_mfma_f32_16x16x32_bf16 v[96:99], a[8:11], a[248:251], v[96:99]
    s_add_u32 s76, s72, 161792
    buffer_load_dwordx4 v1, s[24:27], s76 offen offset:2048 sc1 lds
    v_exp_f32 v118, v118
    v_mfma_f32_16x16x32_bf16 v[96:99], a[12:15], a[252:255], v[96:99]
    v_exp_f32 v119, v119
    v_mfma_f32_16x16x32_bf16 v[100:103], a[16:19], a[64:67], v[140:143]
    ds_read_b128 a[44:47], v3 offset:3072
    v_cvt_pk_bf16_f32 v135, v118, v119
    v_mfma_f32_16x16x32_bf16 v[100:103], a[20:23], a[244:247], v[100:103]
    ds_read_b128 a[48:51], v3 offset:4096
    ds_read_b128 a[52:55], v3 offset:5120
    v_mfma_f32_16x16x32_bf16 v[100:103], a[24:27], a[248:251], v[100:103]
    ds_read_b128 a[56:59], v3 offset:6144
    ds_read_b128 a[60:63], v3 offset:7168
    v_mfma_f32_16x16x32_bf16 v[100:103], a[28:31], a[252:255], v[100:103]
    s_waitcnt lgkmcnt(4)
    s_add_u32 s76, s73, 160768
    buffer_load_dwordx4 v1, s[24:27], s76 offen offset:3072 sc1 lds
    v_mfma_f32_16x16x32_bf16 v[240:243], a[240:243], v[128:131], v[240:243]
    ds_read_b128 a[0:3], v2 offset:16384
    ds_read_b128 a[4:7], v2 offset:17408
    v_mfma_f32_16x16x32_bf16 v[176:179], a[32:35], v[128:131], v[176:179]
    v_exp_f32 v88, v88
    v_mfma_f32_16x16x32_bf16 v[180:183], a[32:35], v[132:135], v[180:183]
    s_add_u32 m0, s30, 106496
    ds_read_b128 a[8:11], v2 offset:18432
    ds_read_b128 a[12:15], v2 offset:19456
    v_mfma_f32_16x16x32_bf16 v[188:191], a[36:39], v[132:135], v[188:191]
    s_add_u32 s76, s74, 163840
    buffer_load_dwordx4 v1, s[24:27], s76 offen offset:0 sc1 lds
    v_exp_f32 v89, v89
    v_mfma_f32_16x16x32_bf16 v[184:187], a[36:39], v[128:131], v[184:187]
    ds_read_b128 a[16:19], v2 offset:20480
    v_cvt_pk_bf16_f32 v120, v88, v89
    v_mfma_f32_16x16x32_bf16 v[192:195], a[40:43], v[128:131], v[192:195]
    s_add_u32 m0, s30, 122880
    v_exp_f32 v90, v90
    v_mfma_f32_16x16x32_bf16 v[196:199], a[40:43], v[132:135], v[196:199]
    s_add_u32 s76, s70, 245760
    buffer_load_dwordx4 v1, s[24:27], s76 offen offset:0 sc1 lds
    v_exp_f32 v91, v91
    v_mfma_f32_16x16x32_bf16 v[204:207], a[44:47], v[132:135], v[204:207]
    s_waitcnt lgkmcnt(5)
    ds_read_b128 a[20:23], v2 offset:21504
    v_cvt_pk_bf16_f32 v121, v90, v91
    v_mfma_f32_16x16x32_bf16 v[200:203], a[44:47], v[128:131], v[200:203]
    v_exp_f32 v92, v92
    v_mfma_f32_16x16x32_bf16 v[208:211], a[48:51], v[128:131], v[208:211]
    s_add_u32 s76, s71, 244736
    ds_read_b128 a[24:27], v2 offset:22528
    ds_read_b128 a[28:31], v2 offset:23552
    buffer_load_dwordx4 v1, s[24:27], s76 offen offset:1024 sc1 lds
    v_mfma_f32_16x16x32_bf16 v[212:215], a[48:51], v[132:135], v[212:215]
    ds_read_b128 a[68:71], v2 offset:24576
    v_exp_f32 v93, v93
    v_mfma_f32_16x16x32_bf16 v[220:223], a[52:55], v[132:135], v[220:223]
    s_add_u32 s76, s72, 243712
    ds_read_b128 a[72:75], v2 offset:25600
    buffer_load_dwordx4 v1, s[24:27], s76 offen offset:2048 sc1 lds
    v_mfma_f32_16x16x32_bf16 v[216:219], a[52:55], v[128:131], v[216:219]
    ds_read_b128 a[76:79], v2 offset:26624
    v_exp_f32 v94, v94
    v_mfma_f32_16x16x32_bf16 v[224:227], a[56:59], v[128:131], v[224:227]
    ds_read_b128 a[80:83], v2 offset:27648
    v_cvt_pk_bf16_f32 v122, v92, v93
    v_mfma_f32_16x16x32_bf16 v[228:231], a[56:59], v[132:135], v[228:231]
    ds_read_b128 a[84:87], v2 offset:28672
    v_exp_f32 v95, v95
    v_mfma_f32_16x16x32_bf16 v[236:239], a[60:63], v[132:135], v[236:239]
    s_add_u32 s76, s73, 242688
    ds_read_b128 a[88:91], v2 offset:29696
    buffer_load_dwordx4 v1, s[24:27], s76 offen offset:3072 sc1 lds
    v_mfma_f32_16x16x32_bf16 v[232:235], a[60:63], v[128:131], v[232:235]
    ds_read_b128 a[92:95], v2 offset:30720
    v_cvt_pk_bf16_f32 v123, v94, v95
    v_mfma_f32_16x16x32_bf16 v[244:247], a[240:243], v[132:135], v[244:247]
    s_waitcnt lgkmcnt(11)
    ds_read_b128 a[96:99], v2 offset:31744
    v_mfma_f32_16x16x32_bf16 v[104:107], a[0:3], a[64:67], v[160:163]
    ds_read_b128 a[32:35], v3 offset:8192
    ds_read_b128 a[36:39], v3 offset:9216
    v_mfma_f32_16x16x32_bf16 v[104:107], a[4:7], a[244:247], v[104:107]
    v_exp_f32 v96, v96
    v_mfma_f32_16x16x32_bf16 v[104:107], a[8:11], a[248:251], v[104:107]
    s_add_u32 m0, s30, 126976
    ds_read_b128 a[40:43], v3 offset:10240
    ds_read_b128 a[44:47], v3 offset:11264
    v_mfma_f32_16x16x32_bf16 v[104:107], a[12:15], a[252:255], v[104:107]
    s_waitcnt lgkmcnt(12)
    s_add_u32 s76, s74, 245760
    buffer_load_dwordx4 v1, s[24:27], s76 offen offset:0 sc1 lds
    v_exp_f32 v97, v97
    v_mfma_f32_16x16x32_bf16 v[108:111], a[16:19], a[64:67], v[164:167]
    ds_read_b128 a[48:51], v3 offset:12288
    v_cvt_pk_bf16_f32 v124, v96, v97
    v_mfma_f32_16x16x32_bf16 v[108:111], a[20:23], a[244:247], v[108:111]
    v_exp_f32 v98, v98
    v_mfma_f32_16x16x32_bf16 v[108:111], a[24:27], a[248:251], v[108:111]
    buffer_load_dword v248, v250, s[8:11], s56 offen sc1
    v_mfma_f32_16x16x32_bf16 v[108:111], a[28:31], a[252:255], v[108:111]
    s_waitcnt lgkmcnt(5)
    v_exp_f32 v99, v99
    v_mfma_f32_16x16x32_bf16 v[112:115], a[68:71], a[64:67], v[168:171]
    ds_read_b128 a[52:55], v3 offset:13312
    v_cvt_pk_bf16_f32 v125, v98, v99
    v_mfma_f32_16x16x32_bf16 v[112:115], a[72:75], a[244:247], v[112:115]
    buffer_load_dword v249, v250, s[8:11], s57 offen sc1
    v_exp_f32 v100, v100
    v_mfma_f32_16x16x32_bf16 v[112:115], a[76:79], a[248:251], v[112:115]
    ds_read_b128 a[56:59], v3 offset:14336
    ds_read_b128 a[60:63], v3 offset:15360
    v_mfma_f32_16x16x32_bf16 v[112:115], a[80:83], a[252:255], v[112:115]
    v_exp_f32 v101, v101
    v_mfma_f32_16x16x32_bf16 v[116:119], a[84:87], a[64:67], v[172:175]
    v_exp_f32 v102, v102
    v_mfma_f32_16x16x32_bf16 v[116:119], a[88:91], a[244:247], v[116:119]
    v_exp_f32 v103, v103
    v_mfma_f32_16x16x32_bf16 v[116:119], a[92:95], a[248:251], v[116:119]
    v_cvt_pk_bf16_f32 v126, v100, v101
    v_cvt_pk_bf16_f32 v127, v102, v103
    v_mfma_f32_16x16x32_bf16 v[116:119], a[96:99], a[252:255], v[116:119]
    s_waitcnt vmcnt(30) lgkmcnt(0)
    s_barrier
    v_mfma_f32_16x16x32_bf16 v[240:243], a[240:243], v[120:123], v[240:243]
    ds_read_b128 a[68:71], v3 offset:16384
    ds_read_b128 a[72:75], v3 offset:17408
    v_mfma_f32_16x16x32_bf16 v[176:179], a[32:35], v[120:123], v[176:179]
    s_add_u32 m0, s30, 0
    v_exp_f32 v104, v104
    v_mfma_f32_16x16x32_bf16 v[180:183], a[32:35], v[124:127], v[180:183]
    s_add_u32 s76, s70, 327680
    ds_read_b128 a[76:79], v3 offset:18432
    ds_read_b128 a[80:83], v3 offset:19456
    buffer_load_dwordx4 v1, s[24:27], s76 offen offset:0 sc1 lds
    v_mfma_f32_16x16x32_bf16 v[188:191], a[36:39], v[124:127], v[188:191]
    v_exp_f32 v105, v105
    v_mfma_f32_16x16x32_bf16 v[184:187], a[36:39], v[120:123], v[184:187]
    ds_read_b128 a[84:87], v3 offset:20480
    v_cvt_pk_bf16_f32 v128, v104, v105
    v_mfma_f32_16x16x32_bf16 v[192:195], a[40:43], v[120:123], v[192:195]
    s_add_u32 s76, s71, 326656
    buffer_load_dwordx4 v1, s[24:27], s76 offen offset:1024 sc1 lds
    v_exp_f32 v106, v106
    v_mfma_f32_16x16x32_bf16 v[196:199], a[40:43], v[124:127], v[196:199]
    v_exp_f32 v107, v107
    v_mfma_f32_16x16x32_bf16 v[204:207], a[44:47], v[124:127], v[204:207]
    ds_read_b128 a[88:91], v3 offset:21504
    v_cvt_pk_bf16_f32 v129, v106, v107
    v_mfma_f32_16x16x32_bf16 v[200:203], a[44:47], v[120:123], v[200:203]
    s_add_u32 s76, s72, 325632
    buffer_load_dwordx4 v1, s[24:27], s76 offen offset:2048 sc1 lds
    v_exp_f32 v108, v108
    v_mfma_f32_16x16x32_bf16 v[208:211], a[48:51], v[120:123], v[208:211]
    ds_read_b128 a[92:95], v3 offset:22528
    ds_read_b128 a[96:99], v3 offset:23552
    v_mfma_f32_16x16x32_bf16 v[212:215], a[48:51], v[124:127], v[212:215]
    v_exp_f32 v109, v109
    v_mfma_f32_16x16x32_bf16 v[220:223], a[52:55], v[124:127], v[220:223]
    v_exp_f32 v112, v112
    v_mfma_f32_16x16x32_bf16 v[216:219], a[52:55], v[120:123], v[216:219]
    s_add_u32 s76, s73, 324608
    buffer_load_dwordx4 v1, s[24:27], s76 offen offset:3072 sc1 lds
    v_exp_f32 v110, v110
    v_mfma_f32_16x16x32_bf16 v[224:227], a[56:59], v[120:123], v[224:227]
    v_cvt_pk_bf16_f32 v130, v108, v109
    v_mfma_f32_16x16x32_bf16 v[228:231], a[56:59], v[124:127], v[228:231]
    s_add_u32 m0, s30, 4096
    v_exp_f32 v111, v111
    v_mfma_f32_16x16x32_bf16 v[236:239], a[60:63], v[124:127], v[236:239]
    s_add_u32 s76, s74, 327680
    buffer_load_dwordx4 v1, s[24:27], s76 offen offset:0 sc1 lds
    v_exp_f32 v113, v113
    v_mfma_f32_16x16x32_bf16 v[232:235], a[60:63], v[120:123], v[232:235]
    v_cvt_pk_bf16_f32 v131, v110, v111
    v_cvt_pk_bf16_f32 v132, v112, v113
    v_mfma_f32_16x16x32_bf16 v[244:247], a[240:243], v[124:127], v[244:247]
    s_waitcnt lgkmcnt(0)
    v_exp_f32 v114, v114
    v_mfma_f32_16x16x32_bf16 v[244:247], a[240:243], v[128:131], v[244:247]
    ds_read_b128 a[32:35], v3 offset:24576
    ds_read_b128 a[36:39], v3 offset:25600
    v_exp_f32 v115, v115
    v_mfma_f32_16x16x32_bf16 v[180:183], a[68:71], v[128:131], v[180:183]
    ds_read_b128 a[40:43], v3 offset:26624
    ds_read_b128 a[44:47], v3 offset:27648
    v_cvt_pk_bf16_f32 v133, v114, v115
    v_mfma_f32_16x16x32_bf16 v[188:191], a[72:75], v[128:131], v[188:191]
pad21:
    s_cbranch_execz pad25
    v_exp_f32 v116, v116
    v_mfma_f32_16x16x32_bf16 v[196:199], a[76:79], v[128:131], v[196:199]
    ds_read_b128 a[48:51], v3 offset:28672
    ds_read_b128 a[52:55], v3 offset:29696
    v_exp_f32 v117, v117
    v_mfma_f32_16x16x32_bf16 v[204:207], a[80:83], v[128:131], v[204:207]
    ds_read_b128 a[56:59], v3 offset:30720
    ds_read_b128 a[60:63], v3 offset:31744
    v_cvt_pk_bf16_f32 v134, v116, v117
    v_mfma_f32_16x16x32_bf16 v[212:215], a[84:87], v[128:131], v[212:215]
    v_exp_f32 v118, v118
    v_mfma_f32_16x16x32_bf16 v[220:223], a[88:91], v[128:131], v[220:223]
    v_exp_f32 v119, v119
    v_mfma_f32_16x16x32_bf16 v[228:231], a[92:95], v[128:131], v[228:231]
    s_add_u32 m0, s30, 20480
    v_cvt_pk_bf16_f32 v135, v118, v119
    v_mfma_f32_16x16x32_bf16 v[236:239], a[96:99], v[128:131], v[236:239]
    s_waitcnt lgkmcnt(4)
    s_add_u32 s76, s70, 409600
    buffer_load_dwordx4 v1, s[24:27], s76 offen offset:0 sc1 lds
    v_mfma_f32_16x16x32_bf16 v[180:183], a[32:35], v[132:135], v[180:183]
    v_mfma_f32_16x16x32_bf16 v[188:191], a[36:39], v[132:135], v[188:191]
    s_add_u32 s76, s71, 408576
    buffer_load_dwordx4 v1, s[24:27], s76 offen offset:1024 sc1 lds
    v_mfma_f32_16x16x32_bf16 v[196:199], a[40:43], v[132:135], v[196:199]
    v_mfma_f32_16x16x32_bf16 v[204:207], a[44:47], v[132:135], v[204:207]
    s_waitcnt lgkmcnt(0)
    s_add_u32 s76, s72, 407552
    buffer_load_dwordx4 v1, s[24:27], s76 offen offset:2048 sc1 lds
    v_mfma_f32_16x16x32_bf16 v[212:215], a[48:51], v[132:135], v[212:215]
    v_mfma_f32_16x16x32_bf16 v[220:223], a[52:55], v[132:135], v[220:223]
    s_add_u32 s76, s73, 406528
    buffer_load_dwordx4 v1, s[24:27], s76 offen offset:3072 sc1 lds
    v_mfma_f32_16x16x32_bf16 v[228:231], a[56:59], v[132:135], v[228:231]
    s_add_u32 m0, s30, 24576
    v_mfma_f32_16x16x32_bf16 v[236:239], a[60:63], v[132:135], v[236:239]
    s_add_u32 s76, s74, 409600
    buffer_load_dwordx4 v1, s[24:27], s76 offen offset:0 sc1 lds
    v_mfma_f32_16x16x32_bf16 v[244:247], a[240:243], v[132:135], v[244:247]
    s_waitcnt vmcnt(52)
    s_barrier
    ds_read_b128 a[196:199], v254 offset:20480
    ds_read_b128 a[200:203], v254 offset:30720
    ds_read_b128 a[204:207], v254 offset:21504
    ds_read_b128 a[208:211], v254 offset:31744
    ds_read_b128 a[212:215], v254 offset:22528
    ds_read_b128 a[216:219], v254 offset:32768
    ds_read_b128 a[220:223], v254 offset:23552
    ds_read_b128 a[224:227], v254 offset:33792
norm2:
    v_rcp_f32 v6, v240
    v_mov_b32 v10, 0
    v_mov_b32 v7, v6
    v_pk_mul_f32 v[176:177], v[176:177], v[6:7]
    v_pk_mul_f32 v[178:179], v[178:179], v[6:7]
    v_pk_mul_f32 v[184:185], v[184:185], v[6:7]
    v_pk_mul_f32 v[186:187], v[186:187], v[6:7]
    v_cvt_pk_bf16_f32 v176, v176, v177
    v_cvt_pk_bf16_f32 v177, v178, v179
    v_cvt_pk_bf16_f32 v178, v184, v185
    v_cvt_pk_bf16_f32 v179, v186, v187
    buffer_store_dwordx4 v[176:179], v1, s[8:11], s22 offen offset:0 sc1
    v_pk_maximum3_f16 v10, v10, v176, v177
    v_pk_maximum3_f16 v10, v10, v178, v179
    v_pk_mul_f32 v[192:193], v[192:193], v[6:7]
    v_pk_mul_f32 v[194:195], v[194:195], v[6:7]
    v_pk_mul_f32 v[200:201], v[200:201], v[6:7]
    v_pk_mul_f32 v[202:203], v[202:203], v[6:7]
    v_cvt_pk_bf16_f32 v192, v192, v193
    v_cvt_pk_bf16_f32 v193, v194, v195
    v_cvt_pk_bf16_f32 v194, v200, v201
    v_cvt_pk_bf16_f32 v195, v202, v203
    v_pk_maximum3_f16 v10, v10, v192, v193
    v_pk_maximum3_f16 v10, v10, v194, v195
    v_pk_mul_f32 v[208:209], v[208:209], v[6:7]
    v_pk_mul_f32 v[210:211], v[210:211], v[6:7]
    v_pk_mul_f32 v[216:217], v[216:217], v[6:7]
    v_pk_mul_f32 v[218:219], v[218:219], v[6:7]
    v_cvt_pk_bf16_f32 v208, v208, v209
    v_cvt_pk_bf16_f32 v209, v210, v211
    v_cvt_pk_bf16_f32 v210, v216, v217
    v_cvt_pk_bf16_f32 v211, v218, v219
    buffer_store_dwordx4 v[192:195], v1, s[8:11], s22 offen offset:1024 sc1
    v_pk_maximum3_f16 v10, v10, v208, v209
    v_pk_maximum3_f16 v10, v10, v210, v211
    v_rcp_f32 v8, v244
    v_min_f32 v12, v240, v244
    v_pk_mul_f32 v[224:225], v[224:225], v[6:7]
    v_pk_mul_f32 v[226:227], v[226:227], v[6:7]
    v_pk_mul_f32 v[232:233], v[232:233], v[6:7]
    v_pk_mul_f32 v[234:235], v[234:235], v[6:7]
    v_cvt_pk_bf16_f32 v224, v224, v225
    v_cvt_pk_bf16_f32 v225, v226, v227
    v_cvt_pk_bf16_f32 v226, v232, v233
    v_cvt_pk_bf16_f32 v227, v234, v235
    v_pk_maximum3_f16 v10, v10, v224, v225
    v_pk_maximum3_f16 v10, v10, v226, v227
    v_mov_b32 v9, v8
    v_maximum3_f32 v13, v240, v244, v244
    v_pk_mul_f32 v[180:181], v[180:181], v[8:9]
    v_pk_mul_f32 v[182:183], v[182:183], v[8:9]
    v_pk_mul_f32 v[188:189], v[188:189], v[8:9]
    v_pk_mul_f32 v[190:191], v[190:191], v[8:9]
    v_cvt_pk_bf16_f32 v180, v180, v181
    v_cvt_pk_bf16_f32 v181, v182, v183
    v_cvt_pk_bf16_f32 v182, v188, v189
    v_cvt_pk_bf16_f32 v183, v190, v191
    buffer_store_dwordx4 v[208:211], v1, s[8:11], s22 offen offset:2048 sc1
    v_pk_maximum3_f16 v10, v10, v180, v181
    v_pk_maximum3_f16 v10, v10, v182, v183
    v_cmp_gt_f32 vcc, 0x1f800000, v12
    v_pk_mul_f32 v[196:197], v[196:197], v[8:9]
    v_pk_mul_f32 v[198:199], v[198:199], v[8:9]
    v_pk_mul_f32 v[204:205], v[204:205], v[8:9]
    v_pk_mul_f32 v[206:207], v[206:207], v[8:9]
    v_cvt_pk_bf16_f32 v196, v196, v197
    v_cvt_pk_bf16_f32 v197, v198, v199
    v_cvt_pk_bf16_f32 v198, v204, v205
    v_cvt_pk_bf16_f32 v199, v206, v207
    v_pk_maximum3_f16 v10, v10, v196, v197
    v_pk_maximum3_f16 v10, v10, v198, v199
    s_mov_b64 s[62:63], vcc
    v_cmp_nge_f32 vcc, 0x4b800000, v13
    v_pk_mul_f32 v[212:213], v[212:213], v[8:9]
    v_pk_mul_f32 v[214:215], v[214:215], v[8:9]
    v_pk_mul_f32 v[220:221], v[220:221], v[8:9]
    v_pk_mul_f32 v[222:223], v[222:223], v[8:9]
    v_cvt_pk_bf16_f32 v212, v212, v213
    v_cvt_pk_bf16_f32 v213, v214, v215
    v_cvt_pk_bf16_f32 v214, v220, v221
    v_cvt_pk_bf16_f32 v215, v222, v223
    buffer_store_dwordx4 v[224:227], v1, s[8:11], s22 offen offset:3072 sc1
    v_pk_maximum3_f16 v10, v10, v212, v213
    v_pk_maximum3_f16 v10, v10, v214, v215
    s_or_b64 s[62:63], s[62:63], vcc
    v_pk_mul_f32 v[228:229], v[228:229], v[8:9]
    v_pk_mul_f32 v[230:231], v[230:231], v[8:9]
    v_pk_mul_f32 v[236:237], v[236:237], v[8:9]
    v_pk_mul_f32 v[238:239], v[238:239], v[8:9]
    v_cvt_pk_bf16_f32 v228, v228, v229
    v_cvt_pk_bf16_f32 v229, v230, v231
    v_cvt_pk_bf16_f32 v230, v236, v237
    v_cvt_pk_bf16_f32 v231, v238, v239
    v_pk_maximum3_f16 v10, v10, v228, v229
    v_pk_maximum3_f16 v10, v10, v230, v231
    v_lshrrev_b32 v11, 16, v10
    v_cmp_u_f16 vcc, v10, v11
    s_or_b64 s[62:63], s[62:63], vcc
    s_cbranch_scc1 redo2
done2:
L_fin0:
    s_waitcnt vmcnt(52) lgkmcnt(6)
    v_mfma_f32_16x16x32_bf16 v[88:91], a[196:199], a[100:103], 0
    ds_read_b128 a[228:231], v254 offset:24576
    ds_read_b128 a[232:235], v254 offset:34816
    v_mfma_f32_16x16x32_bf16 v[88:91], a[200:203], a[104:107], v[88:91]
    buffer_store_dwordx4 v[180:183], v1, s[8:11], s23 offen offset:0 sc1
    v_mfma_f32_16x16x32_bf16 v[92:95], a[200:203], a[112:115], 0
    v_mfma_f32_16x16x32_bf16 v[92:95], a[196:199], a[108:111], v[92:95]
    s_waitcnt lgkmcnt(6)
    v_mfma_f32_16x16x32_bf16 v[96:99], a[204:207], a[100:103], 0
    ds_read_b128 a[196:199], v254 offset:25600
    ds_read_b128 a[200:203], v254 offset:35840
    v_mfma_f32_16x16x32_bf16 v[96:99], a[208:211], a[104:107], v[96:99]
    buffer_store_dwordx4 v[196:199], v1, s[8:11], s23 offen offset:1024 sc1
    v_mfma_f32_16x16x32_bf16 v[100:103], a[208:211], a[112:115], 0
    v_mfma_f32_16x16x32_bf16 v[100:103], a[204:207], a[108:111], v[100:103]
    s_waitcnt lgkmcnt(6)
    v_mfma_f32_16x16x32_bf16 v[104:107], a[212:215], a[100:103], 0
    ds_read_b128 a[204:207], v254 offset:26624
    ds_read_b128 a[208:211], v254 offset:36864
    v_mfma_f32_16x16x32_bf16 v[104:107], a[216:219], a[104:107], v[104:107]
    buffer_store_dwordx4 v[212:215], v1, s[8:11], s23 offen offset:2048 sc1
    v_mfma_f32_16x16x32_bf16 v[108:111], a[216:219], a[112:115], 0
    v_mfma_f32_16x16x32_bf16 v[108:111], a[212:215], a[108:111], v[108:111]
    s_waitcnt lgkmcnt(6)
    v_mfma_f32_16x16x32_bf16 v[112:115], a[220:223], a[100:103], 0
    ds_read_b128 a[212:215], v254 offset:27648
    ds_read_b128 a[216:219], v254 offset:37888
    v_mfma_f32_16x16x32_bf16 v[112:115], a[224:227], a[104:107], v[112:115]
    buffer_store_dwordx4 v[228:231], v1, s[8:11], s23 offen offset:3072 sc1
    v_mfma_f32_16x16x32_bf16 v[116:119], a[224:227], a[112:115], 0
    v_mfma_f32_16x16x32_bf16 v[116:119], a[220:223], a[108:111], v[116:119]
    s_waitcnt lgkmcnt(6)
    v_mfma_f32_16x16x32_bf16 v[120:123], a[228:231], a[100:103], 0
    ds_read_b128 a[220:223], v254 offset:28672
    ds_read_b128 a[224:227], v254 offset:38912
    v_mfma_f32_16x16x32_bf16 v[120:123], a[232:235], a[104:107], v[120:123]
    v_mfma_f32_16x16x32_bf16 v[124:127], a[232:235], a[112:115], 0
    v_mfma_f32_16x16x32_bf16 v[124:127], a[228:231], a[108:111], v[124:127]
    s_waitcnt lgkmcnt(6)
    v_mfma_f32_16x16x32_bf16 v[128:131], a[196:199], a[100:103], 0
    ds_read_b128 a[228:231], v254 offset:29696
    ds_read_b128 a[232:235], v254 offset:39936
    v_mfma_f32_16x16x32_bf16 v[128:131], a[200:203], a[104:107], v[128:131]
    v_mfma_f32_16x16x32_bf16 v[132:135], a[200:203], a[112:115], 0
    v_mfma_f32_16x16x32_bf16 v[132:135], a[196:199], a[108:111], v[132:135]
    s_waitcnt vmcnt(25) lgkmcnt(6)
    s_barrier
    v_mfma_f32_16x16x32_bf16 v[136:139], a[204:207], a[100:103], 0
    ds_read_b128 a[196:199], v1 offset:40960
    ds_read_b128 a[200:203], v1 offset:51200
    v_mfma_f32_16x16x32_bf16 v[136:139], a[208:211], a[104:107], v[136:139]
    v_mfma_f32_16x16x32_bf16 v[140:143], a[208:211], a[112:115], 0
    v_mfma_f32_16x16x32_bf16 v[140:143], a[204:207], a[108:111], v[140:143]
    s_waitcnt lgkmcnt(6)
    v_mfma_f32_16x16x32_bf16 v[144:147], a[212:215], a[100:103], 0
    ds_read_b128 a[204:207], v1 offset:41984
    ds_read_b128 a[208:211], v1 offset:52224
    v_mfma_f32_16x16x32_bf16 v[144:147], a[216:219], a[104:107], v[144:147]
    v_mfma_f32_16x16x32_bf16 v[148:151], a[216:219], a[112:115], 0
    v_mfma_f32_16x16x32_bf16 v[148:151], a[212:215], a[108:111], v[148:151]
    s_waitcnt lgkmcnt(6)
    v_mfma_f32_16x16x32_bf16 v[152:155], a[220:223], a[100:103], 0
    ds_read_b128 a[212:215], v1 offset:43008
    ds_read_b128 a[216:219], v1 offset:53248
    v_mfma_f32_16x16x32_bf16 v[152:155], a[224:227], a[104:107], v[152:155]
    v_mfma_f32_16x16x32_bf16 v[156:159], a[224:227], a[112:115], 0
    v_mfma_f32_16x16x32_bf16 v[156:159], a[220:223], a[108:111], v[156:159]
    s_waitcnt lgkmcnt(6)
    v_mfma_f32_16x16x32_bf16 v[160:163], a[228:231], a[100:103], 0
    ds_read_b128 a[220:223], v1 offset:44032
    ds_read_b128 a[224:227], v1 offset:54272
    v_mfma_f32_16x16x32_bf16 v[160:163], a[232:235], a[104:107], v[160:163]
    v_mfma_f32_16x16x32_bf16 v[164:167], a[232:235], a[112:115], 0
    v_mfma_f32_16x16x32_bf16 v[164:167], a[228:231], a[108:111], v[164:167]
    s_waitcnt vmcnt(50) lgkmcnt(6)
    v_mfma_f32_16x16x32_bf16 v[88:91], a[196:199], a[116:119], v[88:91]
    ds_read_b128 a[228:231], v1 offset:45056
    ds_read_b128 a[232:235], v1 offset:55296
    v_mfma_f32_16x16x32_bf16 v[88:91], a[200:203], a[120:123], v[88:91]
    v_mfma_f32_16x16x32_bf16 v[92:95], a[200:203], a[128:131], v[92:95]
    v_mfma_f32_16x16x32_bf16 v[92:95], a[196:199], a[124:127], v[92:95]
    s_waitcnt lgkmcnt(6)
    v_mfma_f32_16x16x32_bf16 v[96:99], a[204:207], a[116:119], v[96:99]
    ds_read_b128 a[196:199], v1 offset:46080
    ds_read_b128 a[200:203], v1 offset:56320
    v_mfma_f32_16x16x32_bf16 v[96:99], a[208:211], a[120:123], v[96:99]
    v_mfma_f32_16x16x32_bf16 v[100:103], a[208:211], a[128:131], v[100:103]
    v_mfma_f32_16x16x32_bf16 v[100:103], a[204:207], a[124:127], v[100:103]
    s_waitcnt lgkmcnt(6)
    v_mfma_f32_16x16x32_bf16 v[104:107], a[212:215], a[116:119], v[104:107]
    ds_read_b128 a[204:207], v1 offset:47104
    ds_read_b128 a[208:211], v1 offset:57344
    v_mfma_f32_16x16x32_bf16 v[104:107], a[216:219], a[120:123], v[104:107]
    v_mfma_f32_16x16x32_bf16 v[108:111], a[216:219], a[128:131], v[108:111]
    v_mfma_f32_16x16x32_bf16 v[108:111], a[212:215], a[124:127], v[108:111]
    s_waitcnt lgkmcnt(6)
    v_mfma_f32_16x16x32_bf16 v[112:115], a[220:223], a[116:119], v[112:115]
    ds_read_b128 a[212:215], v1 offset:48128
    ds_read_b128 a[216:219], v1 offset:58368
    v_mfma_f32_16x16x32_bf16 v[112:115], a[224:227], a[120:123], v[112:115]
    v_mfma_f32_16x16x32_bf16 v[116:119], a[224:227], a[128:131], v[116:119]
    v_mfma_f32_16x16x32_bf16 v[116:119], a[220:223], a[124:127], v[116:119]
    s_waitcnt lgkmcnt(6)
    v_mfma_f32_16x16x32_bf16 v[120:123], a[228:231], a[116:119], v[120:123]
    ds_read_b128 a[220:223], v1 offset:49152
    ds_read_b128 a[224:227], v1 offset:59392
    v_mfma_f32_16x16x32_bf16 v[120:123], a[232:235], a[120:123], v[120:123]
    v_mfma_f32_16x16x32_bf16 v[124:127], a[232:235], a[128:131], v[124:127]
    v_mfma_f32_16x16x32_bf16 v[124:127], a[228:231], a[124:127], v[124:127]
    s_waitcnt lgkmcnt(6)
    v_mfma_f32_16x16x32_bf16 v[128:131], a[196:199], a[116:119], v[128:131]
    s_mul_i32 s78, s28, 10240
    ds_read_b128 a[228:231], v1 offset:50176
    ds_read_b128 a[232:235], v1 offset:60416
    v_mfma_f32_16x16x32_bf16 v[128:131], a[200:203], a[120:123], v[128:131]
    s_add_u32 s78, s78, s33
    v_lshrrev_b32 v10, 4, v0
    v_lshlrev_b32 v7, 4, v10
    v_mfma_f32_16x16x32_bf16 v[132:135], a[200:203], a[128:131], v[132:135]
    s_add_u32 s12, s78, 8192
    v_mul_u32_u24 v3, 320, v250
    v_add_u32 v3, v3, v7
    v_mfma_f32_16x16x32_bf16 v[132:135], a[196:199], a[124:127], v[132:135]
    s_waitcnt lgkmcnt(6)
    v_and_b32 v10, 3, v0
    v_max_u32 v10, 1, v10
    v_mfma_f32_16x16x32_bf16 v[136:139], a[204:207], a[116:119], v[136:139]
    s_lshl_b32 s19, s28, 11
    ds_read_b128 a[196:199], v253 offset:40960
    ds_read_b128 a[200:203], v253 offset:51200
    v_mfma_f32_16x16x32_bf16 v[136:139], a[208:211], a[120:123], v[136:139]
    s_add_u32 s19, s19, s33
    v_add_lshl_u32 v10, v10, s28, 2
    v_and_b32 v6, 12, v10
    v_mfma_f32_16x16x32_bf16 v[140:143], a[208:211], a[128:131], v[140:143]
    s_add_u32 s79, s28, 1
    v_and_b32 v10, 7, v0
    v_bfe_u32 v11, v0, 3, 2
    v_mfma_f32_16x16x32_bf16 v[140:143], a[204:207], a[124:127], v[140:143]
    s_waitcnt lgkmcnt(6)
    v_lshlrev_b32 v5, 4, v10
    v_lshl_add_u32 v5, v11, 8, v5
    v_mfma_f32_16x16x32_bf16 v[144:147], a[212:215], a[116:119], v[144:147]
    s_and_b32 s79, s79, 3
    ds_read_b128 a[204:207], v253 offset:41984
    ds_read_b128 a[208:211], v253 offset:52224
    v_mfma_f32_16x16x32_bf16 v[144:147], a[216:219], a[120:123], v[144:147]
    s_mul_i32 s16, s79, 10240
    v_mul_u32_u24 v4, 1280, v10
    v_lshl_add_u32 v4, v11, 4, v4
    v_mfma_f32_16x16x32_bf16 v[148:151], a[216:219], a[128:131], v[148:151]
    s_waitcnt vmcnt(0)
    buffer_store_dword v252, off, s[8:11], s92 sc1
    v_mfma_f32_16x16x32_bf16 v[148:151], a[212:215], a[124:127], v[148:151]
    s_waitcnt lgkmcnt(6)
    v_lshrrev_b32 v10, 5, v0
    v_lshl_add_u32 v4, v10, 29, v4
    v_mfma_f32_16x16x32_bf16 v[152:155], a[220:223], a[116:119], v[152:155]
    s_add_u32 m0, s30, 61440
    ds_read_b128 a[212:215], v253 offset:43008
    ds_read_b128 a[216:219], v253 offset:53248
    v_mfma_f32_16x16x32_bf16 v[152:155], a[224:227], a[120:123], v[152:155]
    s_add_u32 s76, s70, 491520
    buffer_load_dwordx4 v1, s[24:27], s76 offen offset:0 sc1 lds
    v_mfma_f32_16x16x32_bf16 v[156:159], a[224:227], a[128:131], v[156:159]
    s_add_u32 s16, s16, s19
    v_mfma_f32_16x16x32_bf16 v[156:159], a[220:223], a[124:127], v[156:159]
    s_waitcnt lgkmcnt(6)
    v_mfma_f32_16x16x32_bf16 v[160:163], a[228:231], a[116:119], v[160:163]
    s_lshl_b32 s79, s79, 11
    ds_read_b128 a[220:223], v253 offset:44032
    ds_read_b128 a[224:227], v253 offset:54272
    v_mfma_f32_16x16x32_bf16 v[160:163], a[232:235], a[120:123], v[160:163]
    s_add_u32 s76, s71, 490496
    buffer_load_dwordx4 v1, s[24:27], s76 offen offset:1024 sc1 lds
    v_mfma_f32_16x16x32_bf16 v[164:167], a[232:235], a[128:131], v[164:167]
    s_add_u32 s13, s79, s78
    v_mfma_f32_16x16x32_bf16 v[164:167], a[228:231], a[124:127], v[164:167]
    s_waitcnt vmcnt(42) lgkmcnt(6)
    v_mfma_f32_16x16x32_bf16 v[88:91], a[196:199], a[132:135], v[88:91]
    s_add_u32 s79, s28, 2
    ds_read_b128 a[228:231], v253 offset:45056
    ds_read_b128 a[232:235], v253 offset:55296
    v_mfma_f32_16x16x32_bf16 v[88:91], a[200:203], a[136:139], v[88:91]
    s_add_u32 s76, s72, 489472
    buffer_load_dwordx4 v1, s[24:27], s76 offen offset:2048 sc1 lds
    v_mfma_f32_16x16x32_bf16 v[92:95], a[200:203], a[144:147], v[92:95]
    s_and_b32 s79, s79, 3
    v_mfma_f32_16x16x32_bf16 v[92:95], a[196:199], a[140:143], v[92:95]
    s_waitcnt lgkmcnt(6)
    v_mfma_f32_16x16x32_bf16 v[96:99], a[204:207], a[132:135], v[96:99]
    s_mul_i32 s17, s79, 10240
    ds_read_b128 a[196:199], v253 offset:46080
    ds_read_b128 a[200:203], v253 offset:56320
    v_mfma_f32_16x16x32_bf16 v[96:99], a[208:211], a[136:139], v[96:99]
    s_add_u32 s76, s73, 488448
    buffer_load_dwordx4 v1, s[24:27], s76 offen offset:3072 sc1 lds
    v_mfma_f32_16x16x32_bf16 v[100:103], a[208:211], a[144:147], v[100:103]
    s_add_u32 s17, s17, s19
    v_mfma_f32_16x16x32_bf16 v[100:103], a[204:207], a[140:143], v[100:103]
    s_waitcnt lgkmcnt(6)
    v_mfma_f32_16x16x32_bf16 v[104:107], a[212:215], a[132:135], v[104:107]
    s_add_u32 m0, s30, 65536
    ds_read_b128 a[204:207], v253 offset:47104
    ds_read_b128 a[208:211], v253 offset:57344
    v_mfma_f32_16x16x32_bf16 v[104:107], a[216:219], a[136:139], v[104:107]
    s_add_u32 s76, s74, 491520
    buffer_load_dwordx4 v1, s[24:27], s76 offen offset:0 sc1 lds
    v_mfma_f32_16x16x32_bf16 v[108:111], a[216:219], a[144:147], v[108:111]
    s_lshl_b32 s79, s79, 11
    v_mfma_f32_16x16x32_bf16 v[108:111], a[212:215], a[140:143], v[108:111]
    s_waitcnt lgkmcnt(6)
    v_mfma_f32_16x16x32_bf16 v[112:115], a[220:223], a[132:135], v[112:115]
    s_add_u32 s14, s79, s78
    ds_read_b128 a[212:215], v253 offset:48128
    ds_read_b128 a[216:219], v253 offset:58368
    v_mfma_f32_16x16x32_bf16 v[112:115], a[224:227], a[136:139], v[112:115]
    s_add_u32 s77, s34, 10240
    buffer_load_dwordx4 a[180:183], v1, s[8:11], s77 offen offset:0 sc1
    v_mfma_f32_16x16x32_bf16 v[116:119], a[224:227], a[144:147], v[116:119]
    s_add_u32 s79, s28, 3
    v_mfma_f32_16x16x32_bf16 v[116:119], a[220:223], a[140:143], v[116:119]
    s_waitcnt lgkmcnt(6)
    v_mfma_f32_16x16x32_bf16 v[120:123], a[228:231], a[132:135], v[120:123]
    s_and_b32 s79, s79, 3
    ds_read_b128 a[220:223], v253 offset:49152
    ds_read_b128 a[224:227], v253 offset:59392
    v_mfma_f32_16x16x32_bf16 v[120:123], a[232:235], a[136:139], v[120:123]
    s_mul_i32 s18, s79, 10240
    buffer_load_dwordx4 a[184:187], v1, s[8:11], s77 offen offset:1024 sc1
    v_mfma_f32_16x16x32_bf16 v[124:127], a[232:235], a[144:147], v[124:127]
    s_add_u32 s18, s18, s19
    v_mfma_f32_16x16x32_bf16 v[124:127], a[228:231], a[140:143], v[124:127]
    s_waitcnt lgkmcnt(6)
    v_mfma_f32_16x16x32_bf16 v[128:131], a[196:199], a[132:135], v[128:131]
    s_lshl_b32 s79, s79, 11
    ds_read_b128 a[228:231], v253 offset:50176
    ds_read_b128 a[232:235], v253 offset:60416
    v_mfma_f32_16x16x32_bf16 v[128:131], a[200:203], a[136:139], v[128:131]
    s_add_u32 s77, s35, 10240
    buffer_load_dwordx4 a[188:191], v1, s[8:11], s77 offen offset:0 sc1
    v_mfma_f32_16x16x32_bf16 v[132:135], a[200:203], a[144:147], v[132:135]
    s_add_u32 s15, s79, s78
    v_mfma_f32_16x16x32_bf16 v[132:135], a[196:199], a[140:143], v[132:135]
    s_waitcnt vmcnt(22) lgkmcnt(6)
    s_barrier
    v_mfma_f32_16x16x32_bf16 v[136:139], a[204:207], a[132:135], v[136:139]
    s_lshr_b32 s78, s28, 1
    ds_read_b128 a[196:199], v254 offset:0
    ds_read_b128 a[200:203], v254 offset:10240
    v_mfma_f32_16x16x32_bf16 v[136:139], a[208:211], a[136:139], v[136:139]
    s_lshl_b32 s78, s78, 10
    buffer_load_dwordx4 a[192:195], v1, s[8:11], s77 offen offset:1024 sc1
    v_mfma_f32_16x16x32_bf16 v[140:143], a[208:211], a[144:147], v[140:143]
    s_and_b32 s79, s28, 1
    v_mfma_f32_16x16x32_bf16 v[140:143], a[204:207], a[140:143], v[140:143]
    s_waitcnt lgkmcnt(6)
    v_mfma_f32_16x16x32_bf16 v[144:147], a[212:215], a[132:135], v[144:147]
    s_lshl_b32 s19, s79, 7
    ds_read_b128 a[204:207], v254 offset:1024
    ds_read_b128 a[208:211], v254 offset:11264
    v_mfma_f32_16x16x32_bf16 v[144:147], a[216:219], a[136:139], v[144:147]
    s_add_u32 s77, s46, 12288
    buffer_load_dwordx4 a[0:3], v1, s[8:11], s77 offen offset:0 sc1
    v_mfma_f32_16x16x32_bf16 v[148:151], a[216:219], a[144:147], v[148:151]
    s_add_u32 s19, s19, s78
    v_mfma_f32_16x16x32_bf16 v[148:151], a[212:215], a[140:143], v[148:151]
    s_waitcnt lgkmcnt(6)
    v_mfma_f32_16x16x32_bf16 v[152:155], a[220:223], a[132:135], v[152:155]
    s_add_u32 s19, s19, s33
    ds_read_b128 a[212:215], v254 offset:2048
    ds_read_b128 a[216:219], v254 offset:12288
    v_mfma_f32_16x16x32_bf16 v[152:155], a[224:227], a[136:139], v[152:155]
    s_add_u32 s19, s19, 8192
    buffer_load_dwordx4 a[4:7], v1, s[8:11], s77 offen offset:1024 sc1
    v_mfma_f32_16x16x32_bf16 v[156:159], a[224:227], a[144:147], v[156:159]
    s_mul_i32 s61, s5, 320
    v_mfma_f32_16x16x32_bf16 v[156:159], a[220:223], a[140:143], v[156:159]
    s_waitcnt lgkmcnt(6)
    v_mfma_f32_16x16x32_bf16 v[160:163], a[228:231], a[132:135], v[160:163]
    s_lshl_b32 s60, s28, 6
    ds_read_b128 a[220:223], v254 offset:3072
    ds_read_b128 a[224:227], v254 offset:13312
    v_mfma_f32_16x16x32_bf16 v[160:163], a[232:235], a[136:139], v[160:163]
    s_add_u32 s77, s47, 12288
    buffer_load_dwordx4 a[8:11], v1, s[8:11], s77 offen offset:0 sc1
    v_mfma_f32_16x16x32_bf16 v[164:167], a[232:235], a[144:147], v[164:167]
    s_add_u32 s60, s60, s61
    v_mfma_f32_16x16x32_bf16 v[164:167], a[228:231], a[140:143], v[164:167]
    s_waitcnt vmcnt(48) lgkmcnt(6)
    v_mfma_f32_16x16x32_bf16 v[88:91], a[196:199], a[148:151], v[88:91]
    s_add_u32 s61, s61, 256
    ds_read_b128 a[228:231], v254 offset:4096
    ds_read_b128 a[232:235], v254 offset:14336
    v_mfma_f32_16x16x32_bf16 v[88:91], a[200:203], a[152:155], v[88:91]
    s_cmp_ge_u32 s28, 2
    s_cselect_b32 s78, s59, s58
    buffer_load_dwordx4 a[12:15], v1, s[8:11], s77 offen offset:1024 sc1
    v_mfma_f32_16x16x32_bf16 v[92:95], a[200:203], a[160:163], v[92:95]
    s_lshl1_add_u32 s78, s78, s79
    v_mfma_f32_16x16x32_bf16 v[92:95], a[196:199], a[156:159], v[92:95]
    s_waitcnt lgkmcnt(6)
    v_mfma_f32_16x16x32_bf16 v[96:99], a[204:207], a[148:151], v[96:99]
    s_add_u32 m0, s30, 81920
    ds_read_b128 a[196:199], v254 offset:5120
    ds_read_b128 a[200:203], v254 offset:15360
    v_mfma_f32_16x16x32_bf16 v[96:99], a[208:211], a[152:155], v[96:99]
    s_add_u32 s70, s70, s31
    s_add_u32 s76, s70, 0
    buffer_load_dwordx4 v1, s[24:27], s76 offen offset:0 sc1 lds
    v_mfma_f32_16x16x32_bf16 v[100:103], a[208:211], a[160:163], v[100:103]
    s_mul_i32 s78, s78, 10240
    v_mfma_f32_16x16x32_bf16 v[100:103], a[204:207], a[156:159], v[100:103]
    s_waitcnt lgkmcnt(6)
    v_mfma_f32_16x16x32_bf16 v[104:107], a[212:215], a[148:151], v[104:107]
    s_add_u32 s22, s78, s61
    ds_read_b128 a[204:207], v254 offset:6144
    ds_read_b128 a[208:211], v254 offset:16384
    v_mfma_f32_16x16x32_bf16 v[104:107], a[216:219], a[152:155], v[104:107]
    s_add_u32 s71, s71, s31
    s_add_u32 s76, s71, 4294966272
    buffer_load_dwordx4 v1, s[24:27], s76 offen offset:1024 sc1 lds
    v_mfma_f32_16x16x32_bf16 v[108:111], a[216:219], a[160:163], v[108:111]
    s_mul_i32 s20, s58, 20480
    v_mfma_f32_16x16x32_bf16 v[108:111], a[212:215], a[156:159], v[108:111]
    s_waitcnt lgkmcnt(6)
    v_mfma_f32_16x16x32_bf16 v[112:115], a[220:223], a[148:151], v[112:115]
    s_add_u32 s20, s20, s60
    ds_read_b128 a[212:215], v254 offset:7168
    ds_read_b128 a[216:219], v254 offset:17408
    v_mfma_f32_16x16x32_bf16 v[112:115], a[224:227], a[152:155], v[112:115]
    s_add_u32 s72, s72, s31
    s_add_u32 s76, s72, 4294965248
    buffer_load_dwordx4 v1, s[24:27], s76 offen offset:2048 sc1 lds
    v_mfma_f32_16x16x32_bf16 v[116:119], a[224:227], a[160:163], v[116:119]
    s_mul_i32 s21, s59, 20480
    v_mfma_f32_16x16x32_bf16 v[116:119], a[220:223], a[156:159], v[116:119]
    s_waitcnt lgkmcnt(6)
    v_mfma_f32_16x16x32_bf16 v[120:123], a[228:231], a[148:151], v[120:123]
    s_add_u32 s21, s21, s60
    ds_read_b128 a[220:223], v254 offset:8192
    ds_read_b128 a[224:227], v254 offset:18432
    v_mfma_f32_16x16x32_bf16 v[120:123], a[232:235], a[152:155], v[120:123]
    s_add_u32 s73, s73, s31
    s_add_u32 s76, s73, 4294964224
    buffer_load_dwordx4 v1, s[24:27], s76 offen offset:3072 sc1 lds
    v_mfma_f32_16x16x32_bf16 v[124:127], a[232:235], a[160:163], v[124:127]
    s_cmp_lg_u32 s28, 0
    s_cmov_b32 s61, 536870912
    v_mfma_f32_16x16x32_bf16 v[124:127], a[228:231], a[156:159], v[124:127]
    s_waitcnt lgkmcnt(6)
    v_mfma_f32_16x16x32_bf16 v[128:131], a[196:199], a[148:151], v[128:131]
    s_add_u32 m0, s30, 86016
    ds_read_b128 a[228:231], v254 offset:9216
    ds_read_b128 a[232:235], v254 offset:19456
    v_mfma_f32_16x16x32_bf16 v[128:131], a[200:203], a[152:155], v[128:131]
    s_add_u32 s74, s74, s31
    s_add_u32 s76, s74, 0
    buffer_load_dwordx4 v1, s[24:27], s76 offen offset:0 sc1 lds
    v_mfma_f32_16x16x32_bf16 v[132:135], a[200:203], a[160:163], v[132:135]
    s_and_b32 s62, s93, 0xffffff80
    v_mfma_f32_16x16x32_bf16 v[132:135], a[196:199], a[156:159], v[132:135]
    s_waitcnt lgkmcnt(6)
    v_mfma_f32_16x16x32_bf16 v[136:139], a[204:207], a[148:151], v[136:139]
    s_add_u32 m0, s30, 143360
    ds_read_b128 a[196:199], v1 offset:0
    ds_read_b128 a[200:203], v1 offset:10240
    v_mfma_f32_16x16x32_bf16 v[136:139], a[208:211], a[152:155], v[136:139]
    s_add_u32 s76, s70, 81920
    buffer_load_dwordx4 v1, s[24:27], s76 offen offset:0 sc1 lds
    v_mfma_f32_16x16x32_bf16 v[140:143], a[208:211], a[160:163], v[140:143]
    buffer_load_dwordx4 v[16:19], v7, s[48:51], s60 offen
    v_mfma_f32_16x16x32_bf16 v[140:143], a[204:207], a[156:159], v[140:143]
    s_waitcnt lgkmcnt(6)
    v_mfma_f32_16x16x32_bf16 v[144:147], a[212:215], a[148:151], v[144:147]
    ds_read_b128 a[204:207], v1 offset:1024
    ds_read_b128 a[208:211], v1 offset:11264
    v_mfma_f32_16x16x32_bf16 v[144:147], a[216:219], a[152:155], v[144:147]
    s_add_u32 s76, s71, 80896
    buffer_load_dwordx4 v1, s[24:27], s76 offen offset:1024 sc1 lds
    v_mfma_f32_16x16x32_bf16 v[148:151], a[216:219], a[160:163], v[148:151]
    buffer_load_dwordx4 v[20:23], v7, s[48:51], s61 offen
    v_mfma_f32_16x16x32_bf16 v[148:151], a[212:215], a[156:159], v[148:151]
    s_waitcnt lgkmcnt(6)
    v_mfma_f32_16x16x32_bf16 v[152:155], a[220:223], a[148:151], v[152:155]
    ds_read_b128 a[212:215], v1 offset:2048
    ds_read_b128 a[216:219], v1 offset:12288
    v_mfma_f32_16x16x32_bf16 v[152:155], a[224:227], a[152:155], v[152:155]
    s_add_u32 s76, s72, 79872
    buffer_load_dwordx4 v1, s[24:27], s76 offen offset:2048 sc1 lds
    v_mfma_f32_16x16x32_bf16 v[156:159], a[224:227], a[160:163], v[156:159]
    buffer_load_dword v14, v251, s[8:11], s98 offen sc1
    v_mfma_f32_16x16x32_bf16 v[156:159], a[220:223], a[156:159], v[156:159]
    s_waitcnt lgkmcnt(6)
    v_mfma_f32_16x16x32_bf16 v[160:163], a[228:231], a[148:151], v[160:163]
    ds_read_b128 a[220:223], v1 offset:3072
    ds_read_b128 a[224:227], v1 offset:13312
    v_mfma_f32_16x16x32_bf16 v[160:163], a[232:235], a[152:155], v[160:163]
    s_add_u32 s76, s73, 78848
    buffer_load_dwordx4 v1, s[24:27], s76 offen offset:3072 sc1 lds
    v_mfma_f32_16x16x32_bf16 v[164:167], a[232:235], a[160:163], v[164:167]
    v_mfma_f32_16x16x32_bf16 v[164:167], a[228:231], a[156:159], v[164:167]
    s_waitcnt vmcnt(57) lgkmcnt(6)
    v_mfma_f32_16x16x32_bf16 v[88:91], a[196:199], a[164:167], v[88:91]
    s_add_u32 m0, s30, 147456
    ds_read_b128 a[228:231], v1 offset:4096
    ds_read_b128 a[232:235], v1 offset:14336
    v_mfma_f32_16x16x32_bf16 v[88:91], a[200:203], a[168:171], v[88:91]
    s_add_u32 s76, s74, 81920
    buffer_load_dwordx4 v1, s[24:27], s76 offen offset:0 sc1 lds
    v_mfma_f32_16x16x32_bf16 v[92:95], a[200:203], a[176:179], v[92:95]
    v_mfma_f32_16x16x32_bf16 v[92:95], a[196:199], a[172:175], v[92:95]
    s_waitcnt lgkmcnt(6)
    v_mfma_f32_16x16x32_bf16 v[96:99], a[204:207], a[164:167], v[96:99]
    s_add_u32 m0, s30, 40960
    ds_read_b128 a[196:199], v1 offset:5120
    ds_read_b128 a[200:203], v1 offset:15360
    v_mfma_f32_16x16x32_bf16 v[96:99], a[208:211], a[168:171], v[96:99]
pad22:
    s_cbranch_execz hopret1
    s_add_u32 s76, s70, 163840
    buffer_load_dwordx4 v1, s[24:27], s76 offen offset:0 sc1 lds
    v_mfma_f32_16x16x32_bf16 v[100:103], a[208:211], a[176:179], v[100:103]
    v_mfma_f32_16x16x32_bf16 v[100:103], a[204:207], a[172:175], v[100:103]
    s_waitcnt lgkmcnt(6)
    v_mfma_f32_16x16x32_bf16 v[104:107], a[212:215], a[164:167], v[104:107]
    ds_read_b128 a[204:207], v1 offset:6144
    ds_read_b128 a[208:211], v1 offset:16384
    v_mfma_f32_16x16x32_bf16 v[104:107], a[216:219], a[168:171], v[104:107]
    s_add_u32 s76, s71, 162816
    buffer_load_dwordx4 v1, s[24:27], s76 offen offset:1024 sc1 lds
    v_mfma_f32_16x16x32_bf16 v[108:111], a[216:219], a[176:179], v[108:111]
    v_mfma_f32_16x16x32_bf16 v[108:111], a[212:215], a[172:175], v[108:111]
    s_waitcnt lgkmcnt(6)
    v_mfma_f32_16x16x32_bf16 v[112:115], a[220:223], a[164:167], v[112:115]
    ds_read_b128 a[212:215], v1 offset:7168
    ds_read_b128 a[216:219], v1 offset:17408
    v_mfma_f32_16x16x32_bf16 v[112:115], a[224:227], a[168:171], v[112:115]
    s_add_u32 s76, s72, 161792
    buffer_load_dwordx4 v1, s[24:27], s76 offen offset:2048 sc1 lds
    v_mfma_f32_16x16x32_bf16 v[116:119], a[224:227], a[176:179], v[116:119]
    v_mfma_f32_16x16x32_bf16 v[116:119], a[220:223], a[172:175], v[116:119]
    s_waitcnt lgkmcnt(6)
    v_mfma_f32_16x16x32_bf16 v[120:123], a[228:231], a[164:167], v[120:123]
    ds_read_b128 a[220:223], v1 offset:8192
    ds_read_b128 a[224:227], v1 offset:18432
    v_mfma_f32_16x16x32_bf16 v[120:123], a[232:235], a[168:171], v[120:123]
    s_add_u32 s76, s73, 160768
    buffer_load_dwordx4 v1, s[24:27], s76 offen offset:3072 sc1 lds
    v_mfma_f32_16x16x32_bf16 v[124:127], a[232:235], a[176:179], v[124:127]
    v_mfma_f32_16x16x32_bf16 v[124:127], a[228:231], a[172:175], v[124:127]
    s_waitcnt lgkmcnt(6)
    v_mfma_f32_16x16x32_bf16 v[128:131], a[196:199], a[164:167], v[128:131]
    s_add_u32 m0, s30, 45056
    ds_read_b128 a[228:231], v1 offset:9216
    ds_read_b128 a[232:235], v1 offset:19456
    v_mfma_f32_16x16x32_bf16 v[128:131], a[200:203], a[168:171], v[128:131]
    s_add_u32 s76, s74, 163840
    buffer_load_dwordx4 v1, s[24:27], s76 offen offset:0 sc1 lds
    v_mfma_f32_16x16x32_bf16 v[132:135], a[200:203], a[176:179], v[132:135]
    v_mfma_f32_16x16x32_bf16 v[132:135], a[196:199], a[172:175], v[132:135]
    s_waitcnt vmcnt(26) lgkmcnt(6)
    s_barrier
    v_mfma_f32_16x16x32_bf16 v[136:139], a[204:207], a[164:167], v[136:139]
    s_add_u32 m0, s30, 102400
    ds_read_b128 a[196:199], v1 offset:20480
    ds_read_b128 a[200:203], v1 offset:30720
    v_mfma_f32_16x16x32_bf16 v[136:139], a[208:211], a[168:171], v[136:139]
    s_add_u32 s76, s70, 245760
    buffer_load_dwordx4 v1, s[24:27], s76 offen offset:0 sc1 lds
    v_mfma_f32_16x16x32_bf16 v[140:143], a[208:211], a[176:179], v[140:143]
    s_waitcnt vmcnt(8)
    v_xor_b32 v14, s97, v14
    v_cmp_eq_u32 vcc, 0, v14
    s_cmp_eq_u64 vcc, -1
    s_cbranch_scc0 spin2
spin2_ok:
    v_mfma_f32_16x16x32_bf16 v[140:143], a[204:207], a[172:175], v[140:143]
    s_waitcnt lgkmcnt(6)
    v_mfma_f32_16x16x32_bf16 v[144:147], a[212:215], a[164:167], v[144:147]
    ds_read_b128 a[204:207], v1 offset:21504
    ds_read_b128 a[208:211], v1 offset:31744
    v_mfma_f32_16x16x32_bf16 v[144:147], a[216:219], a[168:171], v[144:147]
    s_add_u32 s76, s71, 244736
    buffer_load_dwordx4 v1, s[24:27], s76 offen offset:1024 sc1 lds
    v_mfma_f32_16x16x32_bf16 v[148:151], a[216:219], a[176:179], v[148:151]
    v_mfma_f32_16x16x32_bf16 v[148:151], a[212:215], a[172:175], v[148:151]
    s_waitcnt lgkmcnt(6)
    v_mfma_f32_16x16x32_bf16 v[152:155], a[220:223], a[164:167], v[152:155]
    ds_read_b128 a[212:215], v1 offset:22528
    ds_read_b128 a[216:219], v1 offset:32768
    v_mfma_f32_16x16x32_bf16 v[152:155], a[224:227], a[168:171], v[152:155]
    s_add_u32 s76, s72, 243712
    buffer_load_dwordx4 v1, s[24:27], s76 offen offset:2048 sc1 lds
    v_mfma_f32_16x16x32_bf16 v[156:159], a[224:227], a[176:179], v[156:159]
    v_mfma_f32_16x16x32_bf16 v[156:159], a[220:223], a[172:175], v[156:159]
    s_waitcnt lgkmcnt(6)
    v_mfma_f32_16x16x32_bf16 v[160:163], a[228:231], a[164:167], v[160:163]
    ds_read_b128 a[220:223], v1 offset:23552
    ds_read_b128 a[224:227], v1 offset:33792
    v_mfma_f32_16x16x32_bf16 v[160:163], a[232:235], a[168:171], v[160:163]
    s_add_u32 s76, s73, 242688
    buffer_load_dwordx4 v1, s[24:27], s76 offen offset:3072 sc1 lds
    v_mfma_f32_16x16x32_bf16 v[164:167], a[232:235], a[176:179], v[164:167]
    v_mfma_f32_16x16x32_bf16 v[164:167], a[228:231], a[172:175], v[164:167]
    s_waitcnt vmcnt(26) lgkmcnt(6)
    v_mfma_f32_16x16x32_bf16 v[88:91], a[196:199], a[180:183], v[88:91]
    s_add_u32 m0, s30, 106496
    ds_read_b128 a[228:231], v1 offset:24576
    ds_read_b128 a[232:235], v1 offset:34816
    v_mfma_f32_16x16x32_bf16 v[88:91], a[200:203], a[184:187], v[88:91]
    s_add_u32 s76, s74, 245760
    buffer_load_dwordx4 v1, s[24:27], s76 offen offset:0 sc1 lds
    v_mfma_f32_16x16x32_bf16 v[92:95], a[200:203], a[192:195], v[92:95]
    v_mfma_f32_16x16x32_bf16 v[92:95], a[196:199], a[188:191], v[92:95]
    s_waitcnt lgkmcnt(6)
    v_mfma_f32_16x16x32_bf16 v[96:99], a[204:207], a[180:183], v[96:99]
    ds_read_b128 a[196:199], v1 offset:25600
    ds_read_b128 a[200:203], v1 offset:35840
    v_mfma_f32_16x16x32_bf16 v[96:99], a[208:211], a[184:187], v[96:99]
    s_add_u32 s77, s44, 0
    buffer_load_dwordx4 a[16:19], v1, s[8:11], s77 offen offset:0 sc1
    v_mfma_f32_16x16x32_bf16 v[100:103], a[208:211], a[192:195], v[100:103]
    v_mfma_f32_16x16x32_bf16 v[100:103], a[204:207], a[188:191], v[100:103]
    s_waitcnt lgkmcnt(6)
    v_mfma_f32_16x16x32_bf16 v[104:107], a[212:215], a[180:183], v[104:107]
    ds_read_b128 a[204:207], v1 offset:26624
    ds_read_b128 a[208:211], v1 offset:36864
    v_mfma_f32_16x16x32_bf16 v[104:107], a[216:219], a[184:187], v[104:107]
    buffer_load_dwordx4 a[20:23], v1, s[8:11], s77 offen offset:1024 sc1
    v_mfma_f32_16x16x32_bf16 v[108:111], a[216:219], a[192:195], v[108:111]
    v_mfma_f32_16x16x32_bf16 v[108:111], a[212:215], a[188:191], v[108:111]
    s_waitcnt lgkmcnt(6)
    v_mfma_f32_16x16x32_bf16 v[112:115], a[220:223], a[180:183], v[112:115]
    ds_read_b128 a[212:215], v1 offset:27648
    ds_read_b128 a[216:219], v1 offset:37888
    v_mfma_f32_16x16x32_bf16 v[112:115], a[224:227], a[184:187], v[112:115]
    s_add_u32 s77, s45, 0
    buffer_load_dwordx4 a[24:27], v1, s[8:11], s77 offen offset:0 sc1
    v_mfma_f32_16x16x32_bf16 v[116:119], a[224:227], a[192:195], v[116:119]
    v_mfma_f32_16x16x32_bf16 v[116:119], a[220:223], a[188:191], v[116:119]
    s_waitcnt lgkmcnt(6)
    v_mfma_f32_16x16x32_bf16 v[120:123], a[228:231], a[180:183], v[120:123]
    ds_read_b128 a[220:223], v1 offset:28672
    ds_read_b128 a[224:227], v1 offset:38912
    v_mfma_f32_16x16x32_bf16 v[120:123], a[232:235], a[184:187], v[120:123]
    buffer_load_dwordx4 a[28:31], v1, s[8:11], s77 offen offset:1024 sc1
    v_mfma_f32_16x16x32_bf16 v[124:127], a[232:235], a[192:195], v[124:127]
    v_mfma_f32_16x16x32_bf16 v[124:127], a[228:231], a[188:191], v[124:127]
    s_waitcnt lgkmcnt(6)
    v_mfma_f32_16x16x32_bf16 v[128:131], a[196:199], a[180:183], v[128:131]
    ds_read_b128 a[228:231], v1 offset:29696
    ds_read_b128 a[232:235], v1 offset:39936
    v_mfma_f32_16x16x32_bf16 v[128:131], a[200:203], a[184:187], v[128:131]
    s_add_u32 s77, s44, 2048
    buffer_load_dwordx4 a[32:35], v1, s[8:11], s77 offen offset:0 sc1
    v_mfma_f32_16x16x32_bf16 v[132:135], a[200:203], a[192:195], v[132:135]
    v_mfma_f32_16x16x32_bf16 v[132:135], a[196:199], a[188:191], v[132:135]
    s_waitcnt lgkmcnt(6)
    v_mfma_f32_16x16x32_bf16 v[136:139], a[204:207], a[180:183], v[136:139]
    ds_read_b128 a[196:199], v253 offset:0
    ds_read_b128 a[200:203], v253 offset:10240
    v_mfma_f32_16x16x32_bf16 v[136:139], a[208:211], a[184:187], v[136:139]
    buffer_load_dwordx4 a[36:39], v1, s[8:11], s77 offen offset:1024 sc1
    v_mfma_f32_16x16x32_bf16 v[140:143], a[208:211], a[192:195], v[140:143]
    v_mfma_f32_16x16x32_bf16 v[140:143], a[204:207], a[188:191], v[140:143]
    s_waitcnt lgkmcnt(6)
    v_mfma_f32_16x16x32_bf16 v[144:147], a[212:215], a[180:183], v[144:147]
    ds_read_b128 a[204:207], v253 offset:1024
    ds_read_b128 a[208:211], v253 offset:11264
    v_mfma_f32_16x16x32_bf16 v[144:147], a[216:219], a[184:187], v[144:147]
    s_add_u32 s77, s45, 2048
    buffer_load_dwordx4 a[40:43], v1, s[8:11], s77 offen offset:0 sc1
    v_mfma_f32_16x16x32_bf16 v[148:151], a[216:219], a[192:195], v[148:151]
    v_mfma_f32_16x16x32_bf16 v[148:151], a[212:215], a[188:191], v[148:151]
    s_waitcnt lgkmcnt(6)
    v_mfma_f32_16x16x32_bf16 v[152:155], a[220:223], a[180:183], v[152:155]
    ds_read_b128 a[212:215], v253 offset:2048
    ds_read_b128 a[216:219], v253 offset:12288
    v_mfma_f32_16x16x32_bf16 v[152:155], a[224:227], a[184:187], v[152:155]
    buffer_load_dwordx4 a[44:47], v1, s[8:11], s77 offen offset:1024 sc1
    v_mfma_f32_16x16x32_bf16 v[156:159], a[224:227], a[192:195], v[156:159]
    v_mfma_f32_16x16x32_bf16 v[156:159], a[220:223], a[188:191], v[156:159]
    s_waitcnt lgkmcnt(6)
    v_mfma_f32_16x16x32_bf16 v[160:163], a[228:231], a[180:183], v[160:163]
    ds_read_b128 a[220:223], v253 offset:3072
    ds_read_b128 a[224:227], v253 offset:13312
    v_mfma_f32_16x16x32_bf16 v[160:163], a[232:235], a[184:187], v[160:163]
    s_add_u32 s77, s44, 4096
    buffer_load_dwordx4 a[48:51], v1, s[8:11], s77 offen offset:0 sc1
    v_mfma_f32_16x16x32_bf16 v[164:167], a[232:235], a[192:195], v[164:167]
    v_mfma_f32_16x16x32_bf16 v[164:167], a[228:231], a[188:191], v[164:167]
    s_waitcnt vmcnt(32) lgkmcnt(6)
    v_mfma_f32_16x16x32_bf16 v[88:91], a[196:199], a[0:3], v[88:91]
    ds_read_b128 a[228:231], v253 offset:4096
    ds_read_b128 a[232:235], v253 offset:14336
    v_mfma_f32_16x16x32_bf16 v[88:91], a[200:203], a[4:7], v[88:91]
    buffer_load_dwordx4 a[52:55], v1, s[8:11], s77 offen offset:1024 sc1
    v_mfma_f32_16x16x32_bf16 v[92:95], a[200:203], a[12:15], v[92:95]
    v_mfma_f32_16x16x32_bf16 v[92:95], a[196:199], a[8:11], v[92:95]
    s_waitcnt lgkmcnt(6)
    v_mfma_f32_16x16x32_bf16 v[96:99], a[204:207], a[0:3], v[96:99]
    ds_read_b128 a[196:199], v253 offset:5120
    ds_read_b128 a[200:203], v253 offset:15360
    v_mfma_f32_16x16x32_bf16 v[96:99], a[208:211], a[4:7], v[96:99]
    s_add_u32 s77, s45, 4096
    buffer_load_dwordx4 a[56:59], v1, s[8:11], s77 offen offset:0 sc1
    v_mfma_f32_16x16x32_bf16 v[100:103], a[208:211], a[12:15], v[100:103]
    v_mfma_f32_16x16x32_bf16 v[100:103], a[204:207], a[8:11], v[100:103]
    s_waitcnt lgkmcnt(6)
    v_mfma_f32_16x16x32_bf16 v[104:107], a[212:215], a[0:3], v[104:107]
    ds_read_b128 a[204:207], v253 offset:6144
    ds_read_b128 a[208:211], v253 offset:16384
    v_mfma_f32_16x16x32_bf16 v[104:107], a[216:219], a[4:7], v[104:107]
    buffer_load_dwordx4 a[60:63], v1, s[8:11], s77 offen offset:1024 sc1
    v_mfma_f32_16x16x32_bf16 v[108:111], a[216:219], a[12:15], v[108:111]
    v_mfma_f32_16x16x32_bf16 v[108:111], a[212:215], a[8:11], v[108:111]
    s_waitcnt lgkmcnt(6)
    v_mfma_f32_16x16x32_bf16 v[112:115], a[220:223], a[0:3], v[112:115]
    ds_read_b128 a[212:215], v253 offset:7168
    ds_read_b128 a[216:219], v253 offset:17408
    v_mfma_f32_16x16x32_bf16 v[112:115], a[224:227], a[4:7], v[112:115]
    s_add_u32 s77, s44, 6144
    buffer_load_dwordx4 a[64:67], v1, s[8:11], s77 offen offset:0 sc1
    v_mfma_f32_16x16x32_bf16 v[116:119], a[224:227], a[12:15], v[116:119]
    v_mfma_f32_16x16x32_bf16 v[116:119], a[220:223], a[8:11], v[116:119]
    s_waitcnt lgkmcnt(6)
    v_mfma_f32_16x16x32_bf16 v[120:123], a[228:231], a[0:3], v[120:123]
    ds_read_b128 a[220:223], v253 offset:8192
    ds_read_b128 a[224:227], v253 offset:18432
    v_mfma_f32_16x16x32_bf16 v[120:123], a[232:235], a[4:7], v[120:123]
    buffer_load_dwordx4 a[68:71], v1, s[8:11], s77 offen offset:1024 sc1
    v_mfma_f32_16x16x32_bf16 v[124:127], a[232:235], a[12:15], v[124:127]
    v_mfma_f32_16x16x32_bf16 v[124:127], a[228:231], a[8:11], v[124:127]
    s_waitcnt lgkmcnt(6)
    v_mfma_f32_16x16x32_bf16 v[128:131], a[196:199], a[0:3], v[128:131]
    ds_read_b128 a[228:231], v253 offset:9216
    ds_read_b128 a[232:235], v253 offset:19456
    v_mfma_f32_16x16x32_bf16 v[128:131], a[200:203], a[4:7], v[128:131]
    s_add_u32 s77, s45, 6144
    buffer_load_dwordx4 a[72:75], v1, s[8:11], s77 offen offset:0 sc1
    v_mfma_f32_16x16x32_bf16 v[132:135], a[200:203], a[12:15], v[132:135]
    v_mfma_f32_16x16x32_bf16 v[132:135], a[196:199], a[8:11], v[132:135]
    s_waitcnt vmcnt(25) lgkmcnt(6)
    s_barrier
    v_mfma_f32_16x16x32_bf16 v[136:139], a[204:207], a[0:3], v[136:139]
    ds_read_b128 a[196:199], v253 offset:20480
    ds_read_b128 a[200:203], v253 offset:30720
    v_mfma_f32_16x16x32_bf16 v[136:139], a[208:211], a[4:7], v[136:139]
    buffer_load_dwordx4 a[76:79], v1, s[8:11], s77 offen offset:1024 sc1
    v_mfma_f32_16x16x32_bf16 v[140:143], a[208:211], a[12:15], v[140:143]
    v_mfma_f32_16x16x32_bf16 v[140:143], a[204:207], a[8:11], v[140:143]
    s_waitcnt lgkmcnt(6)
    v_mfma_f32_16x16x32_bf16 v[144:147], a[212:215], a[0:3], v[144:147]
    s_add_u32 m0, s30, 122880
    ds_read_b128 a[204:207], v253 offset:21504
    ds_read_b128 a[208:211], v253 offset:31744
    v_mfma_f32_16x16x32_bf16 v[144:147], a[216:219], a[4:7], v[144:147]
    s_add_u32 s76, s70, 327680
    buffer_load_dwordx4 v1, s[24:27], s76 offen offset:0 sc1 lds
    v_mfma_f32_16x16x32_bf16 v[148:151], a[216:219], a[12:15], v[148:151]
    v_mfma_f32_16x16x32_bf16 v[148:151], a[212:215], a[8:11], v[148:151]
    s_waitcnt lgkmcnt(6)
    v_mfma_f32_16x16x32_bf16 v[152:155], a[220:223], a[0:3], v[152:155]
    ds_read_b128 a[212:215], v253 offset:22528
    ds_read_b128 a[216:219], v253 offset:32768
    v_mfma_f32_16x16x32_bf16 v[152:155], a[224:227], a[4:7], v[152:155]
    s_add_u32 s76, s71, 326656
    buffer_load_dwordx4 v1, s[24:27], s76 offen offset:1024 sc1 lds
    v_mfma_f32_16x16x32_bf16 v[156:159], a[224:227], a[12:15], v[156:159]
    v_mfma_f32_16x16x32_bf16 v[156:159], a[220:223], a[8:11], v[156:159]
    s_waitcnt lgkmcnt(6)
    v_mfma_f32_16x16x32_bf16 v[160:163], a[228:231], a[0:3], v[160:163]
    ds_read_b128 a[220:223], v253 offset:23552
    ds_read_b128 a[224:227], v253 offset:33792
    v_mfma_f32_16x16x32_bf16 v[160:163], a[232:235], a[4:7], v[160:163]
    s_add_u32 s76, s72, 325632
    buffer_load_dwordx4 v1, s[24:27], s76 offen offset:2048 sc1 lds
    v_mfma_f32_16x16x32_bf16 v[164:167], a[232:235], a[12:15], v[164:167]
    v_mfma_f32_16x16x32_bf16 v[164:167], a[228:231], a[8:11], v[164:167]
    s_waitcnt vmcnt(15) lgkmcnt(6)
    v_mfma_f32_16x16x32_bf16 v[168:171], a[196:199], a[16:19], 0
    ds_read_b128 a[228:231], v253 offset:24576
    ds_read_b128 a[232:235], v253 offset:34816
    v_mfma_f32_16x16x32_bf16 v[168:171], a[200:203], a[20:23], v[168:171]
    s_add_u32 s76, s73, 324608
    buffer_load_dwordx4 v1, s[24:27], s76 offen offset:3072 sc1 lds
    v_mfma_f32_16x16x32_bf16 v[172:175], a[200:203], a[28:31], 0
    v_mfma_f32_16x16x32_bf16 v[172:175], a[196:199], a[24:27], v[172:175]
    s_waitcnt lgkmcnt(6)
    v_mfma_f32_16x16x32_bf16 v[176:179], a[204:207], a[16:19], 0
    s_add_u32 m0, s30, 126976
    ds_read_b128 a[196:199], v253 offset:25600
    ds_read_b128 a[200:203], v253 offset:35840
    v_mfma_f32_16x16x32_bf16 v[176:179], a[208:211], a[20:23], v[176:179]
    s_add_u32 s76, s74, 327680
    buffer_load_dwordx4 v1, s[24:27], s76 offen offset:0 sc1 lds
    v_mfma_f32_16x16x32_bf16 v[180:183], a[208:211], a[28:31], 0
    v_mfma_f32_16x16x32_bf16 v[180:183], a[204:207], a[24:27], v[180:183]
    s_waitcnt lgkmcnt(6)
    v_mfma_f32_16x16x32_bf16 v[184:187], a[212:215], a[16:19], 0
    s_add_u32 m0, s30, 0
    ds_read_b128 a[204:207], v253 offset:26624
    ds_read_b128 a[208:211], v253 offset:36864
    v_mfma_f32_16x16x32_bf16 v[184:187], a[216:219], a[20:23], v[184:187]
    s_add_u32 s76, s70, 409600
    buffer_load_dwordx4 v1, s[24:27], s76 offen offset:0 sc1 lds
    v_mfma_f32_16x16x32_bf16 v[188:191], a[216:219], a[28:31], 0
    v_mfma_f32_16x16x32_bf16 v[188:191], a[212:215], a[24:27], v[188:191]
    s_waitcnt lgkmcnt(6)
    v_mfma_f32_16x16x32_bf16 v[192:195], a[220:223], a[16:19], 0
    ds_read_b128 a[212:215], v253 offset:27648
    ds_read_b128 a[216:219], v253 offset:37888
    v_mfma_f32_16x16x32_bf16 v[192:195], a[224:227], a[20:23], v[192:195]
    s_add_u32 s76, s71, 408576
    buffer_load_dwordx4 v1, s[24:27], s76 offen offset:1024 sc1 lds
    v_mfma_f32_16x16x32_bf16 v[196:199], a[224:227], a[28:31], 0
    v_mfma_f32_16x16x32_bf16 v[196:199], a[220:223], a[24:27], v[196:199]
    s_waitcnt lgkmcnt(6)
    v_mfma_f32_16x16x32_bf16 v[200:203], a[228:231], a[16:19], 0
    ds_read_b128 a[220:223], v253 offset:28672
    ds_read_b128 a[224:227], v253 offset:38912
    v_mfma_f32_16x16x32_bf16 v[200:203], a[232:235], a[20:23], v[200:203]
    s_add_u32 s76, s72, 407552
    buffer_load_dwordx4 v1, s[24:27], s76 offen offset:2048 sc1 lds
    v_mfma_f32_16x16x32_bf16 v[204:207], a[232:235], a[28:31], 0
    v_mfma_f32_16x16x32_bf16 v[204:207], a[228:231], a[24:27], v[204:207]
    s_waitcnt lgkmcnt(6)
    v_mfma_f32_16x16x32_bf16 v[208:211], a[196:199], a[16:19], 0
    ds_read_b128 a[228:231], v253 offset:29696
    ds_read_b128 a[232:235], v253 offset:39936
    v_mfma_f32_16x16x32_bf16 v[208:211], a[200:203], a[20:23], v[208:211]
    s_add_u32 s76, s73, 406528
    buffer_load_dwordx4 v1, s[24:27], s76 offen offset:3072 sc1 lds
    v_mfma_f32_16x16x32_bf16 v[212:215], a[200:203], a[28:31], 0
    v_mfma_f32_16x16x32_bf16 v[212:215], a[196:199], a[24:27], v[212:215]
    s_waitcnt lgkmcnt(6)
    v_mfma_f32_16x16x32_bf16 v[216:219], a[204:207], a[16:19], 0
    s_add_u32 m0, s30, 4096
    ds_read_b128 a[196:199], v254 offset:20480
    ds_read_b128 a[200:203], v254 offset:30720
    v_mfma_f32_16x16x32_bf16 v[216:219], a[208:211], a[20:23], v[216:219]
    s_add_u32 s76, s74, 409600
    buffer_load_dwordx4 v1, s[24:27], s76 offen offset:0 sc1 lds
    v_mfma_f32_16x16x32_bf16 v[220:223], a[208:211], a[28:31], 0
    v_mfma_f32_16x16x32_bf16 v[220:223], a[204:207], a[24:27], v[220:223]
    s_waitcnt lgkmcnt(6)
    v_mfma_f32_16x16x32_bf16 v[224:227], a[212:215], a[16:19], 0
    ds_read_b128 a[204:207], v254 offset:21504
    ds_read_b128 a[208:211], v254 offset:31744
    v_mfma_f32_16x16x32_bf16 v[224:227], a[216:219], a[20:23], v[224:227]
    s_add_u32 s77, s44, 8192
    buffer_load_dwordx4 a[80:83], v1, s[8:11], s77 offen offset:0 sc1
    v_mfma_f32_16x16x32_bf16 v[228:231], a[216:219], a[28:31], 0
    v_mfma_f32_16x16x32_bf16 v[228:231], a[212:215], a[24:27], v[228:231]
    s_waitcnt lgkmcnt(6)
    v_mfma_f32_16x16x32_bf16 v[232:235], a[220:223], a[16:19], 0
    ds_read_b128 a[212:215], v254 offset:22528
    ds_read_b128 a[216:219], v254 offset:32768
    v_mfma_f32_16x16x32_bf16 v[232:235], a[224:227], a[20:23], v[232:235]
    buffer_load_dwordx4 a[84:87], v1, s[8:11], s77 offen offset:1024 sc1
    v_mfma_f32_16x16x32_bf16 v[236:239], a[224:227], a[28:31], 0
    v_mfma_f32_16x16x32_bf16 v[236:239], a[220:223], a[24:27], v[236:239]
    s_waitcnt lgkmcnt(6)
    v_mfma_f32_16x16x32_bf16 v[240:243], a[228:231], a[16:19], 0
    ds_read_b128 a[220:223], v254 offset:23552
    ds_read_b128 a[224:227], v254 offset:33792
    v_mfma_f32_16x16x32_bf16 v[240:243], a[232:235], a[20:23], v[240:243]
    s_add_u32 s77, s45, 8192
    buffer_load_dwordx4 a[88:91], v1, s[8:11], s77 offen offset:0 sc1
    v_mfma_f32_16x16x32_bf16 v[244:247], a[232:235], a[28:31], 0
    v_mfma_f32_16x16x32_bf16 v[244:247], a[228:231], a[24:27], v[244:247]
    s_waitcnt vmcnt(21) lgkmcnt(6)
    v_mfma_f32_16x16x32_bf16 v[168:171], a[196:199], a[32:35], v[168:171]
    s_waitcnt vmcnt(43)
    ds_read_b128 a[228:231], v254 offset:24576
    ds_read_b128 a[232:235], v254 offset:34816
    v_mfma_f32_16x16x32_bf16 v[168:171], a[200:203], a[36:39], v[168:171]
    buffer_load_dwordx4 a[92:95], v1, s[8:11], s77 offen offset:1024 sc1
    v_mfma_f32_16x16x32_bf16 v[172:175], a[200:203], a[44:47], v[172:175]
    v_sub_f32 v8, 1.0, v248
    v_sub_f32 v9, 1.0, v249
    v_mfma_f32_16x16x32_bf16 v[172:175], a[196:199], a[40:43], v[172:175]
    s_waitcnt lgkmcnt(6)
    v_lshlrev_b32 v24, 16, v16
    v_and_b32 v25, 0xffff0000, v16
    v_mfma_f32_16x16x32_bf16 v[176:179], a[204:207], a[32:35], v[176:179]
    ds_read_b128 a[196:199], v254 offset:25600
    ds_read_b128 a[200:203], v254 offset:35840
    v_mfma_f32_16x16x32_bf16 v[176:179], a[208:211], a[36:39], v[176:179]
    s_add_u32 s77, s44, 10240
    buffer_load_dwordx4 a[100:103], v1, s[8:11], s77 offen offset:0 sc1
    v_mfma_f32_16x16x32_bf16 v[180:183], a[208:211], a[44:47], v[180:183]
    v_lshlrev_b32 v26, 16, v17
    v_and_b32 v27, 0xffff0000, v17
    v_mfma_f32_16x16x32_bf16 v[180:183], a[204:207], a[40:43], v[180:183]
    s_waitcnt lgkmcnt(6)
    v_lshlrev_b32 v28, 16, v18
    v_and_b32 v29, 0xffff0000, v18
    v_mfma_f32_16x16x32_bf16 v[184:187], a[212:215], a[32:35], v[184:187]
    ds_read_b128 a[204:207], v254 offset:26624
    ds_read_b128 a[208:211], v254 offset:36864
    v_mfma_f32_16x16x32_bf16 v[184:187], a[216:219], a[36:39], v[184:187]
    buffer_load_dwordx4 a[104:107], v1, s[8:11], s77 offen offset:1024 sc1
    v_mfma_f32_16x16x32_bf16 v[188:191], a[216:219], a[44:47], v[188:191]
    v_lshlrev_b32 v30, 16, v19
    v_and_b32 v31, 0xffff0000, v19
    v_mfma_f32_16x16x32_bf16 v[188:191], a[212:215], a[40:43], v[188:191]
    s_waitcnt lgkmcnt(6)
    v_lshlrev_b32 v32, 16, v20
    v_and_b32 v33, 0xffff0000, v20
    v_mfma_f32_16x16x32_bf16 v[192:195], a[220:223], a[32:35], v[192:195]
    ds_read_b128 a[212:215], v254 offset:27648
    ds_read_b128 a[216:219], v254 offset:37888
    v_mfma_f32_16x16x32_bf16 v[192:195], a[224:227], a[36:39], v[192:195]
    s_add_u32 s77, s45, 10240
    buffer_load_dwordx4 a[108:111], v1, s[8:11], s77 offen offset:0 sc1
    v_mfma_f32_16x16x32_bf16 v[196:199], a[224:227], a[44:47], v[196:199]
    v_lshlrev_b32 v34, 16, v21
    v_and_b32 v35, 0xffff0000, v21
    v_mfma_f32_16x16x32_bf16 v[196:199], a[220:223], a[40:43], v[196:199]
    s_waitcnt lgkmcnt(6)
    v_lshlrev_b32 v36, 16, v22
    v_and_b32 v37, 0xffff0000, v22
    v_mfma_f32_16x16x32_bf16 v[200:203], a[228:231], a[32:35], v[200:203]
    ds_read_b128 a[220:223], v254 offset:28672
    ds_read_b128 a[224:227], v254 offset:38912
    v_mfma_f32_16x16x32_bf16 v[200:203], a[232:235], a[36:39], v[200:203]
    buffer_load_dwordx4 a[112:115], v1, s[8:11], s77 offen offset:1024 sc1
    v_mfma_f32_16x16x32_bf16 v[204:207], a[232:235], a[44:47], v[204:207]
    v_lshlrev_b32 v38, 16, v23
    v_and_b32 v39, 0xffff0000, v23
    v_mfma_f32_16x16x32_bf16 v[204:207], a[228:231], a[40:43], v[204:207]
    s_waitcnt lgkmcnt(6)
    v_add_f32 v152, v152, v24
    v_add_f32 v153, v153, v25
    v_mfma_f32_16x16x32_bf16 v[208:211], a[196:199], a[32:35], v[208:211]
    s_add_u32 m0, s30, 20480
    ds_read_b128 a[228:231], v254 offset:29696
    ds_read_b128 a[232:235], v254 offset:39936
    v_mfma_f32_16x16x32_bf16 v[208:211], a[200:203], a[36:39], v[208:211]
    s_add_u32 s76, s70, 491520
    buffer_load_dwordx4 v1, s[24:27], s76 offen offset:0 sc1 lds
    v_mfma_f32_16x16x32_bf16 v[212:215], a[200:203], a[44:47], v[212:215]
    v_add_f32 v154, v154, v26
    v_add_f32 v155, v155, v27
    v_mfma_f32_16x16x32_bf16 v[212:215], a[196:199], a[40:43], v[212:215]
    s_waitcnt vmcnt(35) lgkmcnt(6)
    s_barrier
    v_add_f32 v160, v160, v28
    v_mfma_f32_16x16x32_bf16 v[216:219], a[204:207], a[32:35], v[216:219]
    ds_read_b128 a[196:199], v1 offset:40960
    ds_read_b128 a[200:203], v1 offset:51200
    v_mfma_f32_16x16x32_bf16 v[216:219], a[208:211], a[36:39], v[216:219]
    s_add_u32 s76, s71, 490496
    buffer_load_dwordx4 v1, s[24:27], s76 offen offset:1024 sc1 lds
    v_mfma_f32_16x16x32_bf16 v[220:223], a[208:211], a[44:47], v[220:223]
    v_add_f32 v161, v161, v29
    v_add_f32 v162, v162, v30
    v_mfma_f32_16x16x32_bf16 v[220:223], a[204:207], a[40:43], v[220:223]
    s_waitcnt lgkmcnt(6)
    v_add_f32 v163, v163, v31
    v_add_f32 v156, v156, v24
    v_mfma_f32_16x16x32_bf16 v[224:227], a[212:215], a[32:35], v[224:227]
    ds_read_b128 a[204:207], v1 offset:41984
    ds_read_b128 a[208:211], v1 offset:52224
    v_mfma_f32_16x16x32_bf16 v[224:227], a[216:219], a[36:39], v[224:227]
    s_add_u32 s76, s72, 489472
    buffer_load_dwordx4 v1, s[24:27], s76 offen offset:2048 sc1 lds
    v_mfma_f32_16x16x32_bf16 v[228:231], a[216:219], a[44:47], v[228:231]
    v_add_f32 v157, v157, v25
    v_add_f32 v158, v158, v26
    v_mfma_f32_16x16x32_bf16 v[228:231], a[212:215], a[40:43], v[228:231]
    s_waitcnt lgkmcnt(6)
    v_add_f32 v159, v159, v27
    v_add_f32 v164, v164, v28
    v_mfma_f32_16x16x32_bf16 v[232:235], a[220:223], a[32:35], v[232:235]
    ds_read_b128 a[212:215], v1 offset:43008
    ds_read_b128 a[216:219], v1 offset:53248
    v_mfma_f32_16x16x32_bf16 v[232:235], a[224:227], a[36:39], v[232:235]
    s_add_u32 s76, s73, 488448
    buffer_load_dwordx4 v1, s[24:27], s76 offen offset:3072 sc1 lds
    v_mfma_f32_16x16x32_bf16 v[236:239], a[224:227], a[44:47], v[236:239]
    v_add_f32 v165, v165, v29
    v_add_f32 v166, v166, v30
    v_mfma_f32_16x16x32_bf16 v[236:239], a[220:223], a[40:43], v[236:239]
    s_waitcnt lgkmcnt(6)
    v_add_f32 v167, v167, v31
    v_add_f32 v88, v88, v32
    v_mfma_f32_16x16x32_bf16 v[240:243], a[228:231], a[32:35], v[240:243]
    s_add_u32 m0, s30, 24576
    ds_read_b128 a[220:223], v1 offset:44032
    ds_read_b128 a[224:227], v1 offset:54272
    v_mfma_f32_16x16x32_bf16 v[240:243], a[232:235], a[36:39], v[240:243]
    s_add_u32 s76, s74, 491520
    buffer_load_dwordx4 v1, s[24:27], s76 offen offset:0 sc1 lds
    v_mfma_f32_16x16x32_bf16 v[244:247], a[232:235], a[44:47], v[244:247]
    v_add_f32 v89, v89, v33
    v_add_f32 v90, v90, v34
    v_mfma_f32_16x16x32_bf16 v[244:247], a[228:231], a[40:43], v[244:247]
    s_waitcnt vmcnt(27) lgkmcnt(6)
    v_add_f32 v91, v91, v35
    v_add_f32 v96, v96, v36
    v_mfma_f32_16x16x32_bf16 v[168:171], a[196:199], a[48:51], v[168:171]
    s_add_u32 m0, s30, 61440
    ds_read_b128 a[228:231], v1 offset:45056
    ds_read_b128 a[232:235], v1 offset:55296
    v_mfma_f32_16x16x32_bf16 v[168:171], a[200:203], a[52:55], v[168:171]
    s_add_u32 s76, s70, 573440
    buffer_load_dwordx4 v1, s[24:27], s76 offen offset:0 sc1 lds
    v_mfma_f32_16x16x32_bf16 v[172:175], a[200:203], a[60:63], v[172:175]
    v_add_f32 v97, v97, v37
    v_add_f32 v98, v98, v38
    v_mfma_f32_16x16x32_bf16 v[172:175], a[196:199], a[56:59], v[172:175]
    s_waitcnt lgkmcnt(6)
    v_add_f32 v99, v99, v39
    v_add_f32 v92, v92, v32
    v_mfma_f32_16x16x32_bf16 v[176:179], a[204:207], a[48:51], v[176:179]
    ds_read_b128 a[196:199], v1 offset:46080
    ds_read_b128 a[200:203], v1 offset:56320
    v_mfma_f32_16x16x32_bf16 v[176:179], a[208:211], a[52:55], v[176:179]
    s_add_u32 s76, s71, 572416
    buffer_load_dwordx4 v1, s[24:27], s76 offen offset:1024 sc1 lds
    v_mfma_f32_16x16x32_bf16 v[180:183], a[208:211], a[60:63], v[180:183]
    v_add_f32 v93, v93, v33
    v_add_f32 v94, v94, v34
    v_mfma_f32_16x16x32_bf16 v[180:183], a[204:207], a[56:59], v[180:183]
    s_waitcnt lgkmcnt(6)
    v_add_f32 v95, v95, v35
    v_add_f32 v100, v100, v36
    v_mfma_f32_16x16x32_bf16 v[184:187], a[212:215], a[48:51], v[184:187]
    ds_read_b128 a[204:207], v1 offset:47104
    ds_read_b128 a[208:211], v1 offset:57344
    v_mfma_f32_16x16x32_bf16 v[184:187], a[216:219], a[52:55], v[184:187]
    s_add_u32 s76, s72, 571392
    buffer_load_dwordx4 v1, s[24:27], s76 offen offset:2048 sc1 lds
    v_mfma_f32_16x16x32_bf16 v[188:191], a[216:219], a[60:63], v[188:191]
    v_add_f32 v101, v101, v37
    v_add_f32 v102, v102, v38
    v_mfma_f32_16x16x32_bf16 v[188:191], a[212:215], a[56:59], v[188:191]
    s_waitcnt lgkmcnt(6)
    v_add_f32 v103, v103, v39
    v_mul_f32 v88, v88, v8
    v_mfma_f32_16x16x32_bf16 v[192:195], a[220:223], a[48:51], v[192:195]
    ds_read_b128 a[212:215], v1 offset:48128
    ds_read_b128 a[216:219], v1 offset:58368
    v_mfma_f32_16x16x32_bf16 v[192:195], a[224:227], a[52:55], v[192:195]
    s_add_u32 s76, s73, 570368
    buffer_load_dwordx4 v1, s[24:27], s76 offen offset:3072 sc1 lds
    v_mfma_f32_16x16x32_bf16 v[196:199], a[224:227], a[60:63], v[196:199]
    v_mul_f32 v89, v89, v8
    v_mul_f32 v90, v90, v8
    v_mfma_f32_16x16x32_bf16 v[196:199], a[220:223], a[56:59], v[196:199]
    s_waitcnt lgkmcnt(6)
    v_mul_f32 v91, v91, v8
    v_mul_f32 v92, v92, v9
    v_mfma_f32_16x16x32_bf16 v[200:203], a[228:231], a[48:51], v[200:203]
    s_add_u32 m0, s30, 65536
    ds_read_b128 a[220:223], v1 offset:49152
    ds_read_b128 a[224:227], v1 offset:59392
    v_mfma_f32_16x16x32_bf16 v[200:203], a[232:235], a[52:55], v[200:203]
    s_add_u32 s76, s74, 573440
    buffer_load_dwordx4 v1, s[24:27], s76 offen offset:0 sc1 lds
    v_mfma_f32_16x16x32_bf16 v[204:207], a[232:235], a[60:63], v[204:207]
    v_mul_f32 v93, v93, v9
    v_mul_f32 v94, v94, v9
    v_mfma_f32_16x16x32_bf16 v[204:207], a[228:231], a[56:59], v[204:207]
    s_waitcnt lgkmcnt(6)
    v_mul_f32 v95, v95, v9
    v_mul_f32 v96, v96, v8
    v_mfma_f32_16x16x32_bf16 v[208:211], a[196:199], a[48:51], v[208:211]
    ds_read_b128 a[228:231], v1 offset:50176
    ds_read_b128 a[232:235], v1 offset:60416
    v_mfma_f32_16x16x32_bf16 v[208:211], a[200:203], a[52:55], v[208:211]
    s_add_u32 s77, s44, 12288
    buffer_load_dwordx4 a[116:119], v1, s[8:11], s77 offen offset:0 sc1
    v_mfma_f32_16x16x32_bf16 v[212:215], a[200:203], a[60:63], v[212:215]
    v_mul_f32 v97, v97, v8
    v_mul_f32 v98, v98, v8
    v_mfma_f32_16x16x32_bf16 v[212:215], a[196:199], a[56:59], v[212:215]
    s_waitcnt lgkmcnt(6)
    v_mul_f32 v99, v99, v8
    v_mul_f32 v100, v100, v9
    v_mfma_f32_16x16x32_bf16 v[216:219], a[204:207], a[48:51], v[216:219]
    ds_read_b128 a[196:199], v253 offset:40960
    ds_read_b128 a[200:203], v253 offset:51200
    v_mfma_f32_16x16x32_bf16 v[216:219], a[208:211], a[52:55], v[216:219]
    buffer_load_dwordx4 a[120:123], v1, s[8:11], s77 offen offset:1024 sc1
    v_mfma_f32_16x16x32_bf16 v[220:223], a[208:211], a[60:63], v[220:223]
    v_mul_f32 v101, v101, v9
    v_mul_f32 v102, v102, v9
    v_mfma_f32_16x16x32_bf16 v[220:223], a[204:207], a[56:59], v[220:223]
    s_waitcnt lgkmcnt(6)
    v_mul_f32 v103, v103, v9
    v_mul_f32 v104, v104, v8
    v_mfma_f32_16x16x32_bf16 v[224:227], a[212:215], a[48:51], v[224:227]
pad23:
    s_cbranch_execz hopret1
    ds_read_b128 a[204:207], v253 offset:41984
    ds_read_b128 a[208:211], v253 offset:52224
    v_mfma_f32_16x16x32_bf16 v[224:227], a[216:219], a[52:55], v[224:227]
    s_add_u32 s77, s45, 12288
    buffer_load_dwordx4 a[124:127], v1, s[8:11], s77 offen offset:0 sc1
    v_mfma_f32_16x16x32_bf16 v[228:231], a[216:219], a[60:63], v[228:231]
    v_mul_f32 v105, v105, v8
    v_mul_f32 v106, v106, v8
    v_mfma_f32_16x16x32_bf16 v[228:231], a[212:215], a[56:59], v[228:231]
    s_waitcnt lgkmcnt(6)
    v_mul_f32 v107, v107, v8
    v_mul_f32 v108, v108, v9
    v_mfma_f32_16x16x32_bf16 v[232:235], a[220:223], a[48:51], v[232:235]
    ds_read_b128 a[212:215], v253 offset:43008
    ds_read_b128 a[216:219], v253 offset:53248
    v_mfma_f32_16x16x32_bf16 v[232:235], a[224:227], a[52:55], v[232:235]
    buffer_load_dwordx4 a[128:131], v1, s[8:11], s77 offen offset:1024 sc1
    v_mfma_f32_16x16x32_bf16 v[236:239], a[224:227], a[60:63], v[236:239]
    v_mul_f32 v109, v109, v9
    v_mul_f32 v110, v110, v9
    v_mfma_f32_16x16x32_bf16 v[236:239], a[220:223], a[56:59], v[236:239]
    s_waitcnt lgkmcnt(6)
    v_mul_f32 v111, v111, v9
    v_mul_f32 v112, v112, v8
    v_mfma_f32_16x16x32_bf16 v[240:243], a[228:231], a[48:51], v[240:243]
    ds_read_b128 a[220:223], v253 offset:44032
    ds_read_b128 a[224:227], v253 offset:54272
    v_mfma_f32_16x16x32_bf16 v[240:243], a[232:235], a[52:55], v[240:243]
    s_add_u32 s77, s44, 14336
    buffer_load_dwordx4 a[132:135], v1, s[8:11], s77 offen offset:0 sc1
    v_mfma_f32_16x16x32_bf16 v[244:247], a[232:235], a[60:63], v[244:247]
    v_mul_f32 v113, v113, v8
    v_mul_f32 v114, v114, v8
    v_mfma_f32_16x16x32_bf16 v[244:247], a[228:231], a[56:59], v[244:247]
    s_waitcnt vmcnt(33) lgkmcnt(6)
    v_mul_f32 v115, v115, v8
    v_mul_f32 v116, v116, v9
    v_mfma_f32_16x16x32_bf16 v[168:171], a[196:199], a[64:67], v[168:171]
    ds_read_b128 a[228:231], v253 offset:45056
    ds_read_b128 a[232:235], v253 offset:55296
    v_mfma_f32_16x16x32_bf16 v[168:171], a[200:203], a[68:71], v[168:171]
    buffer_load_dwordx4 a[136:139], v1, s[8:11], s77 offen offset:1024 sc1
    v_mfma_f32_16x16x32_bf16 v[172:175], a[200:203], a[76:79], v[172:175]
    v_mul_f32 v117, v117, v9
    v_mul_f32 v118, v118, v9
    v_mfma_f32_16x16x32_bf16 v[172:175], a[196:199], a[72:75], v[172:175]
    s_waitcnt lgkmcnt(6)
    v_mul_f32 v119, v119, v9
    v_mul_f32 v120, v120, v8
    v_mfma_f32_16x16x32_bf16 v[176:179], a[204:207], a[64:67], v[176:179]
    ds_read_b128 a[196:199], v253 offset:46080
    ds_read_b128 a[200:203], v253 offset:56320
    v_mfma_f32_16x16x32_bf16 v[176:179], a[208:211], a[68:71], v[176:179]
    s_add_u32 s77, s45, 14336
    buffer_load_dwordx4 a[140:143], v1, s[8:11], s77 offen offset:0 sc1
    v_mfma_f32_16x16x32_bf16 v[180:183], a[208:211], a[76:79], v[180:183]
    v_mul_f32 v121, v121, v8
    v_mul_f32 v122, v122, v8
    v_mfma_f32_16x16x32_bf16 v[180:183], a[204:207], a[72:75], v[180:183]
    s_waitcnt lgkmcnt(6)
    v_mul_f32 v123, v123, v8
    v_mul_f32 v124, v124, v9
    v_mfma_f32_16x16x32_bf16 v[184:187], a[212:215], a[64:67], v[184:187]
    ds_read_b128 a[204:207], v253 offset:47104
    ds_read_b128 a[208:211], v253 offset:57344
    v_mfma_f32_16x16x32_bf16 v[184:187], a[216:219], a[68:71], v[184:187]
    buffer_load_dwordx4 a[144:147], v1, s[8:11], s77 offen offset:1024 sc1
    v_mfma_f32_16x16x32_bf16 v[188:191], a[216:219], a[76:79], v[188:191]
    v_mul_f32 v125, v125, v9
    v_mul_f32 v126, v126, v9
    v_mfma_f32_16x16x32_bf16 v[188:191], a[212:215], a[72:75], v[188:191]
    s_waitcnt lgkmcnt(6)
    v_mul_f32 v127, v127, v9
    v_mul_f32 v128, v128, v8
    v_mfma_f32_16x16x32_bf16 v[192:195], a[220:223], a[64:67], v[192:195]
    s_add_u32 m0, s30, 81920
    ds_read_b128 a[212:215], v253 offset:48128
    ds_read_b128 a[216:219], v253 offset:58368
    v_mfma_f32_16x16x32_bf16 v[192:195], a[224:227], a[68:71], v[192:195]
    s_add_u32 s76, s70, 655360
    buffer_load_dwordx4 v1, s[24:27], s76 offen offset:0 sc1 lds
    v_mfma_f32_16x16x32_bf16 v[196:199], a[224:227], a[76:79], v[196:199]
    v_mul_f32 v129, v129, v8
    v_mul_f32 v130, v130, v8
    v_mfma_f32_16x16x32_bf16 v[196:199], a[220:223], a[72:75], v[196:199]
    s_waitcnt lgkmcnt(6)
    v_mul_f32 v131, v131, v8
    v_mul_f32 v132, v132, v9
    v_mfma_f32_16x16x32_bf16 v[200:203], a[228:231], a[64:67], v[200:203]
    ds_read_b128 a[220:223], v253 offset:49152
    ds_read_b128 a[224:227], v253 offset:59392
    v_mfma_f32_16x16x32_bf16 v[200:203], a[232:235], a[68:71], v[200:203]
    s_add_u32 s76, s71, 654336
    buffer_load_dwordx4 v1, s[24:27], s76 offen offset:1024 sc1 lds
    v_mfma_f32_16x16x32_bf16 v[204:207], a[232:235], a[76:79], v[204:207]
    v_mul_f32 v133, v133, v9
    v_mul_f32 v134, v134, v9
    v_mfma_f32_16x16x32_bf16 v[204:207], a[228:231], a[72:75], v[204:207]
    s_waitcnt lgkmcnt(6)
    v_mul_f32 v135, v135, v9
    v_mul_f32 v136, v136, v8
    v_mfma_f32_16x16x32_bf16 v[208:211], a[196:199], a[64:67], v[208:211]
    ds_read_b128 a[228:231], v253 offset:50176
    ds_read_b128 a[232:235], v253 offset:60416
    v_mfma_f32_16x16x32_bf16 v[208:211], a[200:203], a[68:71], v[208:211]
    s_add_u32 s76, s72, 653312
    buffer_load_dwordx4 v1, s[24:27], s76 offen offset:2048 sc1 lds
    v_mfma_f32_16x16x32_bf16 v[212:215], a[200:203], a[76:79], v[212:215]
    v_mul_f32 v137, v137, v8
    v_mul_f32 v138, v138, v8
    v_mfma_f32_16x16x32_bf16 v[212:215], a[196:199], a[72:75], v[212:215]
    s_waitcnt vmcnt(29) lgkmcnt(6)
    s_barrier
    v_mul_f32 v139, v139, v8
    v_mfma_f32_16x16x32_bf16 v[216:219], a[204:207], a[64:67], v[216:219]
    ds_read_b128 a[196:199], v254 offset:0
    ds_read_b128 a[200:203], v254 offset:10240
    v_mfma_f32_16x16x32_bf16 v[216:219], a[208:211], a[68:71], v[216:219]
    s_add_u32 s76, s73, 652288
    buffer_load_dwordx4 v1, s[24:27], s76 offen offset:3072 sc1 lds
    v_mfma_f32_16x16x32_bf16 v[220:223], a[208:211], a[76:79], v[220:223]
    v_mul_f32 v140, v140, v9
    v_mul_f32 v141, v141, v9
    v_mfma_f32_16x16x32_bf16 v[220:223], a[204:207], a[72:75], v[220:223]
    s_waitcnt lgkmcnt(6)
    v_mul_f32 v142, v142, v9
    v_mul_f32 v143, v143, v9
    v_mfma_f32_16x16x32_bf16 v[224:227], a[212:215], a[64:67], v[224:227]
    s_add_u32 m0, s30, 86016
    ds_read_b128 a[204:207], v254 offset:1024
    ds_read_b128 a[208:211], v254 offset:11264
    v_mfma_f32_16x16x32_bf16 v[224:227], a[216:219], a[68:71], v[224:227]
    s_add_u32 s76, s74, 655360
    buffer_load_dwordx4 v1, s[24:27], s76 offen offset:0 sc1 lds
    v_mfma_f32_16x16x32_bf16 v[228:231], a[216:219], a[76:79], v[228:231]
    v_mul_f32 v144, v144, v8
    v_mul_f32 v145, v145, v8
    v_mfma_f32_16x16x32_bf16 v[228:231], a[212:215], a[72:75], v[228:231]
    s_waitcnt lgkmcnt(6)
    v_mul_f32 v146, v146, v8
    v_mul_f32 v147, v147, v8
    v_mfma_f32_16x16x32_bf16 v[232:235], a[220:223], a[64:67], v[232:235]
    s_add_u32 m0, s30, 143360
    ds_read_b128 a[212:215], v254 offset:2048
    ds_read_b128 a[216:219], v254 offset:12288
    v_mfma_f32_16x16x32_bf16 v[232:235], a[224:227], a[68:71], v[232:235]
    s_add_u32 s76, s70, 737280
    buffer_load_dwordx4 v1, s[24:27], s76 offen offset:0 sc1 lds
    v_mfma_f32_16x16x32_bf16 v[236:239], a[224:227], a[76:79], v[236:239]
    v_mul_f32 v148, v148, v9
    v_mul_f32 v149, v149, v9
    v_mfma_f32_16x16x32_bf16 v[236:239], a[220:223], a[72:75], v[236:239]
    s_waitcnt lgkmcnt(6)
    v_mul_f32 v150, v150, v9
    v_mul_f32 v151, v151, v9
    v_mfma_f32_16x16x32_bf16 v[240:243], a[228:231], a[64:67], v[240:243]
    ds_read_b128 a[220:223], v254 offset:3072
    ds_read_b128 a[224:227], v254 offset:13312
    v_mfma_f32_16x16x32_bf16 v[240:243], a[232:235], a[68:71], v[240:243]
    s_add_u32 s76, s71, 736256
    buffer_load_dwordx4 v1, s[24:27], s76 offen offset:1024 sc1 lds
    v_mfma_f32_16x16x32_bf16 v[244:247], a[232:235], a[76:79], v[244:247]
    v_mul_f32 v152, v152, v8
    v_mul_f32 v153, v153, v8
    v_mfma_f32_16x16x32_bf16 v[244:247], a[228:231], a[72:75], v[244:247]
    s_waitcnt vmcnt(29) lgkmcnt(6)
    v_mul_f32 v154, v154, v8
    v_mul_f32 v155, v155, v8
    v_mfma_f32_16x16x32_bf16 v[168:171], a[196:199], a[80:83], v[168:171]
    ds_read_b128 a[228:231], v254 offset:4096
    ds_read_b128 a[232:235], v254 offset:14336
    v_mfma_f32_16x16x32_bf16 v[168:171], a[200:203], a[84:87], v[168:171]
    s_add_u32 s76, s72, 735232
    buffer_load_dwordx4 v1, s[24:27], s76 offen offset:2048 sc1 lds
    v_mfma_f32_16x16x32_bf16 v[172:175], a[200:203], a[92:95], v[172:175]
    v_mul_f32 v156, v156, v9
    v_mul_f32 v157, v157, v9
    v_mfma_f32_16x16x32_bf16 v[172:175], a[196:199], a[88:91], v[172:175]
    s_waitcnt lgkmcnt(6)
    v_mul_f32 v158, v158, v9
    v_mul_f32 v159, v159, v9
    v_mfma_f32_16x16x32_bf16 v[176:179], a[204:207], a[80:83], v[176:179]
    ds_read_b128 a[196:199], v254 offset:5120
    ds_read_b128 a[200:203], v254 offset:15360
    v_mfma_f32_16x16x32_bf16 v[176:179], a[208:211], a[84:87], v[176:179]
    s_add_u32 s76, s73, 734208
    buffer_load_dwordx4 v1, s[24:27], s76 offen offset:3072 sc1 lds
    v_mfma_f32_16x16x32_bf16 v[180:183], a[208:211], a[92:95], v[180:183]
    v_mul_f32 v160, v160, v8
    v_mul_f32 v161, v161, v8
    v_mfma_f32_16x16x32_bf16 v[180:183], a[204:207], a[88:91], v[180:183]
    s_waitcnt lgkmcnt(6)
    v_mul_f32 v162, v162, v8
    v_mul_f32 v163, v163, v8
    v_mfma_f32_16x16x32_bf16 v[184:187], a[212:215], a[80:83], v[184:187]
    s_add_u32 m0, s30, 147456
    ds_read_b128 a[204:207], v254 offset:6144
    ds_read_b128 a[208:211], v254 offset:16384
    v_mfma_f32_16x16x32_bf16 v[184:187], a[216:219], a[84:87], v[184:187]
    s_add_u32 s76, s74, 737280
    buffer_load_dwordx4 v1, s[24:27], s76 offen offset:0 sc1 lds
    v_mfma_f32_16x16x32_bf16 v[188:191], a[216:219], a[92:95], v[188:191]
    v_mul_f32 v164, v164, v9
    v_mul_f32 v165, v165, v9
    v_mfma_f32_16x16x32_bf16 v[188:191], a[212:215], a[88:91], v[188:191]
    s_waitcnt lgkmcnt(6)
    v_mul_f32 v166, v166, v9
    v_mul_f32 v167, v167, v9
    v_mfma_f32_16x16x32_bf16 v[192:195], a[220:223], a[80:83], v[192:195]
    ds_read_b128 a[212:215], v254 offset:7168
    ds_read_b128 a[216:219], v254 offset:17408
    v_mfma_f32_16x16x32_bf16 v[192:195], a[224:227], a[84:87], v[192:195]
    s_add_u32 s77, s44, 16384
    buffer_load_dwordx4 a[148:151], v1, s[8:11], s77 offen offset:0 sc1
    v_mfma_f32_16x16x32_bf16 v[196:199], a[224:227], a[92:95], v[196:199]
    v_mfma_f32_16x16x32_bf16 v[196:199], a[220:223], a[88:91], v[196:199]
    s_waitcnt lgkmcnt(6)
    v_mfma_f32_16x16x32_bf16 v[200:203], a[228:231], a[80:83], v[200:203]
    ds_read_b128 a[220:223], v254 offset:8192
    ds_read_b128 a[224:227], v254 offset:18432
    v_mfma_f32_16x16x32_bf16 v[200:203], a[232:235], a[84:87], v[200:203]
    buffer_load_dwordx4 a[152:155], v1, s[8:11], s77 offen offset:1024 sc1
    v_mfma_f32_16x16x32_bf16 v[204:207], a[232:235], a[92:95], v[204:207]
    v_mfma_f32_16x16x32_bf16 v[204:207], a[228:231], a[88:91], v[204:207]
    s_waitcnt lgkmcnt(6)
    v_mfma_f32_16x16x32_bf16 v[208:211], a[196:199], a[80:83], v[208:211]
    ds_read_b128 a[228:231], v254 offset:9216
    ds_read_b128 a[232:235], v254 offset:19456
    v_mfma_f32_16x16x32_bf16 v[208:211], a[200:203], a[84:87], v[208:211]
    s_add_u32 s77, s45, 16384
    buffer_load_dwordx4 a[156:159], v1, s[8:11], s77 offen offset:0 sc1
    v_mfma_f32_16x16x32_bf16 v[212:215], a[200:203], a[92:95], v[212:215]
    v_mfma_f32_16x16x32_bf16 v[212:215], a[196:199], a[88:91], v[212:215]
    s_waitcnt lgkmcnt(6)
    v_mfma_f32_16x16x32_bf16 v[216:219], a[204:207], a[80:83], v[216:219]
    ds_read_b128 a[196:199], v1 offset:0
    ds_read_b128 a[200:203], v1 offset:10240
    v_mfma_f32_16x16x32_bf16 v[216:219], a[208:211], a[84:87], v[216:219]
    buffer_load_dwordx4 a[160:163], v1, s[8:11], s77 offen offset:1024 sc1
    v_mfma_f32_16x16x32_bf16 v[220:223], a[208:211], a[92:95], v[220:223]
    v_mfma_f32_16x16x32_bf16 v[220:223], a[204:207], a[88:91], v[220:223]
    s_waitcnt lgkmcnt(6)
    v_mfma_f32_16x16x32_bf16 v[224:227], a[212:215], a[80:83], v[224:227]
    ds_read_b128 a[204:207], v1 offset:1024
    ds_read_b128 a[208:211], v1 offset:11264
    v_mfma_f32_16x16x32_bf16 v[224:227], a[216:219], a[84:87], v[224:227]
    s_add_u32 s77, s44, 18432
    buffer_load_dwordx4 a[164:167], v1, s[8:11], s77 offen offset:0 sc1
    v_mfma_f32_16x16x32_bf16 v[228:231], a[216:219], a[92:95], v[228:231]
    v_mfma_f32_16x16x32_bf16 v[228:231], a[212:215], a[88:91], v[228:231]
    s_waitcnt lgkmcnt(6)
    v_mfma_f32_16x16x32_bf16 v[232:235], a[220:223], a[80:83], v[232:235]
    ds_read_b128 a[212:215], v1 offset:2048
    ds_read_b128 a[216:219], v1 offset:12288
    v_mfma_f32_16x16x32_bf16 v[232:235], a[224:227], a[84:87], v[232:235]
    buffer_load_dwordx4 a[168:171], v1, s[8:11], s77 offen offset:1024 sc1
    v_mfma_f32_16x16x32_bf16 v[236:239], a[224:227], a[92:95], v[236:239]
    v_mfma_f32_16x16x32_bf16 v[236:239], a[220:223], a[88:91], v[236:239]
    s_waitcnt lgkmcnt(6)
    v_mfma_f32_16x16x32_bf16 v[240:243], a[228:231], a[80:83], v[240:243]
    ds_read_b128 a[220:223], v1 offset:3072
    ds_read_b128 a[224:227], v1 offset:13312
    v_mfma_f32_16x16x32_bf16 v[240:243], a[232:235], a[84:87], v[240:243]
    s_add_u32 s77, s45, 18432
    buffer_load_dwordx4 a[172:175], v1, s[8:11], s77 offen offset:0 sc1
    v_mfma_f32_16x16x32_bf16 v[244:247], a[232:235], a[92:95], v[244:247]
    v_mfma_f32_16x16x32_bf16 v[244:247], a[228:231], a[88:91], v[244:247]
    s_waitcnt vmcnt(35) lgkmcnt(6)
    v_mfma_f32_16x16x32_bf16 v[168:171], a[196:199], a[100:103], v[168:171]
    ds_read_b128 a[228:231], v1 offset:4096
    ds_read_b128 a[232:235], v1 offset:14336
    v_mfma_f32_16x16x32_bf16 v[168:171], a[200:203], a[104:107], v[168:171]
    buffer_load_dwordx4 a[176:179], v1, s[8:11], s77 offen offset:1024 sc1
    v_mfma_f32_16x16x32_bf16 v[172:175], a[200:203], a[112:115], v[172:175]
    v_mfma_f32_16x16x32_bf16 v[172:175], a[196:199], a[108:111], v[172:175]
    s_waitcnt lgkmcnt(6)
    v_mfma_f32_16x16x32_bf16 v[176:179], a[204:207], a[100:103], v[176:179]
    s_add_u32 m0, s30, 40960
    ds_read_b128 a[196:199], v1 offset:5120
    ds_read_b128 a[200:203], v1 offset:15360
    v_mfma_f32_16x16x32_bf16 v[176:179], a[208:211], a[104:107], v[176:179]
    s_add_u32 s76, s70, 819200
    buffer_load_dwordx4 v1, s[24:27], s76 offen offset:0 sc1 lds
    v_mfma_f32_16x16x32_bf16 v[180:183], a[208:211], a[112:115], v[180:183]
    v_mfma_f32_16x16x32_bf16 v[180:183], a[204:207], a[108:111], v[180:183]
    s_waitcnt lgkmcnt(6)
    v_mfma_f32_16x16x32_bf16 v[184:187], a[212:215], a[100:103], v[184:187]
    ds_read_b128 a[204:207], v1 offset:6144
    ds_read_b128 a[208:211], v1 offset:16384
    v_mfma_f32_16x16x32_bf16 v[184:187], a[216:219], a[104:107], v[184:187]
    s_add_u32 s76, s71, 818176
    buffer_load_dwordx4 v1, s[24:27], s76 offen offset:1024 sc1 lds
    v_mfma_f32_16x16x32_bf16 v[188:191], a[216:219], a[112:115], v[188:191]
    v_mfma_f32_16x16x32_bf16 v[188:191], a[212:215], a[108:111], v[188:191]
    s_waitcnt lgkmcnt(6)
    v_mfma_f32_16x16x32_bf16 v[192:195], a[220:223], a[100:103], v[192:195]
    ds_read_b128 a[212:215], v1 offset:7168
    ds_read_b128 a[216:219], v1 offset:17408
    v_mfma_f32_16x16x32_bf16 v[192:195], a[224:227], a[104:107], v[192:195]
    s_add_u32 s76, s72, 817152
    buffer_load_dwordx4 v1, s[24:27], s76 offen offset:2048 sc1 lds
    v_mfma_f32_16x16x32_bf16 v[196:199], a[224:227], a[112:115], v[196:199]
    v_mfma_f32_16x16x32_bf16 v[196:199], a[220:223], a[108:111], v[196:199]
    s_waitcnt lgkmcnt(6)
    v_mfma_f32_16x16x32_bf16 v[200:203], a[228:231], a[100:103], v[200:203]
    ds_read_b128 a[220:223], v1 offset:8192
    ds_read_b128 a[224:227], v1 offset:18432
    v_mfma_f32_16x16x32_bf16 v[200:203], a[232:235], a[104:107], v[200:203]
    s_add_u32 s76, s73, 816128
    buffer_load_dwordx4 v1, s[24:27], s76 offen offset:3072 sc1 lds
    v_mfma_f32_16x16x32_bf16 v[204:207], a[232:235], a[112:115], v[204:207]
    v_mfma_f32_16x16x32_bf16 v[204:207], a[228:231], a[108:111], v[204:207]
    s_waitcnt lgkmcnt(6)
    v_mfma_f32_16x16x32_bf16 v[208:211], a[196:199], a[100:103], v[208:211]
    s_add_u32 m0, s30, 45056
    ds_read_b128 a[228:231], v1 offset:9216
    ds_read_b128 a[232:235], v1 offset:19456
    v_mfma_f32_16x16x32_bf16 v[208:211], a[200:203], a[104:107], v[208:211]
    s_add_u32 s76, s74, 819200
    buffer_load_dwordx4 v1, s[24:27], s76 offen offset:0 sc1 lds
    v_mfma_f32_16x16x32_bf16 v[212:215], a[200:203], a[112:115], v[212:215]
    v_mfma_f32_16x16x32_bf16 v[212:215], a[196:199], a[108:111], v[212:215]
    s_waitcnt vmcnt(31) lgkmcnt(6)
    s_barrier
    v_mfma_f32_16x16x32_bf16 v[216:219], a[204:207], a[100:103], v[216:219]
    s_add_u32 m0, s30, 102400
    ds_read_b128 a[196:199], v1 offset:20480
    ds_read_b128 a[200:203], v1 offset:30720
    v_mfma_f32_16x16x32_bf16 v[216:219], a[208:211], a[104:107], v[216:219]
    s_add_u32 s76, s70, 901120
    buffer_load_dwordx4 v1, s[24:27], s76 offen offset:0 sc1 lds
    v_mfma_f32_16x16x32_bf16 v[220:223], a[208:211], a[112:115], v[220:223]
    v_mfma_f32_16x16x32_bf16 v[220:223], a[204:207], a[108:111], v[220:223]
    s_waitcnt lgkmcnt(6)
    v_mfma_f32_16x16x32_bf16 v[224:227], a[212:215], a[100:103], v[224:227]
    ds_read_b128 a[204:207], v1 offset:21504
    ds_read_b128 a[208:211], v1 offset:31744
    v_mfma_f32_16x16x32_bf16 v[224:227], a[216:219], a[104:107], v[224:227]
    s_add_u32 s76, s71, 900096
    buffer_load_dwordx4 v1, s[24:27], s76 offen offset:1024 sc1 lds
    v_mfma_f32_16x16x32_bf16 v[228:231], a[216:219], a[112:115], v[228:231]
    v_mfma_f32_16x16x32_bf16 v[228:231], a[212:215], a[108:111], v[228:231]
    s_waitcnt lgkmcnt(6)
    v_mfma_f32_16x16x32_bf16 v[232:235], a[220:223], a[100:103], v[232:235]
    ds_read_b128 a[212:215], v1 offset:22528
    ds_read_b128 a[216:219], v1 offset:32768
    v_mfma_f32_16x16x32_bf16 v[232:235], a[224:227], a[104:107], v[232:235]
    s_add_u32 s76, s72, 899072
    buffer_load_dwordx4 v1, s[24:27], s76 offen offset:2048 sc1 lds
    v_mfma_f32_16x16x32_bf16 v[236:239], a[224:227], a[112:115], v[236:239]
    v_mfma_f32_16x16x32_bf16 v[236:239], a[220:223], a[108:111], v[236:239]
    s_waitcnt lgkmcnt(6)
    v_mfma_f32_16x16x32_bf16 v[240:243], a[228:231], a[100:103], v[240:243]
    ds_read_b128 a[220:223], v1 offset:23552
    ds_read_b128 a[224:227], v1 offset:33792
    v_mfma_f32_16x16x32_bf16 v[240:243], a[232:235], a[104:107], v[240:243]
    s_add_u32 s76, s73, 898048
    buffer_load_dwordx4 v1, s[24:27], s76 offen offset:3072 sc1 lds
    v_mfma_f32_16x16x32_bf16 v[244:247], a[232:235], a[112:115], v[244:247]
    v_mfma_f32_16x16x32_bf16 v[244:247], a[228:231], a[108:111], v[244:247]
    s_waitcnt vmcnt(31) lgkmcnt(6)
    v_mfma_f32_16x16x32_bf16 v[168:171], a[196:199], a[116:119], v[168:171]
    s_add_u32 m0, s30, 106496
    ds_read_b128 a[228:231], v1 offset:24576
    ds_read_b128 a[232:235], v1 offset:34816
    v_mfma_f32_16x16x32_bf16 v[168:171], a[200:203], a[120:123], v[168:171]
    s_add_u32 s76, s74, 901120
    buffer_load_dwordx4 v1, s[24:27], s76 offen offset:0 sc1 lds
    v_mfma_f32_16x16x32_bf16 v[172:175], a[200:203], a[128:131], v[172:175]
    v_mfma_f32_16x16x32_bf16 v[172:175], a[196:199], a[124:127], v[172:175]
    s_waitcnt lgkmcnt(6)
    v_mfma_f32_16x16x32_bf16 v[176:179], a[204:207], a[116:119], v[176:179]
    ds_read_b128 a[196:199], v1 offset:25600
    ds_read_b128 a[200:203], v1 offset:35840
    v_mfma_f32_16x16x32_bf16 v[176:179], a[208:211], a[120:123], v[176:179]
    s_add_u32 s77, s44, 20480
    buffer_load_dwordx4 a[180:183], v1, s[8:11], s77 offen offset:0 sc1
    v_mfma_f32_16x16x32_bf16 v[180:183], a[208:211], a[128:131], v[180:183]
    v_mfma_f32_16x16x32_bf16 v[180:183], a[204:207], a[124:127], v[180:183]
    s_waitcnt lgkmcnt(6)
    v_mfma_f32_16x16x32_bf16 v[184:187], a[212:215], a[116:119], v[184:187]
    ds_read_b128 a[204:207], v1 offset:26624
    ds_read_b128 a[208:211], v1 offset:36864
    v_mfma_f32_16x16x32_bf16 v[184:187], a[216:219], a[120:123], v[184:187]
    buffer_load_dwordx4 a[184:187], v1, s[8:11], s77 offen offset:1024 sc1
    v_mfma_f32_16x16x32_bf16 v[188:191], a[216:219], a[128:131], v[188:191]
    v_mfma_f32_16x16x32_bf16 v[188:191], a[212:215], a[124:127], v[188:191]
    s_waitcnt lgkmcnt(6)
    v_mfma_f32_16x16x32_bf16 v[192:195], a[220:223], a[116:119], v[192:195]
    ds_read_b128 a[212:215], v1 offset:27648
    ds_read_b128 a[216:219], v1 offset:37888
    v_mfma_f32_16x16x32_bf16 v[192:195], a[224:227], a[120:123], v[192:195]
    s_add_u32 s77, s45, 20480
    buffer_load_dwordx4 a[188:191], v1, s[8:11], s77 offen offset:0 sc1
    v_mfma_f32_16x16x32_bf16 v[196:199], a[224:227], a[128:131], v[196:199]
    v_mfma_f32_16x16x32_bf16 v[196:199], a[220:223], a[124:127], v[196:199]
    s_waitcnt lgkmcnt(6)
    v_mfma_f32_16x16x32_bf16 v[200:203], a[228:231], a[116:119], v[200:203]
    ds_read_b128 a[220:223], v1 offset:28672
    ds_read_b128 a[224:227], v1 offset:38912
    v_mfma_f32_16x16x32_bf16 v[200:203], a[232:235], a[120:123], v[200:203]
    buffer_load_dwordx4 a[192:195], v1, s[8:11], s77 offen offset:1024 sc1
    v_mfma_f32_16x16x32_bf16 v[204:207], a[232:235], a[128:131], v[204:207]
    v_mfma_f32_16x16x32_bf16 v[204:207], a[228:231], a[124:127], v[204:207]
    s_waitcnt lgkmcnt(6)
    v_mfma_f32_16x16x32_bf16 v[208:211], a[196:199], a[116:119], v[208:211]
    ds_read_b128 a[228:231], v1 offset:29696
    ds_read_b128 a[232:235], v1 offset:39936
    v_mfma_f32_16x16x32_bf16 v[208:211], a[200:203], a[120:123], v[208:211]
    s_add_u32 s77, s44, 22528
    buffer_load_dwordx4 a[0:3], v1, s[8:11], s77 offen offset:0 sc1
    v_mfma_f32_16x16x32_bf16 v[212:215], a[200:203], a[128:131], v[212:215]
    v_mfma_f32_16x16x32_bf16 v[212:215], a[196:199], a[124:127], v[212:215]
    s_waitcnt lgkmcnt(6)
    v_mfma_f32_16x16x32_bf16 v[216:219], a[204:207], a[116:119], v[216:219]
    ds_read_b128 a[196:199], v253 offset:0
    ds_read_b128 a[200:203], v253 offset:10240
    v_mfma_f32_16x16x32_bf16 v[216:219], a[208:211], a[120:123], v[216:219]
    buffer_load_dwordx4 a[4:7], v1, s[8:11], s77 offen offset:1024 sc1
    v_mfma_f32_16x16x32_bf16 v[220:223], a[208:211], a[128:131], v[220:223]
    v_mfma_f32_16x16x32_bf16 v[220:223], a[204:207], a[124:127], v[220:223]
    s_waitcnt lgkmcnt(6)
    v_mfma_f32_16x16x32_bf16 v[224:227], a[212:215], a[116:119], v[224:227]
    ds_read_b128 a[204:207], v253 offset:1024
    ds_read_b128 a[208:211], v253 offset:11264
    v_mfma_f32_16x16x32_bf16 v[224:227], a[216:219], a[120:123], v[224:227]
    s_add_u32 s77, s45, 22528
    buffer_load_dwordx4 a[8:11], v1, s[8:11], s77 offen offset:0 sc1
    v_mfma_f32_16x16x32_bf16 v[228:231], a[216:219], a[128:131], v[228:231]
    v_mfma_f32_16x16x32_bf16 v[228:231], a[212:215], a[124:127], v[228:231]
    s_waitcnt lgkmcnt(6)
    v_mfma_f32_16x16x32_bf16 v[232:235], a[220:223], a[116:119], v[232:235]
    ds_read_b128 a[212:215], v253 offset:2048
    ds_read_b128 a[216:219], v253 offset:12288
    v_mfma_f32_16x16x32_bf16 v[232:235], a[224:227], a[120:123], v[232:235]
    buffer_load_dwordx4 a[12:15], v1, s[8:11], s77 offen offset:1024 sc1
    v_mfma_f32_16x16x32_bf16 v[236:239], a[224:227], a[128:131], v[236:239]
    v_mfma_f32_16x16x32_bf16 v[236:239], a[220:223], a[124:127], v[236:239]
    s_waitcnt lgkmcnt(6)
    v_mfma_f32_16x16x32_bf16 v[240:243], a[228:231], a[116:119], v[240:243]
    s_add_u32 m0, s30, 122880
    ds_read_b128 a[220:223], v253 offset:3072
    ds_read_b128 a[224:227], v253 offset:13312
    v_mfma_f32_16x16x32_bf16 v[240:243], a[232:235], a[120:123], v[240:243]
    s_add_u32 s76, s70, 983040
    buffer_load_dwordx4 v1, s[24:27], s76 offen offset:0 sc1 lds
    v_mfma_f32_16x16x32_bf16 v[244:247], a[232:235], a[128:131], v[244:247]
    v_mfma_f32_16x16x32_bf16 v[244:247], a[228:231], a[124:127], v[244:247]
    s_waitcnt vmcnt(37) lgkmcnt(6)
    v_mfma_f32_16x16x32_bf16 v[168:171], a[196:199], a[132:135], v[168:171]
    ds_read_b128 a[228:231], v253 offset:4096
    ds_read_b128 a[232:235], v253 offset:14336
    v_mfma_f32_16x16x32_bf16 v[168:171], a[200:203], a[136:139], v[168:171]
    s_add_u32 s76, s71, 982016
    buffer_load_dwordx4 v1, s[24:27], s76 offen offset:1024 sc1 lds
    v_mfma_f32_16x16x32_bf16 v[172:175], a[200:203], a[144:147], v[172:175]
    v_mfma_f32_16x16x32_bf16 v[172:175], a[196:199], a[140:143], v[172:175]
    s_waitcnt lgkmcnt(6)
    v_mfma_f32_16x16x32_bf16 v[176:179], a[204:207], a[132:135], v[176:179]
    ds_read_b128 a[196:199], v253 offset:5120
    ds_read_b128 a[200:203], v253 offset:15360
    v_mfma_f32_16x16x32_bf16 v[176:179], a[208:211], a[136:139], v[176:179]
    s_add_u32 s76, s72, 980992
    buffer_load_dwordx4 v1, s[24:27], s76 offen offset:2048 sc1 lds
    v_mfma_f32_16x16x32_bf16 v[180:183], a[208:211], a[144:147], v[180:183]
    v_mfma_f32_16x16x32_bf16 v[180:183], a[204:207], a[140:143], v[180:183]
    s_waitcnt lgkmcnt(6)
    v_mfma_f32_16x16x32_bf16 v[184:187], a[212:215], a[132:135], v[184:187]
    ds_read_b128 a[204:207], v253 offset:6144
    ds_read_b128 a[208:211], v253 offset:16384
    v_mfma_f32_16x16x32_bf16 v[184:187], a[216:219], a[136:139], v[184:187]
    s_add_u32 s76, s73, 979968
    buffer_load_dwordx4 v1, s[24:27], s76 offen offset:3072 sc1 lds
    v_mfma_f32_16x16x32_bf16 v[188:191], a[216:219], a[144:147], v[188:191]
    v_mfma_f32_16x16x32_bf16 v[188:191], a[212:215], a[140:143], v[188:191]
    s_waitcnt lgkmcnt(6)
    v_mfma_f32_16x16x32_bf16 v[192:195], a[220:223], a[132:135], v[192:195]
    s_add_u32 m0, s30, 126976
    ds_read_b128 a[212:215], v253 offset:7168
    ds_read_b128 a[216:219], v253 offset:17408
    v_mfma_f32_16x16x32_bf16 v[192:195], a[224:227], a[136:139], v[192:195]
    s_add_u32 s76, s74, 983040
    buffer_load_dwordx4 v1, s[24:27], s76 offen offset:0 sc1 lds
    v_mfma_f32_16x16x32_bf16 v[196:199], a[224:227], a[144:147], v[196:199]
    v_mfma_f32_16x16x32_bf16 v[196:199], a[220:223], a[140:143], v[196:199]
    s_waitcnt lgkmcnt(6)
    v_mfma_f32_16x16x32_bf16 v[200:203], a[228:231], a[132:135], v[200:203]
    ds_read_b128 a[220:223], v253 offset:8192
    ds_read_b128 a[224:227], v253 offset:18432
    v_mfma_f32_16x16x32_bf16 v[200:203], a[232:235], a[136:139], v[200:203]
    s_add_u32 s77, s44, 24576
    buffer_load_dwordx4 a[16:19], v1, s[8:11], s77 offen offset:0 sc1
    v_mfma_f32_16x16x32_bf16 v[204:207], a[232:235], a[144:147], v[204:207]
    v_mfma_f32_16x16x32_bf16 v[204:207], a[228:231], a[140:143], v[204:207]
    s_waitcnt lgkmcnt(6)
    v_mfma_f32_16x16x32_bf16 v[208:211], a[196:199], a[132:135], v[208:211]
    ds_read_b128 a[228:231], v253 offset:9216
    ds_read_b128 a[232:235], v253 offset:19456
    v_mfma_f32_16x16x32_bf16 v[208:211], a[200:203], a[136:139], v[208:211]
    buffer_load_dwordx4 a[20:23], v1, s[8:11], s77 offen offset:1024 sc1
    v_mfma_f32_16x16x32_bf16 v[212:215], a[200:203], a[144:147], v[212:215]
    v_mfma_f32_16x16x32_bf16 v[212:215], a[196:199], a[140:143], v[212:215]
    s_waitcnt vmcnt(33) lgkmcnt(6)
    s_barrier
    v_mfma_f32_16x16x32_bf16 v[216:219], a[204:207], a[132:135], v[216:219]
    ds_read_b128 a[196:199], v253 offset:20480
    ds_read_b128 a[200:203], v253 offset:30720
    v_mfma_f32_16x16x32_bf16 v[216:219], a[208:211], a[136:139], v[216:219]
    s_add_u32 s77, s45, 24576
    buffer_load_dwordx4 a[24:27], v1, s[8:11], s77 offen offset:0 sc1
    v_mfma_f32_16x16x32_bf16 v[220:223], a[208:211], a[144:147], v[220:223]
    v_mfma_f32_16x16x32_bf16 v[220:223], a[204:207], a[140:143], v[220:223]
    s_waitcnt lgkmcnt(6)
    v_mfma_f32_16x16x32_bf16 v[224:227], a[212:215], a[132:135], v[224:227]
    ds_read_b128 a[204:207], v253 offset:21504
    ds_read_b128 a[208:211], v253 offset:31744
    v_mfma_f32_16x16x32_bf16 v[224:227], a[216:219], a[136:139], v[224:227]
    buffer_load_dwordx4 a[28:31], v1, s[8:11], s77 offen offset:1024 sc1
    v_mfma_f32_16x16x32_bf16 v[228:231], a[216:219], a[144:147], v[228:231]
    v_mfma_f32_16x16x32_bf16 v[228:231], a[212:215], a[140:143], v[228:231]
    s_waitcnt lgkmcnt(6)
    v_mfma_f32_16x16x32_bf16 v[232:235], a[220:223], a[132:135], v[232:235]
    s_add_u32 m0, s30, 0
    ds_read_b128 a[212:215], v253 offset:22528
    ds_read_b128 a[216:219], v253 offset:32768
    v_mfma_f32_16x16x32_bf16 v[232:235], a[224:227], a[136:139], v[232:235]
    s_add_u32 s76, s70, 1064960
    buffer_load_dwordx4 v1, s[24:27], s76 offen offset:0 sc1 lds
    v_mfma_f32_16x16x32_bf16 v[236:239], a[224:227], a[144:147], v[236:239]
    v_mfma_f32_16x16x32_bf16 v[236:239], a[220:223], a[140:143], v[236:239]
    s_waitcnt lgkmcnt(6)
    v_mfma_f32_16x16x32_bf16 v[240:243], a[228:231], a[132:135], v[240:243]
    ds_read_b128 a[220:223], v253 offset:23552
    ds_read_b128 a[224:227], v253 offset:33792
    v_mfma_f32_16x16x32_bf16 v[240:243], a[232:235], a[136:139], v[240:243]
    s_add_u32 s76, s71, 1063936
    buffer_load_dwordx4 v1, s[24:27], s76 offen offset:1024 sc1 lds
    v_mfma_f32_16x16x32_bf16 v[244:247], a[232:235], a[144:147], v[244:247]
    v_mfma_f32_16x16x32_bf16 v[244:247], a[228:231], a[140:143], v[244:247]
    s_waitcnt vmcnt(33) lgkmcnt(6)
    v_mfma_f32_16x16x32_bf16 v[168:171], a[196:199], a[148:151], v[168:171]
    ds_read_b128 a[228:231], v253 offset:24576
    ds_read_b128 a[232:235], v253 offset:34816
    v_mfma_f32_16x16x32_bf16 v[168:171], a[200:203], a[152:155], v[168:171]
    s_add_u32 s76, s72, 1062912
    buffer_load_dwordx4 v1, s[24:27], s76 offen offset:2048 sc1 lds
    v_mfma_f32_16x16x32_bf16 v[172:175], a[200:203], a[160:163], v[172:175]
    v_mfma_f32_16x16x32_bf16 v[172:175], a[196:199], a[156:159], v[172:175]
    s_waitcnt lgkmcnt(6)
    v_mfma_f32_16x16x32_bf16 v[176:179], a[204:207], a[148:151], v[176:179]
    ds_read_b128 a[196:199], v253 offset:25600
    ds_read_b128 a[200:203], v253 offset:35840
    v_mfma_f32_16x16x32_bf16 v[176:179], a[208:211], a[152:155], v[176:179]
    s_add_u32 s76, s73, 1061888
    buffer_load_dwordx4 v1, s[24:27], s76 offen offset:3072 sc1 lds
    v_mfma_f32_16x16x32_bf16 v[180:183], a[208:211], a[160:163], v[180:183]
    v_mfma_f32_16x16x32_bf16 v[180:183], a[204:207], a[156:159], v[180:183]
    s_waitcnt lgkmcnt(6)
    v_mfma_f32_16x16x32_bf16 v[184:187], a[212:215], a[148:151], v[184:187]
    s_add_u32 m0, s30, 4096
    ds_read_b128 a[204:207], v253 offset:26624
    ds_read_b128 a[208:211], v253 offset:36864
    v_mfma_f32_16x16x32_bf16 v[184:187], a[216:219], a[152:155], v[184:187]
    s_add_u32 s76, s74, 1064960
    buffer_load_dwordx4 v1, s[24:27], s76 offen offset:0 sc1 lds
    v_mfma_f32_16x16x32_bf16 v[188:191], a[216:219], a[160:163], v[188:191]
    v_mfma_f32_16x16x32_bf16 v[188:191], a[212:215], a[156:159], v[188:191]
    s_waitcnt lgkmcnt(6)
    v_mfma_f32_16x16x32_bf16 v[192:195], a[220:223], a[148:151], v[192:195]
    s_add_u32 m0, s30, 20480
    ds_read_b128 a[212:215], v253 offset:27648
    ds_read_b128 a[216:219], v253 offset:37888
    v_mfma_f32_16x16x32_bf16 v[192:195], a[224:227], a[152:155], v[192:195]
pad24:
    s_cbranch_execz hopret1
    s_add_u32 s76, s70, 1146880
    buffer_load_dwordx4 v1, s[24:27], s76 offen offset:0 sc1 lds
    v_mfma_f32_16x16x32_bf16 v[196:199], a[224:227], a[160:163], v[196:199]
    v_mfma_f32_16x16x32_bf16 v[196:199], a[220:223], a[156:159], v[196:199]
    s_waitcnt lgkmcnt(6)
    v_mfma_f32_16x16x32_bf16 v[200:203], a[228:231], a[148:151], v[200:203]
    ds_read_b128 a[220:223], v254 offset:20480
    ds_read_b128 a[224:227], v254 offset:30720
    v_mfma_f32_16x16x32_bf16 v[200:203], a[232:235], a[152:155], v[200:203]
    s_add_u32 s76, s71, 1145856
    buffer_load_dwordx4 v1, s[24:27], s76 offen offset:1024 sc1 lds
    v_mfma_f32_16x16x32_bf16 v[204:207], a[232:235], a[160:163], v[204:207]
    v_mfma_f32_16x16x32_bf16 v[204:207], a[228:231], a[156:159], v[204:207]
    s_waitcnt lgkmcnt(6)
    v_mfma_f32_16x16x32_bf16 v[208:211], a[196:199], a[148:151], v[208:211]
    ds_read_b128 a[228:231], v254 offset:21504
    ds_read_b128 a[232:235], v254 offset:31744
    v_mfma_f32_16x16x32_bf16 v[208:211], a[200:203], a[152:155], v[208:211]
    s_add_u32 s76, s72, 1144832
    buffer_load_dwordx4 v1, s[24:27], s76 offen offset:2048 sc1 lds
    v_mfma_f32_16x16x32_bf16 v[212:215], a[200:203], a[160:163], v[212:215]
    v_mfma_f32_16x16x32_bf16 v[212:215], a[196:199], a[156:159], v[212:215]
    s_waitcnt lgkmcnt(6)
    v_mfma_f32_16x16x32_bf16 v[216:219], a[204:207], a[148:151], v[216:219]
    ds_read_b128 a[196:199], v254 offset:22528
    ds_read_b128 a[200:203], v254 offset:32768
    v_mfma_f32_16x16x32_bf16 v[216:219], a[208:211], a[152:155], v[216:219]
    s_add_u32 s76, s73, 1143808
    buffer_load_dwordx4 v1, s[24:27], s76 offen offset:3072 sc1 lds
    v_mfma_f32_16x16x32_bf16 v[220:223], a[208:211], a[160:163], v[220:223]
    v_mfma_f32_16x16x32_bf16 v[220:223], a[204:207], a[156:159], v[220:223]
    s_waitcnt lgkmcnt(6)
    v_mfma_f32_16x16x32_bf16 v[224:227], a[212:215], a[148:151], v[224:227]
    s_add_u32 m0, s30, 24576
    ds_read_b128 a[204:207], v254 offset:23552
    ds_read_b128 a[208:211], v254 offset:33792
    v_mfma_f32_16x16x32_bf16 v[224:227], a[216:219], a[152:155], v[224:227]
    s_add_u32 s76, s74, 1146880
    buffer_load_dwordx4 v1, s[24:27], s76 offen offset:0 sc1 lds
    v_mfma_f32_16x16x32_bf16 v[228:231], a[216:219], a[160:163], v[228:231]
    v_mfma_f32_16x16x32_bf16 v[228:231], a[212:215], a[156:159], v[228:231]
    s_waitcnt vmcnt(37) lgkmcnt(6)
    v_mfma_f32_16x16x32_bf16 v[168:171], a[220:223], a[164:167], v[168:171]
    ds_read_b128 a[212:215], v254 offset:24576
    ds_read_b128 a[216:219], v254 offset:34816
    v_mfma_f32_16x16x32_bf16 v[168:171], a[224:227], a[168:171], v[168:171]
    s_add_u32 s77, s44, 26624
    buffer_load_dwordx4 a[32:35], v1, s[8:11], s77 offen offset:0 sc1
    v_mfma_f32_16x16x32_bf16 v[172:175], a[224:227], a[176:179], v[172:175]
    v_mfma_f32_16x16x32_bf16 v[172:175], a[220:223], a[172:175], v[172:175]
    s_waitcnt lgkmcnt(6)
    v_mfma_f32_16x16x32_bf16 v[176:179], a[228:231], a[164:167], v[176:179]
    ds_read_b128 a[220:223], v254 offset:25600
    ds_read_b128 a[224:227], v254 offset:35840
    v_mfma_f32_16x16x32_bf16 v[176:179], a[232:235], a[168:171], v[176:179]
    buffer_load_dwordx4 a[36:39], v1, s[8:11], s77 offen offset:1024 sc1
    v_mfma_f32_16x16x32_bf16 v[180:183], a[232:235], a[176:179], v[180:183]
    v_mfma_f32_16x16x32_bf16 v[180:183], a[228:231], a[172:175], v[180:183]
    s_waitcnt lgkmcnt(6)
    v_mfma_f32_16x16x32_bf16 v[184:187], a[196:199], a[164:167], v[184:187]
    ds_read_b128 a[228:231], v254 offset:26624
    ds_read_b128 a[232:235], v254 offset:36864
    v_mfma_f32_16x16x32_bf16 v[184:187], a[200:203], a[168:171], v[184:187]
    s_add_u32 s77, s45, 26624
    buffer_load_dwordx4 a[40:43], v1, s[8:11], s77 offen offset:0 sc1
    v_mfma_f32_16x16x32_bf16 v[188:191], a[200:203], a[176:179], v[188:191]
    v_mfma_f32_16x16x32_bf16 v[188:191], a[196:199], a[172:175], v[188:191]
    s_waitcnt lgkmcnt(6)
    v_mfma_f32_16x16x32_bf16 v[192:195], a[204:207], a[164:167], v[192:195]
    ds_read_b128 a[196:199], v254 offset:27648
    ds_read_b128 a[200:203], v254 offset:37888
    v_mfma_f32_16x16x32_bf16 v[192:195], a[208:211], a[168:171], v[192:195]
    buffer_load_dwordx4 a[44:47], v1, s[8:11], s77 offen offset:1024 sc1
    v_mfma_f32_16x16x32_bf16 v[196:199], a[208:211], a[176:179], v[196:199]
    v_mfma_f32_16x16x32_bf16 v[196:199], a[204:207], a[172:175], v[196:199]
    s_waitcnt vmcnt(31) lgkmcnt(6)
    s_barrier
    v_mfma_f32_16x16x32_bf16 v[200:203], a[212:215], a[164:167], v[200:203]
    s_add_u32 m0, s30, 61440
    ds_read_b128 a[204:207], v1 offset:40960
    ds_read_b128 a[208:211], v1 offset:51200
    v_mfma_f32_16x16x32_bf16 v[200:203], a[216:219], a[168:171], v[200:203]
    s_add_u32 s76, s70, 1228800
    buffer_load_dwordx4 v1, s[24:27], s76 offen offset:0 sc1 lds
    v_mfma_f32_16x16x32_bf16 v[204:207], a[216:219], a[176:179], v[204:207]
    v_mfma_f32_16x16x32_bf16 v[204:207], a[212:215], a[172:175], v[204:207]
    s_waitcnt lgkmcnt(6)
    v_mfma_f32_16x16x32_bf16 v[208:211], a[220:223], a[164:167], v[208:211]
    ds_read_b128 a[212:215], v1 offset:41984
    ds_read_b128 a[216:219], v1 offset:52224
    v_mfma_f32_16x16x32_bf16 v[208:211], a[224:227], a[168:171], v[208:211]
    s_add_u32 s76, s71, 1227776
    buffer_load_dwordx4 v1, s[24:27], s76 offen offset:1024 sc1 lds
    v_mfma_f32_16x16x32_bf16 v[212:215], a[224:227], a[176:179], v[212:215]
    v_mfma_f32_16x16x32_bf16 v[212:215], a[220:223], a[172:175], v[212:215]
    s_waitcnt lgkmcnt(6)
    v_mfma_f32_16x16x32_bf16 v[216:219], a[228:231], a[164:167], v[216:219]
    ds_read_b128 a[220:223], v1 offset:43008
    ds_read_b128 a[224:227], v1 offset:53248
    v_mfma_f32_16x16x32_bf16 v[216:219], a[232:235], a[168:171], v[216:219]
    s_add_u32 s76, s72, 1226752
    buffer_load_dwordx4 v1, s[24:27], s76 offen offset:2048 sc1 lds
    v_mfma_f32_16x16x32_bf16 v[220:223], a[232:235], a[176:179], v[220:223]
    v_mfma_f32_16x16x32_bf16 v[220:223], a[228:231], a[172:175], v[220:223]
    s_waitcnt lgkmcnt(6)
    v_mfma_f32_16x16x32_bf16 v[224:227], a[196:199], a[164:167], v[224:227]
    ds_read_b128 a[228:231], v1 offset:44032
    ds_read_b128 a[232:235], v1 offset:54272
    v_mfma_f32_16x16x32_bf16 v[224:227], a[200:203], a[168:171], v[224:227]
    s_add_u32 s76, s73, 1225728
    buffer_load_dwordx4 v1, s[24:27], s76 offen offset:3072 sc1 lds
    v_mfma_f32_16x16x32_bf16 v[228:231], a[200:203], a[176:179], v[228:231]
    v_mfma_f32_16x16x32_bf16 v[228:231], a[196:199], a[172:175], v[228:231]
    s_waitcnt vmcnt(31) lgkmcnt(6)
    v_mfma_f32_16x16x32_bf16 v[168:171], a[204:207], a[180:183], v[168:171]
    s_add_u32 m0, s30, 65536
    ds_read_b128 a[196:199], v1 offset:45056
    ds_read_b128 a[200:203], v1 offset:55296
    v_mfma_f32_16x16x32_bf16 v[168:171], a[208:211], a[184:187], v[168:171]
    s_add_u32 s76, s74, 1228800
    buffer_load_dwordx4 v1, s[24:27], s76 offen offset:0 sc1 lds
    v_mfma_f32_16x16x32_bf16 v[172:175], a[208:211], a[192:195], v[172:175]
    v_mfma_f32_16x16x32_bf16 v[172:175], a[204:207], a[188:191], v[172:175]
    s_waitcnt lgkmcnt(6)
    v_mfma_f32_16x16x32_bf16 v[176:179], a[212:215], a[180:183], v[176:179]
    ds_read_b128 a[204:207], v1 offset:46080
    ds_read_b128 a[208:211], v1 offset:56320
    v_mfma_f32_16x16x32_bf16 v[176:179], a[216:219], a[184:187], v[176:179]
    s_add_u32 s77, s44, 28672
    buffer_load_dwordx4 a[48:51], v1, s[8:11], s77 offen offset:0 sc1
    v_mfma_f32_16x16x32_bf16 v[180:183], a[216:219], a[192:195], v[180:183]
    v_mfma_f32_16x16x32_bf16 v[180:183], a[212:215], a[188:191], v[180:183]
    s_waitcnt lgkmcnt(6)
    v_mfma_f32_16x16x32_bf16 v[184:187], a[220:223], a[180:183], v[184:187]
    ds_read_b128 a[212:215], v1 offset:47104
    ds_read_b128 a[216:219], v1 offset:57344
    v_mfma_f32_16x16x32_bf16 v[184:187], a[224:227], a[184:187], v[184:187]
    buffer_load_dwordx4 a[52:55], v1, s[8:11], s77 offen offset:1024 sc1
    v_mfma_f32_16x16x32_bf16 v[188:191], a[224:227], a[192:195], v[188:191]
    v_mfma_f32_16x16x32_bf16 v[188:191], a[220:223], a[188:191], v[188:191]
    s_waitcnt lgkmcnt(6)
    v_mfma_f32_16x16x32_bf16 v[192:195], a[228:231], a[180:183], v[192:195]
    ds_read_b128 a[220:223], v1 offset:48128
    ds_read_b128 a[224:227], v1 offset:58368
    v_mfma_f32_16x16x32_bf16 v[192:195], a[232:235], a[184:187], v[192:195]
    s_add_u32 s77, s45, 28672
    buffer_load_dwordx4 a[56:59], v1, s[8:11], s77 offen offset:0 sc1
    v_mfma_f32_16x16x32_bf16 v[196:199], a[232:235], a[192:195], v[196:199]
    v_mfma_f32_16x16x32_bf16 v[196:199], a[228:231], a[188:191], v[196:199]
    s_waitcnt lgkmcnt(6)
    v_mfma_f32_16x16x32_bf16 v[200:203], a[196:199], a[180:183], v[200:203]
    ds_read_b128 a[228:231], v253 offset:40960
    ds_read_b128 a[232:235], v253 offset:51200
    v_mfma_f32_16x16x32_bf16 v[200:203], a[200:203], a[184:187], v[200:203]
    buffer_load_dwordx4 a[60:63], v1, s[8:11], s77 offen offset:1024 sc1
    v_mfma_f32_16x16x32_bf16 v[204:207], a[200:203], a[192:195], v[204:207]
    v_mfma_f32_16x16x32_bf16 v[204:207], a[196:199], a[188:191], v[204:207]
    s_waitcnt lgkmcnt(6)
    v_mfma_f32_16x16x32_bf16 v[208:211], a[204:207], a[180:183], v[208:211]
    ds_read_b128 a[196:199], v253 offset:41984
    ds_read_b128 a[200:203], v253 offset:52224
    v_mfma_f32_16x16x32_bf16 v[208:211], a[208:211], a[184:187], v[208:211]
    s_add_u32 s77, s44, 30720
    buffer_load_dwordx4 a[64:67], v1, s[8:11], s77 offen offset:0 sc1
    v_mfma_f32_16x16x32_bf16 v[212:215], a[208:211], a[192:195], v[212:215]
    v_mfma_f32_16x16x32_bf16 v[212:215], a[204:207], a[188:191], v[212:215]
    s_waitcnt lgkmcnt(6)
    v_mfma_f32_16x16x32_bf16 v[216:219], a[212:215], a[180:183], v[216:219]
    ds_read_b128 a[204:207], v253 offset:43008
    ds_read_b128 a[208:211], v253 offset:53248
    v_mfma_f32_16x16x32_bf16 v[216:219], a[216:219], a[184:187], v[216:219]
    buffer_load_dwordx4 a[68:71], v1, s[8:11], s77 offen offset:1024 sc1
    v_mfma_f32_16x16x32_bf16 v[220:223], a[216:219], a[192:195], v[220:223]
    v_mfma_f32_16x16x32_bf16 v[220:223], a[212:215], a[188:191], v[220:223]
    s_waitcnt lgkmcnt(6)
    v_mfma_f32_16x16x32_bf16 v[224:227], a[220:223], a[180:183], v[224:227]
    ds_read_b128 a[212:215], v253 offset:44032
    ds_read_b128 a[216:219], v253 offset:54272
    v_mfma_f32_16x16x32_bf16 v[224:227], a[224:227], a[184:187], v[224:227]
    s_add_u32 s77, s45, 30720
    buffer_load_dwordx4 a[72:75], v1, s[8:11], s77 offen offset:0 sc1
    v_mfma_f32_16x16x32_bf16 v[228:231], a[224:227], a[192:195], v[228:231]
    v_mfma_f32_16x16x32_bf16 v[228:231], a[220:223], a[188:191], v[228:231]
    s_waitcnt vmcnt(35) lgkmcnt(6)
    v_mfma_f32_16x16x32_bf16 v[168:171], a[228:231], a[0:3], v[168:171]
    ds_read_b128 a[220:223], v253 offset:45056
    ds_read_b128 a[224:227], v253 offset:55296
    v_mfma_f32_16x16x32_bf16 v[168:171], a[232:235], a[4:7], v[168:171]
    buffer_load_dwordx4 a[76:79], v1, s[8:11], s77 offen offset:1024 sc1
    v_mfma_f32_16x16x32_bf16 v[172:175], a[232:235], a[12:15], v[172:175]
    v_mfma_f32_16x16x32_bf16 v[172:175], a[228:231], a[8:11], v[172:175]
    s_waitcnt lgkmcnt(6)
    v_mfma_f32_16x16x32_bf16 v[176:179], a[196:199], a[0:3], v[176:179]
    ds_read_b128 a[228:231], v253 offset:46080
    ds_read_b128 a[232:235], v253 offset:56320
    v_mfma_f32_16x16x32_bf16 v[176:179], a[200:203], a[4:7], v[176:179]
    v_mfma_f32_16x16x32_bf16 v[180:183], a[200:203], a[12:15], v[180:183]
    v_mfma_f32_16x16x32_bf16 v[180:183], a[196:199], a[8:11], v[180:183]
    s_waitcnt lgkmcnt(6)
    v_mfma_f32_16x16x32_bf16 v[184:187], a[204:207], a[0:3], v[184:187]
    ds_read_b128 a[196:199], v253 offset:47104
    ds_read_b128 a[200:203], v253 offset:57344
    v_mfma_f32_16x16x32_bf16 v[184:187], a[208:211], a[4:7], v[184:187]
    v_mfma_f32_16x16x32_bf16 v[188:191], a[208:211], a[12:15], v[188:191]
    v_mfma_f32_16x16x32_bf16 v[188:191], a[204:207], a[8:11], v[188:191]
    s_waitcnt lgkmcnt(6)
    v_mfma_f32_16x16x32_bf16 v[192:195], a[212:215], a[0:3], v[192:195]
    ds_read_b128 a[204:207], v253 offset:48128
    ds_read_b128 a[208:211], v253 offset:58368
    v_mfma_f32_16x16x32_bf16 v[192:195], a[216:219], a[4:7], v[192:195]
    v_mfma_f32_16x16x32_bf16 v[196:199], a[216:219], a[12:15], v[196:199]
    v_mfma_f32_16x16x32_bf16 v[196:199], a[212:215], a[8:11], v[196:199]
    s_waitcnt vmcnt(8) lgkmcnt(6)
    s_barrier
    v_mfma_f32_16x16x32_bf16 v[200:203], a[220:223], a[0:3], v[200:203]
    ds_read_b128 a[212:215], v254 offset:0
    ds_read_b128 a[216:219], v254 offset:10240
    v_mfma_f32_16x16x32_bf16 v[200:203], a[224:227], a[4:7], v[200:203]
    v_mfma_f32_16x16x32_bf16 v[204:207], a[224:227], a[12:15], v[204:207]
    v_mfma_f32_16x16x32_bf16 v[204:207], a[220:223], a[8:11], v[204:207]
    s_waitcnt lgkmcnt(6)
    v_mfma_f32_16x16x32_bf16 v[208:211], a[228:231], a[0:3], v[208:211]
    ds_read_b128 a[220:223], v1 offset:0
    ds_read_b128 a[224:227], v1 offset:10240
    v_mfma_f32_16x16x32_bf16 v[208:211], a[232:235], a[4:7], v[208:211]
    v_mfma_f32_16x16x32_bf16 v[212:215], a[232:235], a[12:15], v[212:215]
    v_mfma_f32_16x16x32_bf16 v[212:215], a[228:231], a[8:11], v[212:215]
    s_waitcnt lgkmcnt(6)
    v_mfma_f32_16x16x32_bf16 v[216:219], a[196:199], a[0:3], v[216:219]
    ds_read_b128 a[228:231], v1 offset:20480
    ds_read_b128 a[232:235], v1 offset:30720
    v_mfma_f32_16x16x32_bf16 v[216:219], a[200:203], a[4:7], v[216:219]
    v_mfma_f32_16x16x32_bf16 v[220:223], a[200:203], a[12:15], v[220:223]
    v_mfma_f32_16x16x32_bf16 v[220:223], a[196:199], a[8:11], v[220:223]
    s_waitcnt lgkmcnt(6)
    v_mfma_f32_16x16x32_bf16 v[224:227], a[204:207], a[0:3], v[224:227]
    ds_read_b128 a[196:199], v253 offset:0
    ds_read_b128 a[200:203], v253 offset:10240
    v_mfma_f32_16x16x32_bf16 v[224:227], a[208:211], a[4:7], v[224:227]
    v_mfma_f32_16x16x32_bf16 v[228:231], a[208:211], a[12:15], v[228:231]
    v_mfma_f32_16x16x32_bf16 v[228:231], a[204:207], a[8:11], v[228:231]
    s_waitcnt vmcnt(27) lgkmcnt(6)
    v_mfma_f32_16x16x32_bf16 v[168:171], a[212:215], a[16:19], v[168:171]
    s_add_u32 s76, s2, s3
    ds_read_b128 a[204:207], v254 offset:1024
    ds_read_b128 a[208:211], v254 offset:11264
    v_mfma_f32_16x16x32_bf16 v[168:171], a[216:219], a[20:23], v[168:171]
    s_mov_b32 s77, 84148224
    v_mfma_f32_16x16x32_bf16 v[172:175], a[216:219], a[28:31], v[172:175]
    s_cmp_eq_u32 s76, 0
    s_cselect_b32 s76, s77, 536870912
    v_mfma_f32_16x16x32_bf16 v[172:175], a[212:215], a[24:27], v[172:175]
    s_waitcnt vmcnt(13) lgkmcnt(6)
    v_mfma_f32_16x16x32_bf16 v[168:171], a[220:223], a[32:35], v[168:171]
    s_add_u32 s77, s19, 10240
    ds_read_b128 a[212:215], v1 offset:1024
    ds_read_b128 a[216:219], v1 offset:11264
    v_mfma_f32_16x16x32_bf16 v[168:171], a[224:227], a[36:39], v[168:171]
    s_add_u32 s78, s19, 20480
    v_mfma_f32_16x16x32_bf16 v[172:175], a[224:227], a[44:47], v[172:175]
    s_add_u32 s79, s19, 30720
    v_mfma_f32_16x16x32_bf16 v[172:175], a[220:223], a[40:43], v[172:175]
    s_waitcnt vmcnt(4) lgkmcnt(6)
    v_mfma_f32_16x16x32_bf16 v[168:171], a[228:231], a[48:51], v[168:171]
    ds_read_b128 a[220:223], v1 offset:21504
    ds_read_b128 a[224:227], v1 offset:31744
    v_mfma_f32_16x16x32_bf16 v[168:171], a[232:235], a[52:55], v[168:171]
    v_mfma_f32_16x16x32_bf16 v[172:175], a[232:235], a[60:63], v[172:175]
    v_mfma_f32_16x16x32_bf16 v[172:175], a[228:231], a[56:59], v[172:175]
    s_waitcnt vmcnt(0) lgkmcnt(6)
    v_mfma_f32_16x16x32_bf16 v[168:171], a[196:199], a[64:67], v[168:171]
    ds_read_b128 a[228:231], v253 offset:1024
    ds_read_b128 a[232:235], v253 offset:11264
    v_mfma_f32_16x16x32_bf16 v[168:171], a[200:203], a[68:71], v[168:171]
    v_mfma_f32_16x16x32_bf16 v[172:175], a[200:203], a[76:79], v[172:175]
    v_mfma_f32_16x16x32_bf16 v[172:175], a[196:199], a[72:75], v[172:175]
    s_waitcnt lgkmcnt(6)
    v_mfma_f32_16x16x32_bf16 v[176:179], a[204:207], a[16:19], v[176:179]
    ds_read_b128 a[196:199], v254 offset:2048
    ds_read_b128 a[200:203], v254 offset:12288
    v_mfma_f32_16x16x32_bf16 v[176:179], a[208:211], a[20:23], v[176:179]
    v_mfma_f32_16x16x32_bf16 v[180:183], a[208:211], a[28:31], v[180:183]
    v_mfma_f32_16x16x32_bf16 v[180:183], a[204:207], a[24:27], v[180:183]
    s_waitcnt lgkmcnt(6)
    v_mfma_f32_16x16x32_bf16 v[176:179], a[212:215], a[32:35], v[176:179]
    ds_read_b128 a[204:207], v1 offset:2048
    ds_read_b128 a[208:211], v1 offset:12288
    v_mfma_f32_16x16x32_bf16 v[176:179], a[216:219], a[36:39], v[176:179]
    v_fma_f32 v168, v168, v248, v88
    v_fma_f32 v169, v169, v248, v89
    v_mfma_f32_16x16x32_bf16 v[180:183], a[216:219], a[44:47], v[180:183]
    v_fma_f32 v170, v170, v248, v90
    v_fma_f32 v171, v171, v248, v91
    v_mfma_f32_16x16x32_bf16 v[180:183], a[212:215], a[40:43], v[180:183]
    s_waitcnt lgkmcnt(6)
    v_cvt_pk_bf16_f32 v168, v168, v169
    v_cvt_pk_bf16_f32 v169, v170, v171
    v_mfma_f32_16x16x32_bf16 v[176:179], a[220:223], a[48:51], v[176:179]
    ds_read_b128 a[212:215], v1 offset:22528
    ds_read_b128 a[216:219], v1 offset:32768
    v_mfma_f32_16x16x32_bf16 v[176:179], a[224:227], a[52:55], v[176:179]
    v_fma_f32 v172, v172, v249, v92
    v_fma_f32 v173, v173, v249, v93
    v_mfma_f32_16x16x32_bf16 v[180:183], a[224:227], a[60:63], v[180:183]
    v_fma_f32 v174, v174, v249, v94
    v_fma_f32 v175, v175, v249, v95
    v_mfma_f32_16x16x32_bf16 v[180:183], a[220:223], a[56:59], v[180:183]
    s_waitcnt lgkmcnt(6)
    v_cvt_pk_bf16_f32 v172, v172, v173
    v_cvt_pk_bf16_f32 v173, v174, v175
    v_mfma_f32_16x16x32_bf16 v[176:179], a[228:231], a[64:67], v[176:179]
    ds_read_b128 a[220:223], v253 offset:2048
    ds_read_b128 a[224:227], v253 offset:12288
    v_mfma_f32_16x16x32_bf16 v[176:179], a[232:235], a[68:71], v[176:179]
    v_mfma_f32_16x16x32_bf16 v[180:183], a[232:235], a[76:79], v[180:183]
    v_mfma_f32_16x16x32_bf16 v[180:183], a[228:231], a[72:75], v[180:183]
    s_waitcnt lgkmcnt(6)
    v_mfma_f32_16x16x32_bf16 v[184:187], a[196:199], a[16:19], v[184:187]
    ds_read_b128 a[228:231], v254 offset:3072
    ds_read_b128 a[232:235], v254 offset:13312
    v_mfma_f32_16x16x32_bf16 v[184:187], a[200:203], a[20:23], v[184:187]
    v_mfma_f32_16x16x32_bf16 v[188:191], a[200:203], a[28:31], v[188:191]
    v_fma_f32 v176, v176, v248, v96
    v_fma_f32 v177, v177, v248, v97
    v_mfma_f32_16x16x32_bf16 v[188:191], a[196:199], a[24:27], v[188:191]
    s_waitcnt lgkmcnt(6)
    v_fma_f32 v178, v178, v248, v98
    v_fma_f32 v179, v179, v248, v99
    v_mfma_f32_16x16x32_bf16 v[184:187], a[204:207], a[32:35], v[184:187]
    ds_read_b128 a[196:199], v1 offset:3072
    ds_read_b128 a[200:203], v1 offset:13312
    v_mfma_f32_16x16x32_bf16 v[184:187], a[208:211], a[36:39], v[184:187]
    v_cvt_pk_bf16_f32 v170, v176, v177
    v_cvt_pk_bf16_f32 v171, v178, v179
    v_mfma_f32_16x16x32_bf16 v[188:191], a[208:211], a[44:47], v[188:191]
    buffer_store_dwordx4 v[168:171], v1, s[8:11], s12 offen offset:0 sc1
    v_mfma_f32_16x16x32_bf16 v[188:191], a[204:207], a[40:43], v[188:191]
    s_waitcnt lgkmcnt(6)
    v_fma_f32 v180, v180, v249, v100
    v_fma_f32 v181, v181, v249, v101
    v_mfma_f32_16x16x32_bf16 v[184:187], a[212:215], a[48:51], v[184:187]
    ds_read_b128 a[204:207], v1 offset:23552
    ds_read_b128 a[208:211], v1 offset:33792
    v_mfma_f32_16x16x32_bf16 v[184:187], a[216:219], a[52:55], v[184:187]
    v_fma_f32 v182, v182, v249, v102
    v_fma_f32 v183, v183, v249, v103
    v_mfma_f32_16x16x32_bf16 v[188:191], a[216:219], a[60:63], v[188:191]
    v_cvt_pk_bf16_f32 v174, v180, v181
    v_cvt_pk_bf16_f32 v175, v182, v183
    v_mfma_f32_16x16x32_bf16 v[188:191], a[212:215], a[56:59], v[188:191]
    s_waitcnt lgkmcnt(6)
    v_mfma_f32_16x16x32_bf16 v[184:187], a[220:223], a[64:67], v[184:187]
    ds_read_b128 a[212:215], v253 offset:3072
    ds_read_b128 a[216:219], v253 offset:13312
    v_mfma_f32_16x16x32_bf16 v[184:187], a[224:227], a[68:71], v[184:187]
    buffer_store_dwordx4 v[172:175], v1, s[8:11], s12 offen offset:1024 sc1
    v_mfma_f32_16x16x32_bf16 v[188:191], a[224:227], a[76:79], v[188:191]
    v_mfma_f32_16x16x32_bf16 v[188:191], a[220:223], a[72:75], v[188:191]
    s_waitcnt lgkmcnt(6)
    v_mfma_f32_16x16x32_bf16 v[192:195], a[228:231], a[16:19], v[192:195]
    ds_read_b128 a[220:223], v254 offset:4096
    ds_read_b128 a[224:227], v254 offset:14336
    v_mfma_f32_16x16x32_bf16 v[192:195], a[232:235], a[20:23], v[192:195]
    v_mfma_f32_16x16x32_bf16 v[196:199], a[232:235], a[28:31], v[196:199]
    v_mfma_f32_16x16x32_bf16 v[196:199], a[228:231], a[24:27], v[196:199]
    s_waitcnt lgkmcnt(6)
    v_mfma_f32_16x16x32_bf16 v[192:195], a[196:199], a[32:35], v[192:195]
    ds_read_b128 a[228:231], v1 offset:4096
    ds_read_b128 a[232:235], v1 offset:14336
    v_mfma_f32_16x16x32_bf16 v[192:195], a[200:203], a[36:39], v[192:195]
    v_fma_f32 v184, v184, v248, v104
    v_fma_f32 v185, v185, v248, v105
    v_mfma_f32_16x16x32_bf16 v[196:199], a[200:203], a[44:47], v[196:199]
    v_fma_f32 v186, v186, v248, v106
    v_fma_f32 v187, v187, v248, v107
    v_mfma_f32_16x16x32_bf16 v[196:199], a[196:199], a[40:43], v[196:199]
    s_waitcnt lgkmcnt(6)
    v_cvt_pk_bf16_f32 v184, v184, v185
    v_cvt_pk_bf16_f32 v185, v186, v187
    v_mfma_f32_16x16x32_bf16 v[192:195], a[204:207], a[48:51], v[192:195]
    ds_read_b128 a[196:199], v1 offset:24576
    ds_read_b128 a[200:203], v1 offset:34816
    v_mfma_f32_16x16x32_bf16 v[192:195], a[208:211], a[52:55], v[192:195]
    v_fma_f32 v188, v188, v249, v108
    v_fma_f32 v189, v189, v249, v109
    v_mfma_f32_16x16x32_bf16 v[196:199], a[208:211], a[60:63], v[196:199]
    v_fma_f32 v190, v190, v249, v110
    v_fma_f32 v191, v191, v249, v111
    v_mfma_f32_16x16x32_bf16 v[196:199], a[204:207], a[56:59], v[196:199]
    s_waitcnt lgkmcnt(6)
    v_cvt_pk_bf16_f32 v188, v188, v189
    v_cvt_pk_bf16_f32 v189, v190, v191
    v_mfma_f32_16x16x32_bf16 v[192:195], a[212:215], a[64:67], v[192:195]
    ds_read_b128 a[204:207], v253 offset:4096
    ds_read_b128 a[208:211], v253 offset:14336
    v_mfma_f32_16x16x32_bf16 v[192:195], a[216:219], a[68:71], v[192:195]
    v_mfma_f32_16x16x32_bf16 v[196:199], a[216:219], a[76:79], v[196:199]
    v_mfma_f32_16x16x32_bf16 v[196:199], a[212:215], a[72:75], v[196:199]
    s_waitcnt lgkmcnt(6)
    v_mfma_f32_16x16x32_bf16 v[200:203], a[220:223], a[16:19], v[200:203]
    ds_read_b128 a[212:215], v254 offset:5120
    ds_read_b128 a[216:219], v254 offset:15360
    v_mfma_f32_16x16x32_bf16 v[200:203], a[224:227], a[20:23], v[200:203]
    v_mfma_f32_16x16x32_bf16 v[204:207], a[224:227], a[28:31], v[204:207]
    v_fma_f32 v192, v192, v248, v112
    v_fma_f32 v193, v193, v248, v113
    v_mfma_f32_16x16x32_bf16 v[204:207], a[220:223], a[24:27], v[204:207]
    s_waitcnt lgkmcnt(6)
    v_fma_f32 v194, v194, v248, v114
    v_fma_f32 v195, v195, v248, v115
    v_mfma_f32_16x16x32_bf16 v[200:203], a[228:231], a[32:35], v[200:203]
    ds_read_b128 a[220:223], v1 offset:5120
    ds_read_b128 a[224:227], v1 offset:15360
    v_mfma_f32_16x16x32_bf16 v[200:203], a[232:235], a[36:39], v[200:203]
    v_cvt_pk_bf16_f32 v186, v192, v193
    v_cvt_pk_bf16_f32 v187, v194, v195
    v_mfma_f32_16x16x32_bf16 v[204:207], a[232:235], a[44:47], v[204:207]
    buffer_store_dwordx4 v[184:187], v1, s[8:11], s13 offen offset:0 sc1
    v_mfma_f32_16x16x32_bf16 v[204:207], a[228:231], a[40:43], v[204:207]
    s_waitcnt lgkmcnt(6)
    v_fma_f32 v196, v196, v249, v116
    v_fma_f32 v197, v197, v249, v117
    v_mfma_f32_16x16x32_bf16 v[200:203], a[196:199], a[48:51], v[200:203]
    ds_read_b128 a[228:231], v1 offset:25600
    ds_read_b128 a[232:235], v1 offset:35840
    v_mfma_f32_16x16x32_bf16 v[200:203], a[200:203], a[52:55], v[200:203]
    v_fma_f32 v198, v198, v249, v118
    v_fma_f32 v199, v199, v249, v119
    v_mfma_f32_16x16x32_bf16 v[204:207], a[200:203], a[60:63], v[204:207]
    v_cvt_pk_bf16_f32 v190, v196, v197
    v_cvt_pk_bf16_f32 v191, v198, v199
    v_mfma_f32_16x16x32_bf16 v[204:207], a[196:199], a[56:59], v[204:207]
    s_waitcnt lgkmcnt(6)
    v_mfma_f32_16x16x32_bf16 v[200:203], a[204:207], a[64:67], v[200:203]
    ds_read_b128 a[196:199], v253 offset:5120
    ds_read_b128 a[200:203], v253 offset:15360
    v_mfma_f32_16x16x32_bf16 v[200:203], a[208:211], a[68:71], v[200:203]
    buffer_store_dwordx4 v[188:191], v1, s[8:11], s13 offen offset:1024 sc1
    v_mfma_f32_16x16x32_bf16 v[204:207], a[208:211], a[76:79], v[204:207]
    v_mfma_f32_16x16x32_bf16 v[204:207], a[204:207], a[72:75], v[204:207]
    s_waitcnt lgkmcnt(6)
    v_mfma_f32_16x16x32_bf16 v[208:211], a[212:215], a[16:19], v[208:211]
    ds_read_b128 a[204:207], v254 offset:6144
    ds_read_b128 a[208:211], v254 offset:16384
    v_mfma_f32_16x16x32_bf16 v[208:211], a[216:219], a[20:23], v[208:211]
    v_mfma_f32_16x16x32_bf16 v[212:215], a[216:219], a[28:31], v[212:215]
    v_mfma_f32_16x16x32_bf16 v[212:215], a[212:215], a[24:27], v[212:215]
    s_waitcnt lgkmcnt(6)
    v_mfma_f32_16x16x32_bf16 v[208:211], a[220:223], a[32:35], v[208:211]
    ds_read_b128 a[212:215], v1 offset:6144
    ds_read_b128 a[216:219], v1 offset:16384
    v_mfma_f32_16x16x32_bf16 v[208:211], a[224:227], a[36:39], v[208:211]
    v_fma_f32 v200, v200, v248, v120
    v_fma_f32 v201, v201, v248, v121
    v_mfma_f32_16x16x32_bf16 v[212:215], a[224:227], a[44:47], v[212:215]
    v_fma_f32 v202, v202, v248, v122
    v_fma_f32 v203, v203, v248, v123
    v_mfma_f32_16x16x32_bf16 v[212:215], a[220:223], a[40:43], v[212:215]
    s_waitcnt lgkmcnt(6)
    v_cvt_pk_bf16_f32 v200, v200, v201
    v_cvt_pk_bf16_f32 v201, v202, v203
    v_mfma_f32_16x16x32_bf16 v[208:211], a[228:231], a[48:51], v[208:211]
    ds_read_b128 a[220:223], v1 offset:26624
    ds_read_b128 a[224:227], v1 offset:36864
    v_mfma_f32_16x16x32_bf16 v[208:211], a[232:235], a[52:55], v[208:211]
    v_fma_f32 v204, v204, v249, v124
    v_fma_f32 v205, v205, v249, v125
    v_mfma_f32_16x16x32_bf16 v[212:215], a[232:235], a[60:63], v[212:215]
    v_fma_f32 v206, v206, v249, v126
    v_fma_f32 v207, v207, v249, v127
    v_mfma_f32_16x16x32_bf16 v[212:215], a[228:231], a[56:59], v[212:215]
    s_waitcnt lgkmcnt(6)
    v_cvt_pk_bf16_f32 v204, v204, v205
    v_cvt_pk_bf16_f32 v205, v206, v207
    v_mfma_f32_16x16x32_bf16 v[208:211], a[196:199], a[64:67], v[208:211]
    ds_read_b128 a[228:231], v253 offset:6144
    ds_read_b128 a[232:235], v253 offset:16384
    v_mfma_f32_16x16x32_bf16 v[208:211], a[200:203], a[68:71], v[208:211]
    v_mfma_f32_16x16x32_bf16 v[212:215], a[200:203], a[76:79], v[212:215]
    v_mfma_f32_16x16x32_bf16 v[212:215], a[196:199], a[72:75], v[212:215]
    s_waitcnt lgkmcnt(6)
    v_mfma_f32_16x16x32_bf16 v[216:219], a[204:207], a[16:19], v[216:219]
    ds_read_b128 a[196:199], v254 offset:7168
    ds_read_b128 a[200:203], v254 offset:17408
    v_mfma_f32_16x16x32_bf16 v[216:219], a[208:211], a[20:23], v[216:219]
    v_mfma_f32_16x16x32_bf16 v[220:223], a[208:211], a[28:31], v[220:223]
    v_fma_f32 v208, v208, v248, v128
    v_fma_f32 v209, v209, v248, v129
    v_mfma_f32_16x16x32_bf16 v[220:223], a[204:207], a[24:27], v[220:223]
    s_waitcnt lgkmcnt(6)
    v_fma_f32 v210, v210, v248, v130
    v_fma_f32 v211, v211, v248, v131
    v_mfma_f32_16x16x32_bf16 v[216:219], a[212:215], a[32:35], v[216:219]
    ds_read_b128 a[204:207], v1 offset:7168
    ds_read_b128 a[208:211], v1 offset:17408
    v_mfma_f32_16x16x32_bf16 v[216:219], a[216:219], a[36:39], v[216:219]
    v_cvt_pk_bf16_f32 v202, v208, v209
    v_cvt_pk_bf16_f32 v203, v210, v211
    v_mfma_f32_16x16x32_bf16 v[220:223], a[216:219], a[44:47], v[220:223]
    buffer_store_dwordx4 v[200:203], v1, s[8:11], s14 offen offset:0 sc1
    v_mfma_f32_16x16x32_bf16 v[220:223], a[212:215], a[40:43], v[220:223]
    s_waitcnt lgkmcnt(6)
    v_fma_f32 v212, v212, v249, v132
    v_fma_f32 v213, v213, v249, v133
    v_mfma_f32_16x16x32_bf16 v[216:219], a[220:223], a[48:51], v[216:219]
    ds_read_b128 a[212:215], v1 offset:27648
    ds_read_b128 a[216:219], v1 offset:37888
    v_mfma_f32_16x16x32_bf16 v[216:219], a[224:227], a[52:55], v[216:219]
    v_fma_f32 v214, v214, v249, v134
    v_fma_f32 v215, v215, v249, v135
    v_mfma_f32_16x16x32_bf16 v[220:223], a[224:227], a[60:63], v[220:223]
    v_cvt_pk_bf16_f32 v206, v212, v213
    v_cvt_pk_bf16_f32 v207, v214, v215
    v_mfma_f32_16x16x32_bf16 v[220:223], a[220:223], a[56:59], v[220:223]
    s_waitcnt lgkmcnt(6)
    v_mfma_f32_16x16x32_bf16 v[216:219], a[228:231], a[64:67], v[216:219]
    ds_read_b128 a[220:223], v253 offset:7168
    ds_read_b128 a[224:227], v253 offset:17408
    v_mfma_f32_16x16x32_bf16 v[216:219], a[232:235], a[68:71], v[216:219]
    buffer_store_dwordx4 v[204:207], v1, s[8:11], s14 offen offset:1024 sc1
    v_mfma_f32_16x16x32_bf16 v[220:223], a[232:235], a[76:79], v[220:223]
    v_mfma_f32_16x16x32_bf16 v[220:223], a[228:231], a[72:75], v[220:223]
    s_waitcnt lgkmcnt(6)
    v_mfma_f32_16x16x32_bf16 v[224:227], a[196:199], a[16:19], v[224:227]
    ds_read_b128 a[228:231], v253 offset:28672
    ds_read_b128 a[232:235], v253 offset:38912
    v_mfma_f32_16x16x32_bf16 v[224:227], a[200:203], a[20:23], v[224:227]
    v_mfma_f32_16x16x32_bf16 v[228:231], a[200:203], a[28:31], v[228:231]
    v_mfma_f32_16x16x32_bf16 v[228:231], a[196:199], a[24:27], v[228:231]
    s_waitcnt lgkmcnt(6)
    v_mfma_f32_16x16x32_bf16 v[224:227], a[204:207], a[32:35], v[224:227]
    ds_read_b128 a[196:199], v254 offset:28672
    ds_read_b128 a[200:203], v254 offset:38912
    v_mfma_f32_16x16x32_bf16 v[224:227], a[208:211], a[36:39], v[224:227]
    v_fma_f32 v216, v216, v248, v136
    v_fma_f32 v217, v217, v248, v137
    v_mfma_f32_16x16x32_bf16 v[228:231], a[208:211], a[44:47], v[228:231]
    v_fma_f32 v218, v218, v248, v138
    v_fma_f32 v219, v219, v248, v139
    v_mfma_f32_16x16x32_bf16 v[228:231], a[204:207], a[40:43], v[228:231]
    s_waitcnt lgkmcnt(6)
    v_cvt_pk_bf16_f32 v216, v216, v217
    v_cvt_pk_bf16_f32 v217, v218, v219
    v_mfma_f32_16x16x32_bf16 v[224:227], a[212:215], a[48:51], v[224:227]
pad25:
    s_cbranch_execz hopret1
    ds_read_b128 a[204:207], v1 offset:49152
    ds_read_b128 a[208:211], v1 offset:59392
    v_mfma_f32_16x16x32_bf16 v[224:227], a[216:219], a[52:55], v[224:227]
    v_fma_f32 v220, v220, v249, v140
    v_fma_f32 v221, v221, v249, v141
    v_mfma_f32_16x16x32_bf16 v[228:231], a[216:219], a[60:63], v[228:231]
    v_fma_f32 v222, v222, v249, v142
    v_fma_f32 v223, v223, v249, v143
    v_mfma_f32_16x16x32_bf16 v[228:231], a[212:215], a[56:59], v[228:231]
    s_waitcnt lgkmcnt(6)
    v_cvt_pk_bf16_f32 v220, v220, v221
    v_cvt_pk_bf16_f32 v221, v222, v223
    v_mfma_f32_16x16x32_bf16 v[224:227], a[220:223], a[64:67], v[224:227]
    ds_read_b128 a[212:215], v253 offset:49152
    ds_read_b128 a[216:219], v253 offset:59392
    v_mfma_f32_16x16x32_bf16 v[224:227], a[224:227], a[68:71], v[224:227]
    v_mfma_f32_16x16x32_bf16 v[228:231], a[224:227], a[76:79], v[228:231]
    v_mfma_f32_16x16x32_bf16 v[228:231], a[220:223], a[72:75], v[228:231]
    s_waitcnt lgkmcnt(6)
    v_mfma_f32_16x16x32_bf16 v[232:235], a[228:231], a[148:151], v[232:235]
    ds_read_b128 a[220:223], v254 offset:8192
    ds_read_b128 a[224:227], v254 offset:18432
    v_mfma_f32_16x16x32_bf16 v[232:235], a[232:235], a[152:155], v[232:235]
    v_mfma_f32_16x16x32_bf16 v[236:239], a[232:235], a[160:163], v[236:239]
    v_fma_f32 v224, v224, v248, v144
    v_fma_f32 v225, v225, v248, v145
    v_mfma_f32_16x16x32_bf16 v[236:239], a[228:231], a[156:159], v[236:239]
    s_waitcnt lgkmcnt(6)
    v_fma_f32 v226, v226, v248, v146
    v_fma_f32 v227, v227, v248, v147
    v_mfma_f32_16x16x32_bf16 v[232:235], a[196:199], a[164:167], v[232:235]
    ds_read_b128 a[228:231], v1 offset:8192
    ds_read_b128 a[232:235], v1 offset:18432
    v_mfma_f32_16x16x32_bf16 v[232:235], a[200:203], a[168:171], v[232:235]
    v_cvt_pk_bf16_f32 v218, v224, v225
    v_cvt_pk_bf16_f32 v219, v226, v227
    v_mfma_f32_16x16x32_bf16 v[236:239], a[200:203], a[176:179], v[236:239]
    buffer_store_dwordx4 v[216:219], v1, s[8:11], s15 offen offset:0 sc1
    v_mfma_f32_16x16x32_bf16 v[236:239], a[196:199], a[172:175], v[236:239]
    s_waitcnt lgkmcnt(6)
    v_fma_f32 v228, v228, v249, v148
    v_fma_f32 v229, v229, v249, v149
    v_mfma_f32_16x16x32_bf16 v[232:235], a[204:207], a[180:183], v[232:235]
    ds_read_b128 a[196:199], v1 offset:28672
    ds_read_b128 a[200:203], v1 offset:38912
    v_mfma_f32_16x16x32_bf16 v[232:235], a[208:211], a[184:187], v[232:235]
    v_fma_f32 v230, v230, v249, v150
    v_fma_f32 v231, v231, v249, v151
    v_mfma_f32_16x16x32_bf16 v[236:239], a[208:211], a[192:195], v[236:239]
    v_cvt_pk_bf16_f32 v222, v228, v229
    v_cvt_pk_bf16_f32 v223, v230, v231
    v_mfma_f32_16x16x32_bf16 v[236:239], a[204:207], a[188:191], v[236:239]
    s_waitcnt lgkmcnt(6)
    v_mfma_f32_16x16x32_bf16 v[232:235], a[212:215], a[0:3], v[232:235]
    ds_read_b128 a[204:207], v253 offset:8192
    ds_read_b128 a[208:211], v253 offset:18432
    v_mfma_f32_16x16x32_bf16 v[232:235], a[216:219], a[4:7], v[232:235]
    buffer_store_dwordx4 v[220:223], v1, s[8:11], s15 offen offset:1024 sc1
    v_mfma_f32_16x16x32_bf16 v[236:239], a[216:219], a[12:15], v[236:239]
    v_mfma_f32_16x16x32_bf16 v[236:239], a[212:215], a[8:11], v[236:239]
    s_waitcnt lgkmcnt(6)
    v_mfma_f32_16x16x32_bf16 v[232:235], a[220:223], a[16:19], v[232:235]
    ds_read_b128 a[212:215], v253 offset:29696
    ds_read_b128 a[216:219], v253 offset:39936
    v_mfma_f32_16x16x32_bf16 v[232:235], a[224:227], a[20:23], v[232:235]
    v_mfma_f32_16x16x32_bf16 v[236:239], a[224:227], a[28:31], v[236:239]
    v_mfma_f32_16x16x32_bf16 v[236:239], a[220:223], a[24:27], v[236:239]
    s_waitcnt lgkmcnt(6)
    v_mfma_f32_16x16x32_bf16 v[232:235], a[228:231], a[32:35], v[232:235]
    ds_read_b128 a[220:223], v254 offset:29696
    ds_read_b128 a[224:227], v254 offset:39936
    v_mfma_f32_16x16x32_bf16 v[232:235], a[232:235], a[36:39], v[232:235]
    v_mfma_f32_16x16x32_bf16 v[236:239], a[232:235], a[44:47], v[236:239]
    v_mfma_f32_16x16x32_bf16 v[236:239], a[228:231], a[40:43], v[236:239]
    s_waitcnt lgkmcnt(6)
    v_mfma_f32_16x16x32_bf16 v[232:235], a[196:199], a[48:51], v[232:235]
    ds_read_b128 a[228:231], v1 offset:50176
    ds_read_b128 a[232:235], v1 offset:60416
    v_mfma_f32_16x16x32_bf16 v[232:235], a[200:203], a[52:55], v[232:235]
    v_mfma_f32_16x16x32_bf16 v[236:239], a[200:203], a[60:63], v[236:239]
    v_mfma_f32_16x16x32_bf16 v[236:239], a[196:199], a[56:59], v[236:239]
    s_waitcnt lgkmcnt(6)
    v_mfma_f32_16x16x32_bf16 v[232:235], a[204:207], a[64:67], v[232:235]
    ds_read_b128 a[196:199], v253 offset:50176
    ds_read_b128 a[200:203], v253 offset:60416
    v_mfma_f32_16x16x32_bf16 v[232:235], a[208:211], a[68:71], v[232:235]
    v_mfma_f32_16x16x32_bf16 v[236:239], a[208:211], a[76:79], v[236:239]
    v_mfma_f32_16x16x32_bf16 v[236:239], a[204:207], a[72:75], v[236:239]
    s_waitcnt lgkmcnt(6)
    v_mfma_f32_16x16x32_bf16 v[240:243], a[212:215], a[148:151], v[240:243]
    ds_read_b128 a[204:207], v254 offset:9216
    ds_read_b128 a[208:211], v254 offset:19456
    v_mfma_f32_16x16x32_bf16 v[240:243], a[216:219], a[152:155], v[240:243]
    buffer_load_dword v14, v6, s[8:11], s62 offen sc1
    v_mfma_f32_16x16x32_bf16 v[244:247], a[216:219], a[160:163], v[244:247]
    v_mfma_f32_16x16x32_bf16 v[244:247], a[212:215], a[156:159], v[244:247]
    s_waitcnt lgkmcnt(6)
    v_mfma_f32_16x16x32_bf16 v[240:243], a[220:223], a[164:167], v[240:243]
    ds_read_b128 a[212:215], v1 offset:9216
    ds_read_b128 a[216:219], v1 offset:19456
    v_mfma_f32_16x16x32_bf16 v[240:243], a[224:227], a[168:171], v[240:243]
    v_mfma_f32_16x16x32_bf16 v[244:247], a[224:227], a[176:179], v[244:247]
    v_mfma_f32_16x16x32_bf16 v[244:247], a[220:223], a[172:175], v[244:247]
    s_waitcnt lgkmcnt(6)
    v_mfma_f32_16x16x32_bf16 v[240:243], a[228:231], a[180:183], v[240:243]
    ds_read_b128 a[220:223], v1 offset:29696
    ds_read_b128 a[224:227], v1 offset:39936
    v_mfma_f32_16x16x32_bf16 v[240:243], a[232:235], a[184:187], v[240:243]
    v_fma_f32 v232, v232, v248, v152
    v_fma_f32 v233, v233, v248, v153
    v_mfma_f32_16x16x32_bf16 v[244:247], a[232:235], a[192:195], v[244:247]
    v_fma_f32 v234, v234, v248, v154
    v_fma_f32 v235, v235, v248, v155
    v_mfma_f32_16x16x32_bf16 v[244:247], a[228:231], a[188:191], v[244:247]
    s_waitcnt lgkmcnt(6)
    v_fma_f32 v236, v236, v249, v156
    v_fma_f32 v237, v237, v249, v157
    v_mfma_f32_16x16x32_bf16 v[240:243], a[196:199], a[0:3], v[240:243]
    ds_read_b128 a[228:231], v253 offset:9216
    ds_read_b128 a[232:235], v253 offset:19456
    v_mfma_f32_16x16x32_bf16 v[240:243], a[200:203], a[4:7], v[240:243]
    v_fma_f32 v238, v238, v249, v158
    v_fma_f32 v239, v239, v249, v159
    v_mfma_f32_16x16x32_bf16 v[244:247], a[200:203], a[12:15], v[244:247]
    v_mfma_f32_16x16x32_bf16 v[244:247], a[196:199], a[8:11], v[244:247]
    s_waitcnt lgkmcnt(6)
    v_mfma_f32_16x16x32_bf16 v[240:243], a[204:207], a[16:19], v[240:243]
    v_mfma_f32_16x16x32_bf16 v[240:243], a[208:211], a[20:23], v[240:243]
    v_mfma_f32_16x16x32_bf16 v[244:247], a[208:211], a[28:31], v[244:247]
    v_mfma_f32_16x16x32_bf16 v[244:247], a[204:207], a[24:27], v[244:247]
    s_waitcnt lgkmcnt(4)
    v_mfma_f32_16x16x32_bf16 v[240:243], a[212:215], a[32:35], v[240:243]
    v_mfma_f32_16x16x32_bf16 v[240:243], a[216:219], a[36:39], v[240:243]
    v_mfma_f32_16x16x32_bf16 v[244:247], a[216:219], a[44:47], v[244:247]
    v_mfma_f32_16x16x32_bf16 v[244:247], a[212:215], a[40:43], v[244:247]
    s_waitcnt lgkmcnt(2)
    v_mfma_f32_16x16x32_bf16 v[240:243], a[220:223], a[48:51], v[240:243]
    v_mfma_f32_16x16x32_bf16 v[240:243], a[224:227], a[52:55], v[240:243]
    v_mfma_f32_16x16x32_bf16 v[244:247], a[224:227], a[60:63], v[244:247]
    v_mfma_f32_16x16x32_bf16 v[244:247], a[220:223], a[56:59], v[244:247]
    s_waitcnt lgkmcnt(0)
    v_mfma_f32_16x16x32_bf16 v[240:243], a[228:231], a[64:67], v[240:243]
    v_mfma_f32_16x16x32_bf16 v[240:243], a[232:235], a[68:71], v[240:243]
    s_waitcnt vmcnt(1)
    buffer_store_dword v252, off, s[8:11], s93 sc1
    v_mfma_f32_16x16x32_bf16 v[244:247], a[232:235], a[76:79], v[244:247]
    v_mfma_f32_16x16x32_bf16 v[244:247], a[228:231], a[72:75], v[244:247]
    s_nop 7
    v_pk_fma_f32 v[240:241], v[240:241], v[248:249], v[160:161] op_sel:[0,0,0] op_sel_hi:[1,0,1]
    v_pk_fma_f32 v[242:243], v[242:243], v[248:249], v[162:163] op_sel:[0,0,0] op_sel_hi:[1,0,1]
    v_pk_fma_f32 v[244:245], v[244:245], v[248:249], v[164:165] op_sel:[0,1,0] op_sel_hi:[1,1,1]
    v_pk_fma_f32 v[246:247], v[246:247], v[248:249], v[166:167] op_sel:[0,1,0] op_sel_hi:[1,1,1]
    s_waitcnt vmcnt(1)
    v_xor_b32 v14, s97, v14
    v_cmp_eq_u32 vcc, 0, v14
    s_cmp_eq_u64 vcc, -1
    s_cbranch_scc0 spin3
spin3_ok:
    buffer_load_dwordx4 v[88:91], v1, s[8:11], s16 offen offset:0 sc1
    buffer_load_dwordx4 v[92:95], v1, s[8:11], s17 offen offset:0 sc1
    buffer_load_dwordx4 v[96:99], v1, s[8:11], s18 offen offset:0 sc1
    buffer_load_dwordx4 v[100:103], v1, s[8:11], s16 offen offset:1024 sc1
    buffer_load_dwordx4 v[104:107], v1, s[8:11], s17 offen offset:1024 sc1
    buffer_load_dwordx4 v[108:111], v1, s[8:11], s18 offen offset:1024 sc1
    buffer_load_dwordx4 v[112:115], v5, s[8:11], s19 offen sc1
    buffer_load_dwordx4 v[116:119], v5, s[8:11], s77 offen sc1
    buffer_load_dwordx4 v[120:123], v5, s[8:11], s78 offen sc1
    buffer_load_dwordx4 v[124:127], v5, s[8:11], s79 offen sc1
    buffer_store_dword v252, off, s[8:11], s76 sc1
    s_waitcnt vmcnt(10)
    v_lshlrev_b32 v16, 16, v88
    v_and_b32 v17, 0xffff0000, v88
    v_lshlrev_b32 v18, 16, v89
    v_and_b32 v19, 0xffff0000, v89
    v_lshlrev_b32 v20, 16, v90
    v_and_b32 v21, 0xffff0000, v90
    v_lshlrev_b32 v22, 16, v91
    v_and_b32 v23, 0xffff0000, v91
    v_pk_add_f32 v[232:233], v[232:233], v[16:17]
    v_pk_add_f32 v[234:235], v[234:235], v[18:19]
    v_pk_add_f32 v[240:241], v[240:241], v[20:21]
    v_pk_add_f32 v[242:243], v[242:243], v[22:23]
    s_waitcnt vmcnt(9)
    v_lshlrev_b32 v16, 16, v92
    v_and_b32 v17, 0xffff0000, v92
    v_lshlrev_b32 v18, 16, v93
    v_and_b32 v19, 0xffff0000, v93
    v_lshlrev_b32 v20, 16, v94
    v_and_b32 v21, 0xffff0000, v94
    v_lshlrev_b32 v22, 16, v95
    v_and_b32 v23, 0xffff0000, v95
    v_pk_add_f32 v[232:233], v[232:233], v[16:17]
    v_pk_add_f32 v[234:235], v[234:235], v[18:19]
    v_pk_add_f32 v[240:241], v[240:241], v[20:21]
    v_pk_add_f32 v[242:243], v[242:243], v[22:23]
    s_waitcnt vmcnt(8)
    v_lshlrev_b32 v16, 16, v96
    v_and_b32 v17, 0xffff0000, v96
    v_lshlrev_b32 v18, 16, v97
    v_and_b32 v19, 0xffff0000, v97
    v_lshlrev_b32 v20, 16, v98
    v_and_b32 v21, 0xffff0000, v98
    v_lshlrev_b32 v22, 16, v99
    v_and_b32 v23, 0xffff0000, v99
    v_pk_add_f32 v[232:233], v[232:233], v[16:17]
    v_pk_add_f32 v[234:235], v[234:235], v[18:19]
    v_pk_add_f32 v[240:241], v[240:241], v[20:21]
    v_pk_add_f32 v[242:243], v[242:243], v[22:23]
    v_cvt_pk_bf16_f32 v232, v232, v233
    v_cvt_pk_bf16_f32 v233, v234, v235
    v_cvt_pk_bf16_f32 v234, v240, v241
    v_cvt_pk_bf16_f32 v235, v242, v243
    buffer_store_dwordx4 v[232:235], v3, s[52:55], s20 offen
    s_waitcnt vmcnt(8)
    v_lshlrev_b32 v16, 16, v100
    v_and_b32 v17, 0xffff0000, v100
    v_lshlrev_b32 v18, 16, v101
    v_and_b32 v19, 0xffff0000, v101
    v_lshlrev_b32 v20, 16, v102
    v_and_b32 v21, 0xffff0000, v102
    v_lshlrev_b32 v22, 16, v103
    v_and_b32 v23, 0xffff0000, v103
    v_pk_add_f32 v[236:237], v[236:237], v[16:17]
    v_pk_add_f32 v[238:239], v[238:239], v[18:19]
    v_pk_add_f32 v[244:245], v[244:245], v[20:21]
    v_pk_add_f32 v[246:247], v[246:247], v[22:23]
    s_waitcnt vmcnt(7)
    v_lshlrev_b32 v16, 16, v104
    v_and_b32 v17, 0xffff0000, v104
    v_lshlrev_b32 v18, 16, v105
    v_and_b32 v19, 0xffff0000, v105
    v_lshlrev_b32 v20, 16, v106
    v_and_b32 v21, 0xffff0000, v106
    v_lshlrev_b32 v22, 16, v107
    v_and_b32 v23, 0xffff0000, v107
    v_pk_add_f32 v[236:237], v[236:237], v[16:17]
    v_pk_add_f32 v[238:239], v[238:239], v[18:19]
    v_pk_add_f32 v[244:245], v[244:245], v[20:21]
    v_pk_add_f32 v[246:247], v[246:247], v[22:23]
    s_waitcnt vmcnt(6)
    v_lshlrev_b32 v16, 16, v108
    v_and_b32 v17, 0xffff0000, v108
    v_lshlrev_b32 v18, 16, v109
    v_and_b32 v19, 0xffff0000, v109
    v_lshlrev_b32 v20, 16, v110
    v_and_b32 v21, 0xffff0000, v110
    v_lshlrev_b32 v22, 16, v111
    v_and_b32 v23, 0xffff0000, v111
    v_pk_add_f32 v[236:237], v[236:237], v[16:17]
    v_pk_add_f32 v[238:239], v[238:239], v[18:19]
    v_pk_add_f32 v[244:245], v[244:245], v[20:21]
    v_pk_add_f32 v[246:247], v[246:247], v[22:23]
    v_cvt_pk_bf16_f32 v236, v236, v237
    v_cvt_pk_bf16_f32 v237, v238, v239
    v_cvt_pk_bf16_f32 v238, v244, v245
    v_cvt_pk_bf16_f32 v239, v246, v247
    buffer_store_dwordx4 v[236:239], v3, s[52:55], s21 offen
    s_waitcnt vmcnt(3)
    v_lshlrev_b32 v24, 16, v112
    v_and_b32 v25, 0xffff0000, v112
    v_lshlrev_b32 v26, 16, v113
    v_and_b32 v27, 0xffff0000, v113
    v_lshlrev_b32 v28, 16, v114
    v_and_b32 v29, 0xffff0000, v114
    v_lshlrev_b32 v30, 16, v115
    v_and_b32 v31, 0xffff0000, v115
    v_lshlrev_b32 v16, 16, v116
    v_and_b32 v17, 0xffff0000, v116
    v_lshlrev_b32 v18, 16, v117
    v_and_b32 v19, 0xffff0000, v117
    v_lshlrev_b32 v20, 16, v118
    v_and_b32 v21, 0xffff0000, v118
    v_lshlrev_b32 v22, 16, v119
    v_and_b32 v23, 0xffff0000, v119
    v_pk_add_f32 v[24:25], v[24:25], v[16:17]
    v_pk_add_f32 v[26:27], v[26:27], v[18:19]
    v_pk_add_f32 v[28:29], v[28:29], v[20:21]
    v_pk_add_f32 v[30:31], v[30:31], v[22:23]
    v_lshlrev_b32 v16, 16, v120
    v_and_b32 v17, 0xffff0000, v120
    v_lshlrev_b32 v18, 16, v121
    v_and_b32 v19, 0xffff0000, v121
    v_lshlrev_b32 v20, 16, v122
    v_and_b32 v21, 0xffff0000, v122
    v_lshlrev_b32 v22, 16, v123
    v_and_b32 v23, 0xffff0000, v123
    v_pk_add_f32 v[24:25], v[24:25], v[16:17]
    v_pk_add_f32 v[26:27], v[26:27], v[18:19]
    v_pk_add_f32 v[28:29], v[28:29], v[20:21]
    v_pk_add_f32 v[30:31], v[30:31], v[22:23]
    v_lshlrev_b32 v16, 16, v124
    v_and_b32 v17, 0xffff0000, v124
    v_lshlrev_b32 v18, 16, v125
    v_and_b32 v19, 0xffff0000, v125
    v_lshlrev_b32 v20, 16, v126
    v_and_b32 v21, 0xffff0000, v126
    v_lshlrev_b32 v22, 16, v127
    v_and_b32 v23, 0xffff0000, v127
    v_pk_add_f32 v[24:25], v[24:25], v[16:17]
    v_pk_add_f32 v[26:27], v[26:27], v[18:19]
    v_pk_add_f32 v[28:29], v[28:29], v[20:21]
    v_pk_add_f32 v[30:31], v[30:31], v[22:23]
    v_cvt_pk_bf16_f32 v24, v24, v25
    v_cvt_pk_bf16_f32 v25, v26, v27
    v_cvt_pk_bf16_f32 v26, v28, v29
    v_cvt_pk_bf16_f32 v27, v30, v31
    buffer_store_dwordx4 v[24:27], v4, s[52:55], s22 offen
    s_endpgm
L_cold:
spin0:
    s_mov_b32 s94, 1
spin0_l:
    s_sleep 1
    buffer_load_dword v22, v21, s[8:11], s96 offen sc1
    s_waitcnt vmcnt(0)
    v_xor_b32 v22, s97, v22
    v_cmp_eq_u32 vcc, 0, v22
    s_or_b64 vcc, vcc, s[86:87]
    s_cmp_eq_u64 vcc, -1
    s_cbranch_scc1 spin0_x
    s_add_u32 s94, s94, 1
    s_cmp_lt_u32 s94, 0x20000
    s_cbranch_scc1 spin0_l
spin0_x:
    s_branch spin0_ok
spin1:
    s_mov_b32 s94, 1
spin1_l:
    s_sleep 1
    buffer_load_dwordx4 v[6:9], v1, s[8:11], s65 offen sc1
    s_waitcnt vmcnt(0)
    v_xor_b32 v7, s97, v7
    v_xor_b32 v8, s97, v8
    v_xor_b32 v9, s97, v9
    v_xor_b32 v6, s97, v6
    v_or3_b32 v6, v6, v7, v8
    v_or_b32 v6, v6, v9
    v_cmp_eq_u32 vcc, 0, v6
    s_cmp_eq_u64 vcc, -1
    s_cbranch_scc1 spin1_x
    s_add_u32 s94, s94, 1
    s_cmp_lt_u32 s94, 0x20000
    s_cbranch_scc1 spin1_l
spin1_x:
    s_branch spin1_ok
spin2:
    s_mov_b32 s94, 1
spin2_l:
    s_sleep 1
    buffer_load_dword v14, v251, s[8:11], s98 offen sc1
    s_waitcnt vmcnt(0)
    v_xor_b32 v14, s97, v14
    v_cmp_eq_u32 vcc, 0, v14
    s_cmp_eq_u64 vcc, -1
    s_cbranch_scc1 spin2_x
    s_add_u32 s94, s94, 1
    s_cmp_lt_u32 s94, 0x20000
    s_cbranch_scc1 spin2_l
spin2_x:
    s_branch spin2_ok
spin3:
    s_mov_b32 s94, 1
spin3_l:
    s_sleep 1
    buffer_load_dword v14, v6, s[8:11], s62 offen sc1
    s_waitcnt vmcnt(0)
    v_xor_b32 v14, s97, v14
    v_cmp_eq_u32 vcc, 0, v14
    s_cmp_eq_u64 vcc, -1
    s_cbranch_scc1 spin3_x
    s_add_u32 s94, s94, 1
    s_cmp_lt_u32 s94, 0x20000
    s_cbranch_scc1 spin3_l
spin3_x:
    s_branch spin3_ok
redo1:
    s_cmp_lg_u32 s66, 0
    s_cbranch_scc1 done1
    s_mov_b32 s66, 1
    s_lshl_b32 s67, s7, 20
    s_lshl_b32 s68, s20, 2
    s_add_u32 s68, s68, 4
    s_lshl_b32 s62, s20, 7
    v_cvt_f32_u32 v6, s62
    v_mul_f32 v6, 0x71800000, v6
    v_add_f32 v10, v4, v6
    v_mov_b32 v12, 0xfe800000
    v_add_f32 v11, v5, v6
    v_mov_b32 v13, 0xfe800000
    v_mov_b32 v16, 0
    v_mov_b32 v17, 0
    v_mov_b32 v18, 0
    v_mov_b32 v19, 0
    v_mov_b32 v20, 0
    v_mov_b32 v21, 0
    v_mov_b32 v22, 0
    v_mov_b32 v23, 0
    v_mov_b32 v24, 0
    v_mov_b32 v25, 0
    v_mov_b32 v26, 0
    v_mov_b32 v27, 0
    v_mov_b32 v28, 0
    v_mov_b32 v29, 0
    v_mov_b32 v30, 0
    v_mov_b32 v31, 0
    v_mov_b32 v32, 0
    v_mov_b32 v33, 0
    v_mov_b32 v34, 0
    v_mov_b32 v35, 0
    v_mov_b32 v36, 0
    v_mov_b32 v37, 0
    v_mov_b32 v38, 0
    v_mov_b32 v39, 0
    v_mov_b32 v40, 0
    v_mov_b32 v41, 0
    v_mov_b32 v42, 0
    v_mov_b32 v43, 0
    v_mov_b32 v44, 0
    v_mov_b32 v45, 0
    v_mov_b32 v46, 0
    v_mov_b32 v47, 0
    v_mov_b32 v48, 0
    v_mov_b32 v49, 0
    v_mov_b32 v50, 0
    v_mov_b32 v51, 0
    v_mov_b32 v52, 0
    v_mov_b32 v53, 0
    v_mov_b32 v54, 0
    v_mov_b32 v55, 0
    v_mov_b32 v56, 0
    v_mov_b32 v57, 0
    v_mov_b32 v58, 0
    v_mov_b32 v59, 0
    v_mov_b32 v60, 0
    v_mov_b32 v61, 0
    v_mov_b32 v62, 0
    v_mov_b32 v63, 0
    v_mov_b32 v64, 0
    v_mov_b32 v65, 0
    v_mov_b32 v66, 0
    v_mov_b32 v67, 0
    v_mov_b32 v68, 0
    v_mov_b32 v69, 0
    v_mov_b32 v70, 0
    v_mov_b32 v71, 0
    v_mov_b32 v72, 0
    v_mov_b32 v73, 0
    v_mov_b32 v74, 0
    v_mov_b32 v75, 0
    v_mov_b32 v76, 0
    v_mov_b32 v77, 0
    v_mov_b32 v78, 0
    v_mov_b32 v79, 0
    v_mov_b32 v80, 0
    v_mov_b32 v81, 0
    v_mov_b32 v82, 0
    v_mov_b32 v83, 0
    v_mov_b32 v84, 0
    v_mov_b32 v85, 0
    v_mov_b32 v86, 0
    v_mov_b32 v87, 0
slow_loop1:
    s_add_u32 s62, s67, 0
    s_add_u32 s63, s67, 4096
    buffer_load_dwordx4 a[68:71], v1, s[8:11], s62 offen offset:0 sc1
    buffer_load_dwordx4 a[72:75], v1, s[8:11], s62 offen offset:1024 sc1
    buffer_load_dwordx4 a[76:79], v1, s[8:11], s62 offen offset:2048 sc1
    buffer_load_dwordx4 a[80:83], v1, s[8:11], s62 offen offset:3072 sc1
    buffer_load_dwordx4 a[84:87], v1, s[8:11], s63 offen offset:0 sc1
    buffer_load_dwordx4 a[88:91], v1, s[8:11], s63 offen offset:1024 sc1
    buffer_load_dwordx4 a[92:95], v1, s[8:11], s63 offen offset:2048 sc1
    buffer_load_dwordx4 a[96:99], v1, s[8:11], s63 offen offset:3072 sc1
    s_waitcnt vmcnt(0)
    v_mfma_f32_16x16x32_bf16 v[88:91], a[68:71], a[100:103], 0
    v_mfma_f32_16x16x32_bf16 v[88:91], a[72:75], a[104:107], v[88:91]
    v_mfma_f32_16x16x32_bf16 v[88:91], a[76:79], a[108:111], v[88:91]
    v_mfma_f32_16x16x32_bf16 v[88:91], a[80:83], a[112:115], v[88:91]
    v_mfma_f32_16x16x32_bf16 v[92:95], a[84:87], a[100:103], 0
    v_mfma_f32_16x16x32_bf16 v[92:95], a[88:91], a[104:107], v[92:95]
    v_mfma_f32_16x16x32_bf16 v[92:95], a[92:95], a[108:111], v[92:95]
    v_mfma_f32_16x16x32_bf16 v[92:95], a[96:99], a[112:115], v[92:95]
    v_mfma_f32_16x16x32_bf16 v[96:99], a[68:71], a[116:119], 0
    v_mfma_f32_16x16x32_bf16 v[96:99], a[72:75], a[120:123], v[96:99]
    v_mfma_f32_16x16x32_bf16 v[96:99], a[76:79], a[124:127], v[96:99]
    v_mfma_f32_16x16x32_bf16 v[96:99], a[80:83], a[128:131], v[96:99]
    v_mfma_f32_16x16x32_bf16 v[100:103], a[84:87], a[116:119], 0
    v_mfma_f32_16x16x32_bf16 v[100:103], a[88:91], a[120:123], v[100:103]
    v_mfma_f32_16x16x32_bf16 v[100:103], a[92:95], a[124:127], v[100:103]
    v_mfma_f32_16x16x32_bf16 v[100:103], a[96:99], a[128:131], v[100:103]
    s_nop 7
    s_add_u32 s62, s67, 16384
    s_add_u32 s63, s67, 20480
    buffer_load_dwordx4 a[68:71], v1, s[8:11], s62 offen offset:0 sc1
    buffer_load_dwordx4 a[72:75], v1, s[8:11], s62 offen offset:1024 sc1
    buffer_load_dwordx4 a[76:79], v1, s[8:11], s62 offen offset:2048 sc1
    buffer_load_dwordx4 a[80:83], v1, s[8:11], s62 offen offset:3072 sc1
    buffer_load_dwordx4 a[84:87], v1, s[8:11], s63 offen offset:0 sc1
    buffer_load_dwordx4 a[88:91], v1, s[8:11], s63 offen offset:1024 sc1
    buffer_load_dwordx4 a[92:95], v1, s[8:11], s63 offen offset:2048 sc1
    buffer_load_dwordx4 a[96:99], v1, s[8:11], s63 offen offset:3072 sc1
    v_subrev_f32 v6, 0x00000000, v10
    v_min_f32 v6, 0, v6
    v_add_f32 v88, v88, v6
    v_subrev_f32 v6, 0x71800000, v10
    v_min_f32 v6, 0, v6
    v_add_f32 v89, v89, v6
    v_subrev_f32 v6, 0x72000000, v10
    v_min_f32 v6, 0, v6
    v_add_f32 v90, v90, v6
    v_subrev_f32 v6, 0x72400000, v10
    v_min_f32 v6, 0, v6
    v_add_f32 v91, v91, v6
    v_subrev_f32 v6, 0x73800000, v10
    v_min_f32 v6, 0, v6
    v_add_f32 v92, v92, v6
    v_subrev_f32 v6, 0x73880000, v10
    v_min_f32 v6, 0, v6
    v_add_f32 v93, v93, v6
    v_subrev_f32 v6, 0x73900000, v10
    v_min_f32 v6, 0, v6
    v_add_f32 v94, v94, v6
    v_subrev_f32 v6, 0x73980000, v10
    v_min_f32 v6, 0, v6
    v_add_f32 v95, v95, v6
    v_subrev_f32 v10, 0x74000000, v10
    v_subrev_f32 v6, 0x00000000, v11
    v_min_f32 v6, 0, v6
    v_add_f32 v96, v96, v6
    v_subrev_f32 v6, 0x71800000, v11
    v_min_f32 v6, 0, v6
    v_add_f32 v97, v97, v6
    v_subrev_f32 v6, 0x72000000, v11
    v_min_f32 v6, 0, v6
    v_add_f32 v98, v98, v6
    v_subrev_f32 v6, 0x72400000, v11
    v_min_f32 v6, 0, v6
    v_add_f32 v99, v99, v6
    v_subrev_f32 v6, 0x73800000, v11
    v_min_f32 v6, 0, v6
    v_add_f32 v100, v100, v6
    v_subrev_f32 v6, 0x73880000, v11
    v_min_f32 v6, 0, v6
    v_add_f32 v101, v101, v6
    v_subrev_f32 v6, 0x73900000, v11
    v_min_f32 v6, 0, v6
    v_add_f32 v102, v102, v6
    v_subrev_f32 v6, 0x73980000, v11
    v_min_f32 v6, 0, v6
    v_add_f32 v103, v103, v6
    v_subrev_f32 v11, 0x74000000, v11
    v_max3_f32 v6, v88, v89, v90
    v_max3_f32 v6, v6, v91, v92
    v_max3_f32 v6, v6, v93, v94
    v_max3_f32 v6, v6, v95, v12
    v_max3_f32 v7, v96, v97, v98
    v_max3_f32 v7, v7, v99, v100
    v_max3_f32 v7, v7, v101, v102
    v_max3_f32 v7, v7, v103, v13
    v_mov_b32 v8, v6
    v_mov_b32 v9, v7
    s_nop 1
    v_permlane32_swap_b32 v8, v6
    v_permlane32_swap_b32 v9, v7
    s_nop 1
    v_max_f32 v6, v6, v8
    v_max_f32 v7, v7, v9
    v_mov_b32 v8, v6
    v_mov_b32 v9, v7
    s_nop 1
    v_permlane16_swap_b32 v8, v6
    v_permlane16_swap_b32 v9, v7
    s_nop 1
    v_max_f32 v6, v6, v8
    v_max_f32 v7, v7, v9
    v_sub_f32 v8, v12, v6
    v_mov_b32 v12, v6
    v_exp_f32 v8, v8
    v_sub_f32 v88, v88, v6
    v_sub_f32 v89, v89, v6
    v_sub_f32 v90, v90, v6
    v_sub_f32 v91, v91, v6
    v_sub_f32 v92, v92, v6
    v_sub_f32 v93, v93, v6
    v_sub_f32 v94, v94, v6
    v_sub_f32 v95, v95, v6
    v_exp_f32 v88, v88
    v_exp_f32 v89, v89
    v_exp_f32 v90, v90
    v_exp_f32 v91, v91
    v_exp_f32 v92, v92
    v_exp_f32 v93, v93
    v_exp_f32 v94, v94
    v_exp_f32 v95, v95
    s_nop 0
    v_cvt_pk_bf16_f32 v120, v88, v89
    v_cvt_pk_bf16_f32 v121, v90, v91
    v_cvt_pk_bf16_f32 v122, v92, v93
    v_cvt_pk_bf16_f32 v123, v94, v95
    v_mul_f32 v16, v16, v8
    v_mul_f32 v17, v17, v8
    v_mul_f32 v18, v18, v8
    v_mul_f32 v19, v19, v8
    v_mul_f32 v24, v24, v8
    v_mul_f32 v25, v25, v8
    v_mul_f32 v26, v26, v8
    v_mul_f32 v27, v27, v8
    v_mul_f32 v32, v32, v8
    v_mul_f32 v33, v33, v8
    v_mul_f32 v34, v34, v8
    v_mul_f32 v35, v35, v8
    v_mul_f32 v40, v40, v8
    v_mul_f32 v41, v41, v8
    v_mul_f32 v42, v42, v8
    v_mul_f32 v43, v43, v8
    v_mul_f32 v48, v48, v8
    v_mul_f32 v49, v49, v8
    v_mul_f32 v50, v50, v8
    v_mul_f32 v51, v51, v8
    v_mul_f32 v56, v56, v8
    v_mul_f32 v57, v57, v8
    v_mul_f32 v58, v58, v8
    v_mul_f32 v59, v59, v8
    v_mul_f32 v64, v64, v8
    v_mul_f32 v65, v65, v8
    v_mul_f32 v66, v66, v8
    v_mul_f32 v67, v67, v8
    v_mul_f32 v72, v72, v8
    v_mul_f32 v73, v73, v8
    v_mul_f32 v74, v74, v8
    v_mul_f32 v75, v75, v8
    v_mul_f32 v80, v80, v8
    v_mul_f32 v81, v81, v8
    v_mul_f32 v82, v82, v8
    v_mul_f32 v83, v83, v8
    v_sub_f32 v9, v13, v7
    v_mov_b32 v13, v7
    v_exp_f32 v9, v9
    v_sub_f32 v96, v96, v7
    v_sub_f32 v97, v97, v7
    v_sub_f32 v98, v98, v7
    v_sub_f32 v99, v99, v7
    v_sub_f32 v100, v100, v7
    v_sub_f32 v101, v101, v7
    v_sub_f32 v102, v102, v7
    v_sub_f32 v103, v103, v7
    v_exp_f32 v96, v96
    v_exp_f32 v97, v97
    v_exp_f32 v98, v98
    v_exp_f32 v99, v99
    v_exp_f32 v100, v100
    v_exp_f32 v101, v101
    v_exp_f32 v102, v102
    v_exp_f32 v103, v103
    s_nop 0
    v_cvt_pk_bf16_f32 v124, v96, v97
    v_cvt_pk_bf16_f32 v125, v98, v99
    v_cvt_pk_bf16_f32 v126, v100, v101
    v_cvt_pk_bf16_f32 v127, v102, v103
    v_mul_f32 v20, v20, v9
    v_mul_f32 v21, v21, v9
    v_mul_f32 v22, v22, v9
    v_mul_f32 v23, v23, v9
    v_mul_f32 v28, v28, v9
    v_mul_f32 v29, v29, v9
    v_mul_f32 v30, v30, v9
    v_mul_f32 v31, v31, v9
    v_mul_f32 v36, v36, v9
    v_mul_f32 v37, v37, v9
    v_mul_f32 v38, v38, v9
    v_mul_f32 v39, v39, v9
    v_mul_f32 v44, v44, v9
    v_mul_f32 v45, v45, v9
    v_mul_f32 v46, v46, v9
    v_mul_f32 v47, v47, v9
    v_mul_f32 v52, v52, v9
    v_mul_f32 v53, v53, v9
    v_mul_f32 v54, v54, v9
    v_mul_f32 v55, v55, v9
    v_mul_f32 v60, v60, v9
    v_mul_f32 v61, v61, v9
    v_mul_f32 v62, v62, v9
    v_mul_f32 v63, v63, v9
    v_mul_f32 v68, v68, v9
    v_mul_f32 v69, v69, v9
    v_mul_f32 v70, v70, v9
    v_mul_f32 v71, v71, v9
    v_mul_f32 v76, v76, v9
    v_mul_f32 v77, v77, v9
    v_mul_f32 v78, v78, v9
    v_mul_f32 v79, v79, v9
    v_mul_f32 v84, v84, v9
    v_mul_f32 v85, v85, v9
    v_mul_f32 v86, v86, v9
    v_mul_f32 v87, v87, v9
    s_waitcnt vmcnt(0)
    s_nop 0
    v_mfma_f32_16x16x32_bf16 v[80:83], a[240:243], v[120:123], v[80:83]
    v_mfma_f32_16x16x32_bf16 v[16:19], a[68:71], v[120:123], v[16:19]
    v_mfma_f32_16x16x32_bf16 v[24:27], a[72:75], v[120:123], v[24:27]
    v_mfma_f32_16x16x32_bf16 v[32:35], a[76:79], v[120:123], v[32:35]
    v_mfma_f32_16x16x32_bf16 v[40:43], a[80:83], v[120:123], v[40:43]
    v_mfma_f32_16x16x32_bf16 v[48:51], a[84:87], v[120:123], v[48:51]
    v_mfma_f32_16x16x32_bf16 v[56:59], a[88:91], v[120:123], v[56:59]
    v_mfma_f32_16x16x32_bf16 v[64:67], a[92:95], v[120:123], v[64:67]
    v_mfma_f32_16x16x32_bf16 v[72:75], a[96:99], v[120:123], v[72:75]
    v_mfma_f32_16x16x32_bf16 v[84:87], a[240:243], v[124:127], v[84:87]
    v_mfma_f32_16x16x32_bf16 v[20:23], a[68:71], v[124:127], v[20:23]
    v_mfma_f32_16x16x32_bf16 v[28:31], a[72:75], v[124:127], v[28:31]
    v_mfma_f32_16x16x32_bf16 v[36:39], a[76:79], v[124:127], v[36:39]
    v_mfma_f32_16x16x32_bf16 v[44:47], a[80:83], v[124:127], v[44:47]
    v_mfma_f32_16x16x32_bf16 v[52:55], a[84:87], v[124:127], v[52:55]
    v_mfma_f32_16x16x32_bf16 v[60:63], a[88:91], v[124:127], v[60:63]
    v_mfma_f32_16x16x32_bf16 v[68:71], a[92:95], v[124:127], v[68:71]
    v_mfma_f32_16x16x32_bf16 v[76:79], a[96:99], v[124:127], v[76:79]
    s_bitcmp1_b32 s67, 13
    s_mov_b32 s62, 8192
    s_cmov_b32 s62, 24576
    s_add_u32 s67, s67, s62
    s_sub_u32 s68, s68, 1
    s_cmp_lg_u32 s68, 0
    s_nop 7
    s_cbranch_scc1 slow_loop1
    s_branch norm1
redo2:
    s_cmp_lg_u32 s66, 0
    s_cbranch_scc1 done2
    s_mov_b32 s66, 1
    s_lshl_b32 s67, s7, 20
    s_lshl_b32 s68, s20, 2
    s_add_u32 s68, s68, 4
    s_lshl_b32 s62, s20, 7
    v_cvt_f32_u32 v6, s62
    v_mul_f32 v6, 0x71800000, v6
    v_add_f32 v10, v4, v6
    v_mov_b32 v12, 0xfe800000
    v_add_f32 v11, v5, v6
    v_mov_b32 v13, 0xfe800000
    v_mov_b32 v176, 0
    v_mov_b32 v177, 0
    v_mov_b32 v178, 0
    v_mov_b32 v179, 0
    v_mov_b32 v180, 0
    v_mov_b32 v181, 0
    v_mov_b32 v182, 0
    v_mov_b32 v183, 0
    v_mov_b32 v184, 0
    v_mov_b32 v185, 0
    v_mov_b32 v186, 0
    v_mov_b32 v187, 0
    v_mov_b32 v188, 0
    v_mov_b32 v189, 0
    v_mov_b32 v190, 0
    v_mov_b32 v191, 0
    v_mov_b32 v192, 0
    v_mov_b32 v193, 0
    v_mov_b32 v194, 0
    v_mov_b32 v195, 0
    v_mov_b32 v196, 0
    v_mov_b32 v197, 0
    v_mov_b32 v198, 0
    v_mov_b32 v199, 0
    v_mov_b32 v200, 0
    v_mov_b32 v201, 0
    v_mov_b32 v202, 0
    v_mov_b32 v203, 0
    v_mov_b32 v204, 0
    v_mov_b32 v205, 0
    v_mov_b32 v206, 0
    v_mov_b32 v207, 0
    v_mov_b32 v208, 0
    v_mov_b32 v209, 0
    v_mov_b32 v210, 0
    v_mov_b32 v211, 0
    v_mov_b32 v212, 0
    v_mov_b32 v213, 0
    v_mov_b32 v214, 0
    v_mov_b32 v215, 0
    v_mov_b32 v216, 0
    v_mov_b32 v217, 0
    v_mov_b32 v218, 0
    v_mov_b32 v219, 0
    v_mov_b32 v220, 0
    v_mov_b32 v221, 0
    v_mov_b32 v222, 0
    v_mov_b32 v223, 0
    v_mov_b32 v224, 0
    v_mov_b32 v225, 0
    v_mov_b32 v226, 0
    v_mov_b32 v227, 0
    v_mov_b32 v228, 0
    v_mov_b32 v229, 0
    v_mov_b32 v230, 0
    v_mov_b32 v231, 0
    v_mov_b32 v232, 0
    v_mov_b32 v233, 0
    v_mov_b32 v234, 0
    v_mov_b32 v235, 0
    v_mov_b32 v236, 0
    v_mov_b32 v237, 0
    v_mov_b32 v238, 0
    v_mov_b32 v239, 0
    v_mov_b32 v240, 0
    v_mov_b32 v241, 0
    v_mov_b32 v242, 0
    v_mov_b32 v243, 0
    v_mov_b32 v244, 0
    v_mov_b32 v245, 0
    v_mov_b32 v246, 0
    v_mov_b32 v247, 0
slow_loop2:
    s_add_u32 s62, s67, 0
    s_add_u32 s63, s67, 4096
    buffer_load_dwordx4 a[68:71], v1, s[8:11], s62 offen offset:0 sc1
    buffer_load_dwordx4 a[72:75], v1, s[8:11], s62 offen offset:1024 sc1
    buffer_load_dwordx4 a[76:79], v1, s[8:11], s62 offen offset:2048 sc1
    buffer_load_dwordx4 a[80:83], v1, s[8:11], s62 offen offset:3072 sc1
    buffer_load_dwordx4 a[84:87], v1, s[8:11], s63 offen offset:0 sc1
    buffer_load_dwordx4 a[88:91], v1, s[8:11], s63 offen offset:1024 sc1
    buffer_load_dwordx4 a[92:95], v1, s[8:11], s63 offen offset:2048 sc1
    buffer_load_dwordx4 a[96:99], v1, s[8:11], s63 offen offset:3072 sc1
    s_waitcnt vmcnt(0)
    v_mfma_f32_16x16x32_bf16 v[88:91], a[68:71], a[180:183], 0
    v_mfma_f32_16x16x32_bf16 v[88:91], a[72:75], a[184:187], v[88:91]
    v_mfma_f32_16x16x32_bf16 v[88:91], a[76:79], a[188:191], v[88:91]
    v_mfma_f32_16x16x32_bf16 v[88:91], a[80:83], a[192:195], v[88:91]
    v_mfma_f32_16x16x32_bf16 v[92:95], a[84:87], a[180:183], 0
    v_mfma_f32_16x16x32_bf16 v[92:95], a[88:91], a[184:187], v[92:95]
    v_mfma_f32_16x16x32_bf16 v[92:95], a[92:95], a[188:191], v[92:95]
    v_mfma_f32_16x16x32_bf16 v[92:95], a[96:99], a[192:195], v[92:95]
    v_mfma_f32_16x16x32_bf16 v[96:99], a[68:71], a[64:67], 0
    v_mfma_f32_16x16x32_bf16 v[96:99], a[72:75], a[244:247], v[96:99]
    v_mfma_f32_16x16x32_bf16 v[96:99], a[76:79], a[248:251], v[96:99]
    v_mfma_f32_16x16x32_bf16 v[96:99], a[80:83], a[252:255], v[96:99]
    v_mfma_f32_16x16x32_bf16 v[100:103], a[84:87], a[64:67], 0
    v_mfma_f32_16x16x32_bf16 v[100:103], a[88:91], a[244:247], v[100:103]
    v_mfma_f32_16x16x32_bf16 v[100:103], a[92:95], a[248:251], v[100:103]
    v_mfma_f32_16x16x32_bf16 v[100:103], a[96:99], a[252:255], v[100:103]
    s_nop 7
    s_add_u32 s62, s67, 16384
    s_add_u32 s63, s67, 20480
    buffer_load_dwordx4 a[68:71], v1, s[8:11], s62 offen offset:0 sc1
    buffer_load_dwordx4 a[72:75], v1, s[8:11], s62 offen offset:1024 sc1
    buffer_load_dwordx4 a[76:79], v1, s[8:11], s62 offen offset:2048 sc1
    buffer_load_dwordx4 a[80:83], v1, s[8:11], s62 offen offset:3072 sc1
    buffer_load_dwordx4 a[84:87], v1, s[8:11], s63 offen offset:0 sc1
    buffer_load_dwordx4 a[88:91], v1, s[8:11], s63 offen offset:1024 sc1
    buffer_load_dwordx4 a[92:95], v1, s[8:11], s63 offen offset:2048 sc1
    buffer_load_dwordx4 a[96:99], v1, s[8:11], s63 offen offset:3072 sc1
    v_subrev_f32 v6, 0x00000000, v10
    v_min_f32 v6, 0, v6
    v_add_f32 v88, v88, v6
    v_subrev_f32 v6, 0x71800000, v10
    v_min_f32 v6, 0, v6
    v_add_f32 v89, v89, v6
    v_subrev_f32 v6, 0x72000000, v10
    v_min_f32 v6, 0, v6
    v_add_f32 v90, v90, v6
    v_subrev_f32 v6, 0x72400000, v10
    v_min_f32 v6, 0, v6
    v_add_f32 v91, v91, v6
    v_subrev_f32 v6, 0x73800000, v10
    v_min_f32 v6, 0, v6
    v_add_f32 v92, v92, v6
    v_subrev_f32 v6, 0x73880000, v10
    v_min_f32 v6, 0, v6
    v_add_f32 v93, v93, v6
    v_subrev_f32 v6, 0x73900000, v10
    v_min_f32 v6, 0, v6
    v_add_f32 v94, v94, v6
    v_subrev_f32 v6, 0x73980000, v10
    v_min_f32 v6, 0, v6
    v_add_f32 v95, v95, v6
    v_subrev_f32 v10, 0x74000000, v10
    v_subrev_f32 v6, 0x00000000, v11
    v_min_f32 v6, 0, v6
    v_add_f32 v96, v96, v6
    v_subrev_f32 v6, 0x71800000, v11
    v_min_f32 v6, 0, v6
    v_add_f32 v97, v97, v6
    v_subrev_f32 v6, 0x72000000, v11
    v_min_f32 v6, 0, v6
    v_add_f32 v98, v98, v6
    v_subrev_f32 v6, 0x72400000, v11
    v_min_f32 v6, 0, v6
    v_add_f32 v99, v99, v6
    v_subrev_f32 v6, 0x73800000, v11
    v_min_f32 v6, 0, v6
    v_add_f32 v100, v100, v6
    v_subrev_f32 v6, 0x73880000, v11
    v_min_f32 v6, 0, v6
    v_add_f32 v101, v101, v6
    v_subrev_f32 v6, 0x73900000, v11
    v_min_f32 v6, 0, v6
    v_add_f32 v102, v102, v6
    v_subrev_f32 v6, 0x73980000, v11
    v_min_f32 v6, 0, v6
    v_add_f32 v103, v103, v6
    v_subrev_f32 v11, 0x74000000, v11
    v_max3_f32 v6, v88, v89, v90
    v_max3_f32 v6, v6, v91, v92
    v_max3_f32 v6, v6, v93, v94
    v_max3_f32 v6, v6, v95, v12
    v_max3_f32 v7, v96, v97, v98
    v_max3_f32 v7, v7, v99, v100
    v_max3_f32 v7, v7, v101, v102
    v_max3_f32 v7, v7, v103, v13
    v_mov_b32 v8, v6
    v_mov_b32 v9, v7
    s_nop 1
    v_permlane32_swap_b32 v8, v6
    v_permlane32_swap_b32 v9, v7
    s_nop 1
    v_max_f32 v6, v6, v8
    v_max_f32 v7, v7, v9
    v_mov_b32 v8, v6
    v_mov_b32 v9, v7
    s_nop 1
    v_permlane16_swap_b32 v8, v6
    v_permlane16_swap_b32 v9, v7
    s_nop 1
    v_max_f32 v6, v6, v8
    v_max_f32 v7, v7, v9
    v_sub_f32 v8, v12, v6
    v_mov_b32 v12, v6
    v_exp_f32 v8, v8
    v_sub_f32 v88, v88, v6
    v_sub_f32 v89, v89, v6
    v_sub_f32 v90, v90, v6
    v_sub_f32 v91, v91, v6
    v_sub_f32 v92, v92, v6
    v_sub_f32 v93, v93, v6
    v_sub_f32 v94, v94, v6
    v_sub_f32 v95, v95, v6
    v_exp_f32 v88, v88
    v_exp_f32 v89, v89
    v_exp_f32 v90, v90
    v_exp_f32 v91, v91
    v_exp_f32 v92, v92
    v_exp_f32 v93, v93
    v_exp_f32 v94, v94
    v_exp_f32 v95, v95
    s_nop 0
    v_cvt_pk_bf16_f32 v120, v88, v89
    v_cvt_pk_bf16_f32 v121, v90, v91
    v_cvt_pk_bf16_f32 v122, v92, v93
    v_cvt_pk_bf16_f32 v123, v94, v95
    v_mul_f32 v176, v176, v8
    v_mul_f32 v177, v177, v8
    v_mul_f32 v178, v178, v8
    v_mul_f32 v179, v179, v8
    v_mul_f32 v184, v184, v8
    v_mul_f32 v185, v185, v8
    v_mul_f32 v186, v186, v8
    v_mul_f32 v187, v187, v8
    v_mul_f32 v192, v192, v8
    v_mul_f32 v193, v193, v8
    v_mul_f32 v194, v194, v8
    v_mul_f32 v195, v195, v8
    v_mul_f32 v200, v200, v8
    v_mul_f32 v201, v201, v8
    v_mul_f32 v202, v202, v8
    v_mul_f32 v203, v203, v8
    v_mul_f32 v208, v208, v8
    v_mul_f32 v209, v209, v8
    v_mul_f32 v210, v210, v8
    v_mul_f32 v211, v211, v8
    v_mul_f32 v216, v216, v8
    v_mul_f32 v217, v217, v8
    v_mul_f32 v218, v218, v8
    v_mul_f32 v219, v219, v8
    v_mul_f32 v224, v224, v8
    v_mul_f32 v225, v225, v8
    v_mul_f32 v226, v226, v8
    v_mul_f32 v227, v227, v8
    v_mul_f32 v232, v232, v8
    v_mul_f32 v233, v233, v8
    v_mul_f32 v234, v234, v8
    v_mul_f32 v235, v235, v8
    v_mul_f32 v240, v240, v8
    v_mul_f32 v241, v241, v8
    v_mul_f32 v242, v242, v8
    v_mul_f32 v243, v243, v8
    v_sub_f32 v9, v13, v7
    v_mov_b32 v13, v7
    v_exp_f32 v9, v9
    v_sub_f32 v96, v96, v7
    v_sub_f32 v97, v97, v7
    v_sub_f32 v98, v98, v7
    v_sub_f32 v99, v99, v7
    v_sub_f32 v100, v100, v7
    v_sub_f32 v101, v101, v7
    v_sub_f32 v102, v102, v7
    v_sub_f32 v103, v103, v7
    v_exp_f32 v96, v96
    v_exp_f32 v97, v97
    v_exp_f32 v98, v98
    v_exp_f32 v99, v99
    v_exp_f32 v100, v100
    v_exp_f32 v101, v101
    v_exp_f32 v102, v102
    v_exp_f32 v103, v103
    s_nop 0
    v_cvt_pk_bf16_f32 v124, v96, v97
    v_cvt_pk_bf16_f32 v125, v98, v99
    v_cvt_pk_bf16_f32 v126, v100, v101
    v_cvt_pk_bf16_f32 v127, v102, v103
    v_mul_f32 v180, v180, v9
    v_mul_f32 v181, v181, v9
    v_mul_f32 v182, v182, v9
    v_mul_f32 v183, v183, v9
    v_mul_f32 v188, v188, v9
    v_mul_f32 v189, v189, v9
    v_mul_f32 v190, v190, v9
    v_mul_f32 v191, v191, v9
    v_mul_f32 v196, v196, v9
    v_mul_f32 v197, v197, v9
    v_mul_f32 v198, v198, v9
    v_mul_f32 v199, v199, v9
    v_mul_f32 v204, v204, v9
    v_mul_f32 v205, v205, v9
    v_mul_f32 v206, v206, v9
    v_mul_f32 v207, v207, v9
    v_mul_f32 v212, v212, v9
    v_mul_f32 v213, v213, v9
    v_mul_f32 v214, v214, v9
    v_mul_f32 v215, v215, v9
    v_mul_f32 v220, v220, v9
    v_mul_f32 v221, v221, v9
    v_mul_f32 v222, v222, v9
    v_mul_f32 v223, v223, v9
    v_mul_f32 v228, v228, v9
    v_mul_f32 v229, v229, v9
    v_mul_f32 v230, v230, v9
    v_mul_f32 v231, v231, v9
    v_mul_f32 v236, v236, v9
    v_mul_f32 v237, v237, v9
    v_mul_f32 v238, v238, v9
    v_mul_f32 v239, v239, v9
    v_mul_f32 v244, v244, v9
    v_mul_f32 v245, v245, v9
    v_mul_f32 v246, v246, v9
    v_mul_f32 v247, v247, v9
    s_waitcnt vmcnt(0)
    s_nop 0
    v_mfma_f32_16x16x32_bf16 v[240:243], a[240:243], v[120:123], v[240:243]
    v_mfma_f32_16x16x32_bf16 v[176:179], a[68:71], v[120:123], v[176:179]
    v_mfma_f32_16x16x32_bf16 v[184:187], a[72:75], v[120:123], v[184:187]
    v_mfma_f32_16x16x32_bf16 v[192:195], a[76:79], v[120:123], v[192:195]
    v_mfma_f32_16x16x32_bf16 v[200:203], a[80:83], v[120:123], v[200:203]
    v_mfma_f32_16x16x32_bf16 v[208:211], a[84:87], v[120:123], v[208:211]
    v_mfma_f32_16x16x32_bf16 v[216:219], a[88:91], v[120:123], v[216:219]
    v_mfma_f32_16x16x32_bf16 v[224:227], a[92:95], v[120:123], v[224:227]
    v_mfma_f32_16x16x32_bf16 v[232:235], a[96:99], v[120:123], v[232:235]
    v_mfma_f32_16x16x32_bf16 v[244:247], a[240:243], v[124:127], v[244:247]
    v_mfma_f32_16x16x32_bf16 v[180:183], a[68:71], v[124:127], v[180:183]
    v_mfma_f32_16x16x32_bf16 v[188:191], a[72:75], v[124:127], v[188:191]
    v_mfma_f32_16x16x32_bf16 v[196:199], a[76:79], v[124:127], v[196:199]
    v_mfma_f32_16x16x32_bf16 v[204:207], a[80:83], v[124:127], v[204:207]
    v_mfma_f32_16x16x32_bf16 v[212:215], a[84:87], v[124:127], v[212:215]
    v_mfma_f32_16x16x32_bf16 v[220:223], a[88:91], v[124:127], v[220:223]
    v_mfma_f32_16x16x32_bf16 v[228:231], a[92:95], v[124:127], v[228:231]
    v_mfma_f32_16x16x32_bf16 v[236:239], a[96:99], v[124:127], v[236:239]
    s_bitcmp1_b32 s67, 13
    s_mov_b32 s62, 8192
    s_cmov_b32 s62, 24576
    s_add_u32 s67, s67, s62
    s_sub_u32 s68, s68, 1
    s_cmp_lg_u32 s68, 0
    s_nop 7
    s_cbranch_scc1 slow_loop2
    s_branch norm2
L_gate:
    s_nop 7
    v_lshlrev_b32 v16, 2, v0
    v_mov_b32 v17, 536870912
    v_cmp_gt_u32 vcc, 16, v0
    s_lshl_b32 s76, s80, 6
    s_add_u32 s76, s76, 67108864
    s_lshl_b32 s77, s81, 6
    s_add_u32 s77, s77, 67108864
    s_lshl_b32 s78, s82, 6
    s_add_u32 s78, s78, 67108864
    s_lshl_b32 s79, s83, 6
    s_add_u32 s79, s79, 67108864
    v_cndmask_b32 v16, v17, v16, vcc
    v_permlane32_swap_b32 v97, v98
    v_permlane32_swap_b32 v101, v102
    v_permlane32_swap_b32 v105, v106
    v_permlane32_swap_b32 v109, v110
    s_nop 1
    v_add_f32 v96, v96, v98
    v_add_f32 v100, v100, v102
    v_add_f32 v104, v104, v106
    v_add_f32 v108, v108, v110
    v_mul_f32 v96, 0xbfb8aa3b, v96
    v_mul_f32 v100, 0xbfb8aa3b, v100
    v_mul_f32 v104, 0xbfb8aa3b, v104
    v_mul_f32 v108, 0xbfb8aa3b, v108
    v_exp_f32 v96, v96
    v_exp_f32 v100, v100
    v_exp_f32 v104, v104
    v_exp_f32 v108, v108
    v_add_f32 v96, 1.0, v96
    v_add_f32 v100, 1.0, v100
    v_add_f32 v104, 1.0, v104
    v_add_f32 v108, 1.0, v108
    v_rcp_f32 v96, v96
    v_rcp_f32 v100, v100
    v_rcp_f32 v104, v104
    v_rcp_f32 v108, v108
    s_nop 0
    buffer_store_dword v96, v16, s[8:11], s76 offen sc1
    buffer_store_dword v100, v16, s[8:11], s77 offen sc1
    buffer_store_dword v104, v16, s[8:11], s78 offen sc1
    buffer_store_dword v108, v16, s[8:11], s79 offen sc1
    v_mov_b32 v16, 0x3e0293ee
    v_mov_b32 v17, v16
    s_waitcnt vmcnt(16)
    s_barrier
    v_pk_mul_f32 v[176:177], v[176:177], v[16:17]
    v_pk_mul_f32 v[178:179], v[178:179], v[16:17]
    v_pk_mul_f32 v[32:33], v[32:33], v[16:17]
    v_pk_mul_f32 v[34:35], v[34:35], v[16:17]
    v_cvt_pk_bf16_f32 v176, v176, v177
    v_cvt_pk_bf16_f32 v177, v178, v179
    v_cvt_pk_bf16_f32 v178, v32, v33
    v_cvt_pk_bf16_f32 v179, v34, v35
    ds_read_b128 a[68:71], v2 offset:0
    ds_read_b128 a[72:75], v2 offset:1024
    v_pk_mul_f32 v[180:181], v[180:181], v[16:17]
    v_pk_mul_f32 v[182:183], v[182:183], v[16:17]
    v_pk_mul_f32 v[36:37], v[36:37], v[16:17]
    v_pk_mul_f32 v[38:39], v[38:39], v[16:17]
    v_cvt_pk_bf16_f32 v180, v180, v181
    v_cvt_pk_bf16_f32 v181, v182, v183
    v_cvt_pk_bf16_f32 v182, v36, v37
    v_cvt_pk_bf16_f32 v183, v38, v39
    ds_read_b128 a[76:79], v2 offset:2048
    ds_read_b128 a[80:83], v2 offset:3072
    v_pk_mul_f32 v[184:185], v[184:185], v[16:17]
    v_pk_mul_f32 v[186:187], v[186:187], v[16:17]
    v_pk_mul_f32 v[40:41], v[40:41], v[16:17]
    v_pk_mul_f32 v[42:43], v[42:43], v[16:17]
    v_cvt_pk_bf16_f32 v184, v184, v185
    v_cvt_pk_bf16_f32 v185, v186, v187
    v_cvt_pk_bf16_f32 v186, v40, v41
    v_cvt_pk_bf16_f32 v187, v42, v43
    ds_read_b128 a[84:87], v2 offset:4096
    ds_read_b128 a[88:91], v2 offset:5120
    v_pk_mul_f32 v[188:189], v[188:189], v[16:17]
    v_pk_mul_f32 v[190:191], v[190:191], v[16:17]
    v_pk_mul_f32 v[44:45], v[44:45], v[16:17]
    v_pk_mul_f32 v[46:47], v[46:47], v[16:17]
    v_cvt_pk_bf16_f32 v188, v188, v189
    v_cvt_pk_bf16_f32 v189, v190, v191
    v_cvt_pk_bf16_f32 v190, v44, v45
    v_cvt_pk_bf16_f32 v191, v46, v47
    ds_read_b128 a[92:95], v2 offset:6144
    ds_read_b128 a[96:99], v2 offset:7168
    v_pk_mul_f32 v[192:193], v[192:193], v[16:17]
    v_pk_mul_f32 v[194:195], v[194:195], v[16:17]
    v_pk_mul_f32 v[48:49], v[48:49], v[16:17]
    v_pk_mul_f32 v[50:51], v[50:51], v[16:17]
    v_cvt_pk_bf16_f32 v192, v192, v193
    v_cvt_pk_bf16_f32 v193, v194, v195
    v_cvt_pk_bf16_f32 v194, v48, v49
    v_cvt_pk_bf16_f32 v195, v50, v51
    ds_read_b128 a[0:3], v2 offset:8192
    ds_read_b128 a[4:7], v2 offset:9216
    v_pk_mul_f32 v[196:197], v[196:197], v[16:17]
    v_pk_mul_f32 v[198:199], v[198:199], v[16:17]
    v_pk_mul_f32 v[52:53], v[52:53], v[16:17]
    v_pk_mul_f32 v[54:55], v[54:55], v[16:17]
    v_cvt_pk_bf16_f32 v196, v196, v197
    v_cvt_pk_bf16_f32 v197, v198, v199
    v_cvt_pk_bf16_f32 v198, v52, v53
    v_cvt_pk_bf16_f32 v199, v54, v55
    ds_read_b128 a[8:11], v2 offset:10240
    ds_read_b128 a[12:15], v2 offset:11264
    v_pk_mul_f32 v[200:201], v[200:201], v[16:17]
    v_pk_mul_f32 v[202:203], v[202:203], v[16:17]
    v_pk_mul_f32 v[56:57], v[56:57], v[16:17]
    v_pk_mul_f32 v[58:59], v[58:59], v[16:17]
    v_cvt_pk_bf16_f32 v200, v200, v201
    v_cvt_pk_bf16_f32 v201, v202, v203
    v_cvt_pk_bf16_f32 v202, v56, v57
    v_cvt_pk_bf16_f32 v203, v58, v59
    ds_read_b128 a[16:19], v2 offset:12288
    ds_read_b128 a[20:23], v2 offset:13312
    v_pk_mul_f32 v[204:205], v[204:205], v[16:17]
    v_pk_mul_f32 v[206:207], v[206:207], v[16:17]
    v_pk_mul_f32 v[60:61], v[60:61], v[16:17]
    v_pk_mul_f32 v[62:63], v[62:63], v[16:17]
    v_cvt_pk_bf16_f32 v204, v204, v205
    v_cvt_pk_bf16_f32 v205, v206, v207
    v_cvt_pk_bf16_f32 v206, v60, v61
    v_cvt_pk_bf16_f32 v207, v62, v63
    ds_read_b128 a[24:27], v2 offset:14336
    ds_read_b128 a[28:31], v2 offset:15360
    v_pk_mul_f32 v[208:209], v[208:209], v[16:17]
    v_pk_mul_f32 v[210:211], v[210:211], v[16:17]
    v_pk_mul_f32 v[64:65], v[64:65], v[16:17]
    v_pk_mul_f32 v[66:67], v[66:67], v[16:17]
    v_cvt_pk_bf16_f32 v208, v208, v209
    v_cvt_pk_bf16_f32 v209, v210, v211
    v_cvt_pk_bf16_f32 v210, v64, v65
    v_cvt_pk_bf16_f32 v211, v66, v67
    v_pk_mul_f32 v[212:213], v[212:213], v[16:17]
    v_pk_mul_f32 v[214:215], v[214:215], v[16:17]
    v_pk_mul_f32 v[68:69], v[68:69], v[16:17]
    v_pk_mul_f32 v[70:71], v[70:71], v[16:17]
    v_cvt_pk_bf16_f32 v212, v212, v213
    v_cvt_pk_bf16_f32 v213, v214, v215
    v_cvt_pk_bf16_f32 v214, v68, v69
    v_cvt_pk_bf16_f32 v215, v70, v71
    v_pk_mul_f32 v[216:217], v[216:217], v[16:17]
    v_pk_mul_f32 v[218:219], v[218:219], v[16:17]
    v_pk_mul_f32 v[72:73], v[72:73], v[16:17]
    v_pk_mul_f32 v[74:75], v[74:75], v[16:17]
    v_cvt_pk_bf16_f32 v216, v216, v217
    v_cvt_pk_bf16_f32 v217, v218, v219
    v_cvt_pk_bf16_f32 v218, v72, v73
    v_cvt_pk_bf16_f32 v219, v74, v75
    v_pk_mul_f32 v[220:221], v[220:221], v[16:17]
    v_pk_mul_f32 v[222:223], v[222:223], v[16:17]
    v_pk_mul_f32 v[76:77], v[76:77], v[16:17]
    v_pk_mul_f32 v[78:79], v[78:79], v[16:17]
    v_cvt_pk_bf16_f32 v220, v220, v221
    v_cvt_pk_bf16_f32 v221, v222, v223
    v_cvt_pk_bf16_f32 v222, v76, v77
    v_cvt_pk_bf16_f32 v223, v78, v79
    v_pk_mul_f32 v[224:225], v[224:225], v[16:17]
    v_pk_mul_f32 v[226:227], v[226:227], v[16:17]
    v_pk_mul_f32 v[80:81], v[80:81], v[16:17]
    v_pk_mul_f32 v[82:83], v[82:83], v[16:17]
    v_cvt_pk_bf16_f32 v224, v224, v225
    v_cvt_pk_bf16_f32 v225, v226, v227
    v_cvt_pk_bf16_f32 v226, v80, v81
    v_cvt_pk_bf16_f32 v227, v82, v83
    v_pk_mul_f32 v[228:229], v[228:229], v[16:17]
    v_pk_mul_f32 v[230:231], v[230:231], v[16:17]
    v_pk_mul_f32 v[84:85], v[84:85], v[16:17]
    v_pk_mul_f32 v[86:87], v[86:87], v[16:17]
    v_cvt_pk_bf16_f32 v228, v228, v229
    v_cvt_pk_bf16_f32 v229, v230, v231
    v_cvt_pk_bf16_f32 v230, v84, v85
    v_cvt_pk_bf16_f32 v231, v86, v87
    v_pk_mul_f32 v[232:233], v[232:233], v[16:17]
    v_pk_mul_f32 v[234:235], v[234:235], v[16:17]
    v_pk_mul_f32 v[88:89], v[88:89], v[16:17]
    v_pk_mul_f32 v[90:91], v[90:91], v[16:17]
    v_cvt_pk_bf16_f32 v232, v232, v233
    v_cvt_pk_bf16_f32 v233, v234, v235
    v_cvt_pk_bf16_f32 v234, v88, v89
    v_cvt_pk_bf16_f32 v235, v90, v91
    v_pk_mul_f32 v[236:237], v[236:237], v[16:17]
    v_pk_mul_f32 v[238:239], v[238:239], v[16:17]
    v_pk_mul_f32 v[92:93], v[92:93], v[16:17]
    v_pk_mul_f32 v[94:95], v[94:95], v[16:17]
    v_cvt_pk_bf16_f32 v236, v236, v237
    v_cvt_pk_bf16_f32 v237, v238, v239
    v_cvt_pk_bf16_f32 v238, v92, v93
    v_cvt_pk_bf16_f32 v239, v94, v95
    s_branch L_qepi
.fill 256, 4, 0xbf810000
L_code_end:

.section .rodata,"a"
.p2align 6
.amdhsa_kernel gated_mix__compressed_kv_cla__dense_activation_gelu__prompt_kernel
  .amdhsa_next_free_vgpr 512
  .amdhsa_next_free_sgpr 102
  .amdhsa_accum_offset 256
  .amdhsa_group_segment_fixed_size 0
  .amdhsa_kernarg_size 120
  .amdhsa_user_sgpr_count 2
  .amdhsa_user_sgpr_kernarg_segment_ptr 1
  .amdhsa_system_sgpr_workgroup_id_x 1
  .amdhsa_float_denorm_mode_32 3
.end_amdhsa_kernel
```
